```python
import torch

def _softmax(x, axis=-1):
    return torch.softmax(x, dim=axis)
def _gelu(x):
    return torch.nn.functional.gelu(x, approximate="tanh")
def _silu(x):
    return torch.nn.functional.silu(x)
def _sigmoid(x):
    return torch.sigmoid(x)
def _layernorm(x, axis=-1, eps=1e-5):
    m = x.mean(dim=axis, keepdim=True)
    v = x.var(dim=axis, keepdim=True, unbiased=False)
    return (x - m) / torch.sqrt(v + eps)
def _scatter_add(tgt, idx, src, axis=0):
    return tgt.clone().index_add_(axis, idx, src)
def _segment_sum(src, seg, n):
    out = torch.zeros((n,) + src.shape[1:], dtype=src.dtype)
    return out.index_add_(0, seg, src)
def _pad(x, pw):
    flat = tuple(v for pair in reversed(pw) for v in pair)
    return torch.nn.functional.pad(x, flat)

kernel_name = 'gather_scatter__hybrid_graph_tf_graphgps__graph'

def setup_inputs():

    _w = (lambda a: (lambda t: t.to(torch.bfloat16) if t.is_floating_point() else t)(torch.as_tensor(a)))
    N, deg, D = 12500, 32, 128
    E = N * deg
    src = (lambda lo, hi, *s: torch.randint(lo, hi, s))(0, N, E).to(torch.int64)
    dst = (lambda lo, hi, *s: torch.randint(lo, hi, s))(0, N, E).to(torch.int64)
    deg_cnt = torch.bincount(dst, minlength=N).to(float) + 1.0
    sc = 1.0 / float(D) ** 0.5
    return {
        "x": _w((lambda *s: torch.randn(*s, dtype=torch.bfloat16) * 0.05)(N, D)),
        "src": _w(src),
        "dst": _w(dst),
        "deg_inv": _w((1.0 / deg_cnt).to(float)),
        "w_msg": _w((lambda *s: torch.randn(*s, dtype=torch.bfloat16) * 0.4)(D, D) * sc),
        "wq": _w((lambda *s: torch.randn(*s, dtype=torch.bfloat16) * 1.6)(D, D) * sc),
        "wk": _w((lambda *s: torch.randn(*s, dtype=torch.bfloat16) * 1.6)(D, D) * sc),
        "wv": _w((lambda *s: torch.randn(*s, dtype=torch.bfloat16) * 0.2)(D, D) * sc),
        "w_out": _w((lambda *s: torch.randn(*s, dtype=torch.bfloat16) * 0.2)(D, D) * sc),
    }

def reference(x, src, dst, deg_inv, w_msg, wq, wk, wv, w_out):
    N, D = x.shape[0], x.shape[1]
    h = _layernorm(x, axis=-1)
    m_e = torch.einsum('nd,de->ne', h, w_msg)
    h_local = _segment_sum(m_e[src], dst, N) * deg_inv[:, None]
    q = torch.einsum('nd,de->ne', h, wq)
    k = torch.einsum('nd,de->ne', h, wk)
    v = torch.einsum('nd,de->ne', h, wv)
    logits = torch.einsum('id,jd->ij', q, k) / (float(D) ** 0.5)
    attn = _softmax(logits, axis=-1)
    h_global = torch.einsum('ij,jd->id', attn, v)
    y = torch.einsum('nd,de->ne', h_local + h_global, w_out)
    return x + y
```

```asm
; @launch grid=(256,1,1) block=(256,1,1) lds=163840
.amdgcn_target "amdgcn-amd-amdhsa--gfx950"
.text
.globl gather_scatter__hybrid_graph_tf_graphgps__graph_kernel
.p2align 8
.type gather_scatter__hybrid_graph_tf_graphgps__graph_kernel,@function
gather_scatter__hybrid_graph_tf_graphgps__graph_kernel:
    s_cmp_ge_u32 s2, 256
    s_cbranch_scc1 L2_done
    s_load_dwordx2 s[4:5], s[0:1], 88
    s_load_dwordx2 s[100:101], s[0:1], 80
    s_min_u32 s3, s2, 31
    s_bitcmp1_b32 28927, s3
    s_cbranch_scc1 L_helper
    s_load_dwordx2 s[6:7], s[0:1], 0
    s_load_dwordx2 s[84:85], s[0:1], 24
    s_load_dwordx2 s[86:87], s[0:1], 72
    s_load_dwordx4 s[76:79], s[0:1], 40

    v_lshrrev_b32 v1, 6, v0
    v_and_b32 v0, 63, v0
    v_mov_b32 v221, v0
    s_mov_b32 s3, 0x33333334
    v_readfirstlane_b32 s26, v1
    s_lshr_b32 s33, s2, 3
    s_lshl_b32 s40, s33, 2
    s_sub_u32 s33, s33, 2
    s_mul_hi_u32 s24, s33, s3
    s_mul_i32 s3, s24, 5
    s_sub_u32 s25, s33, s3
    s_lshl_b32 s24, s24, 3
    s_and_b32 s3, s2, 7
    s_add_u32 s24, s24, s3
    s_bfm_b32 s3, s3, 8
    s_andn2_b32 s3, s3, 28927
    s_bcnt1_i32_b32 s3, s3
    s_cmp_lt_u32 s2, 16
    s_cselect_b32 s24, 48, s24
    s_cselect_b32 s25, s3, s25
    v_and_b32 v2, 15, v0
    v_lshrrev_b32 v3, 4, v0
    v_lshlrev_b32 v255, 4, v0
    s_cmp_gt_u32 s25, s26
    s_cselect_b32 s41, 1, 0
    s_sub_u32 s41, s25, s41
    s_cmp_lg_u32 s25, s26
    s_cselect_b32 s82, 1, 0
    s_cselect_b32 s41, s41, 0
    s_lshl_b32 s3, s24, 4
    s_lshl2_add_u32 s72, s26, s3
    s_add_u32 s72, s72, s41
    s_cmp_eq_u32 s82, 1
    s_cselect_b32 s72, s72, 0x100000
    s_mov_b32 s81, s41
    s_mul_i32 s73, s26, 24576
    s_add_u32 s73, s73, 65536
    s_add_u32 s74, s73, 8192
    s_add_u32 s75, s73, 16384
    s_add_u32 s40, s40, s26
    s_sub_u32 s40, s40, 4

    s_getpc_b64 s[42:43]
Lpf_k2:
    s_sub_u32 s42, s42, Lpf_k2-gather_scatter__hybrid_graph_tf_graphgps__graph_kernel
    s_subb_u32 s43, s43, 0
    s_lshl_b32 s41, s40, 10
    s_min_u32 s41, s41, L_code_end-gather_scatter__hybrid_graph_tf_graphgps__graph_kernel-1024
    s_add_u32 s42, s42, s41
    s_addc_u32 s43, s43, 0
    global_load_dwordx4 v[200:203], v255, s[42:43]
    s_waitcnt lgkmcnt(0)
    s_mov_b32 s0, s81
    s_add_u32 s88, s76, 0
    s_addc_u32 s89, s77, 0
    s_mov_b32 s90, 32768
    s_mov_b32 s91, 0x20000
    s_add_u32 s92, s78, 0
    s_addc_u32 s93, s79, 0
    s_mov_b32 s94, 32768
    s_mov_b32 s95, 0x20000
    s_add_u32 s64, s4, 10485760
    s_addc_u32 s65, s5, 0
    s_mov_b32 s66, 1757184
    s_mov_b32 s67, 0x20000
    s_add_u32 s20, s4, 8388608
    s_addc_u32 s21, s5, 0
    s_mov_b32 s22, 1114112
    s_mov_b32 s23, 0x20000
    s_cmp_eq_u32 s82, 0
    s_cbranch_scc1 L_binw
    s_add_u32 s68, s6, 0
    s_addc_u32 s69, s7, 0
    s_mov_b32 s70, 3200000
    s_mov_b32 s71, 0x20000
    s_lshl_b32 s38, s72, 12
    v_lshlrev_b32 v4, 8, v2
    v_lshl_add_u32 v4, v3, 4, v4
    buffer_load_dwordx4 v[8:11], v4, s[68:71], s38 offen offset:0
    buffer_load_dwordx4 v[12:15], v4, s[68:71], s38 offen offset:64
    buffer_load_dwordx4 v[16:19], v4, s[68:71], s38 offen offset:128
    buffer_load_dwordx4 v[20:23], v4, s[68:71], s38 offen offset:192
    v_lshlrev_b32 v5, 1, v3
    v_xor_b32 v5, v5, v2
    v_lshlrev_b32 v5, 4, v5
    v_lshl_add_u32 v5, v3, 8, v5
    v_xor_b32 v6, 0x80, v5
    s_lshl_b32 s36, s26, 13
    s_add_u32 s37, s36, 4096

    s_add_u32 m0, s36, 0
    s_nop 0
    buffer_load_dwordx4 v5, s[88:91], s36 offen offset:0 lds
    buffer_load_dwordx4 v5, s[88:91], s36 offen offset:1024 lds
    buffer_load_dwordx4 v6, s[88:91], s36 offen offset:2048 lds
    buffer_load_dwordx4 v6, s[88:91], s36 offen offset:3072 lds
    s_add_u32 m0, s37, 0
    s_nop 0
    buffer_load_dwordx4 v5, s[88:91], s37 offen offset:0 lds
    buffer_load_dwordx4 v5, s[88:91], s37 offen offset:1024 lds
    buffer_load_dwordx4 v6, s[88:91], s37 offen offset:2048 lds
    buffer_load_dwordx4 v6, s[88:91], s37 offen offset:3072 lds
    s_add_u32 s8, s4, 4096
    s_addc_u32 s9, s5, 0
    s_mov_b32 s10, 3200000
    s_mov_b32 s11, 0x20000
    s_add_u32 s12, s4, 4194304
    s_addc_u32 s13, s5, 0
    s_mov_b32 s14, 3211264
    s_mov_b32 s15, 0x20000
    v_and_b32 v26, 7, v2
    v_lshlrev_b32 v26, 1, v26
    v_xor_b32 v26, v26, v3
    v_lshlrev_b32 v27, 8, v2
    v_lshrrev_b32 v29, 2, v2
    v_lshlrev_b32 v29, 3, v29
    v_and_b32 v28, 3, v2
    v_add_u32 v29, v29, v28
    v_lshlrev_b32 v29, 8, v29
    v_xor_b32 v28, 0, v26
    v_lshl_add_u32 v80, v28, 4, v27
    v_lshl_add_u32 v88, v28, 4, v29
    v_xor_b32 v28, 4, v26
    v_lshl_add_u32 v81, v28, 4, v27
    v_lshl_add_u32 v89, v28, 4, v29
    v_xor_b32 v28, 8, v26
    v_lshl_add_u32 v82, v28, 4, v27
    v_lshl_add_u32 v90, v28, 4, v29
    v_xor_b32 v28, 12, v26
    v_lshl_add_u32 v83, v28, 4, v27
    v_lshl_add_u32 v91, v28, 4, v29
    v_bfe_u32 v26, v0, 2, 2
    v_and_b32 v27, 1, v3
    v_lshl_add_u32 v27, v27, 2, v26
    v_lshlrev_b32 v27, 1, v27
    v_and_b32 v28, 3, v0
    v_xor_b32 v27, v27, v28
    v_lshl_add_u32 v26, v3, 3, v26
    v_lshlrev_b32 v26, 8, v26
    v_xor_b32 v28, 0, v27
    v_lshl_add_u32 v84, v28, 4, v26
    v_xor_b32 v28, 4, v27
    v_lshl_add_u32 v85, v28, 4, v26
    v_xor_b32 v28, 8, v27
    v_lshl_add_u32 v86, v28, 4, v26
    v_xor_b32 v28, 12, v27
    v_lshl_add_u32 v87, v28, 4, v26
    v_cmp_eq_u32 vcc, 3, v3
    v_lshlrev_b32 v30, 4, v0
    s_waitcnt vmcnt(8)
    v_lshlrev_b32 v32, 16, v8
    v_and_b32 v33, 0xffff0000, v8
    s_add_u32 m0, s36, 32768
    s_nop 0
    buffer_load_dwordx4 v5, s[92:95], s36 offen offset:0 lds
    v_lshlrev_b32 v34, 16, v9
    v_and_b32 v35, 0xffff0000, v9
    v_lshlrev_b32 v36, 16, v10
    v_and_b32 v37, 0xffff0000, v10
    v_lshlrev_b32 v38, 16, v11
    v_and_b32 v39, 0xffff0000, v11
    v_lshlrev_b32 v40, 16, v12
    v_and_b32 v41, 0xffff0000, v12
    v_lshlrev_b32 v42, 16, v13
    v_and_b32 v43, 0xffff0000, v13
    v_lshlrev_b32 v44, 16, v14
    v_and_b32 v45, 0xffff0000, v14
    v_lshlrev_b32 v46, 16, v15
    v_and_b32 v47, 0xffff0000, v15
    buffer_load_dwordx4 v5, s[92:95], s36 offen offset:1024 lds
    v_lshlrev_b32 v48, 16, v16
    v_and_b32 v49, 0xffff0000, v16
    v_lshlrev_b32 v50, 16, v17
    v_and_b32 v51, 0xffff0000, v17
    v_lshlrev_b32 v52, 16, v18
    v_and_b32 v53, 0xffff0000, v18
    v_lshlrev_b32 v54, 16, v19
    v_and_b32 v55, 0xffff0000, v19
    v_lshlrev_b32 v56, 16, v20
    v_and_b32 v57, 0xffff0000, v20
    v_lshlrev_b32 v58, 16, v21
    v_and_b32 v59, 0xffff0000, v21
    v_lshlrev_b32 v60, 16, v22
    v_and_b32 v61, 0xffff0000, v22
    buffer_load_dwordx4 v6, s[92:95], s36 offen offset:2048 lds
    v_lshlrev_b32 v62, 16, v23
    v_and_b32 v63, 0xffff0000, v23
    v_pk_add_f32 v[26:27], v[32:33], v[34:35]
    v_pk_add_f32 v[28:29], v[36:37], v[38:39]
    v_pk_add_f32 v[26:27], v[26:27], v[40:41]
    v_pk_add_f32 v[28:29], v[28:29], v[42:43]
    v_pk_add_f32 v[26:27], v[26:27], v[44:45]
    v_pk_add_f32 v[28:29], v[28:29], v[46:47]
    v_pk_add_f32 v[26:27], v[26:27], v[48:49]
    v_pk_add_f32 v[28:29], v[28:29], v[50:51]
    v_pk_add_f32 v[26:27], v[26:27], v[52:53]
    v_pk_add_f32 v[28:29], v[28:29], v[54:55]
    v_pk_add_f32 v[26:27], v[26:27], v[56:57]
    v_pk_add_f32 v[28:29], v[28:29], v[58:59]
    buffer_load_dwordx4 v6, s[92:95], s36 offen offset:3072 lds
    v_pk_add_f32 v[26:27], v[26:27], v[60:61]
    v_pk_add_f32 v[28:29], v[28:29], v[62:63]
    v_pk_add_f32 v[26:27], v[26:27], v[28:29]
    v_add_f32 v24, v26, v27
    v_mov_b32 v25, v24
    s_nop 1
    v_permlane16_swap_b32 v24, v25
    v_add_f32 v24, v24, v25
    v_mov_b32 v25, v24
    s_nop 1
    v_permlane32_swap_b32 v24, v25
    v_add_f32 v24, v24, v25
    v_mul_f32 v24, 0xbc000000, v24
    v_pk_add_f32 v[32:33], v[32:33], v[24:25] op_sel_hi:[1,0]
    s_add_u32 m0, s37, 32768
    s_nop 0
    buffer_load_dwordx4 v5, s[92:95], s37 offen offset:0 lds
    v_pk_add_f32 v[34:35], v[34:35], v[24:25] op_sel_hi:[1,0]
    v_pk_add_f32 v[36:37], v[36:37], v[24:25] op_sel_hi:[1,0]
    v_pk_add_f32 v[38:39], v[38:39], v[24:25] op_sel_hi:[1,0]
    v_pk_add_f32 v[40:41], v[40:41], v[24:25] op_sel_hi:[1,0]
    v_pk_add_f32 v[42:43], v[42:43], v[24:25] op_sel_hi:[1,0]
    v_pk_add_f32 v[44:45], v[44:45], v[24:25] op_sel_hi:[1,0]
    v_pk_add_f32 v[46:47], v[46:47], v[24:25] op_sel_hi:[1,0]
    v_pk_add_f32 v[48:49], v[48:49], v[24:25] op_sel_hi:[1,0]
    v_pk_add_f32 v[50:51], v[50:51], v[24:25] op_sel_hi:[1,0]
    v_pk_add_f32 v[52:53], v[52:53], v[24:25] op_sel_hi:[1,0]
    v_pk_add_f32 v[54:55], v[54:55], v[24:25] op_sel_hi:[1,0]
    v_pk_add_f32 v[56:57], v[56:57], v[24:25] op_sel_hi:[1,0]
    v_pk_add_f32 v[58:59], v[58:59], v[24:25] op_sel_hi:[1,0]
    v_pk_add_f32 v[60:61], v[60:61], v[24:25] op_sel_hi:[1,0]
    buffer_load_dwordx4 v5, s[92:95], s37 offen offset:1024 lds
    v_pk_add_f32 v[62:63], v[62:63], v[24:25] op_sel_hi:[1,0]
    v_pk_mul_f32 v[26:27], v[32:33], v[32:33]
    v_pk_mul_f32 v[28:29], v[34:35], v[34:35]
    v_pk_fma_f32 v[26:27], v[36:37], v[36:37], v[26:27]
    v_pk_fma_f32 v[28:29], v[38:39], v[38:39], v[28:29]
    v_pk_fma_f32 v[26:27], v[40:41], v[40:41], v[26:27]
    v_pk_fma_f32 v[28:29], v[42:43], v[42:43], v[28:29]
    v_pk_fma_f32 v[26:27], v[44:45], v[44:45], v[26:27]
    v_pk_fma_f32 v[28:29], v[46:47], v[46:47], v[28:29]
    v_pk_fma_f32 v[26:27], v[48:49], v[48:49], v[26:27]
    v_pk_fma_f32 v[28:29], v[50:51], v[50:51], v[28:29]
    v_pk_fma_f32 v[26:27], v[52:53], v[52:53], v[26:27]
    v_pk_fma_f32 v[28:29], v[54:55], v[54:55], v[28:29]
    v_pk_fma_f32 v[26:27], v[56:57], v[56:57], v[26:27]
    buffer_load_dwordx4 v6, s[92:95], s37 offen offset:2048 lds
    v_pk_fma_f32 v[28:29], v[58:59], v[58:59], v[28:29]
    v_pk_fma_f32 v[26:27], v[60:61], v[60:61], v[26:27]
    v_pk_fma_f32 v[28:29], v[62:63], v[62:63], v[28:29]
    v_pk_add_f32 v[26:27], v[26:27], v[28:29]
    v_add_f32 v24, v26, v27
    v_mov_b32 v25, v24
    s_nop 1
    v_permlane16_swap_b32 v24, v25
    v_add_f32 v24, v24, v25
    v_mov_b32 v25, v24
    s_nop 1
    v_permlane32_swap_b32 v24, v25
    v_add_f32 v24, v24, v25
    v_mov_b32 v25, 0x3727c5ac
    buffer_load_dwordx4 v6, s[92:95], s37 offen offset:3072 lds
    v_fmac_f32 v25, 0x3c000000, v24
    v_rsq_f32 v24, v25
    s_nop 0
    v_pk_mul_f32 v[32:33], v[32:33], v[24:25] op_sel_hi:[1,0]
    v_pk_mul_f32 v[34:35], v[34:35], v[24:25] op_sel_hi:[1,0]
    v_pk_mul_f32 v[36:37], v[36:37], v[24:25] op_sel_hi:[1,0]
    v_pk_mul_f32 v[38:39], v[38:39], v[24:25] op_sel_hi:[1,0]
    v_pk_mul_f32 v[40:41], v[40:41], v[24:25] op_sel_hi:[1,0]
    v_pk_mul_f32 v[42:43], v[42:43], v[24:25] op_sel_hi:[1,0]
    v_pk_mul_f32 v[44:45], v[44:45], v[24:25] op_sel_hi:[1,0]
    v_pk_mul_f32 v[46:47], v[46:47], v[24:25] op_sel_hi:[1,0]
    v_pk_mul_f32 v[48:49], v[48:49], v[24:25] op_sel_hi:[1,0]
    v_pk_mul_f32 v[50:51], v[50:51], v[24:25] op_sel_hi:[1,0]
    v_pk_mul_f32 v[52:53], v[52:53], v[24:25] op_sel_hi:[1,0]
    v_pk_mul_f32 v[54:55], v[54:55], v[24:25] op_sel_hi:[1,0]
    v_pk_mul_f32 v[56:57], v[56:57], v[24:25] op_sel_hi:[1,0]
    v_pk_mul_f32 v[58:59], v[58:59], v[24:25] op_sel_hi:[1,0]
    v_pk_mul_f32 v[60:61], v[60:61], v[24:25] op_sel_hi:[1,0]
    v_pk_mul_f32 v[62:63], v[62:63], v[24:25] op_sel_hi:[1,0]
    v_cvt_pk_bf16_f32 v128, v32, v33
    v_cvt_pk_bf16_f32 v129, v34, v35
    v_cvt_pk_bf16_f32 v130, v36, v37
    v_cvt_pk_bf16_f32 v131, v38, v39
    v_cvt_pk_bf16_f32 v132, v40, v41
    v_cvt_pk_bf16_f32 v133, v42, v43
    v_cvt_pk_bf16_f32 v134, v44, v45
    v_cvt_pk_bf16_f32 v135, v46, v47
    v_cvt_pk_bf16_f32 v136, v48, v49
    v_cvt_pk_bf16_f32 v137, v50, v51
    v_cvt_pk_bf16_f32 v138, v52, v53
    v_cvt_pk_bf16_f32 v139, v54, v55
    v_cvt_pk_bf16_f32 v140, v56, v57
    v_cvt_pk_bf16_f32 v141, v58, v59
    v_cvt_pk_bf16_f32 v142, v60, v61
    v_cvt_pk_bf16_f32 v143, v62, v63
    s_waitcnt vmcnt(8)
    s_barrier
    ds_read_b64_tr_b16 a[0:1], v84 offset:0
    ds_read_b64_tr_b16 a[2:3], v84 offset:1024
    ds_read_b64_tr_b16 a[4:5], v84 offset:8192
    ds_read_b64_tr_b16 a[6:7], v84 offset:9216
    ds_read_b64_tr_b16 a[8:9], v84 offset:16384
    ds_read_b64_tr_b16 a[10:11], v84 offset:17408
    ds_read_b64_tr_b16 a[12:13], v84 offset:24576
    ds_read_b64_tr_b16 a[14:15], v84 offset:25600
    ds_read_b64_tr_b16 a[16:17], v84 offset:8
    ds_read_b64_tr_b16 a[18:19], v84 offset:1032
    ds_read_b64_tr_b16 a[20:21], v84 offset:8200
    ds_read_b64_tr_b16 a[22:23], v84 offset:9224
    ds_read_b64_tr_b16 a[24:25], v84 offset:16392
    ds_read_b64_tr_b16 a[26:27], v84 offset:17416
    ds_read_b64_tr_b16 a[28:29], v84 offset:24584
    ds_read_b64_tr_b16 a[30:31], v84 offset:25608
    v_mov_b32 v25, v63
    v_mov_b32 v24, v63
    s_nop 1
    v_permlane16_swap_b32 v25, v24
    v_mov_b32 v25, v24
    s_nop 1
    v_permlane32_swap_b32 v25, v24
    s_waitcnt lgkmcnt(8)
    v_mfma_f32_16x16x32_bf16 v[96:99], a[0:3], v[128:131], 0
    v_mfma_f32_16x16x32_bf16 v[96:99], a[4:7], v[132:135], v[96:99]
    v_mfma_f32_16x16x32_bf16 v[96:99], a[8:11], v[136:139], v[96:99]
    v_mfma_f32_16x16x32_bf16 v[96:99], a[12:15], v[140:143], v[96:99]
    ds_read_b64_tr_b16 a[32:33], v85 offset:0
    ds_read_b64_tr_b16 a[34:35], v85 offset:1024
    ds_read_b64_tr_b16 a[36:37], v85 offset:8192
    ds_read_b64_tr_b16 a[38:39], v85 offset:9216
    ds_read_b64_tr_b16 a[40:41], v85 offset:16384
    ds_read_b64_tr_b16 a[42:43], v85 offset:17408
    ds_read_b64_tr_b16 a[44:45], v85 offset:24576
    ds_read_b64_tr_b16 a[46:47], v85 offset:25600
    v_mul_f32 v24, 0x3dc69217, v24
    v_pk_add_f32 v[32:33], v[32:33], v[24:25] op_sel_hi:[1,0]
    v_pk_add_f32 v[34:35], v[34:35], v[24:25] op_sel_hi:[1,0]
    v_pk_add_f32 v[36:37], v[36:37], v[24:25] op_sel_hi:[1,0]
    v_pk_add_f32 v[38:39], v[38:39], v[24:25] op_sel_hi:[1,0]
    v_pk_add_f32 v[40:41], v[40:41], v[24:25] op_sel_hi:[1,0]
    v_pk_add_f32 v[42:43], v[42:43], v[24:25] op_sel_hi:[1,0]
    s_waitcnt lgkmcnt(8)
    v_mfma_f32_16x16x32_bf16 v[100:103], a[16:19], v[128:131], 0
    v_mfma_f32_16x16x32_bf16 v[100:103], a[20:23], v[132:135], v[100:103]
    v_mfma_f32_16x16x32_bf16 v[100:103], a[24:27], v[136:139], v[100:103]
    v_mfma_f32_16x16x32_bf16 v[100:103], a[28:31], v[140:143], v[100:103]
    ds_read_b64_tr_b16 a[48:49], v85 offset:8
    ds_read_b64_tr_b16 a[50:51], v85 offset:1032
    ds_read_b64_tr_b16 a[52:53], v85 offset:8200
    ds_read_b64_tr_b16 a[54:55], v85 offset:9224
    ds_read_b64_tr_b16 a[56:57], v85 offset:16392
    ds_read_b64_tr_b16 a[58:59], v85 offset:17416
    ds_read_b64_tr_b16 a[60:61], v85 offset:24584
    ds_read_b64_tr_b16 a[62:63], v85 offset:25608
    v_pk_add_f32 v[44:45], v[44:45], v[24:25] op_sel_hi:[1,0]
    v_pk_add_f32 v[46:47], v[46:47], v[24:25] op_sel_hi:[1,0]
    v_pk_add_f32 v[48:49], v[48:49], v[24:25] op_sel_hi:[1,0]
    v_pk_add_f32 v[50:51], v[50:51], v[24:25] op_sel_hi:[1,0]
    v_pk_add_f32 v[52:53], v[52:53], v[24:25] op_sel_hi:[1,0]
    v_pk_add_f32 v[54:55], v[54:55], v[24:25] op_sel_hi:[1,0]
    v_pk_add_f32 v[56:57], v[56:57], v[24:25] op_sel_hi:[1,0]
    s_waitcnt lgkmcnt(8)
    v_mfma_f32_16x16x32_bf16 v[104:107], a[32:35], v[128:131], 0
    v_mfma_f32_16x16x32_bf16 v[104:107], a[36:39], v[132:135], v[104:107]
    v_mfma_f32_16x16x32_bf16 v[104:107], a[40:43], v[136:139], v[104:107]
    v_mfma_f32_16x16x32_bf16 v[104:107], a[44:47], v[140:143], v[104:107]
    ds_read_b64_tr_b16 a[64:65], v86 offset:0
    ds_read_b64_tr_b16 a[66:67], v86 offset:1024
    ds_read_b64_tr_b16 a[68:69], v86 offset:8192
    ds_read_b64_tr_b16 a[70:71], v86 offset:9216
    ds_read_b64_tr_b16 a[72:73], v86 offset:16384
    ds_read_b64_tr_b16 a[74:75], v86 offset:17408
    ds_read_b64_tr_b16 a[76:77], v86 offset:24576
    ds_read_b64_tr_b16 a[78:79], v86 offset:25600
    v_pk_add_f32 v[58:59], v[58:59], v[24:25] op_sel_hi:[1,0]
    v_pk_add_f32 v[60:61], v[60:61], v[24:25] op_sel_hi:[1,0]
    v_pk_add_f32 v[62:63], v[62:63], v[24:25] op_sel_hi:[1,0]
    v_cndmask_b32 v63, v63, 1.0, vcc
    v_cvt_pk_bf16_f32 v64, v32, v33
    v_cvt_pk_bf16_f32 v65, v34, v35
    v_cvt_pk_bf16_f32 v66, v36, v37
    s_waitcnt lgkmcnt(8)
    v_mfma_f32_16x16x32_bf16 v[108:111], a[48:51], v[128:131], 0
    v_mfma_f32_16x16x32_bf16 v[108:111], a[52:55], v[132:135], v[108:111]
    v_mfma_f32_16x16x32_bf16 v[108:111], a[56:59], v[136:139], v[108:111]
    v_mfma_f32_16x16x32_bf16 v[108:111], a[60:63], v[140:143], v[108:111]
    ds_read_b64_tr_b16 a[80:81], v86 offset:8
    ds_read_b64_tr_b16 a[82:83], v86 offset:1032
    ds_read_b64_tr_b16 a[84:85], v86 offset:8200
    ds_read_b64_tr_b16 a[86:87], v86 offset:9224
    ds_read_b64_tr_b16 a[88:89], v86 offset:16392
    ds_read_b64_tr_b16 a[90:91], v86 offset:17416
    ds_read_b64_tr_b16 a[92:93], v86 offset:24584
    ds_read_b64_tr_b16 a[94:95], v86 offset:25608
    v_cvt_pk_bf16_f32 v67, v38, v39
    buffer_store_dwordx4 v[64:67], v80, s[8:11], s38 offen sc1
    v_cvt_pk_bf16_f32 v68, v40, v41
    v_cvt_pk_bf16_f32 v69, v42, v43
    v_cvt_pk_bf16_f32 v70, v44, v45
    v_cvt_pk_bf16_f32 v71, v46, v47
    buffer_store_dwordx4 v[68:71], v81, s[8:11], s38 offen sc1
    s_waitcnt lgkmcnt(8)
    v_mfma_f32_16x16x32_bf16 v[112:115], a[64:67], v[128:131], 0
    v_mfma_f32_16x16x32_bf16 v[112:115], a[68:71], v[132:135], v[112:115]
    v_mfma_f32_16x16x32_bf16 v[112:115], a[72:75], v[136:139], v[112:115]
    v_mfma_f32_16x16x32_bf16 v[112:115], a[76:79], v[140:143], v[112:115]
    ds_read_b64_tr_b16 a[96:97], v87 offset:0
    ds_read_b64_tr_b16 a[98:99], v87 offset:1024
    ds_read_b64_tr_b16 a[100:101], v87 offset:8192
    ds_read_b64_tr_b16 a[102:103], v87 offset:9216
    ds_read_b64_tr_b16 a[104:105], v87 offset:16384
    ds_read_b64_tr_b16 a[106:107], v87 offset:17408
    ds_read_b64_tr_b16 a[108:109], v87 offset:24576
    ds_read_b64_tr_b16 a[110:111], v87 offset:25600
    v_cvt_pk_bf16_f32 v72, v48, v49
    v_cvt_pk_bf16_f32 v73, v50, v51
    v_cvt_pk_bf16_f32 v74, v52, v53
    v_cvt_pk_bf16_f32 v75, v54, v55
    buffer_store_dwordx4 v[72:75], v82, s[8:11], s38 offen sc1
    v_cvt_pk_bf16_f32 v76, v56, v57
    v_cvt_pk_bf16_f32 v77, v58, v59
    s_waitcnt lgkmcnt(8)
    v_mfma_f32_16x16x32_bf16 v[116:119], a[80:83], v[128:131], 0
    v_mfma_f32_16x16x32_bf16 v[116:119], a[84:87], v[132:135], v[116:119]
    v_mfma_f32_16x16x32_bf16 v[116:119], a[88:91], v[136:139], v[116:119]
    v_mfma_f32_16x16x32_bf16 v[116:119], a[92:95], v[140:143], v[116:119]
    ds_read_b64_tr_b16 a[112:113], v87 offset:8
    ds_read_b64_tr_b16 a[114:115], v87 offset:1032
    ds_read_b64_tr_b16 a[116:117], v87 offset:8200
    ds_read_b64_tr_b16 a[118:119], v87 offset:9224
    ds_read_b64_tr_b16 a[120:121], v87 offset:16392
    ds_read_b64_tr_b16 a[122:123], v87 offset:17416
    ds_read_b64_tr_b16 a[124:125], v87 offset:24584
    ds_read_b64_tr_b16 a[126:127], v87 offset:25608
    v_cvt_pk_bf16_f32 v78, v60, v61
    v_cvt_pk_bf16_f32 v79, v62, v63
    buffer_store_dwordx4 v[76:79], v83, s[8:11], s38 offen sc1
    s_waitcnt lgkmcnt(8)
    v_mfma_f32_16x16x32_bf16 v[120:123], a[96:99], v[128:131], 0
    v_mfma_f32_16x16x32_bf16 v[120:123], a[100:103], v[132:135], v[120:123]
    v_mfma_f32_16x16x32_bf16 v[120:123], a[104:107], v[136:139], v[120:123]
    v_mfma_f32_16x16x32_bf16 v[120:123], a[108:111], v[140:143], v[120:123]
    s_waitcnt lgkmcnt(0)
    v_mfma_f32_16x16x32_bf16 v[124:127], a[112:115], v[128:131], 0
    v_mfma_f32_16x16x32_bf16 v[124:127], a[116:119], v[132:135], v[124:127]
    v_mfma_f32_16x16x32_bf16 v[124:127], a[120:123], v[136:139], v[124:127]
    v_mfma_f32_16x16x32_bf16 v[124:127], a[124:127], v[140:143], v[124:127]
    s_waitcnt vmcnt(4)
    s_barrier
    ds_read_b128 a[0:3], v88 offset:32768
    ds_read_b128 a[4:7], v89 offset:32768
    ds_read_b128 a[8:11], v90 offset:32768
    ds_read_b128 a[12:15], v91 offset:32768
    ds_read_b128 a[16:19], v88 offset:33792
    ds_read_b128 a[20:23], v89 offset:33792
    ds_read_b128 a[24:27], v90 offset:33792
    ds_read_b128 a[28:31], v91 offset:33792
    ds_read_b128 a[32:35], v88 offset:40960
    ds_read_b128 a[36:39], v89 offset:40960
    ds_read_b128 a[40:43], v90 offset:40960
    ds_read_b128 a[44:47], v91 offset:40960
    v_cvt_pk_bf16_f32 v144, v96, v97
    v_cvt_pk_bf16_f32 v145, v98, v99
    v_cvt_pk_bf16_f32 v146, v100, v101
    v_cvt_pk_bf16_f32 v147, v102, v103
    v_cvt_pk_bf16_f32 v148, v104, v105
    v_cvt_pk_bf16_f32 v149, v106, v107
    v_cvt_pk_bf16_f32 v150, v108, v109
    v_cvt_pk_bf16_f32 v151, v110, v111
    v_cvt_pk_bf16_f32 v152, v112, v113
    v_cvt_pk_bf16_f32 v153, v114, v115
    v_cvt_pk_bf16_f32 v154, v116, v117
    v_cvt_pk_bf16_f32 v155, v118, v119
    v_cvt_pk_bf16_f32 v156, v120, v121
    v_cvt_pk_bf16_f32 v157, v122, v123
    v_cvt_pk_bf16_f32 v158, v124, v125
    v_cvt_pk_bf16_f32 v159, v126, v127
    s_nop 1
    s_waitcnt lgkmcnt(8)
    v_mfma_f32_16x16x32_bf16 v[32:35], a[0:3], v[144:147], 0
    v_mfma_f32_16x16x32_bf16 v[32:35], a[4:7], v[148:151], v[32:35]
    v_mfma_f32_16x16x32_bf16 v[32:35], a[8:11], v[152:155], v[32:35]
    v_mfma_f32_16x16x32_bf16 v[32:35], a[12:15], v[156:159], v[32:35]
    ds_read_b128 a[48:51], v88 offset:41984
    ds_read_b128 a[52:55], v89 offset:41984
    ds_read_b128 a[56:59], v90 offset:41984
    ds_read_b128 a[60:63], v91 offset:41984
    s_waitcnt lgkmcnt(8)
    v_mfma_f32_16x16x32_bf16 v[36:39], a[16:19], v[144:147], 0
    v_mfma_f32_16x16x32_bf16 v[36:39], a[20:23], v[148:151], v[36:39]
    v_mfma_f32_16x16x32_bf16 v[36:39], a[24:27], v[152:155], v[36:39]
    v_mfma_f32_16x16x32_bf16 v[36:39], a[28:31], v[156:159], v[36:39]
    ds_read_b128 a[64:67], v88 offset:49152
    ds_read_b128 a[68:71], v89 offset:49152
    ds_read_b128 a[72:75], v90 offset:49152
    ds_read_b128 a[76:79], v91 offset:49152
    s_waitcnt lgkmcnt(8)
    v_mfma_f32_16x16x32_bf16 v[40:43], a[32:35], v[144:147], 0
    v_mfma_f32_16x16x32_bf16 v[40:43], a[36:39], v[148:151], v[40:43]
    v_mfma_f32_16x16x32_bf16 v[40:43], a[40:43], v[152:155], v[40:43]
    v_mfma_f32_16x16x32_bf16 v[40:43], a[44:47], v[156:159], v[40:43]
    ds_read_b128 a[80:83], v88 offset:50176
    ds_read_b128 a[84:87], v89 offset:50176
    ds_read_b128 a[88:91], v90 offset:50176
    ds_read_b128 a[92:95], v91 offset:50176
    s_waitcnt lgkmcnt(8)
    v_mfma_f32_16x16x32_bf16 v[44:47], a[48:51], v[144:147], 0
    v_mfma_f32_16x16x32_bf16 v[44:47], a[52:55], v[148:151], v[44:47]
    v_mfma_f32_16x16x32_bf16 v[44:47], a[56:59], v[152:155], v[44:47]
    v_mfma_f32_16x16x32_bf16 v[44:47], a[60:63], v[156:159], v[44:47]
    ds_read_b128 a[96:99], v88 offset:57344
    ds_read_b128 a[100:103], v89 offset:57344
    ds_read_b128 a[104:107], v90 offset:57344
    ds_read_b128 a[108:111], v91 offset:57344
    s_waitcnt lgkmcnt(8)
    v_mfma_f32_16x16x32_bf16 v[48:51], a[64:67], v[144:147], 0
    v_mfma_f32_16x16x32_bf16 v[48:51], a[68:71], v[148:151], v[48:51]
    v_mfma_f32_16x16x32_bf16 v[48:51], a[72:75], v[152:155], v[48:51]
    v_mfma_f32_16x16x32_bf16 v[48:51], a[76:79], v[156:159], v[48:51]
    ds_read_b128 a[112:115], v88 offset:58368
    ds_read_b128 a[116:119], v89 offset:58368
    ds_read_b128 a[120:123], v90 offset:58368
    ds_read_b128 a[124:127], v91 offset:58368
    s_waitcnt lgkmcnt(8)
    v_mfma_f32_16x16x32_bf16 v[52:55], a[80:83], v[144:147], 0
    v_mfma_f32_16x16x32_bf16 v[52:55], a[84:87], v[148:151], v[52:55]
    v_mfma_f32_16x16x32_bf16 v[52:55], a[88:91], v[152:155], v[52:55]
    v_mfma_f32_16x16x32_bf16 v[52:55], a[92:95], v[156:159], v[52:55]
    s_waitcnt lgkmcnt(4)
    v_mfma_f32_16x16x32_bf16 v[56:59], a[96:99], v[144:147], 0
    v_mfma_f32_16x16x32_bf16 v[56:59], a[100:103], v[148:151], v[56:59]
    v_mfma_f32_16x16x32_bf16 v[56:59], a[104:107], v[152:155], v[56:59]
    v_mfma_f32_16x16x32_bf16 v[56:59], a[108:111], v[156:159], v[56:59]
    s_waitcnt lgkmcnt(0)
    v_mfma_f32_16x16x32_bf16 v[60:63], a[112:115], v[144:147], 0
    v_mfma_f32_16x16x32_bf16 v[60:63], a[116:119], v[148:151], v[60:63]
    v_mfma_f32_16x16x32_bf16 v[60:63], a[120:123], v[152:155], v[60:63]
    v_mfma_f32_16x16x32_bf16 v[60:63], a[124:127], v[156:159], v[60:63]
    v_mov_b32 v92, 0x3e0293ee
    s_nop 6
    v_pk_add_f32 v[26:27], v[32:33], v[34:35]
    v_pk_add_f32 v[28:29], v[36:37], v[38:39]
    v_pk_add_f32 v[26:27], v[26:27], v[40:41]
    v_pk_add_f32 v[28:29], v[28:29], v[42:43]
    v_pk_add_f32 v[26:27], v[26:27], v[44:45]
    v_pk_add_f32 v[28:29], v[28:29], v[46:47]
    v_pk_add_f32 v[26:27], v[26:27], v[48:49]
    v_pk_add_f32 v[28:29], v[28:29], v[50:51]
    v_pk_add_f32 v[26:27], v[26:27], v[52:53]
    v_pk_add_f32 v[28:29], v[28:29], v[54:55]
    v_pk_add_f32 v[26:27], v[26:27], v[56:57]
    v_pk_add_f32 v[28:29], v[28:29], v[58:59]
    v_pk_add_f32 v[26:27], v[26:27], v[60:61]
    v_pk_add_f32 v[28:29], v[28:29], v[62:63]
    v_pk_add_f32 v[26:27], v[26:27], v[28:29]
    v_add_f32 v24, v26, v27
    v_mov_b32 v25, v24
    s_nop 1
    v_permlane16_swap_b32 v24, v25
    v_add_f32 v24, v24, v25
    v_mov_b32 v25, v24
    s_nop 1
    v_permlane32_swap_b32 v24, v25
    v_add_f32 v24, v24, v25
    v_mov_b32 v25, v63
    v_mov_b32 v26, v63
    s_nop 1
    v_permlane16_swap_b32 v25, v26
    v_mov_b32 v25, v26
    s_nop 1
    v_permlane32_swap_b32 v25, v26
    v_mul_f32 v24, 0x3db504f3, v24
    v_sub_f32 v24, v26, v24
    v_mul_f32 v24, 0x3c4a91dd, v24
    v_pk_fma_f32 v[32:33], v[32:33], v[92:93], v[24:25] op_sel_hi:[1,0,0]
    v_pk_fma_f32 v[34:35], v[34:35], v[92:93], v[24:25] op_sel_hi:[1,0,0]
    v_pk_fma_f32 v[36:37], v[36:37], v[92:93], v[24:25] op_sel_hi:[1,0,0]
    v_pk_fma_f32 v[38:39], v[38:39], v[92:93], v[24:25] op_sel_hi:[1,0,0]
    v_pk_fma_f32 v[40:41], v[40:41], v[92:93], v[24:25] op_sel_hi:[1,0,0]
    v_pk_fma_f32 v[42:43], v[42:43], v[92:93], v[24:25] op_sel_hi:[1,0,0]
    v_pk_fma_f32 v[44:45], v[44:45], v[92:93], v[24:25] op_sel_hi:[1,0,0]
    v_pk_fma_f32 v[46:47], v[46:47], v[92:93], v[24:25] op_sel_hi:[1,0,0]
    v_pk_fma_f32 v[48:49], v[48:49], v[92:93], v[24:25] op_sel_hi:[1,0,0]
    v_pk_fma_f32 v[50:51], v[50:51], v[92:93], v[24:25] op_sel_hi:[1,0,0]
    v_pk_fma_f32 v[52:53], v[52:53], v[92:93], v[24:25] op_sel_hi:[1,0,0]
    v_pk_fma_f32 v[54:55], v[54:55], v[92:93], v[24:25] op_sel_hi:[1,0,0]
    v_pk_fma_f32 v[56:57], v[56:57], v[92:93], v[24:25] op_sel_hi:[1,0,0]
    v_pk_fma_f32 v[58:59], v[58:59], v[92:93], v[24:25] op_sel_hi:[1,0,0]
    v_pk_fma_f32 v[60:61], v[60:61], v[92:93], v[24:25] op_sel_hi:[1,0,0]
    v_pk_fma_f32 v[62:63], v[62:63], v[92:93], v[24:25] op_sel_hi:[1,0,0]
    v_cndmask_b32 v63, v63, 0, vcc
    v_cvt_pk_bf16_f32 v160, v32, v33
    v_cvt_pk_bf16_f32 v161, v34, v35
    v_cvt_pk_bf16_f32 v162, v36, v37
    v_cvt_pk_bf16_f32 v163, v38, v39
    buffer_store_dwordx4 v[160:163], v30, s[12:15], s38 offen offset:0 sc1
    v_cvt_pk_bf16_f32 v164, v40, v41
    v_cvt_pk_bf16_f32 v165, v42, v43
    v_cvt_pk_bf16_f32 v166, v44, v45
    v_cvt_pk_bf16_f32 v167, v46, v47
    buffer_store_dwordx4 v[164:167], v30, s[12:15], s38 offen offset:1024 sc1
    v_cvt_pk_bf16_f32 v168, v48, v49
    v_cvt_pk_bf16_f32 v169, v50, v51
    v_cvt_pk_bf16_f32 v170, v52, v53
    v_cvt_pk_bf16_f32 v171, v54, v55
    buffer_store_dwordx4 v[168:171], v30, s[12:15], s38 offen offset:2048 sc1
    v_cvt_pk_bf16_f32 v172, v56, v57
    v_cvt_pk_bf16_f32 v173, v58, v59
    v_cvt_pk_bf16_f32 v174, v60, v61
    v_cvt_pk_bf16_f32 v175, v62, v63
    buffer_store_dwordx4 v[172:175], v30, s[12:15], s38 offen offset:3072 sc1
    v_pk_mul_f32 v[26:27], v[32:33], v[32:33]
    v_pk_mul_f32 v[28:29], v[34:35], v[34:35]
    v_pk_fma_f32 v[26:27], v[36:37], v[36:37], v[26:27]
    v_pk_fma_f32 v[28:29], v[38:39], v[38:39], v[28:29]
    v_pk_fma_f32 v[26:27], v[40:41], v[40:41], v[26:27]
    v_pk_fma_f32 v[28:29], v[42:43], v[42:43], v[28:29]
    v_pk_fma_f32 v[26:27], v[44:45], v[44:45], v[26:27]
    v_pk_fma_f32 v[28:29], v[46:47], v[46:47], v[28:29]
    v_pk_fma_f32 v[26:27], v[48:49], v[48:49], v[26:27]
    v_pk_fma_f32 v[28:29], v[50:51], v[50:51], v[28:29]
    v_pk_fma_f32 v[26:27], v[52:53], v[52:53], v[26:27]
    v_pk_fma_f32 v[28:29], v[54:55], v[54:55], v[28:29]
    v_pk_fma_f32 v[26:27], v[56:57], v[56:57], v[26:27]
    v_pk_fma_f32 v[28:29], v[58:59], v[58:59], v[28:29]
    v_pk_fma_f32 v[26:27], v[60:61], v[60:61], v[26:27]
    v_pk_fma_f32 v[28:29], v[62:63], v[62:63], v[28:29]
    v_pk_add_f32 v[26:27], v[26:27], v[28:29]
    v_add_f32 v24, v26, v27
    v_mov_b32 v25, v24
    s_nop 1
    v_permlane16_swap_b32 v24, v25
    v_add_f32 v24, v24, v25
    v_mov_b32 v25, v24
    s_nop 1
    v_permlane32_swap_b32 v24, v25
    v_add_f32 v24, v24, v25
    s_lshl_b32 s33, s72, 6
    v_lshlrev_b32 v27, 2, v2
    s_mov_b64 exec, 0xffff
    buffer_store_dword v24, v27, s[20:23], s33 offen sc1
    s_mov_b64 exec, -1
    v_accvgpr_write_b32 a232, v8
    v_accvgpr_write_b32 a233, v9
    v_accvgpr_write_b32 a234, v10
    v_accvgpr_write_b32 a235, v11
    v_accvgpr_write_b32 a236, v12
    v_accvgpr_write_b32 a237, v13
    v_accvgpr_write_b32 a238, v14
    v_accvgpr_write_b32 a239, v15
    v_accvgpr_write_b32 a240, v16
    v_accvgpr_write_b32 a241, v17
    v_accvgpr_write_b32 a242, v18
    v_accvgpr_write_b32 a243, v19
    v_accvgpr_write_b32 a244, v20
    v_accvgpr_write_b32 a245, v21
    v_accvgpr_write_b32 a246, v22
    v_accvgpr_write_b32 a247, v23
    s_branch L_adone
L_binw:
    v_lshlrev_b32 v5, 1, v3
    v_xor_b32 v5, v5, v2
    v_lshlrev_b32 v5, 4, v5
    v_lshl_add_u32 v5, v3, 8, v5
    v_xor_b32 v6, 0x80, v5
    s_lshl_b32 s36, s26, 13
    s_add_u32 s37, s36, 4096

    s_add_u32 m0, s36, 0
    s_nop 0
    buffer_load_dwordx4 v5, s[88:91], s36 offen offset:0 lds
    buffer_load_dwordx4 v5, s[88:91], s36 offen offset:1024 lds
    buffer_load_dwordx4 v6, s[88:91], s36 offen offset:2048 lds
    buffer_load_dwordx4 v6, s[88:91], s36 offen offset:3072 lds
    s_add_u32 m0, s37, 0
    s_nop 0
    buffer_load_dwordx4 v5, s[88:91], s37 offen offset:0 lds
    buffer_load_dwordx4 v5, s[88:91], s37 offen offset:1024 lds
    buffer_load_dwordx4 v6, s[88:91], s37 offen offset:2048 lds
    buffer_load_dwordx4 v6, s[88:91], s37 offen offset:3072 lds
    s_add_u32 m0, s36, 32768
    s_nop 0
    buffer_load_dwordx4 v5, s[92:95], s36 offen offset:0 lds
    buffer_load_dwordx4 v5, s[92:95], s36 offen offset:1024 lds
    buffer_load_dwordx4 v6, s[92:95], s36 offen offset:2048 lds
    buffer_load_dwordx4 v6, s[92:95], s36 offen offset:3072 lds
    s_add_u32 m0, s37, 32768
    s_nop 0
    buffer_load_dwordx4 v5, s[92:95], s37 offen offset:0 lds
    buffer_load_dwordx4 v5, s[92:95], s37 offen offset:1024 lds
    buffer_load_dwordx4 v6, s[92:95], s37 offen offset:2048 lds
    buffer_load_dwordx4 v6, s[92:95], s37 offen offset:3072 lds
    s_waitcnt vmcnt(8)
    s_barrier
    s_waitcnt vmcnt(0)
    s_barrier
L_adone:
    s_add_u32 s96, s100, 0
    s_addc_u32 s97, s101, 0
    s_mov_b32 s98, 256
    s_mov_b32 s99, 0x20000
    v_mov_b32 v10, 0
    buffer_load_dword v11, v10, s[96:99], 0 offen sc1
    s_add_u32 s8, s4, 4096
    s_addc_u32 s9, s5, 0
    s_mov_b32 s10, 3200000
    s_mov_b32 s11, 0x20000
    s_add_u32 s12, s4, 4194304
    s_addc_u32 s13, s5, 0
    s_mov_b32 s14, 3211264
    s_mov_b32 s15, 0x20000
    s_add_u32 s16, s4, 16777216
    s_addc_u32 s17, s5, 0
    s_mov_b32 s18, 16056320
    s_mov_b32 s19, 0x20000
    s_add_u32 s68, s4, 9699328
    s_addc_u32 s69, s5, 0
    s_mov_b32 s70, 50176
    s_mov_b32 s71, 0x20000
    s_lshl_b32 s33, s26, 12
    v_add_u32 v220, s33, v255
    s_mul_i32 s88, s25, 647168
    s_cmp_eq_u32 s25, 4
    s_cselect_b32 s89, 37, 39
    s_lshl_b32 s89, s89, 14
    s_add_u32 s89, s89, s88
    s_add_u32 s91, s88, 65535
    s_lshr_b32 s91, s91, 16
    s_sub_u32 s27, s2, s91
    s_and_b32 s27, s27, 7
    s_add_u32 s91, s91, s27
    s_lshl_b32 s27, s91, 16
    s_sub_u32 s27, s27, s88
    s_add_u32 s27, s27, 16383
    s_and_b32 s27, s27, 0xffffc000
    s_add_u32 s27, s27, s88
    s_mov_b32 s90, s27
    s_add_u32 s28, s33, 0
    s_add_u32 s29, s33, 16384
    s_add_u32 s30, s33, 32768
    s_add_u32 s31, s33, 49152
    s_lshl_b32 s34, s24, 4
    s_lshl_b32 s35, s26, 2
    s_add_u32 s34, s34, s35
    v_and_b32 v4, 7, v221
    v_lshlrev_b32 v4, 1, v4
    v_lshrrev_b32 v5, 4, v221
    v_xor_b32 v4, v4, v5
    v_and_b32 v6, 15, v221
    v_lshlrev_b32 v7, 8, v6

    v_xor_b32 v8, 0, v4
    v_lshl_add_u32 v208, v8, 4, v7
    v_xor_b32 v8, 4, v4
    v_lshl_add_u32 v209, v8, 4, v7
    v_xor_b32 v8, 8, v4
    v_lshl_add_u32 v210, v8, 4, v7
    v_xor_b32 v8, 12, v4
    v_lshl_add_u32 v211, v8, 4, v7
    v_lshrrev_b32 v4, 2, v221
    v_lshlrev_b32 v7, 8, v4
    v_and_b32 v4, 7, v4
    v_and_b32 v8, 3, v221
    v_lshl_add_u32 v7, v8, 3, v7

    v_xor_b32 v8, 0, v4
    v_lshl_add_u32 v212, v8, 5, v7
    v_add_u32 v230, s74, v212
    v_xor_b32 v8, 1, v4
    v_lshl_add_u32 v213, v8, 5, v7
    v_add_u32 v231, s74, v213
    v_xor_b32 v8, 2, v4
    v_lshl_add_u32 v214, v8, 5, v7
    v_add_u32 v232, s74, v214
    v_xor_b32 v8, 3, v4
    v_lshl_add_u32 v215, v8, 5, v7
    v_add_u32 v233, s74, v215
    v_xor_b32 v8, 4, v4
    v_lshl_add_u32 v216, v8, 5, v7
    v_add_u32 v234, s74, v216
    v_xor_b32 v8, 5, v4
    v_lshl_add_u32 v217, v8, 5, v7
    v_add_u32 v235, s74, v217
    v_xor_b32 v8, 6, v4
    v_lshl_add_u32 v218, v8, 5, v7
    v_add_u32 v236, s74, v218
    v_xor_b32 v8, 7, v4
    v_lshl_add_u32 v219, v8, 5, v7
    v_add_u32 v237, s74, v219
    v_lshlrev_b32 v8, 1, v5
    v_xor_b32 v8, v8, v6
    v_lshlrev_b32 v238, 4, v8
    v_xor_b32 v239, 0x80, v238
    v_bfe_u32 v8, v221, 2, 2
    v_lshlrev_b32 v8, 4, v8
    v_bfe_u32 v9, v221, 4, 1
    v_lshl_add_u32 v8, v9, 3, v8
    v_and_b32 v9, 3, v221
    v_lshl_add_u32 v8, v9, 1, v8
    s_add_u32 s83, s73, 5120
    v_add_u32 v242, s83, v8
    v_lshlrev_b32 v8, 6, v6
    v_lshl_add_u32 v8, v5, 4, v8
    v_add_u32 v243, s83, v8
    v_mov_b32 v244, 0x3f80
    v_mov_b32 v248, 0

    v_accvgpr_write_b32 a128, 0
    v_accvgpr_write_b32 a129, 0
    v_accvgpr_write_b32 a130, 0
    v_accvgpr_write_b32 a131, 0
    v_accvgpr_write_b32 a132, 0
    v_accvgpr_write_b32 a133, 0
    v_accvgpr_write_b32 a134, 0
    v_accvgpr_write_b32 a135, 0
    v_accvgpr_write_b32 a136, 0
    v_accvgpr_write_b32 a137, 0
    v_accvgpr_write_b32 a138, 0
    v_accvgpr_write_b32 a139, 0
    v_accvgpr_write_b32 a140, 0
    v_accvgpr_write_b32 a141, 0
    v_accvgpr_write_b32 a142, 0
    v_accvgpr_write_b32 a143, 0
    v_accvgpr_write_b32 a144, 0
    v_accvgpr_write_b32 a145, 0
    v_accvgpr_write_b32 a146, 0
    v_accvgpr_write_b32 a147, 0
    v_accvgpr_write_b32 a148, 0
    v_accvgpr_write_b32 a149, 0
    v_accvgpr_write_b32 a150, 0
    v_accvgpr_write_b32 a151, 0
    v_accvgpr_write_b32 a152, 0
    v_accvgpr_write_b32 a153, 0
    v_accvgpr_write_b32 a154, 0
    v_accvgpr_write_b32 a155, 0
    v_accvgpr_write_b32 a156, 0
    v_accvgpr_write_b32 a157, 0
    v_accvgpr_write_b32 a158, 0
    v_accvgpr_write_b32 a159, 0
    v_accvgpr_write_b32 a196, 0
    v_accvgpr_write_b32 a197, 0
    v_accvgpr_write_b32 a198, 0
    v_accvgpr_write_b32 a199, 0
    s_add_u32 s92, s84, 0
    s_addc_u32 s93, s85, 0
    s_mov_b32 s94, 25000
    s_mov_b32 s95, 0x20000
    v_lshlrev_b32 v14, 1, v6
    s_lshl_b32 s33, s72, 5
    s_waitcnt vmcnt(0)
    s_barrier
    s_cmp_lg_u32 s26, 0
    s_cbranch_scc1 L_depok
    v_cmp_ne_u32 vcc, 1, v11
    s_cbranch_vccz L_rsokm
    s_mov_b32 s41, 0x20000
L_rsm:
    buffer_load_dword v11, v10, s[96:99], 0 offen sc1
    s_waitcnt vmcnt(0)
    v_cmp_ne_u32 vcc, 1, v11
    s_cbranch_vccz L_rsokm
    s_sub_u32 s41, s41, 1
    s_cmp_lg_u32 s41, 0
    s_cbranch_scc1 L_rsm

L_rsokm:
    s_lshl_b32 s40, s24, 8
    s_lshl_b32 s41, s25, 2
    s_add_u32 s41, s41, s40
    s_add_u32 s41, s41, 1048608
    v_mov_b32 v11, 1
    s_mov_b64 exec, 1
    buffer_store_dword v11, v10, s[20:23], s41 offen sc1
    s_mov_b64 exec, -1
    s_lshl_b32 s41, s91, 8
    v_mov_b32 v12, s40
    v_mov_b32 v13, s41
    v_cmp_eq_u32 vcc, 1, v221
    s_nop 1
    v_cndmask_b32 v12, v12, v13, vcc
    s_mov_b32 s39, 1048608
    buffer_load_dwordx4 v[16:19], v12, s[20:23], s39 offen sc1
    buffer_load_dword v20, v12, s[20:23], s39 offen offset:16 sc1

    s_mov_b32 s41, 0x20000
    s_waitcnt vmcnt(0)
L2_fsa:
    v_and_b32 v16, v16, v17
    v_and_b32 v18, v18, v19
    v_and_b32 v16, v16, v20
    v_and_b32 v16, v16, v18
    v_cmp_ne_u32 vcc, 1, v16
    s_cbranch_vccz L2_fsoka
    s_sub_u32 s41, s41, 1
    s_cmp_eq_u32 s41, 0
    s_cbranch_scc1 L2_fsoka
    s_sleep 1
    buffer_load_dwordx4 v[16:19], v12, s[20:23], s39 offen sc1
    buffer_load_dword v20, v12, s[20:23], s39 offen offset:16 sc1
    s_waitcnt vmcnt(0)
    s_branch L2_fsa

L2_fsoka:
L_depok:
    s_barrier
    s_mov_b32 m0, s30
    s_nop 0
    buffer_load_dwordx4 v220, s[8:11], s27 offen offset:0 sc1 lds
    buffer_load_dwordx4 v220, s[8:11], s27 offen offset:1024 sc1 lds
    buffer_load_dwordx4 v220, s[8:11], s27 offen offset:2048 sc1 lds
    buffer_load_dwordx4 v220, s[8:11], s27 offen offset:3072 sc1 lds
    s_add_u32 s35, s34, s0
    s_lshl_b32 s35, s35, 12
    s_xor_b32 s36, s35, 4096
    s_xor_b32 s37, s35, 8192
    s_xor_b32 s38, s35, 12288
    s_lshl_b32 s39, s24, 10

    buffer_load_dwordx4 v[0:3], v255, s[20:23], s39 offen sc1
    buffer_load_dwordx4 a[0:3], v255, s[12:15], s35 offen offset:0 sc1
    buffer_load_dwordx4 a[4:7], v255, s[12:15], s35 offen offset:1024 sc1
    buffer_load_dwordx4 a[8:11], v255, s[12:15], s35 offen offset:2048 sc1
    buffer_load_dwordx4 a[12:15], v255, s[12:15], s35 offen offset:3072 sc1
    buffer_load_dwordx4 a[16:19], v255, s[12:15], s36 offen offset:0 sc1
    buffer_load_dwordx4 a[20:23], v255, s[12:15], s36 offen offset:1024 sc1
    buffer_load_dwordx4 a[24:27], v255, s[12:15], s36 offen offset:2048 sc1
    buffer_load_dwordx4 a[28:31], v255, s[12:15], s36 offen offset:3072 sc1
    s_waitcnt vmcnt(8)
    s_barrier
    ds_read_b128 a[160:163], v208 offset:32768
    ds_read_b128 a[164:167], v209 offset:32768
    ds_read_b128 a[168:171], v210 offset:32768
    ds_read_b128 a[172:175], v211 offset:32768
    ds_read_b128 a[176:179], v208 offset:36864
    ds_read_b128 a[180:183], v209 offset:36864
    ds_read_b128 a[184:187], v210 offset:36864
    ds_read_b128 a[188:191], v211 offset:36864
    ds_read_b128 a[200:203], v208 offset:40960
    ds_read_b128 a[204:207], v209 offset:40960
    ds_read_b128 a[208:211], v210 offset:40960
    ds_read_b128 a[212:215], v211 offset:40960
    v_max3_f32 v0, v0, v1, v2
    v_max_f32 v0, v0, v3
    v_cmp_lt_f32 vcc, 0x42900000, v0
    s_cbranch_vccnz L2_slow

    buffer_load_dwordx4 a[32:35], v255, s[12:15], s37 offen offset:0 sc1
    buffer_load_dwordx4 a[36:39], v255, s[12:15], s37 offen offset:1024 sc1
    buffer_load_dwordx4 a[40:43], v255, s[12:15], s37 offen offset:2048 sc1
    buffer_load_dwordx4 a[44:47], v255, s[12:15], s37 offen offset:3072 sc1
    ds_read_b128 a[216:219], v208 offset:45056
    ds_read_b128 a[220:223], v209 offset:45056
    ds_read_b128 a[224:227], v210 offset:45056
    ds_read_b128 a[228:231], v211 offset:45056
    s_waitcnt vmcnt(8)
    s_add_u32 s27, s27, 16384
    s_cmp_eq_u32 s27, s89
    s_cselect_b32 s27, s88, s27
    s_cmp_eq_u32 s27, s90
    s_cselect_b32 s27, s89, s27
    s_mov_b32 m0, s31
    s_nop 0
    s_waitcnt lgkmcnt(15)
    v_mfma_f32_16x16x32_bf16 v[192:195], a[160:163], a[0:3], 0
    buffer_load_dwordx4 v220, s[8:11], s27 offen offset:0 sc1 lds
    s_waitcnt lgkmcnt(14)
    v_mfma_f32_16x16x32_bf16 v[192:195], a[164:167], a[4:7], v[192:195]
    buffer_load_dwordx4 a[48:51], v255, s[12:15], s38 offen offset:0 sc1
    s_waitcnt lgkmcnt(13)
    v_mfma_f32_16x16x32_bf16 v[192:195], a[168:171], a[8:11], v[192:195]
    s_waitcnt lgkmcnt(12)
    v_mfma_f32_16x16x32_bf16 v[192:195], a[172:175], a[12:15], v[192:195]
    s_waitcnt lgkmcnt(11)
    v_mfma_f32_16x16x32_bf16 v[196:199], a[176:179], a[0:3], 0
    buffer_load_dwordx4 v220, s[8:11], s27 offen offset:1024 sc1 lds
    s_waitcnt lgkmcnt(10)
    v_mfma_f32_16x16x32_bf16 v[196:199], a[180:183], a[4:7], v[196:199]
    buffer_load_dwordx4 a[52:55], v255, s[12:15], s38 offen offset:1024 sc1
    s_waitcnt lgkmcnt(9)
    v_mfma_f32_16x16x32_bf16 v[196:199], a[184:187], a[8:11], v[196:199]
    s_waitcnt lgkmcnt(8)
    v_mfma_f32_16x16x32_bf16 v[196:199], a[188:191], a[12:15], v[196:199]
    s_waitcnt lgkmcnt(7)
    v_mfma_f32_16x16x32_bf16 v[200:203], a[200:203], a[0:3], 0
    buffer_load_dwordx4 v220, s[8:11], s27 offen offset:2048 sc1 lds
    v_exp_f32 v192, v192
    s_waitcnt lgkmcnt(6)
    v_mfma_f32_16x16x32_bf16 v[200:203], a[204:207], a[4:7], v[200:203]
    buffer_load_dwordx4 a[56:59], v255, s[12:15], s38 offen offset:2048 sc1
    v_exp_f32 v193, v193
    s_waitcnt lgkmcnt(5)
    v_mfma_f32_16x16x32_bf16 v[200:203], a[208:211], a[8:11], v[200:203]
    v_exp_f32 v194, v194
    s_waitcnt lgkmcnt(4)
    v_mfma_f32_16x16x32_bf16 v[200:203], a[212:215], a[12:15], v[200:203]
    v_exp_f32 v195, v195
    v_cvt_pk_bf16_f32 v128, v192, v193
    v_cvt_pk_bf16_f32 v129, v194, v195
    s_waitcnt lgkmcnt(3)
    v_mfma_f32_16x16x32_bf16 v[204:207], a[216:219], a[0:3], 0
    buffer_load_dwordx4 v220, s[8:11], s27 offen offset:3072 sc1 lds
    v_exp_f32 v196, v196
    s_waitcnt lgkmcnt(2)
    v_mfma_f32_16x16x32_bf16 v[204:207], a[220:223], a[4:7], v[204:207]
    buffer_load_dwordx4 a[60:63], v255, s[12:15], s38 offen offset:3072 sc1
    v_exp_f32 v197, v197
    s_waitcnt lgkmcnt(1)
    v_mfma_f32_16x16x32_bf16 v[204:207], a[224:227], a[8:11], v[204:207]
    v_exp_f32 v198, v198
    s_waitcnt lgkmcnt(0)
    v_mfma_f32_16x16x32_bf16 v[204:207], a[228:231], a[12:15], v[204:207]
    v_exp_f32 v199, v199
    v_cvt_pk_bf16_f32 v130, v196, v197
    v_cvt_pk_bf16_f32 v131, v198, v199
    s_waitcnt vmcnt(12)
    s_add_u32 s27, s27, 16384
    s_cmp_eq_u32 s27, s89
    s_cselect_b32 s27, s88, s27
    s_cmp_eq_u32 s27, s90
    s_cselect_b32 s27, s89, s27
    s_mov_b32 m0, s28
    s_nop 0
    v_mfma_f32_16x16x32_bf16 v[192:195], a[160:163], a[16:19], 0
    buffer_load_dwordx4 v220, s[8:11], s27 offen offset:0 sc1 lds
    v_exp_f32 v200, v200
    v_mfma_f32_16x16x32_bf16 v[192:195], a[164:167], a[20:23], v[192:195]
    v_exp_f32 v201, v201
    v_mfma_f32_16x16x32_bf16 v[192:195], a[168:171], a[24:27], v[192:195]
    v_exp_f32 v202, v202
    v_mfma_f32_16x16x32_bf16 v[192:195], a[172:175], a[28:31], v[192:195]
    v_exp_f32 v203, v203
    v_cvt_pk_bf16_f32 v144, v200, v201
    v_cvt_pk_bf16_f32 v145, v202, v203
    v_mfma_f32_16x16x32_bf16 v[196:199], a[176:179], a[16:19], 0
    buffer_load_dwordx4 v220, s[8:11], s27 offen offset:1024 sc1 lds
    v_exp_f32 v204, v204
    v_mfma_f32_16x16x32_bf16 v[196:199], a[180:183], a[20:23], v[196:199]
    v_exp_f32 v205, v205
    v_mfma_f32_16x16x32_bf16 v[196:199], a[184:187], a[24:27], v[196:199]
    v_exp_f32 v206, v206
    v_mfma_f32_16x16x32_bf16 v[196:199], a[188:191], a[28:31], v[196:199]
    v_exp_f32 v207, v207
    v_cvt_pk_bf16_f32 v146, v204, v205
    v_cvt_pk_bf16_f32 v147, v206, v207
    v_mfma_f32_16x16x32_bf16 v[200:203], a[200:203], a[16:19], 0
    buffer_load_dwordx4 v220, s[8:11], s27 offen offset:2048 sc1 lds
    v_exp_f32 v192, v192
    v_mfma_f32_16x16x32_bf16 v[200:203], a[204:207], a[20:23], v[200:203]
    v_exp_f32 v193, v193
    v_mfma_f32_16x16x32_bf16 v[200:203], a[208:211], a[24:27], v[200:203]
    v_exp_f32 v194, v194
    v_mfma_f32_16x16x32_bf16 v[200:203], a[212:215], a[28:31], v[200:203]
    v_exp_f32 v195, v195
    v_cvt_pk_bf16_f32 v132, v192, v193
    v_cvt_pk_bf16_f32 v133, v194, v195
    v_mfma_f32_16x16x32_bf16 v[204:207], a[216:219], a[16:19], 0
    buffer_load_dwordx4 v220, s[8:11], s27 offen offset:3072 sc1 lds
    v_exp_f32 v196, v196
    v_mfma_f32_16x16x32_bf16 v[204:207], a[220:223], a[20:23], v[204:207]
    v_exp_f32 v197, v197
    v_mfma_f32_16x16x32_bf16 v[204:207], a[224:227], a[24:27], v[204:207]
    v_exp_f32 v198, v198
    v_mfma_f32_16x16x32_bf16 v[204:207], a[228:231], a[28:31], v[204:207]
    v_exp_f32 v199, v199
    v_cvt_pk_bf16_f32 v134, v196, v197
    v_cvt_pk_bf16_f32 v135, v198, v199
    s_waitcnt vmcnt(12)
    v_mfma_f32_16x16x32_bf16 v[192:195], a[160:163], a[32:35], 0
    v_exp_f32 v200, v200
    v_mfma_f32_16x16x32_bf16 v[192:195], a[164:167], a[36:39], v[192:195]
    v_exp_f32 v201, v201
    v_mfma_f32_16x16x32_bf16 v[192:195], a[168:171], a[40:43], v[192:195]
    v_exp_f32 v202, v202
    v_mfma_f32_16x16x32_bf16 v[192:195], a[172:175], a[44:47], v[192:195]
    v_exp_f32 v203, v203
    v_cvt_pk_bf16_f32 v148, v200, v201
    v_cvt_pk_bf16_f32 v149, v202, v203
    v_mfma_f32_16x16x32_bf16 v[196:199], a[176:179], a[32:35], 0
    v_exp_f32 v204, v204
    v_mfma_f32_16x16x32_bf16 v[196:199], a[180:183], a[36:39], v[196:199]
    v_exp_f32 v205, v205
    v_mfma_f32_16x16x32_bf16 v[196:199], a[184:187], a[40:43], v[196:199]
    v_exp_f32 v206, v206
    v_mfma_f32_16x16x32_bf16 v[196:199], a[188:191], a[44:47], v[196:199]
    v_exp_f32 v207, v207
    v_cvt_pk_bf16_f32 v150, v204, v205
    v_cvt_pk_bf16_f32 v151, v206, v207
    v_mfma_f32_16x16x32_bf16 v[200:203], a[200:203], a[32:35], 0
    v_exp_f32 v192, v192
    v_mfma_f32_16x16x32_bf16 v[200:203], a[204:207], a[36:39], v[200:203]
    v_exp_f32 v193, v193
    v_mfma_f32_16x16x32_bf16 v[200:203], a[208:211], a[40:43], v[200:203]
    v_exp_f32 v194, v194
    v_mfma_f32_16x16x32_bf16 v[200:203], a[212:215], a[44:47], v[200:203]
    v_exp_f32 v195, v195
    v_cvt_pk_bf16_f32 v136, v192, v193
    v_cvt_pk_bf16_f32 v137, v194, v195
    v_mfma_f32_16x16x32_bf16 v[204:207], a[216:219], a[32:35], 0
    v_exp_f32 v196, v196
    v_mfma_f32_16x16x32_bf16 v[204:207], a[220:223], a[36:39], v[204:207]
    v_exp_f32 v197, v197
    v_mfma_f32_16x16x32_bf16 v[204:207], a[224:227], a[40:43], v[204:207]
    v_exp_f32 v198, v198
    v_mfma_f32_16x16x32_bf16 v[204:207], a[228:231], a[44:47], v[204:207]
    v_exp_f32 v199, v199
    v_cvt_pk_bf16_f32 v138, v196, v197
    v_cvt_pk_bf16_f32 v139, v198, v199
    s_waitcnt vmcnt(4)
    s_barrier
    v_mfma_f32_16x16x32_bf16 v[192:195], a[160:163], a[48:51], 0
    ds_read_b128 a[64:67], v208 offset:49152
    v_exp_f32 v200, v200
    v_mfma_f32_16x16x32_bf16 v[192:195], a[164:167], a[52:55], v[192:195]
    v_exp_f32 v201, v201
    v_mfma_f32_16x16x32_bf16 v[192:195], a[168:171], a[56:59], v[192:195]
    ds_read_b64_tr_b16 a[96:97], v212 offset:32768
    ds_read_b64_tr_b16 a[98:99], v212 offset:36864
    v_exp_f32 v202, v202
    v_mfma_f32_16x16x32_bf16 v[192:195], a[172:175], a[60:63], v[192:195]
    v_exp_f32 v203, v203
    v_cvt_pk_bf16_f32 v152, v200, v201
    v_cvt_pk_bf16_f32 v153, v202, v203
    v_mfma_f32_16x16x32_bf16 v[196:199], a[176:179], a[48:51], 0
    ds_read_b128 a[68:71], v209 offset:49152
    v_exp_f32 v204, v204
    v_mfma_f32_16x16x32_bf16 v[196:199], a[180:183], a[52:55], v[196:199]
    v_exp_f32 v205, v205
    v_mfma_f32_16x16x32_bf16 v[196:199], a[184:187], a[56:59], v[196:199]
    ds_read_b64_tr_b16 a[100:101], v212 offset:40960
    ds_read_b64_tr_b16 a[102:103], v212 offset:45056
    v_exp_f32 v206, v206
    v_mfma_f32_16x16x32_bf16 v[196:199], a[188:191], a[60:63], v[196:199]
    v_exp_f32 v207, v207
    v_cvt_pk_bf16_f32 v154, v204, v205
    v_cvt_pk_bf16_f32 v155, v206, v207
    v_mfma_f32_16x16x32_bf16 v[200:203], a[200:203], a[48:51], 0
    ds_read_b128 a[72:75], v210 offset:49152
    v_exp_f32 v192, v192
    v_mfma_f32_16x16x32_bf16 v[200:203], a[204:207], a[52:55], v[200:203]
    v_exp_f32 v193, v193
    v_mfma_f32_16x16x32_bf16 v[200:203], a[208:211], a[56:59], v[200:203]
    ds_read_b64_tr_b16 a[104:105], v213 offset:32768
    ds_read_b64_tr_b16 a[106:107], v213 offset:36864
    v_exp_f32 v194, v194
    v_mfma_f32_16x16x32_bf16 v[200:203], a[212:215], a[60:63], v[200:203]
    v_exp_f32 v195, v195
    v_cvt_pk_bf16_f32 v140, v192, v193
    v_cvt_pk_bf16_f32 v141, v194, v195
    v_mfma_f32_16x16x32_bf16 v[204:207], a[216:219], a[48:51], 0
    ds_read_b128 a[76:79], v211 offset:49152
    v_exp_f32 v196, v196
    v_mfma_f32_16x16x32_bf16 v[204:207], a[220:223], a[52:55], v[204:207]
    v_exp_f32 v197, v197
    v_mfma_f32_16x16x32_bf16 v[204:207], a[224:227], a[56:59], v[204:207]
    ds_read_b64_tr_b16 a[108:109], v213 offset:40960
    ds_read_b64_tr_b16 a[110:111], v213 offset:45056
    v_exp_f32 v198, v198
    v_mfma_f32_16x16x32_bf16 v[204:207], a[228:231], a[60:63], v[204:207]
    v_exp_f32 v199, v199
    v_cvt_pk_bf16_f32 v142, v196, v197
    v_cvt_pk_bf16_f32 v143, v198, v199
    v_exp_f32 v200, v200
    v_exp_f32 v201, v201
    v_exp_f32 v202, v202
    v_exp_f32 v203, v203
    v_cvt_pk_bf16_f32 v156, v200, v201
    v_cvt_pk_bf16_f32 v157, v202, v203
    buffer_load_ushort a248, v14, s[92:95], s33 offen
    v_min_u32 v228, 48, v221
    v_lshlrev_b32 v228, 8, v228
    s_mov_b32 s39, 1048608
    buffer_load_dwordx4 v[222:225], v228, s[20:23], s39 offen sc1
    buffer_load_dword v226, v228, s[20:23], s39 offen offset:16 sc1
    s_nop 3
    s_waitcnt lgkmcnt(11)
    v_mfma_f32_16x16x32_bf16 v[192:195], a[64:67], a[0:3], 0
    v_exp_f32 v204, v204
    s_waitcnt lgkmcnt(8)
    v_mfma_f32_16x16x32_bf16 v[192:195], a[68:71], a[4:7], v[192:195]
    v_exp_f32 v205, v205
    s_waitcnt lgkmcnt(5)
    v_mfma_f32_16x16x32_bf16 v[192:195], a[72:75], a[8:11], v[192:195]
    v_exp_f32 v206, v206
    s_waitcnt lgkmcnt(2)
    v_mfma_f32_16x16x32_bf16 v[192:195], a[76:79], a[12:15], v[192:195]
    v_exp_f32 v207, v207
    v_mfma_f32_16x16x32_bf16 v[0:3], a[96:99], v[128:131], 0
    v_cvt_pk_bf16_f32 v158, v204, v205
    v_cvt_pk_bf16_f32 v159, v206, v207
    v_mfma_f32_16x16x32_bf16 v[0:3], a[100:103], v[144:147], v[0:3]
    ds_read_b64_tr_b16 a[112:113], v214 offset:32768
    ds_read_b64_tr_b16 a[114:115], v214 offset:36864
    v_mfma_f32_16x16x32_bf16 v[4:7], a[100:103], v[148:151], 0
    ds_read_b128 a[80:83], v208 offset:53248
    ds_read_b128 a[84:87], v209 offset:53248
    v_mfma_f32_16x16x32_bf16 v[4:7], a[96:99], v[132:135], v[4:7]
    v_mfma_f32_16x16x32_bf16 v[196:199], a[64:67], a[16:19], 0
    v_exp_f32 v192, v192
    v_mfma_f32_16x16x32_bf16 v[196:199], a[68:71], a[20:23], v[196:199]
    v_exp_f32 v193, v193
    v_mfma_f32_16x16x32_bf16 v[196:199], a[72:75], a[24:27], v[196:199]
    v_exp_f32 v194, v194
    v_mfma_f32_16x16x32_bf16 v[196:199], a[76:79], a[28:31], v[196:199]
    v_exp_f32 v195, v195
    v_mfma_f32_16x16x32_bf16 v[8:11], a[96:99], v[136:139], 0
    v_cvt_pk_bf16_f32 v160, v192, v193
    v_cvt_pk_bf16_f32 v161, v194, v195
    v_mfma_f32_16x16x32_bf16 v[8:11], a[100:103], v[152:155], v[8:11]
    ds_read_b64_tr_b16 a[116:117], v214 offset:40960
    ds_read_b64_tr_b16 a[118:119], v214 offset:45056
    v_mfma_f32_16x16x32_bf16 v[12:15], a[100:103], v[156:159], 0
    ds_read_b128 a[88:91], v210 offset:53248
    ds_read_b128 a[92:95], v211 offset:53248
    v_mfma_f32_16x16x32_bf16 v[12:15], a[96:99], v[140:143], v[12:15]
    s_waitcnt lgkmcnt(8)
    v_mfma_f32_16x16x32_bf16 v[200:203], a[64:67], a[32:35], 0
    v_exp_f32 v196, v196
    v_mfma_f32_16x16x32_bf16 v[200:203], a[68:71], a[36:39], v[200:203]
    v_exp_f32 v197, v197
    v_mfma_f32_16x16x32_bf16 v[200:203], a[72:75], a[40:43], v[200:203]
    v_exp_f32 v198, v198
    v_mfma_f32_16x16x32_bf16 v[200:203], a[76:79], a[44:47], v[200:203]
    v_exp_f32 v199, v199
    v_mfma_f32_16x16x32_bf16 v[16:19], a[104:107], v[128:131], 0
    v_cvt_pk_bf16_f32 v164, v196, v197
    v_cvt_pk_bf16_f32 v165, v198, v199
    v_mfma_f32_16x16x32_bf16 v[16:19], a[108:111], v[144:147], v[16:19]
    ds_read_b64_tr_b16 a[120:121], v215 offset:32768
    ds_read_b64_tr_b16 a[122:123], v215 offset:36864
    v_mfma_f32_16x16x32_bf16 v[20:23], a[108:111], v[148:151], 0
    v_mfma_f32_16x16x32_bf16 v[20:23], a[104:107], v[132:135], v[20:23]
    v_mfma_f32_16x16x32_bf16 v[204:207], a[64:67], a[48:51], 0
    v_exp_f32 v200, v200
    v_mfma_f32_16x16x32_bf16 v[204:207], a[68:71], a[52:55], v[204:207]
    v_exp_f32 v201, v201
    v_mfma_f32_16x16x32_bf16 v[204:207], a[72:75], a[56:59], v[204:207]
    v_exp_f32 v202, v202
    v_mfma_f32_16x16x32_bf16 v[204:207], a[76:79], a[60:63], v[204:207]
    v_exp_f32 v203, v203
    v_mfma_f32_16x16x32_bf16 v[24:27], a[104:107], v[136:139], 0
    v_cvt_pk_bf16_f32 v168, v200, v201
    v_cvt_pk_bf16_f32 v169, v202, v203
    v_mfma_f32_16x16x32_bf16 v[24:27], a[108:111], v[152:155], v[24:27]
    ds_read_b64_tr_b16 a[124:125], v215 offset:40960
    ds_read_b64_tr_b16 a[126:127], v215 offset:45056
    v_mfma_f32_16x16x32_bf16 v[28:31], a[108:111], v[156:159], 0
    v_mfma_f32_16x16x32_bf16 v[28:31], a[104:107], v[140:143], v[28:31]
    s_waitcnt lgkmcnt(4)
    v_mfma_f32_16x16x32_bf16 v[192:195], a[80:83], a[0:3], 0
    v_exp_f32 v204, v204
    v_mfma_f32_16x16x32_bf16 v[192:195], a[84:87], a[4:7], v[192:195]
    v_exp_f32 v205, v205
    v_mfma_f32_16x16x32_bf16 v[192:195], a[88:91], a[8:11], v[192:195]
    v_exp_f32 v206, v206
    v_mfma_f32_16x16x32_bf16 v[192:195], a[92:95], a[12:15], v[192:195]
    v_exp_f32 v207, v207
    v_mfma_f32_16x16x32_bf16 v[32:35], a[112:115], v[128:131], 0
    v_cvt_pk_bf16_f32 v172, v204, v205
    v_cvt_pk_bf16_f32 v173, v206, v207
    v_mfma_f32_16x16x32_bf16 v[32:35], a[116:119], v[144:147], v[32:35]
    ds_read_b64_tr_b16 a[96:97], v216 offset:32768
    ds_read_b64_tr_b16 a[98:99], v216 offset:36864
    v_mfma_f32_16x16x32_bf16 v[36:39], a[116:119], v[148:151], 0
    ds_read_b128 a[64:67], v208 offset:57344
    ds_read_b128 a[68:71], v209 offset:57344
    v_mfma_f32_16x16x32_bf16 v[36:39], a[112:115], v[132:135], v[36:39]
    v_mfma_f32_16x16x32_bf16 v[196:199], a[80:83], a[16:19], 0
    v_exp_f32 v192, v192
    v_mfma_f32_16x16x32_bf16 v[196:199], a[84:87], a[20:23], v[196:199]
    v_exp_f32 v193, v193
    v_mfma_f32_16x16x32_bf16 v[196:199], a[88:91], a[24:27], v[196:199]
    v_exp_f32 v194, v194
    v_mfma_f32_16x16x32_bf16 v[196:199], a[92:95], a[28:31], v[196:199]
    v_exp_f32 v195, v195
    v_mfma_f32_16x16x32_bf16 v[40:43], a[112:115], v[136:139], 0
    v_cvt_pk_bf16_f32 v162, v192, v193
    v_cvt_pk_bf16_f32 v163, v194, v195
    v_mfma_f32_16x16x32_bf16 v[40:43], a[116:119], v[152:155], v[40:43]
    ds_read_b64_tr_b16 a[100:101], v216 offset:40960
    ds_read_b64_tr_b16 a[102:103], v216 offset:45056
    v_mfma_f32_16x16x32_bf16 v[44:47], a[116:119], v[156:159], 0
    ds_read_b128 a[72:75], v210 offset:57344
    ds_read_b128 a[76:79], v211 offset:57344
    v_mfma_f32_16x16x32_bf16 v[44:47], a[112:115], v[140:143], v[44:47]
    s_waitcnt lgkmcnt(8)
    v_mfma_f32_16x16x32_bf16 v[200:203], a[80:83], a[32:35], 0
    v_exp_f32 v196, v196
    v_mfma_f32_16x16x32_bf16 v[200:203], a[84:87], a[36:39], v[200:203]
    v_exp_f32 v197, v197
    v_mfma_f32_16x16x32_bf16 v[200:203], a[88:91], a[40:43], v[200:203]
    v_exp_f32 v198, v198
    v_mfma_f32_16x16x32_bf16 v[200:203], a[92:95], a[44:47], v[200:203]
    v_exp_f32 v199, v199
    v_mfma_f32_16x16x32_bf16 v[48:51], a[120:123], v[128:131], 0
    v_cvt_pk_bf16_f32 v166, v196, v197
    v_cvt_pk_bf16_f32 v167, v198, v199
    v_mfma_f32_16x16x32_bf16 v[48:51], a[124:127], v[144:147], v[48:51]
    ds_read_b64_tr_b16 a[104:105], v217 offset:32768
    ds_read_b64_tr_b16 a[106:107], v217 offset:36864
    v_mfma_f32_16x16x32_bf16 v[52:55], a[124:127], v[148:151], 0
    v_mfma_f32_16x16x32_bf16 v[52:55], a[120:123], v[132:135], v[52:55]
    v_mfma_f32_16x16x32_bf16 v[204:207], a[80:83], a[48:51], 0
    v_exp_f32 v200, v200
    v_mfma_f32_16x16x32_bf16 v[204:207], a[84:87], a[52:55], v[204:207]
    v_exp_f32 v201, v201
    v_mfma_f32_16x16x32_bf16 v[204:207], a[88:91], a[56:59], v[204:207]
    v_exp_f32 v202, v202
    v_mfma_f32_16x16x32_bf16 v[204:207], a[92:95], a[60:63], v[204:207]
    v_exp_f32 v203, v203
    v_mfma_f32_16x16x32_bf16 v[56:59], a[120:123], v[136:139], 0
    v_cvt_pk_bf16_f32 v170, v200, v201
    v_cvt_pk_bf16_f32 v171, v202, v203
    v_mfma_f32_16x16x32_bf16 v[56:59], a[124:127], v[152:155], v[56:59]
    ds_read_b64_tr_b16 a[108:109], v217 offset:40960
    ds_read_b64_tr_b16 a[110:111], v217 offset:45056
    v_mfma_f32_16x16x32_bf16 v[60:63], a[124:127], v[156:159], 0
    v_mfma_f32_16x16x32_bf16 v[60:63], a[120:123], v[140:143], v[60:63]
    s_waitcnt lgkmcnt(4)
    v_mfma_f32_16x16x32_bf16 v[192:195], a[64:67], a[0:3], 0
    v_exp_f32 v204, v204
    v_mfma_f32_16x16x32_bf16 v[192:195], a[68:71], a[4:7], v[192:195]
    v_exp_f32 v205, v205
    v_mfma_f32_16x16x32_bf16 v[192:195], a[72:75], a[8:11], v[192:195]
    v_exp_f32 v206, v206
    v_mfma_f32_16x16x32_bf16 v[192:195], a[76:79], a[12:15], v[192:195]
    v_exp_f32 v207, v207
    v_mfma_f32_16x16x32_bf16 v[64:67], a[96:99], v[128:131], 0
    v_cvt_pk_bf16_f32 v174, v204, v205
    v_cvt_pk_bf16_f32 v175, v206, v207
    v_mfma_f32_16x16x32_bf16 v[64:67], a[100:103], v[144:147], v[64:67]
    ds_read_b64_tr_b16 a[112:113], v218 offset:32768
    ds_read_b64_tr_b16 a[114:115], v218 offset:36864
    v_mfma_f32_16x16x32_bf16 v[68:71], a[100:103], v[148:151], 0
    ds_read_b128 a[80:83], v208 offset:61440
    ds_read_b128 a[84:87], v209 offset:61440
    v_mfma_f32_16x16x32_bf16 v[68:71], a[96:99], v[132:135], v[68:71]
    v_mfma_f32_16x16x32_bf16 v[196:199], a[64:67], a[16:19], 0
    v_exp_f32 v192, v192
    v_mfma_f32_16x16x32_bf16 v[196:199], a[68:71], a[20:23], v[196:199]
    v_exp_f32 v193, v193
    v_mfma_f32_16x16x32_bf16 v[196:199], a[72:75], a[24:27], v[196:199]
    v_exp_f32 v194, v194
    v_mfma_f32_16x16x32_bf16 v[196:199], a[76:79], a[28:31], v[196:199]
    v_exp_f32 v195, v195
    v_mfma_f32_16x16x32_bf16 v[72:75], a[96:99], v[136:139], 0
    v_cvt_pk_bf16_f32 v176, v192, v193
    v_cvt_pk_bf16_f32 v177, v194, v195
    v_mfma_f32_16x16x32_bf16 v[72:75], a[100:103], v[152:155], v[72:75]
    ds_read_b64_tr_b16 a[116:117], v218 offset:40960
    ds_read_b64_tr_b16 a[118:119], v218 offset:45056
    v_mfma_f32_16x16x32_bf16 v[76:79], a[100:103], v[156:159], 0
    ds_read_b128 a[88:91], v210 offset:61440
    ds_read_b128 a[92:95], v211 offset:61440
    v_mfma_f32_16x16x32_bf16 v[76:79], a[96:99], v[140:143], v[76:79]
    s_waitcnt lgkmcnt(8)
    v_mfma_f32_16x16x32_bf16 v[200:203], a[64:67], a[32:35], 0
    v_exp_f32 v196, v196
    v_mfma_f32_16x16x32_bf16 v[200:203], a[68:71], a[36:39], v[200:203]
    v_exp_f32 v197, v197
    v_mfma_f32_16x16x32_bf16 v[200:203], a[72:75], a[40:43], v[200:203]
    v_exp_f32 v198, v198
    v_mfma_f32_16x16x32_bf16 v[200:203], a[76:79], a[44:47], v[200:203]
    v_exp_f32 v199, v199
    v_mfma_f32_16x16x32_bf16 v[80:83], a[104:107], v[128:131], 0
    v_cvt_pk_bf16_f32 v180, v196, v197
    v_cvt_pk_bf16_f32 v181, v198, v199
    v_mfma_f32_16x16x32_bf16 v[80:83], a[108:111], v[144:147], v[80:83]
    ds_read_b64_tr_b16 a[120:121], v219 offset:32768
    ds_read_b64_tr_b16 a[122:123], v219 offset:36864
    v_mfma_f32_16x16x32_bf16 v[84:87], a[108:111], v[148:151], 0
    v_mfma_f32_16x16x32_bf16 v[84:87], a[104:107], v[132:135], v[84:87]
    v_mfma_f32_16x16x32_bf16 v[204:207], a[64:67], a[48:51], 0
    v_exp_f32 v200, v200
    v_mfma_f32_16x16x32_bf16 v[204:207], a[68:71], a[52:55], v[204:207]
    v_exp_f32 v201, v201
    v_mfma_f32_16x16x32_bf16 v[204:207], a[72:75], a[56:59], v[204:207]
    v_exp_f32 v202, v202
    v_mfma_f32_16x16x32_bf16 v[204:207], a[76:79], a[60:63], v[204:207]
    v_exp_f32 v203, v203
    v_mfma_f32_16x16x32_bf16 v[88:91], a[104:107], v[136:139], 0
    v_cvt_pk_bf16_f32 v184, v200, v201
    v_cvt_pk_bf16_f32 v185, v202, v203
    v_mfma_f32_16x16x32_bf16 v[88:91], a[108:111], v[152:155], v[88:91]
    ds_read_b64_tr_b16 a[124:125], v219 offset:40960
    ds_read_b64_tr_b16 a[126:127], v219 offset:45056
    v_mfma_f32_16x16x32_bf16 v[92:95], a[108:111], v[156:159], 0
    v_mfma_f32_16x16x32_bf16 v[92:95], a[104:107], v[140:143], v[92:95]
    s_waitcnt lgkmcnt(4)
    v_mfma_f32_16x16x32_bf16 v[192:195], a[80:83], a[0:3], 0
    v_exp_f32 v204, v204
    v_mfma_f32_16x16x32_bf16 v[192:195], a[84:87], a[4:7], v[192:195]
    v_exp_f32 v205, v205
    v_mfma_f32_16x16x32_bf16 v[192:195], a[88:91], a[8:11], v[192:195]
    v_exp_f32 v206, v206
    v_mfma_f32_16x16x32_bf16 v[192:195], a[92:95], a[12:15], v[192:195]
    v_exp_f32 v207, v207
    v_mfma_f32_16x16x32_bf16 v[96:99], a[112:115], v[128:131], 0
    v_cvt_pk_bf16_f32 v188, v204, v205
    v_cvt_pk_bf16_f32 v189, v206, v207
    v_mfma_f32_16x16x32_bf16 v[96:99], a[116:119], v[144:147], v[96:99]
    ds_read_b64_tr_b16 a[96:97], v212 offset:49152
    ds_read_b64_tr_b16 a[98:99], v212 offset:53248
    s_waitcnt vmcnt(2) lgkmcnt(2)
    s_barrier
    v_mfma_f32_16x16x32_bf16 v[100:103], a[116:119], v[148:151], 0
    ds_read_b128 a[64:67], v208 offset:0
    ds_read_b128 a[68:71], v209 offset:0
    v_mfma_f32_16x16x32_bf16 v[100:103], a[112:115], v[132:135], v[100:103]
    v_mfma_f32_16x16x32_bf16 v[196:199], a[80:83], a[16:19], 0
    v_exp_f32 v192, v192
    v_mfma_f32_16x16x32_bf16 v[196:199], a[84:87], a[20:23], v[196:199]
    v_exp_f32 v193, v193
    v_mfma_f32_16x16x32_bf16 v[196:199], a[88:91], a[24:27], v[196:199]
    v_exp_f32 v194, v194
    v_mfma_f32_16x16x32_bf16 v[196:199], a[92:95], a[28:31], v[196:199]
    v_exp_f32 v195, v195
    v_mfma_f32_16x16x32_bf16 v[104:107], a[112:115], v[136:139], 0
    v_cvt_pk_bf16_f32 v178, v192, v193
    v_cvt_pk_bf16_f32 v179, v194, v195
    v_mfma_f32_16x16x32_bf16 v[104:107], a[116:119], v[152:155], v[104:107]
    ds_read_b64_tr_b16 a[100:101], v212 offset:57344
    ds_read_b64_tr_b16 a[102:103], v212 offset:61440
    v_mfma_f32_16x16x32_bf16 v[108:111], a[116:119], v[156:159], 0
    ds_read_b128 a[72:75], v210 offset:0
    ds_read_b128 a[76:79], v211 offset:0
    v_mfma_f32_16x16x32_bf16 v[108:111], a[112:115], v[140:143], v[108:111]
    v_mfma_f32_16x16x32_bf16 v[200:203], a[80:83], a[32:35], 0
    v_exp_f32 v196, v196
    v_mfma_f32_16x16x32_bf16 v[200:203], a[84:87], a[36:39], v[200:203]
    v_exp_f32 v197, v197
    v_mfma_f32_16x16x32_bf16 v[200:203], a[88:91], a[40:43], v[200:203]
    v_exp_f32 v198, v198
    v_mfma_f32_16x16x32_bf16 v[200:203], a[92:95], a[44:47], v[200:203]
    v_exp_f32 v199, v199
    v_mfma_f32_16x16x32_bf16 v[112:115], a[120:123], v[128:131], 0
    v_cvt_pk_bf16_f32 v182, v196, v197
    v_cvt_pk_bf16_f32 v183, v198, v199
    v_mfma_f32_16x16x32_bf16 v[112:115], a[124:127], v[144:147], v[112:115]
    ds_read_b64_tr_b16 a[104:105], v213 offset:49152
    ds_read_b64_tr_b16 a[106:107], v213 offset:53248
    v_mfma_f32_16x16x32_bf16 v[116:119], a[124:127], v[148:151], 0
    v_mfma_f32_16x16x32_bf16 v[116:119], a[120:123], v[132:135], v[116:119]
    v_mfma_f32_16x16x32_bf16 v[204:207], a[80:83], a[48:51], 0
    v_exp_f32 v200, v200
    v_mfma_f32_16x16x32_bf16 v[204:207], a[84:87], a[52:55], v[204:207]
    v_exp_f32 v201, v201
    v_mfma_f32_16x16x32_bf16 v[204:207], a[88:91], a[56:59], v[204:207]
    v_exp_f32 v202, v202
    v_mfma_f32_16x16x32_bf16 v[204:207], a[92:95], a[60:63], v[204:207]
    v_exp_f32 v203, v203
    v_mfma_f32_16x16x32_bf16 v[120:123], a[120:123], v[136:139], 0
    v_cvt_pk_bf16_f32 v186, v200, v201
    v_cvt_pk_bf16_f32 v187, v202, v203
    v_mfma_f32_16x16x32_bf16 v[120:123], a[124:127], v[152:155], v[120:123]
    ds_read_b64_tr_b16 a[108:109], v213 offset:57344
    ds_read_b64_tr_b16 a[110:111], v213 offset:61440
    v_mfma_f32_16x16x32_bf16 v[124:127], a[124:127], v[156:159], 0
    v_mfma_f32_16x16x32_bf16 v[124:127], a[120:123], v[140:143], v[124:127]
    s_waitcnt lgkmcnt(4)
    s_mov_b32 s41, 0x20000
    s_waitcnt vmcnt(0)
L2_fsb:
    v_and_b32 v222, v222, v223
    v_and_b32 v224, v224, v225
    v_and_b32 v222, v222, v226
    v_and_b32 v222, v222, v224
    v_cmp_ne_u32 vcc, 1, v222
    s_cbranch_vccz L2_fsokb
    s_sub_u32 s41, s41, 1
    s_cmp_eq_u32 s41, 0
    s_cbranch_scc1 L2_fsokb
    s_sleep 1
    buffer_load_dwordx4 v[222:225], v228, s[20:23], s39 offen sc1
    buffer_load_dword v226, v228, s[20:23], s39 offen offset:16 sc1
    s_waitcnt vmcnt(0)
    s_branch L2_fsb

L2_fsokb:
    s_add_u32 s27, s27, 16384
    s_cmp_eq_u32 s27, s89
    s_cselect_b32 s27, s88, s27
    s_cmp_eq_u32 s27, s90
    s_cselect_b32 s27, s89, s27
    s_mov_b32 m0, s29
    s_nop 0
    buffer_load_dwordx4 v220, s[8:11], s27 offen offset:0 sc1 lds
    s_waitcnt lgkmcnt(0)
    s_lshl_b32 s33, s26, 2
    s_add_u32 s33, s33, 70528
    v_mov_b32 v251, s33
    v_mov_b32 v250, 0
    v_and_b32 v254, 3, v221
    v_lshlrev_b32 v254, 2, v254
    v_add_u32 v254, 70528, v254
    ds_write_b32 v251, v250
    s_waitcnt lgkmcnt(0)
    v_mfma_f32_16x16x32_bf16 v[192:195], a[64:67], a[0:3], 0
    v_exp_f32 v204, v204
    v_mfma_f32_16x16x32_bf16 v[192:195], a[68:71], a[4:7], v[192:195]
    v_exp_f32 v205, v205
    v_mfma_f32_16x16x32_bf16 v[192:195], a[72:75], a[8:11], v[192:195]
    v_exp_f32 v206, v206
    v_mfma_f32_16x16x32_bf16 v[192:195], a[76:79], a[12:15], v[192:195]
    v_exp_f32 v207, v207
    v_mfma_f32_16x16x32_bf16 v[0:3], a[96:99], v[160:163], v[0:3]
    v_cvt_pk_bf16_f32 v190, v204, v205
    v_cvt_pk_bf16_f32 v191, v206, v207
    v_mfma_f32_16x16x32_bf16 v[0:3], a[100:103], v[176:179], v[0:3]
    ds_read_b64_tr_b16 a[112:113], v214 offset:49152
    ds_read_b64_tr_b16 a[114:115], v214 offset:53248
    v_mfma_f32_16x16x32_bf16 v[4:7], a[100:103], v[180:183], v[4:7]
    ds_read_b128 a[80:83], v208 offset:4096
    ds_read_b128 a[84:87], v209 offset:4096
    v_mfma_f32_16x16x32_bf16 v[4:7], a[96:99], v[164:167], v[4:7]
    buffer_load_dwordx4 v220, s[8:11], s27 offen offset:1024 sc1 lds
    v_mfma_f32_16x16x32_bf16 v[196:199], a[64:67], a[16:19], 0
    v_exp_f32 v192, v192
    v_mfma_f32_16x16x32_bf16 v[196:199], a[68:71], a[20:23], v[196:199]
    v_exp_f32 v193, v193
    v_mfma_f32_16x16x32_bf16 v[196:199], a[72:75], a[24:27], v[196:199]
    v_exp_f32 v194, v194
    v_mfma_f32_16x16x32_bf16 v[196:199], a[76:79], a[28:31], v[196:199]
    v_exp_f32 v195, v195
    v_mfma_f32_16x16x32_bf16 v[8:11], a[96:99], v[168:171], v[8:11]
    v_cvt_pk_bf16_f32 v128, v192, v193
    v_cvt_pk_bf16_f32 v129, v194, v195
    v_mfma_f32_16x16x32_bf16 v[8:11], a[100:103], v[184:187], v[8:11]
    ds_read_b64_tr_b16 a[116:117], v214 offset:57344
    ds_read_b64_tr_b16 a[118:119], v214 offset:61440
    v_mfma_f32_16x16x32_bf16 v[12:15], a[100:103], v[188:191], v[12:15]
    ds_read_b128 a[88:91], v210 offset:4096
    ds_read_b128 a[92:95], v211 offset:4096
    v_mfma_f32_16x16x32_bf16 v[12:15], a[96:99], v[172:175], v[12:15]
    v_mfma_f32_16x16x32_bf16 v[200:203], a[64:67], a[32:35], 0
    v_exp_f32 v196, v196
    v_mfma_f32_16x16x32_bf16 v[200:203], a[68:71], a[36:39], v[200:203]
    v_exp_f32 v197, v197
    v_mfma_f32_16x16x32_bf16 v[200:203], a[72:75], a[40:43], v[200:203]
    v_exp_f32 v198, v198
    v_mfma_f32_16x16x32_bf16 v[200:203], a[76:79], a[44:47], v[200:203]
    v_exp_f32 v199, v199
    v_mfma_f32_16x16x32_bf16 v[16:19], a[104:107], v[160:163], v[16:19]
    v_cvt_pk_bf16_f32 v132, v196, v197
    v_cvt_pk_bf16_f32 v133, v198, v199
    v_mfma_f32_16x16x32_bf16 v[16:19], a[108:111], v[176:179], v[16:19]
    ds_read_b64_tr_b16 a[120:121], v215 offset:49152
    ds_read_b64_tr_b16 a[122:123], v215 offset:53248
    v_mfma_f32_16x16x32_bf16 v[20:23], a[108:111], v[180:183], v[20:23]
    buffer_load_dwordx4 v220, s[8:11], s27 offen offset:2048 sc1 lds
    v_mfma_f32_16x16x32_bf16 v[20:23], a[104:107], v[164:167], v[20:23]
    buffer_load_dwordx4 v220, s[8:11], s27 offen offset:3072 sc1 lds
    v_mfma_f32_16x16x32_bf16 v[204:207], a[64:67], a[48:51], 0
    v_exp_f32 v200, v200
    v_mfma_f32_16x16x32_bf16 v[204:207], a[68:71], a[52:55], v[204:207]
    v_exp_f32 v201, v201
    v_mfma_f32_16x16x32_bf16 v[204:207], a[72:75], a[56:59], v[204:207]
    v_exp_f32 v202, v202
    v_mfma_f32_16x16x32_bf16 v[204:207], a[76:79], a[60:63], v[204:207]
    v_exp_f32 v203, v203
    v_mfma_f32_16x16x32_bf16 v[24:27], a[104:107], v[168:171], v[24:27]
    v_cvt_pk_bf16_f32 v136, v200, v201
    v_cvt_pk_bf16_f32 v137, v202, v203
    v_mfma_f32_16x16x32_bf16 v[24:27], a[108:111], v[184:187], v[24:27]
    ds_read_b64_tr_b16 a[124:125], v215 offset:57344
    ds_read_b64_tr_b16 a[126:127], v215 offset:61440
    v_mfma_f32_16x16x32_bf16 v[28:31], a[108:111], v[188:191], v[28:31]
    s_add_u32 s27, s27, 16384
    v_mfma_f32_16x16x32_bf16 v[28:31], a[104:107], v[172:175], v[28:31]
    s_waitcnt lgkmcnt(4)
    v_mfma_f32_16x16x32_bf16 v[192:195], a[80:83], a[0:3], 0
    v_exp_f32 v204, v204
    v_mfma_f32_16x16x32_bf16 v[192:195], a[84:87], a[4:7], v[192:195]
    v_exp_f32 v205, v205
    v_mfma_f32_16x16x32_bf16 v[192:195], a[88:91], a[8:11], v[192:195]
    v_exp_f32 v206, v206
    v_mfma_f32_16x16x32_bf16 v[192:195], a[92:95], a[12:15], v[192:195]
    v_exp_f32 v207, v207
    v_mfma_f32_16x16x32_bf16 v[32:35], a[112:115], v[160:163], v[32:35]
    v_cvt_pk_bf16_f32 v140, v204, v205
    v_cvt_pk_bf16_f32 v141, v206, v207
    v_mfma_f32_16x16x32_bf16 v[32:35], a[116:119], v[176:179], v[32:35]
    ds_read_b64_tr_b16 a[96:97], v216 offset:49152
    ds_read_b64_tr_b16 a[98:99], v216 offset:53248
    v_mfma_f32_16x16x32_bf16 v[36:39], a[116:119], v[180:183], v[36:39]
    ds_read_b128 a[64:67], v208 offset:8192
    ds_read_b128 a[68:71], v209 offset:8192
    v_mfma_f32_16x16x32_bf16 v[36:39], a[112:115], v[164:167], v[36:39]
    s_cmp_eq_u32 s27, s89
    s_cselect_b32 s27, s88, s27
    v_mfma_f32_16x16x32_bf16 v[196:199], a[80:83], a[16:19], 0
    v_exp_f32 v192, v192
    v_mfma_f32_16x16x32_bf16 v[196:199], a[84:87], a[20:23], v[196:199]
    v_exp_f32 v193, v193
    v_mfma_f32_16x16x32_bf16 v[196:199], a[88:91], a[24:27], v[196:199]
    v_exp_f32 v194, v194
    v_mfma_f32_16x16x32_bf16 v[196:199], a[92:95], a[28:31], v[196:199]
    v_exp_f32 v195, v195
    v_mfma_f32_16x16x32_bf16 v[40:43], a[112:115], v[168:171], v[40:43]
    v_cvt_pk_bf16_f32 v130, v192, v193
    v_cvt_pk_bf16_f32 v131, v194, v195
    v_mfma_f32_16x16x32_bf16 v[40:43], a[116:119], v[184:187], v[40:43]
    ds_read_b64_tr_b16 a[100:101], v216 offset:57344
    ds_read_b64_tr_b16 a[102:103], v216 offset:61440
    v_mfma_f32_16x16x32_bf16 v[44:47], a[116:119], v[188:191], v[44:47]
    ds_read_b128 a[72:75], v210 offset:8192
    ds_read_b128 a[76:79], v211 offset:8192
    v_mfma_f32_16x16x32_bf16 v[44:47], a[112:115], v[172:175], v[44:47]
    s_waitcnt lgkmcnt(8)
    s_mov_b32 m0, s30
    v_mfma_f32_16x16x32_bf16 v[200:203], a[80:83], a[32:35], 0
    v_exp_f32 v196, v196
    v_mfma_f32_16x16x32_bf16 v[200:203], a[84:87], a[36:39], v[200:203]
    v_exp_f32 v197, v197
    v_mfma_f32_16x16x32_bf16 v[200:203], a[88:91], a[40:43], v[200:203]
    v_exp_f32 v198, v198
    v_mfma_f32_16x16x32_bf16 v[200:203], a[92:95], a[44:47], v[200:203]
    v_exp_f32 v199, v199
    v_mfma_f32_16x16x32_bf16 v[48:51], a[120:123], v[160:163], v[48:51]
    v_cvt_pk_bf16_f32 v134, v196, v197
    v_cvt_pk_bf16_f32 v135, v198, v199
    v_mfma_f32_16x16x32_bf16 v[48:51], a[124:127], v[176:179], v[48:51]
    ds_read_b64_tr_b16 a[104:105], v217 offset:49152
    ds_read_b64_tr_b16 a[106:107], v217 offset:53248
    v_mfma_f32_16x16x32_bf16 v[52:55], a[124:127], v[180:183], v[52:55]
    s_cmp_eq_u32 s27, s90
    s_cselect_b32 s27, s89, s27
    v_mfma_f32_16x16x32_bf16 v[52:55], a[120:123], v[164:167], v[52:55]
    buffer_load_dwordx4 v220, s[8:11], s27 offen offset:0 sc1 lds
    v_mfma_f32_16x16x32_bf16 v[204:207], a[80:83], a[48:51], 0
    v_exp_f32 v200, v200
    v_mfma_f32_16x16x32_bf16 v[204:207], a[84:87], a[52:55], v[204:207]
    v_exp_f32 v201, v201
    v_mfma_f32_16x16x32_bf16 v[204:207], a[88:91], a[56:59], v[204:207]
    v_exp_f32 v202, v202
    v_mfma_f32_16x16x32_bf16 v[204:207], a[92:95], a[60:63], v[204:207]
    v_exp_f32 v203, v203
    v_mfma_f32_16x16x32_bf16 v[56:59], a[120:123], v[168:171], v[56:59]
    v_cvt_pk_bf16_f32 v138, v200, v201
    v_cvt_pk_bf16_f32 v139, v202, v203
    v_mfma_f32_16x16x32_bf16 v[56:59], a[124:127], v[184:187], v[56:59]
    ds_read_b64_tr_b16 a[108:109], v217 offset:57344
    ds_read_b64_tr_b16 a[110:111], v217 offset:61440
    v_mfma_f32_16x16x32_bf16 v[60:63], a[124:127], v[188:191], v[60:63]
    buffer_load_dwordx4 v220, s[8:11], s27 offen offset:1024 sc1 lds
    v_mfma_f32_16x16x32_bf16 v[60:63], a[120:123], v[172:175], v[60:63]
    s_waitcnt lgkmcnt(4)
    v_mfma_f32_16x16x32_bf16 v[192:195], a[64:67], a[0:3], 0
    v_exp_f32 v204, v204
    v_mfma_f32_16x16x32_bf16 v[192:195], a[68:71], a[4:7], v[192:195]
    v_exp_f32 v205, v205
    v_mfma_f32_16x16x32_bf16 v[192:195], a[72:75], a[8:11], v[192:195]
    v_exp_f32 v206, v206
    v_mfma_f32_16x16x32_bf16 v[192:195], a[76:79], a[12:15], v[192:195]
    v_exp_f32 v207, v207
    v_mfma_f32_16x16x32_bf16 v[64:67], a[96:99], v[160:163], v[64:67]
    v_cvt_pk_bf16_f32 v142, v204, v205
    v_cvt_pk_bf16_f32 v143, v206, v207
    v_mfma_f32_16x16x32_bf16 v[64:67], a[100:103], v[176:179], v[64:67]
    ds_read_b64_tr_b16 a[112:113], v218 offset:49152
    ds_read_b64_tr_b16 a[114:115], v218 offset:53248
    v_mfma_f32_16x16x32_bf16 v[68:71], a[100:103], v[180:183], v[68:71]
    ds_read_b128 a[80:83], v208 offset:12288
    ds_read_b128 a[84:87], v209 offset:12288
    v_mfma_f32_16x16x32_bf16 v[68:71], a[96:99], v[164:167], v[68:71]
    buffer_load_dwordx4 v220, s[8:11], s27 offen offset:2048 sc1 lds
    v_mfma_f32_16x16x32_bf16 v[196:199], a[64:67], a[16:19], 0
    v_exp_f32 v192, v192
    v_mfma_f32_16x16x32_bf16 v[196:199], a[68:71], a[20:23], v[196:199]
    v_exp_f32 v193, v193
    v_mfma_f32_16x16x32_bf16 v[196:199], a[72:75], a[24:27], v[196:199]
    v_exp_f32 v194, v194
    v_mfma_f32_16x16x32_bf16 v[196:199], a[76:79], a[28:31], v[196:199]
    v_exp_f32 v195, v195
    v_mfma_f32_16x16x32_bf16 v[72:75], a[96:99], v[168:171], v[72:75]
    v_cvt_pk_bf16_f32 v144, v192, v193
    v_cvt_pk_bf16_f32 v145, v194, v195
    v_mfma_f32_16x16x32_bf16 v[72:75], a[100:103], v[184:187], v[72:75]
    ds_read_b64_tr_b16 a[116:117], v218 offset:57344
    ds_read_b64_tr_b16 a[118:119], v218 offset:61440
    v_mfma_f32_16x16x32_bf16 v[76:79], a[100:103], v[188:191], v[76:79]
    ds_read_b128 a[88:91], v210 offset:12288
    ds_read_b128 a[92:95], v211 offset:12288
    v_mfma_f32_16x16x32_bf16 v[76:79], a[96:99], v[172:175], v[76:79]
    s_waitcnt lgkmcnt(8)
    v_mfma_f32_16x16x32_bf16 v[200:203], a[64:67], a[32:35], 0
    v_exp_f32 v196, v196
    v_mfma_f32_16x16x32_bf16 v[200:203], a[68:71], a[36:39], v[200:203]
    v_exp_f32 v197, v197
    v_mfma_f32_16x16x32_bf16 v[200:203], a[72:75], a[40:43], v[200:203]
    v_exp_f32 v198, v198
    v_mfma_f32_16x16x32_bf16 v[200:203], a[76:79], a[44:47], v[200:203]
    v_exp_f32 v199, v199
    v_mfma_f32_16x16x32_bf16 v[80:83], a[104:107], v[160:163], v[80:83]
    v_cvt_pk_bf16_f32 v148, v196, v197
    v_cvt_pk_bf16_f32 v149, v198, v199
    v_mfma_f32_16x16x32_bf16 v[80:83], a[108:111], v[176:179], v[80:83]
    ds_read_b64_tr_b16 a[120:121], v219 offset:49152
    ds_read_b64_tr_b16 a[122:123], v219 offset:53248
    v_mfma_f32_16x16x32_bf16 v[84:87], a[108:111], v[180:183], v[84:87]
    buffer_load_dwordx4 v220, s[8:11], s27 offen offset:3072 sc1 lds
    v_mfma_f32_16x16x32_bf16 v[84:87], a[104:107], v[164:167], v[84:87]
    v_mfma_f32_16x16x32_bf16 v[204:207], a[64:67], a[48:51], 0
    v_exp_f32 v200, v200
    v_mfma_f32_16x16x32_bf16 v[204:207], a[68:71], a[52:55], v[204:207]
    v_exp_f32 v201, v201
    v_mfma_f32_16x16x32_bf16 v[204:207], a[72:75], a[56:59], v[204:207]
    v_exp_f32 v202, v202
    v_mfma_f32_16x16x32_bf16 v[204:207], a[76:79], a[60:63], v[204:207]
    v_exp_f32 v203, v203
    v_mfma_f32_16x16x32_bf16 v[88:91], a[104:107], v[168:171], v[88:91]
    v_cvt_pk_bf16_f32 v152, v200, v201
    v_cvt_pk_bf16_f32 v153, v202, v203
    v_mfma_f32_16x16x32_bf16 v[88:91], a[108:111], v[184:187], v[88:91]
    ds_read_b64_tr_b16 a[124:125], v219 offset:57344
    ds_read_b64_tr_b16 a[126:127], v219 offset:61440
    v_mfma_f32_16x16x32_bf16 v[92:95], a[108:111], v[188:191], v[92:95]
    v_mfma_f32_16x16x32_bf16 v[92:95], a[104:107], v[172:175], v[92:95]
    s_waitcnt lgkmcnt(4)
    v_mfma_f32_16x16x32_bf16 v[192:195], a[80:83], a[0:3], 0
    v_exp_f32 v204, v204
    v_mfma_f32_16x16x32_bf16 v[192:195], a[84:87], a[4:7], v[192:195]
    v_exp_f32 v205, v205
    v_mfma_f32_16x16x32_bf16 v[192:195], a[88:91], a[8:11], v[192:195]
    v_exp_f32 v206, v206
    v_mfma_f32_16x16x32_bf16 v[192:195], a[92:95], a[12:15], v[192:195]
    v_exp_f32 v207, v207
    v_mfma_f32_16x16x32_bf16 v[96:99], a[112:115], v[160:163], v[96:99]
    v_cvt_pk_bf16_f32 v156, v204, v205
    v_cvt_pk_bf16_f32 v157, v206, v207
    v_mfma_f32_16x16x32_bf16 v[96:99], a[116:119], v[176:179], v[96:99]
    ds_read_b64_tr_b16 a[96:97], v212 offset:0
    ds_read_b64_tr_b16 a[98:99], v212 offset:4096
    s_waitcnt vmcnt(4) lgkmcnt(2)
    s_barrier
    v_mfma_f32_16x16x32_bf16 v[100:103], a[116:119], v[180:183], v[100:103]
    ds_read_b128 a[64:67], v208 offset:16384
    ds_read_b128 a[68:71], v209 offset:16384
    v_mfma_f32_16x16x32_bf16 v[100:103], a[112:115], v[164:167], v[100:103]
    v_mfma_f32_16x16x32_bf16 v[196:199], a[80:83], a[16:19], 0
    v_exp_f32 v192, v192
    v_mfma_f32_16x16x32_bf16 v[196:199], a[84:87], a[20:23], v[196:199]
    v_exp_f32 v193, v193
    v_mfma_f32_16x16x32_bf16 v[196:199], a[88:91], a[24:27], v[196:199]
    v_exp_f32 v194, v194
    v_mfma_f32_16x16x32_bf16 v[196:199], a[92:95], a[28:31], v[196:199]
    v_exp_f32 v195, v195
    v_mfma_f32_16x16x32_bf16 v[104:107], a[112:115], v[168:171], v[104:107]
    v_cvt_pk_bf16_f32 v146, v192, v193
    v_cvt_pk_bf16_f32 v147, v194, v195
    v_mfma_f32_16x16x32_bf16 v[104:107], a[116:119], v[184:187], v[104:107]
    ds_read_b64_tr_b16 a[100:101], v212 offset:8192
    ds_read_b64_tr_b16 a[102:103], v212 offset:12288
    v_mfma_f32_16x16x32_bf16 v[108:111], a[116:119], v[188:191], v[108:111]
    ds_read_b128 a[72:75], v210 offset:16384
    ds_read_b128 a[76:79], v211 offset:16384
    v_mfma_f32_16x16x32_bf16 v[108:111], a[112:115], v[172:175], v[108:111]
    v_mfma_f32_16x16x32_bf16 v[200:203], a[80:83], a[32:35], 0
    v_exp_f32 v196, v196
    v_mfma_f32_16x16x32_bf16 v[200:203], a[84:87], a[36:39], v[200:203]
    v_exp_f32 v197, v197
    v_mfma_f32_16x16x32_bf16 v[200:203], a[88:91], a[40:43], v[200:203]
    v_exp_f32 v198, v198
    v_mfma_f32_16x16x32_bf16 v[200:203], a[92:95], a[44:47], v[200:203]
    v_exp_f32 v199, v199
    v_mfma_f32_16x16x32_bf16 v[112:115], a[120:123], v[160:163], v[112:115]
    v_cvt_pk_bf16_f32 v150, v196, v197
    v_cvt_pk_bf16_f32 v151, v198, v199
    v_mfma_f32_16x16x32_bf16 v[112:115], a[124:127], v[176:179], v[112:115]
    ds_read_b64_tr_b16 a[104:105], v213 offset:0
    ds_read_b64_tr_b16 a[106:107], v213 offset:4096
    v_mfma_f32_16x16x32_bf16 v[116:119], a[124:127], v[180:183], v[116:119]
    v_mfma_f32_16x16x32_bf16 v[116:119], a[120:123], v[164:167], v[116:119]
    v_mfma_f32_16x16x32_bf16 v[204:207], a[80:83], a[48:51], 0
    v_exp_f32 v200, v200
    v_mfma_f32_16x16x32_bf16 v[204:207], a[84:87], a[52:55], v[204:207]
    v_exp_f32 v201, v201
    v_mfma_f32_16x16x32_bf16 v[204:207], a[88:91], a[56:59], v[204:207]
    v_exp_f32 v202, v202
    v_mfma_f32_16x16x32_bf16 v[204:207], a[92:95], a[60:63], v[204:207]
    v_exp_f32 v203, v203
    v_mfma_f32_16x16x32_bf16 v[120:123], a[120:123], v[168:171], v[120:123]
    v_cvt_pk_bf16_f32 v154, v200, v201
    v_cvt_pk_bf16_f32 v155, v202, v203
    v_mfma_f32_16x16x32_bf16 v[120:123], a[124:127], v[184:187], v[120:123]
    ds_read_b64_tr_b16 a[108:109], v213 offset:8192
    ds_read_b64_tr_b16 a[110:111], v213 offset:12288
    v_mfma_f32_16x16x32_bf16 v[124:127], a[124:127], v[188:191], v[124:127]
    v_mfma_f32_16x16x32_bf16 v[124:127], a[120:123], v[172:175], v[124:127]
    s_waitcnt lgkmcnt(4)
    s_add_u32 s27, s27, 16384
    s_cmp_eq_u32 s27, s89
    s_cselect_b32 s27, s88, s27
    s_cmp_eq_u32 s27, s90
    s_cselect_b32 s27, s89, s27
    s_mov_b32 s3, 0
    s_mov_b32 s78, 0
    s_mov_b32 s32, 9
    s_cmp_eq_u32 s25, 4
    s_cselect_b32 s83, 1, 0
    s_branch L2_head
L2_lastp:
    v_min_u32 v248, 3, v221
    v_lshlrev_b32 v248, 2, v248
    s_mov_b32 s39, 1061120
    buffer_load_dword v247, v248, s[20:23], s39 offen sc1
    s_branch L2_body0
L2_hk0:
    v_min_u32 v223, 10, v221
    v_lshlrev_b32 v223, 2, v223
    s_mov_b32 s39, 1061376
    buffer_load_dword v222, v223, s[20:23], s39 offen sc1
    s_branch L2_body1
L2_hk1:
    s_mov_b32 s41, 0x20000
L2_hfa:
    v_cmp_ne_u32 vcc, 1, v222
    s_cbranch_vccz L2_hfoka
    s_sub_u32 s41, s41, 1
    s_cmp_eq_u32 s41, 0
    s_cbranch_scc1 L2_hfoka
    s_sleep 2
    buffer_load_dword v222, v223, s[20:23], s39 offen sc1
    s_waitcnt vmcnt(0)
    s_branch L2_hfa

L2_hfoka:
    v_lshlrev_b32 v223, 2, v221
    v_mov_b32 v224, 0x7ffffff0
    v_cmp_gt_u32 vcc, 11, v221
    s_lshl_b32 s80, s72, 6
    s_nop 0
    v_cndmask_b32 v223, v224, v223, vcc
    buffer_load_dword v246, v223, s[68:71], s80 offen sc1

    s_branch L2_body2
L2_hk2:
    s_mov_b32 s79, 63
L2_retrya:
    v_lshrrev_b32 v222, 16, v246
    v_min_u32 v222, s79, v222
    v_mov_b32 v223, v222

    s_nop 1
    v_add_u32_dpp v223, v223, v223 row_shr:1 row_mask:0xf bank_mask:0xf
    s_nop 1
    v_add_u32_dpp v223, v223, v223 row_shr:2 row_mask:0xf bank_mask:0xf
    s_nop 1
    v_add_u32_dpp v223, v223, v223 row_shr:4 row_mask:0xf bank_mask:0xf
    s_nop 1
    v_add_u32_dpp v223, v223, v223 row_shr:8 row_mask:0xf bank_mask:0xf
    s_nop 0
    v_readlane_b32 s76, v223, 15
    s_cmp_le_u32 s76, 176
    s_cbranch_scc1 L2_oka
    s_mov_b32 s79, 16
    s_branch L2_retrya

L2_oka:
    v_sub_u32 v223, v223, v222
    v_lshl_add_u32 v223, v223, 4, s73
    v_mov_b32 v224, 159744
    v_mul_u32_u24 v224, v224, v221
    v_and_b32 v225, 0xffff, v246
    v_lshl_add_u32 v224, v225, 4, v224
    v_lshlrev_b32 v225, 4, v221
    s_lshl_b32 s76, s76, 2
    s_cbranch_scc0 L2_lba

    v_readlane_b32 s36, v224, 0
    v_readlane_b32 s37, v224, 1
    v_readlane_b32 s38, v224, 2
    v_readlane_b32 s39, v224, 3
    v_readlane_b32 s33, v223, 0
    v_readlane_b32 s42, v223, 1
    v_readlane_b32 s43, v223, 2
    v_readlane_b32 s79, v223, 3
    v_readlane_b32 s80, v222, 0
    v_readlane_b32 s81, v222, 1
    v_readlane_b32 s91, v222, 2
    v_readlane_b32 s77, v222, 3
    s_mov_b32 m0, s33
    s_bfm_b64 exec, s80, 0
    buffer_load_dwordx4 v225, s[64:67], s36 offen sc1 lds
    s_mov_b32 m0, s42
    s_bfm_b64 exec, s81, 0
    buffer_load_dwordx4 v225, s[64:67], s37 offen sc1 lds
    s_mov_b32 m0, s43
    s_bfm_b64 exec, s91, 0
    buffer_load_dwordx4 v225, s[64:67], s38 offen sc1 lds
    s_mov_b32 m0, s79
    s_bfm_b64 exec, s77, 0
    buffer_load_dwordx4 v225, s[64:67], s39 offen sc1 lds
    v_readlane_b32 s36, v224, 4
    v_readlane_b32 s37, v224, 5
    v_readlane_b32 s38, v224, 6
    v_readlane_b32 s39, v224, 7
    v_readlane_b32 s33, v223, 4
    v_readlane_b32 s42, v223, 5
    v_readlane_b32 s43, v223, 6
    v_readlane_b32 s79, v223, 7
    v_readlane_b32 s80, v222, 4
    v_readlane_b32 s81, v222, 5
    v_readlane_b32 s91, v222, 6
    v_readlane_b32 s77, v222, 7
    s_mov_b32 m0, s33
    s_bfm_b64 exec, s80, 0
    buffer_load_dwordx4 v225, s[64:67], s36 offen sc1 lds
    s_mov_b32 m0, s42
    s_bfm_b64 exec, s81, 0
    buffer_load_dwordx4 v225, s[64:67], s37 offen sc1 lds
    s_mov_b32 m0, s43
    s_bfm_b64 exec, s91, 0
    buffer_load_dwordx4 v225, s[64:67], s38 offen sc1 lds
    s_mov_b32 m0, s79
    s_bfm_b64 exec, s77, 0
    buffer_load_dwordx4 v225, s[64:67], s39 offen sc1 lds
    v_readlane_b32 s36, v224, 8
    v_readlane_b32 s37, v224, 9
    v_readlane_b32 s38, v224, 10
    v_readlane_b32 s33, v223, 8
    v_readlane_b32 s42, v223, 9
    v_readlane_b32 s43, v223, 10
    v_readlane_b32 s80, v222, 8
    v_readlane_b32 s81, v222, 9
    v_readlane_b32 s91, v222, 10
    s_mov_b32 m0, s33
    s_bfm_b64 exec, s80, 0
    buffer_load_dwordx4 v225, s[64:67], s36 offen sc1 lds
    s_mov_b32 m0, s42
    s_bfm_b64 exec, s81, 0
    buffer_load_dwordx4 v225, s[64:67], s37 offen sc1 lds
    s_mov_b32 m0, s43
    s_bfm_b64 exec, s91, 0
    buffer_load_dwordx4 v225, s[64:67], s38 offen sc1 lds
L2_lba:
    s_mov_b64 exec, -1
    v_add_u32 v223, s76, v221
    v_lshl_add_u32 v223, v223, 2, s73
    v_mov_b32 v224, 0x7ffffff0
    ds_write_b32 v223, v224
    ds_write_b32 v223, v224 offset:256
    ds_write_b32 v223, v224 offset:512
    v_add_u32 v246, v246, v222
    v_lshlrev_b32 v222, 16, v222
    v_sub_u32 v246, v246, v222
    s_add_u32 s77, s76, 31
    s_lshr_b32 s77, s77, 5
    s_mov_b32 s78, 0
    s_max_u32 s3, s77, 1
    s_sub_u32 s3, s3, 1
    s_and_b32 s3, s3, -2
    v_lshrrev_b32 v240, 4, v221
    v_lshl_add_u32 v240, v240, 2, s73
    v_and_b32 v241, 31, v221
    v_lshl_add_u32 v241, v241, 2, s73

    s_sub_u32 s92, s8, 3072
    s_subb_u32 s93, s9, 0
    s_mov_b32 s94, 3203072
    s_mov_b32 s95, 0x20000
    s_mov_b32 s36, 3072
    s_mov_b32 s37, 2048
    s_mov_b32 s38, 1024
    s_sub_u32 s32, s32, 1
    s_waitcnt lgkmcnt(0)

    v_mfma_f32_16x16x32_bf16 v[192:195], a[64:67], a[0:3], 0
    v_exp_f32 v204, v204
    v_mfma_f32_16x16x32_bf16 v[192:195], a[68:71], a[4:7], v[192:195]
    v_exp_f32 v205, v205
    v_mfma_f32_16x16x32_bf16 v[192:195], a[72:75], a[8:11], v[192:195]
    v_exp_f32 v206, v206
    v_mfma_f32_16x16x32_bf16 v[192:195], a[76:79], a[12:15], v[192:195]
    v_exp_f32 v207, v207
    v_mfma_f32_16x16x32_bf16 v[0:3], a[96:99], v[160:163], v[0:3]
    v_cvt_pk_bf16_f32 v190, v204, v205
    v_cvt_pk_bf16_f32 v191, v206, v207
    v_mfma_f32_16x16x32_bf16 v[0:3], a[100:103], v[176:179], v[0:3]
    ds_read_b64_tr_b16 a[112:113], v214 offset:49152
    ds_read_b64_tr_b16 a[114:115], v214 offset:53248
    v_mfma_f32_16x16x32_bf16 v[4:7], a[100:103], v[180:183], v[4:7]
    ds_read_b128 a[80:83], v208 offset:4096
    ds_read_b128 a[84:87], v209 offset:4096
    v_mfma_f32_16x16x32_bf16 v[4:7], a[96:99], v[164:167], v[4:7]
    ds_read_b32 v255, v254
    v_mfma_f32_16x16x32_bf16 v[196:199], a[64:67], a[16:19], 0
    v_exp_f32 v192, v192
    v_mfma_f32_16x16x32_bf16 v[196:199], a[68:71], a[20:23], v[196:199]
    v_exp_f32 v193, v193
    v_mfma_f32_16x16x32_bf16 v[196:199], a[72:75], a[24:27], v[196:199]
    v_exp_f32 v194, v194
    v_mfma_f32_16x16x32_bf16 v[196:199], a[76:79], a[28:31], v[196:199]
    v_exp_f32 v195, v195
    v_mfma_f32_16x16x32_bf16 v[8:11], a[96:99], v[168:171], v[8:11]
    v_cvt_pk_bf16_f32 v128, v192, v193
    v_cvt_pk_bf16_f32 v129, v194, v195
    v_mfma_f32_16x16x32_bf16 v[8:11], a[100:103], v[184:187], v[8:11]
    ds_read_b64_tr_b16 a[116:117], v214 offset:57344
    ds_read_b64_tr_b16 a[118:119], v214 offset:61440
    v_mfma_f32_16x16x32_bf16 v[12:15], a[100:103], v[188:191], v[12:15]
    ds_read_b128 a[88:91], v210 offset:4096
    ds_read_b128 a[92:95], v211 offset:4096
    v_mfma_f32_16x16x32_bf16 v[12:15], a[96:99], v[172:175], v[12:15]
    s_waitcnt lgkmcnt(9)
    s_mov_b32 m0, s30
    v_mfma_f32_16x16x32_bf16 v[200:203], a[64:67], a[32:35], 0
    v_exp_f32 v196, v196
    v_mfma_f32_16x16x32_bf16 v[200:203], a[68:71], a[36:39], v[200:203]
    v_exp_f32 v197, v197
    v_mfma_f32_16x16x32_bf16 v[200:203], a[72:75], a[40:43], v[200:203]
    v_exp_f32 v198, v198
    v_mfma_f32_16x16x32_bf16 v[200:203], a[76:79], a[44:47], v[200:203]
    v_exp_f32 v199, v199
    v_mfma_f32_16x16x32_bf16 v[16:19], a[104:107], v[160:163], v[16:19]
    v_cvt_pk_bf16_f32 v132, v196, v197
    v_cvt_pk_bf16_f32 v133, v198, v199
    v_mfma_f32_16x16x32_bf16 v[16:19], a[108:111], v[176:179], v[16:19]
    ds_read_b64_tr_b16 a[120:121], v215 offset:49152
    ds_read_b64_tr_b16 a[122:123], v215 offset:53248
    v_mfma_f32_16x16x32_bf16 v[20:23], a[108:111], v[180:183], v[20:23]
    v_mfma_f32_16x16x32_bf16 v[20:23], a[104:107], v[164:167], v[20:23]
    s_waitcnt lgkmcnt(6)
    v_cmp_lt_u32 vcc, v255, v250
    v_mfma_f32_16x16x32_bf16 v[204:207], a[64:67], a[48:51], 0
    v_exp_f32 v200, v200
    v_mfma_f32_16x16x32_bf16 v[204:207], a[68:71], a[52:55], v[204:207]
    v_exp_f32 v201, v201
    v_mfma_f32_16x16x32_bf16 v[204:207], a[72:75], a[56:59], v[204:207]
    v_exp_f32 v202, v202
    v_mfma_f32_16x16x32_bf16 v[204:207], a[76:79], a[60:63], v[204:207]
    v_exp_f32 v203, v203
    v_mfma_f32_16x16x32_bf16 v[24:27], a[104:107], v[168:171], v[24:27]
    v_cvt_pk_bf16_f32 v136, v200, v201
    v_cvt_pk_bf16_f32 v137, v202, v203
    v_mfma_f32_16x16x32_bf16 v[24:27], a[108:111], v[184:187], v[24:27]
    ds_read_b64_tr_b16 a[124:125], v215 offset:57344
    ds_read_b64_tr_b16 a[126:127], v215 offset:61440
    v_mfma_f32_16x16x32_bf16 v[28:31], a[108:111], v[188:191], v[28:31]
    s_cbranch_vccnz L2_spx3F
L2_sprx3F:
    v_mfma_f32_16x16x32_bf16 v[28:31], a[104:107], v[172:175], v[28:31]
    s_waitcnt lgkmcnt(4)
    v_mfma_f32_16x16x32_bf16 v[192:195], a[80:83], a[0:3], 0
    v_exp_f32 v204, v204
    v_mfma_f32_16x16x32_bf16 v[192:195], a[84:87], a[4:7], v[192:195]
    v_exp_f32 v205, v205
    v_mfma_f32_16x16x32_bf16 v[192:195], a[88:91], a[8:11], v[192:195]
    v_exp_f32 v206, v206
    v_mfma_f32_16x16x32_bf16 v[192:195], a[92:95], a[12:15], v[192:195]
    v_exp_f32 v207, v207
    v_mfma_f32_16x16x32_bf16 v[32:35], a[112:115], v[160:163], v[32:35]
    v_cvt_pk_bf16_f32 v140, v204, v205
    v_cvt_pk_bf16_f32 v141, v206, v207
    v_mfma_f32_16x16x32_bf16 v[32:35], a[116:119], v[176:179], v[32:35]
    ds_read_b64_tr_b16 a[96:97], v216 offset:49152
    ds_read_b64_tr_b16 a[98:99], v216 offset:53248
    v_mfma_f32_16x16x32_bf16 v[36:39], a[116:119], v[180:183], v[36:39]
    ds_read_b128 a[64:67], v208 offset:8192
    ds_read_b128 a[68:71], v209 offset:8192
    v_mfma_f32_16x16x32_bf16 v[36:39], a[112:115], v[164:167], v[36:39]
    buffer_load_dwordx4 v220, s[8:11], s27 offen offset:0 sc1 lds
    v_mfma_f32_16x16x32_bf16 v[196:199], a[80:83], a[16:19], 0
    v_exp_f32 v192, v192
    v_mfma_f32_16x16x32_bf16 v[196:199], a[84:87], a[20:23], v[196:199]
    v_exp_f32 v193, v193
    v_mfma_f32_16x16x32_bf16 v[196:199], a[88:91], a[24:27], v[196:199]
    v_exp_f32 v194, v194
    v_mfma_f32_16x16x32_bf16 v[196:199], a[92:95], a[28:31], v[196:199]
    v_exp_f32 v195, v195
    v_mfma_f32_16x16x32_bf16 v[40:43], a[112:115], v[168:171], v[40:43]
    v_cvt_pk_bf16_f32 v130, v192, v193
    v_cvt_pk_bf16_f32 v131, v194, v195
    v_mfma_f32_16x16x32_bf16 v[40:43], a[116:119], v[184:187], v[40:43]
    ds_read_b64_tr_b16 a[100:101], v216 offset:57344
    ds_read_b64_tr_b16 a[102:103], v216 offset:61440
    v_mfma_f32_16x16x32_bf16 v[44:47], a[116:119], v[188:191], v[44:47]
    ds_read_b128 a[72:75], v210 offset:8192
    ds_read_b128 a[76:79], v211 offset:8192
    v_mfma_f32_16x16x32_bf16 v[44:47], a[112:115], v[172:175], v[44:47]
    s_waitcnt lgkmcnt(8)
    buffer_load_dwordx4 v220, s[8:11], s27 offen offset:1024 sc1 lds
    v_add_u32 v250, 1, v250
    v_mfma_f32_16x16x32_bf16 v[200:203], a[80:83], a[32:35], 0
    v_exp_f32 v196, v196
    v_mfma_f32_16x16x32_bf16 v[200:203], a[84:87], a[36:39], v[200:203]
    v_exp_f32 v197, v197
    v_mfma_f32_16x16x32_bf16 v[200:203], a[88:91], a[40:43], v[200:203]
    v_exp_f32 v198, v198
    v_mfma_f32_16x16x32_bf16 v[200:203], a[92:95], a[44:47], v[200:203]
    v_exp_f32 v199, v199
    v_mfma_f32_16x16x32_bf16 v[48:51], a[120:123], v[160:163], v[48:51]
    v_cvt_pk_bf16_f32 v134, v196, v197
    v_cvt_pk_bf16_f32 v135, v198, v199
    v_mfma_f32_16x16x32_bf16 v[48:51], a[124:127], v[176:179], v[48:51]
    ds_read_b64_tr_b16 a[104:105], v217 offset:49152
    ds_read_b64_tr_b16 a[106:107], v217 offset:53248
    v_mfma_f32_16x16x32_bf16 v[52:55], a[124:127], v[180:183], v[52:55]
    v_mfma_f32_16x16x32_bf16 v[52:55], a[120:123], v[164:167], v[52:55]
    buffer_load_dwordx4 v220, s[8:11], s27 offen offset:2048 sc1 lds
    v_mfma_f32_16x16x32_bf16 v[204:207], a[80:83], a[48:51], 0
    v_exp_f32 v200, v200
    v_mfma_f32_16x16x32_bf16 v[204:207], a[84:87], a[52:55], v[204:207]
    v_exp_f32 v201, v201
    v_mfma_f32_16x16x32_bf16 v[204:207], a[88:91], a[56:59], v[204:207]
    v_exp_f32 v202, v202
    v_mfma_f32_16x16x32_bf16 v[204:207], a[92:95], a[60:63], v[204:207]
    v_exp_f32 v203, v203
    v_mfma_f32_16x16x32_bf16 v[56:59], a[120:123], v[168:171], v[56:59]
    v_cvt_pk_bf16_f32 v138, v200, v201
    v_cvt_pk_bf16_f32 v139, v202, v203
    v_mfma_f32_16x16x32_bf16 v[56:59], a[124:127], v[184:187], v[56:59]
    ds_read_b64_tr_b16 a[108:109], v217 offset:57344
    ds_read_b64_tr_b16 a[110:111], v217 offset:61440
    v_mfma_f32_16x16x32_bf16 v[60:63], a[124:127], v[188:191], v[60:63]
    buffer_load_dwordx4 v220, s[8:11], s27 offen offset:3072 sc1 lds
    v_mfma_f32_16x16x32_bf16 v[60:63], a[120:123], v[172:175], v[60:63]
    s_waitcnt lgkmcnt(4)
    s_waitcnt vmcnt(4)
    s_mov_b32 m0, s74
    v_mfma_f32_16x16x32_bf16 v[192:195], a[64:67], a[0:3], 0
    v_exp_f32 v204, v204
    v_mfma_f32_16x16x32_bf16 v[192:195], a[68:71], a[4:7], v[192:195]
    v_exp_f32 v205, v205
    v_mfma_f32_16x16x32_bf16 v[192:195], a[72:75], a[8:11], v[192:195]
    v_exp_f32 v206, v206
    v_mfma_f32_16x16x32_bf16 v[192:195], a[76:79], a[12:15], v[192:195]
    v_exp_f32 v207, v207
    v_mfma_f32_16x16x32_bf16 v[64:67], a[96:99], v[160:163], v[64:67]
    v_cvt_pk_bf16_f32 v142, v204, v205
    v_cvt_pk_bf16_f32 v143, v206, v207
    v_mfma_f32_16x16x32_bf16 v[64:67], a[100:103], v[176:179], v[64:67]
    ds_read_b64_tr_b16 a[112:113], v218 offset:49152
    ds_read_b64_tr_b16 a[114:115], v218 offset:53248
    ds_read2_b32 v[222:223], v240 offset0:0 offset1:4
    ds_read2_b32 v[224:225], v240 offset0:8 offset1:12
    v_mfma_f32_16x16x32_bf16 v[68:71], a[100:103], v[180:183], v[68:71]
    ds_read_b128 a[80:83], v208 offset:12288
    ds_read_b128 a[84:87], v209 offset:12288
    v_mfma_f32_16x16x32_bf16 v[68:71], a[96:99], v[164:167], v[68:71]
    ds_write_b32 v251, v250
    ds_read2_b32 v[226:227], v240 offset0:16 offset1:20
    v_mfma_f32_16x16x32_bf16 v[196:199], a[64:67], a[16:19], 0
    v_exp_f32 v192, v192
    v_mfma_f32_16x16x32_bf16 v[196:199], a[68:71], a[20:23], v[196:199]
    v_exp_f32 v193, v193
    v_mfma_f32_16x16x32_bf16 v[196:199], a[72:75], a[24:27], v[196:199]
    v_exp_f32 v194, v194
    v_mfma_f32_16x16x32_bf16 v[196:199], a[76:79], a[28:31], v[196:199]
    v_exp_f32 v195, v195
    v_mfma_f32_16x16x32_bf16 v[72:75], a[96:99], v[168:171], v[72:75]
    v_cvt_pk_bf16_f32 v144, v192, v193
    v_cvt_pk_bf16_f32 v145, v194, v195
    s_waitcnt lgkmcnt(5)
    v_bitop3_b32 v222, v222, -16, v238 bitop3:0x6a
    v_bitop3_b32 v223, v223, -16, v239 bitop3:0x6a
    v_mfma_f32_16x16x32_bf16 v[72:75], a[100:103], v[184:187], v[72:75]
    ds_read_b64_tr_b16 a[116:117], v218 offset:57344
    ds_read_b64_tr_b16 a[118:119], v218 offset:61440
    buffer_load_dwordx4 v222, s[92:95], s36 offen offset:0 sc1 lds
    v_mfma_f32_16x16x32_bf16 v[76:79], a[100:103], v[188:191], v[76:79]
    ds_read_b128 a[88:91], v210 offset:12288
    ds_read_b128 a[92:95], v211 offset:12288
    v_mfma_f32_16x16x32_bf16 v[76:79], a[96:99], v[172:175], v[76:79]
    ds_read2_b32 v[228:229], v240 offset0:24 offset1:28
    v_mfma_f32_16x16x32_bf16 v[200:203], a[64:67], a[32:35], 0
    v_exp_f32 v196, v196
    v_mfma_f32_16x16x32_bf16 v[200:203], a[68:71], a[36:39], v[200:203]
    v_exp_f32 v197, v197
    v_mfma_f32_16x16x32_bf16 v[200:203], a[72:75], a[40:43], v[200:203]
    v_exp_f32 v198, v198
    v_mfma_f32_16x16x32_bf16 v[200:203], a[76:79], a[44:47], v[200:203]
    v_exp_f32 v199, v199
    v_mfma_f32_16x16x32_bf16 v[80:83], a[104:107], v[160:163], v[80:83]
    v_cvt_pk_bf16_f32 v148, v196, v197
    v_cvt_pk_bf16_f32 v149, v198, v199
    s_waitcnt lgkmcnt(9)
    v_bitop3_b32 v224, v224, -16, v238 bitop3:0x6a
    v_mfma_f32_16x16x32_bf16 v[80:83], a[108:111], v[176:179], v[80:83]
    ds_read_b64_tr_b16 a[120:121], v219 offset:49152
    ds_read_b64_tr_b16 a[122:123], v219 offset:53248
    buffer_load_dwordx4 v223, s[92:95], s37 offen offset:1024 sc1 lds
    v_mfma_f32_16x16x32_bf16 v[84:87], a[108:111], v[180:183], v[84:87]
    ds_read_b32 v255, v254
    v_mfma_f32_16x16x32_bf16 v[84:87], a[104:107], v[164:167], v[84:87]
    s_add_u32 s27, s27, 16384
    buffer_load_dwordx4 v224, s[92:95], s38 offen offset:2048 sc1 lds
    v_mfma_f32_16x16x32_bf16 v[204:207], a[64:67], a[48:51], 0
    v_exp_f32 v200, v200
    v_mfma_f32_16x16x32_bf16 v[204:207], a[68:71], a[52:55], v[204:207]
    v_exp_f32 v201, v201
    v_mfma_f32_16x16x32_bf16 v[204:207], a[72:75], a[56:59], v[204:207]
    v_exp_f32 v202, v202
    v_mfma_f32_16x16x32_bf16 v[204:207], a[76:79], a[60:63], v[204:207]
    v_exp_f32 v203, v203
    v_mfma_f32_16x16x32_bf16 v[88:91], a[104:107], v[168:171], v[88:91]
    v_cvt_pk_bf16_f32 v152, v200, v201
    v_cvt_pk_bf16_f32 v153, v202, v203
    v_bitop3_b32 v225, v225, -16, v239 bitop3:0x6a
    v_mfma_f32_16x16x32_bf16 v[88:91], a[108:111], v[184:187], v[88:91]
    ds_read_b64_tr_b16 a[124:125], v219 offset:57344
    ds_read_b64_tr_b16 a[126:127], v219 offset:61440
    buffer_load_dwordx4 v225, s[92:95], 0 offen offset:3072 sc1 lds
    v_mfma_f32_16x16x32_bf16 v[92:95], a[108:111], v[188:191], v[92:95]
    s_waitcnt lgkmcnt(2)
    v_cmp_lt_u32 vcc, v255, v250
    v_mfma_f32_16x16x32_bf16 v[92:95], a[104:107], v[172:175], v[92:95]
    s_cbranch_vccnz L2_spx3L
L2_sprx3L:
    s_add_u32 m0, s74, 4096
    v_mfma_f32_16x16x32_bf16 v[192:195], a[80:83], a[0:3], 0
    v_exp_f32 v204, v204
    v_mfma_f32_16x16x32_bf16 v[192:195], a[84:87], a[4:7], v[192:195]
    v_exp_f32 v205, v205
    v_mfma_f32_16x16x32_bf16 v[192:195], a[88:91], a[8:11], v[192:195]
    v_exp_f32 v206, v206
    v_mfma_f32_16x16x32_bf16 v[192:195], a[92:95], a[12:15], v[192:195]
    v_exp_f32 v207, v207
    v_mfma_f32_16x16x32_bf16 v[96:99], a[112:115], v[160:163], v[96:99]
    v_cvt_pk_bf16_f32 v156, v204, v205
    v_cvt_pk_bf16_f32 v157, v206, v207
    v_bitop3_b32 v226, v226, -16, v238 bitop3:0x6a
    v_mfma_f32_16x16x32_bf16 v[96:99], a[116:119], v[176:179], v[96:99]
    ds_read_b64_tr_b16 a[96:97], v212 offset:0
    ds_read_b64_tr_b16 a[98:99], v212 offset:4096
    buffer_load_dwordx4 v226, s[92:95], s36 offen offset:0 sc1 lds
    v_mfma_f32_16x16x32_bf16 v[100:103], a[116:119], v[180:183], v[100:103]
    ds_read_b128 a[64:67], v208 offset:16384
    ds_read_b128 a[68:71], v209 offset:16384
    v_mfma_f32_16x16x32_bf16 v[100:103], a[112:115], v[164:167], v[100:103]
    v_add_u32 v250, 1, v250
    v_mfma_f32_16x16x32_bf16 v[196:199], a[80:83], a[16:19], 0
    v_exp_f32 v192, v192
    v_mfma_f32_16x16x32_bf16 v[196:199], a[84:87], a[20:23], v[196:199]
    v_exp_f32 v193, v193
    v_mfma_f32_16x16x32_bf16 v[196:199], a[88:91], a[24:27], v[196:199]
    v_exp_f32 v194, v194
    v_mfma_f32_16x16x32_bf16 v[196:199], a[92:95], a[28:31], v[196:199]
    v_exp_f32 v195, v195
    v_mfma_f32_16x16x32_bf16 v[104:107], a[112:115], v[168:171], v[104:107]
    v_cvt_pk_bf16_f32 v146, v192, v193
    v_cvt_pk_bf16_f32 v147, v194, v195
    v_bitop3_b32 v227, v227, -16, v239 bitop3:0x6a
    v_mfma_f32_16x16x32_bf16 v[104:107], a[116:119], v[184:187], v[104:107]
    ds_read_b64_tr_b16 a[100:101], v212 offset:8192
    ds_read_b64_tr_b16 a[102:103], v212 offset:12288
    buffer_load_dwordx4 v227, s[92:95], s37 offen offset:1024 sc1 lds
    v_mfma_f32_16x16x32_bf16 v[108:111], a[116:119], v[188:191], v[108:111]
    ds_read_b128 a[72:75], v210 offset:16384
    ds_read_b128 a[76:79], v211 offset:16384
    v_mfma_f32_16x16x32_bf16 v[108:111], a[112:115], v[172:175], v[108:111]
    s_waitcnt lgkmcnt(8)
    ds_write_b32 v251, v250
    v_mfma_f32_16x16x32_bf16 v[200:203], a[80:83], a[32:35], 0
    v_exp_f32 v196, v196
    v_mfma_f32_16x16x32_bf16 v[200:203], a[84:87], a[36:39], v[200:203]
    v_exp_f32 v197, v197
    v_mfma_f32_16x16x32_bf16 v[200:203], a[88:91], a[40:43], v[200:203]
    v_exp_f32 v198, v198
    v_mfma_f32_16x16x32_bf16 v[200:203], a[92:95], a[44:47], v[200:203]
    v_exp_f32 v199, v199
    v_mfma_f32_16x16x32_bf16 v[112:115], a[120:123], v[160:163], v[112:115]
    v_cvt_pk_bf16_f32 v150, v196, v197
    v_cvt_pk_bf16_f32 v151, v198, v199
    v_bitop3_b32 v228, v228, -16, v238 bitop3:0x6a
    v_bitop3_b32 v229, v229, -16, v239 bitop3:0x6a
    v_mfma_f32_16x16x32_bf16 v[112:115], a[124:127], v[176:179], v[112:115]
    ds_read_b64_tr_b16 a[104:105], v213 offset:0
    ds_read_b64_tr_b16 a[106:107], v213 offset:4096
    buffer_load_dwordx4 v228, s[92:95], s38 offen offset:2048 sc1 lds
    v_mfma_f32_16x16x32_bf16 v[116:119], a[124:127], v[180:183], v[116:119]
    s_cmp_eq_u32 s27, s89
    s_cselect_b32 s27, s88, s27
    v_mfma_f32_16x16x32_bf16 v[116:119], a[120:123], v[164:167], v[116:119]
    s_cmp_eq_u32 s27, s90
    s_cselect_b32 s27, s89, s27
    v_mfma_f32_16x16x32_bf16 v[204:207], a[80:83], a[48:51], 0
    v_exp_f32 v200, v200
    v_mfma_f32_16x16x32_bf16 v[204:207], a[84:87], a[52:55], v[204:207]
    v_exp_f32 v201, v201
    v_mfma_f32_16x16x32_bf16 v[204:207], a[88:91], a[56:59], v[204:207]
    v_exp_f32 v202, v202
    v_mfma_f32_16x16x32_bf16 v[204:207], a[92:95], a[60:63], v[204:207]
    v_exp_f32 v203, v203
    v_mfma_f32_16x16x32_bf16 v[120:123], a[120:123], v[168:171], v[120:123]
    v_cvt_pk_bf16_f32 v154, v200, v201
    v_cvt_pk_bf16_f32 v155, v202, v203
    v_mfma_f32_16x16x32_bf16 v[120:123], a[124:127], v[184:187], v[120:123]
    ds_read_b64_tr_b16 a[108:109], v213 offset:8192
    ds_read_b64_tr_b16 a[110:111], v213 offset:12288
    v_mfma_f32_16x16x32_bf16 v[124:127], a[124:127], v[188:191], v[124:127]
    buffer_load_dwordx4 v229, s[92:95], 0 offen offset:3072 sc1 lds
    v_mfma_f32_16x16x32_bf16 v[124:127], a[120:123], v[172:175], v[124:127]
    s_waitcnt lgkmcnt(5)
.p2align 6
L2_head:
    s_cmp_eq_u32 s32, 1
    s_cbranch_scc1 L2_lastp
    s_cmp_lt_u32 s78, s3
    s_cbranch_scc1 L2_gbody
L2_body0:
    v_mfma_f32_16x16x32_bf16 v[192:195], a[64:67], a[0:3], 0
    v_exp_f32 v204, v204
    v_mfma_f32_16x16x32_bf16 v[192:195], a[68:71], a[4:7], v[192:195]
    v_exp_f32 v205, v205
    v_mfma_f32_16x16x32_bf16 v[192:195], a[72:75], a[8:11], v[192:195]
    v_exp_f32 v206, v206
    v_mfma_f32_16x16x32_bf16 v[192:195], a[76:79], a[12:15], v[192:195]
    v_exp_f32 v207, v207
    v_mfma_f32_16x16x32_bf16 v[0:3], a[96:99], v[128:131], v[0:3]
    v_cvt_pk_bf16_f32 v158, v204, v205
    v_cvt_pk_bf16_f32 v159, v206, v207
    v_mfma_f32_16x16x32_bf16 v[0:3], a[100:103], v[144:147], v[0:3]
    ds_read_b64_tr_b16 a[112:113], v214 offset:0
    ds_read_b64_tr_b16 a[114:115], v214 offset:4096
    v_mfma_f32_16x16x32_bf16 v[4:7], a[100:103], v[148:151], v[4:7]
    ds_read_b128 a[80:83], v208 offset:20480
    ds_read_b128 a[84:87], v209 offset:20480
    v_mfma_f32_16x16x32_bf16 v[4:7], a[96:99], v[132:135], v[4:7]
    ds_read_b32 v255, v254
    v_mfma_f32_16x16x32_bf16 v[196:199], a[64:67], a[16:19], 0
    v_exp_f32 v192, v192
    v_mfma_f32_16x16x32_bf16 v[196:199], a[68:71], a[20:23], v[196:199]
    v_exp_f32 v193, v193
    v_mfma_f32_16x16x32_bf16 v[196:199], a[72:75], a[24:27], v[196:199]
    v_exp_f32 v194, v194
    v_mfma_f32_16x16x32_bf16 v[196:199], a[76:79], a[28:31], v[196:199]
    v_exp_f32 v195, v195
    v_mfma_f32_16x16x32_bf16 v[8:11], a[96:99], v[136:139], v[8:11]
    v_cvt_pk_bf16_f32 v160, v192, v193
    v_cvt_pk_bf16_f32 v161, v194, v195
    v_mfma_f32_16x16x32_bf16 v[8:11], a[100:103], v[152:155], v[8:11]
    ds_read_b64_tr_b16 a[116:117], v214 offset:8192
    ds_read_b64_tr_b16 a[118:119], v214 offset:12288
    v_mfma_f32_16x16x32_bf16 v[12:15], a[100:103], v[156:159], v[12:15]
    ds_read_b128 a[88:91], v210 offset:20480
    ds_read_b128 a[92:95], v211 offset:20480
    v_mfma_f32_16x16x32_bf16 v[12:15], a[96:99], v[140:143], v[12:15]
    s_waitcnt lgkmcnt(9)
    s_mov_b32 m0, s31
    v_mfma_f32_16x16x32_bf16 v[200:203], a[64:67], a[32:35], 0
    v_exp_f32 v196, v196
    v_mfma_f32_16x16x32_bf16 v[200:203], a[68:71], a[36:39], v[200:203]
    v_exp_f32 v197, v197
    v_mfma_f32_16x16x32_bf16 v[200:203], a[72:75], a[40:43], v[200:203]
    v_exp_f32 v198, v198
    v_mfma_f32_16x16x32_bf16 v[200:203], a[76:79], a[44:47], v[200:203]
    v_exp_f32 v199, v199
    v_mfma_f32_16x16x32_bf16 v[16:19], a[104:107], v[128:131], v[16:19]
    v_cvt_pk_bf16_f32 v164, v196, v197
    v_cvt_pk_bf16_f32 v165, v198, v199
    v_mfma_f32_16x16x32_bf16 v[16:19], a[108:111], v[144:147], v[16:19]
    ds_read_b64_tr_b16 a[120:121], v215 offset:0
    ds_read_b64_tr_b16 a[122:123], v215 offset:4096
    v_mfma_f32_16x16x32_bf16 v[20:23], a[108:111], v[148:151], v[20:23]
    v_mfma_f32_16x16x32_bf16 v[20:23], a[104:107], v[132:135], v[20:23]
    s_waitcnt lgkmcnt(6)
    v_cmp_lt_u32 vcc, v255, v250
    v_mfma_f32_16x16x32_bf16 v[204:207], a[64:67], a[48:51], 0
    v_exp_f32 v200, v200
    v_mfma_f32_16x16x32_bf16 v[204:207], a[68:71], a[52:55], v[204:207]
    v_exp_f32 v201, v201
    v_mfma_f32_16x16x32_bf16 v[204:207], a[72:75], a[56:59], v[204:207]
    v_exp_f32 v202, v202
    v_mfma_f32_16x16x32_bf16 v[204:207], a[76:79], a[60:63], v[204:207]
    v_exp_f32 v203, v203
    v_mfma_f32_16x16x32_bf16 v[24:27], a[104:107], v[136:139], v[24:27]
    v_cvt_pk_bf16_f32 v168, v200, v201
    v_cvt_pk_bf16_f32 v169, v202, v203
    v_mfma_f32_16x16x32_bf16 v[24:27], a[108:111], v[152:155], v[24:27]
    ds_read_b64_tr_b16 a[124:125], v215 offset:8192
    ds_read_b64_tr_b16 a[126:127], v215 offset:12288
    v_mfma_f32_16x16x32_bf16 v[28:31], a[108:111], v[156:159], v[28:31]
    s_cbranch_vccnz L2_spp0F
L2_sprp0F:
    v_mfma_f32_16x16x32_bf16 v[28:31], a[104:107], v[140:143], v[28:31]
    s_waitcnt lgkmcnt(4)
    v_mfma_f32_16x16x32_bf16 v[192:195], a[80:83], a[0:3], 0
    v_exp_f32 v204, v204
    v_mfma_f32_16x16x32_bf16 v[192:195], a[84:87], a[4:7], v[192:195]
    v_exp_f32 v205, v205
    v_mfma_f32_16x16x32_bf16 v[192:195], a[88:91], a[8:11], v[192:195]
    v_exp_f32 v206, v206
    v_mfma_f32_16x16x32_bf16 v[192:195], a[92:95], a[12:15], v[192:195]
    v_exp_f32 v207, v207
    v_mfma_f32_16x16x32_bf16 v[32:35], a[112:115], v[128:131], v[32:35]
    v_cvt_pk_bf16_f32 v172, v204, v205
    v_cvt_pk_bf16_f32 v173, v206, v207
    v_mfma_f32_16x16x32_bf16 v[32:35], a[116:119], v[144:147], v[32:35]
    ds_read_b64_tr_b16 a[96:97], v216 offset:0
    ds_read_b64_tr_b16 a[98:99], v216 offset:4096
    v_mfma_f32_16x16x32_bf16 v[36:39], a[116:119], v[148:151], v[36:39]
    ds_read_b128 a[64:67], v208 offset:24576
    ds_read_b128 a[68:71], v209 offset:24576
    v_mfma_f32_16x16x32_bf16 v[36:39], a[112:115], v[132:135], v[36:39]
    buffer_load_dwordx4 v220, s[8:11], s27 offen offset:0 sc1 lds
    v_mfma_f32_16x16x32_bf16 v[196:199], a[80:83], a[16:19], 0
    v_exp_f32 v192, v192
    v_mfma_f32_16x16x32_bf16 v[196:199], a[84:87], a[20:23], v[196:199]
    v_exp_f32 v193, v193
    v_mfma_f32_16x16x32_bf16 v[196:199], a[88:91], a[24:27], v[196:199]
    v_exp_f32 v194, v194
    v_mfma_f32_16x16x32_bf16 v[196:199], a[92:95], a[28:31], v[196:199]
    v_exp_f32 v195, v195
    v_mfma_f32_16x16x32_bf16 v[40:43], a[112:115], v[136:139], v[40:43]
    v_cvt_pk_bf16_f32 v162, v192, v193
    v_cvt_pk_bf16_f32 v163, v194, v195
    v_mfma_f32_16x16x32_bf16 v[40:43], a[116:119], v[152:155], v[40:43]
    ds_read_b64_tr_b16 a[100:101], v216 offset:8192
    ds_read_b64_tr_b16 a[102:103], v216 offset:12288
    v_mfma_f32_16x16x32_bf16 v[44:47], a[116:119], v[156:159], v[44:47]
    ds_read_b128 a[72:75], v210 offset:24576
    ds_read_b128 a[76:79], v211 offset:24576
    v_mfma_f32_16x16x32_bf16 v[44:47], a[112:115], v[140:143], v[44:47]
    s_waitcnt lgkmcnt(8)
    v_add_u32 v250, 1, v250
    v_mfma_f32_16x16x32_bf16 v[200:203], a[80:83], a[32:35], 0
    v_exp_f32 v196, v196
    v_mfma_f32_16x16x32_bf16 v[200:203], a[84:87], a[36:39], v[200:203]
    v_exp_f32 v197, v197
    v_mfma_f32_16x16x32_bf16 v[200:203], a[88:91], a[40:43], v[200:203]
    v_exp_f32 v198, v198
    v_mfma_f32_16x16x32_bf16 v[200:203], a[92:95], a[44:47], v[200:203]
    v_exp_f32 v199, v199
    v_mfma_f32_16x16x32_bf16 v[48:51], a[120:123], v[128:131], v[48:51]
    v_cvt_pk_bf16_f32 v166, v196, v197
    v_cvt_pk_bf16_f32 v167, v198, v199
    v_mfma_f32_16x16x32_bf16 v[48:51], a[124:127], v[144:147], v[48:51]
    ds_read_b64_tr_b16 a[104:105], v217 offset:0
    ds_read_b64_tr_b16 a[106:107], v217 offset:4096
    v_mfma_f32_16x16x32_bf16 v[52:55], a[124:127], v[148:151], v[52:55]
    buffer_load_dwordx4 v220, s[8:11], s27 offen offset:1024 sc1 lds
    v_mfma_f32_16x16x32_bf16 v[52:55], a[120:123], v[132:135], v[52:55]
    buffer_load_dwordx4 v220, s[8:11], s27 offen offset:2048 sc1 lds
    v_mfma_f32_16x16x32_bf16 v[204:207], a[80:83], a[48:51], 0
    v_exp_f32 v200, v200
    v_mfma_f32_16x16x32_bf16 v[204:207], a[84:87], a[52:55], v[204:207]
    v_exp_f32 v201, v201
    v_mfma_f32_16x16x32_bf16 v[204:207], a[88:91], a[56:59], v[204:207]
    v_exp_f32 v202, v202
    v_mfma_f32_16x16x32_bf16 v[204:207], a[92:95], a[60:63], v[204:207]
    v_exp_f32 v203, v203
    v_mfma_f32_16x16x32_bf16 v[56:59], a[120:123], v[136:139], v[56:59]
    v_cvt_pk_bf16_f32 v170, v200, v201
    v_cvt_pk_bf16_f32 v171, v202, v203
    v_mfma_f32_16x16x32_bf16 v[56:59], a[124:127], v[152:155], v[56:59]
    ds_read_b64_tr_b16 a[108:109], v217 offset:8192
    ds_read_b64_tr_b16 a[110:111], v217 offset:12288
    v_mfma_f32_16x16x32_bf16 v[60:63], a[124:127], v[156:159], v[60:63]
    buffer_load_dwordx4 v220, s[8:11], s27 offen offset:3072 sc1 lds
    v_mfma_f32_16x16x32_bf16 v[60:63], a[120:123], v[140:143], v[60:63]
    s_waitcnt lgkmcnt(4)
    s_waitcnt vmcnt(4)
    v_mfma_f32_16x16x32_bf16 v[192:195], a[64:67], a[0:3], 0
    v_exp_f32 v204, v204
    v_mfma_f32_16x16x32_bf16 v[192:195], a[68:71], a[4:7], v[192:195]
    v_exp_f32 v205, v205
    v_mfma_f32_16x16x32_bf16 v[192:195], a[72:75], a[8:11], v[192:195]
    v_exp_f32 v206, v206
    v_mfma_f32_16x16x32_bf16 v[192:195], a[76:79], a[12:15], v[192:195]
    v_exp_f32 v207, v207
    v_mfma_f32_16x16x32_bf16 v[64:67], a[96:99], v[128:131], v[64:67]
    v_cvt_pk_bf16_f32 v174, v204, v205
    v_cvt_pk_bf16_f32 v175, v206, v207
    v_mfma_f32_16x16x32_bf16 v[64:67], a[100:103], v[144:147], v[64:67]
    ds_read_b64_tr_b16 a[112:113], v218 offset:0
    ds_read_b64_tr_b16 a[114:115], v218 offset:4096
    v_mfma_f32_16x16x32_bf16 v[68:71], a[100:103], v[148:151], v[68:71]
    ds_read_b128 a[80:83], v208 offset:28672
    ds_read_b128 a[84:87], v209 offset:28672
    v_mfma_f32_16x16x32_bf16 v[68:71], a[96:99], v[132:135], v[68:71]
    ds_write_b32 v251, v250
    v_mfma_f32_16x16x32_bf16 v[196:199], a[64:67], a[16:19], 0
    v_exp_f32 v192, v192
    v_mfma_f32_16x16x32_bf16 v[196:199], a[68:71], a[20:23], v[196:199]
    v_exp_f32 v193, v193
    v_mfma_f32_16x16x32_bf16 v[196:199], a[72:75], a[24:27], v[196:199]
    v_exp_f32 v194, v194
    v_mfma_f32_16x16x32_bf16 v[196:199], a[76:79], a[28:31], v[196:199]
    v_exp_f32 v195, v195
    v_mfma_f32_16x16x32_bf16 v[72:75], a[96:99], v[136:139], v[72:75]
    v_cvt_pk_bf16_f32 v176, v192, v193
    v_cvt_pk_bf16_f32 v177, v194, v195
    v_mfma_f32_16x16x32_bf16 v[72:75], a[100:103], v[152:155], v[72:75]
    ds_read_b64_tr_b16 a[116:117], v218 offset:8192
    ds_read_b64_tr_b16 a[118:119], v218 offset:12288
    v_mfma_f32_16x16x32_bf16 v[76:79], a[100:103], v[156:159], v[76:79]
    ds_read_b128 a[88:91], v210 offset:28672
    ds_read_b128 a[92:95], v211 offset:28672
    v_mfma_f32_16x16x32_bf16 v[76:79], a[96:99], v[140:143], v[76:79]
    s_waitcnt lgkmcnt(9)
    v_mfma_f32_16x16x32_bf16 v[200:203], a[64:67], a[32:35], 0
    v_exp_f32 v196, v196
    v_mfma_f32_16x16x32_bf16 v[200:203], a[68:71], a[36:39], v[200:203]
    v_exp_f32 v197, v197
    v_mfma_f32_16x16x32_bf16 v[200:203], a[72:75], a[40:43], v[200:203]
    v_exp_f32 v198, v198
    v_mfma_f32_16x16x32_bf16 v[200:203], a[76:79], a[44:47], v[200:203]
    v_exp_f32 v199, v199
    v_mfma_f32_16x16x32_bf16 v[80:83], a[104:107], v[128:131], v[80:83]
    v_cvt_pk_bf16_f32 v180, v196, v197
    v_cvt_pk_bf16_f32 v181, v198, v199
    v_mfma_f32_16x16x32_bf16 v[80:83], a[108:111], v[144:147], v[80:83]
    ds_read_b64_tr_b16 a[120:121], v219 offset:0
    ds_read_b64_tr_b16 a[122:123], v219 offset:4096
    v_mfma_f32_16x16x32_bf16 v[84:87], a[108:111], v[148:151], v[84:87]
    ds_read_b32 v255, v254
    v_mfma_f32_16x16x32_bf16 v[84:87], a[104:107], v[132:135], v[84:87]
    s_add_u32 s27, s27, 16384
    v_mfma_f32_16x16x32_bf16 v[204:207], a[64:67], a[48:51], 0
    v_exp_f32 v200, v200
    v_mfma_f32_16x16x32_bf16 v[204:207], a[68:71], a[52:55], v[204:207]
    v_exp_f32 v201, v201
    v_mfma_f32_16x16x32_bf16 v[204:207], a[72:75], a[56:59], v[204:207]
    v_exp_f32 v202, v202
    v_mfma_f32_16x16x32_bf16 v[204:207], a[76:79], a[60:63], v[204:207]
    v_exp_f32 v203, v203
    v_mfma_f32_16x16x32_bf16 v[88:91], a[104:107], v[136:139], v[88:91]
    v_cvt_pk_bf16_f32 v184, v200, v201
    v_cvt_pk_bf16_f32 v185, v202, v203
    v_mfma_f32_16x16x32_bf16 v[88:91], a[108:111], v[152:155], v[88:91]
    ds_read_b64_tr_b16 a[124:125], v219 offset:8192
    ds_read_b64_tr_b16 a[126:127], v219 offset:12288
    v_mfma_f32_16x16x32_bf16 v[92:95], a[108:111], v[156:159], v[92:95]
    s_waitcnt lgkmcnt(2)
    v_cmp_lt_u32 vcc, v255, v250
    v_mfma_f32_16x16x32_bf16 v[92:95], a[104:107], v[140:143], v[92:95]
    s_cbranch_vccnz L2_spp0L
L2_sprp0L:
    v_mfma_f32_16x16x32_bf16 v[192:195], a[80:83], a[0:3], 0
    v_exp_f32 v204, v204
    v_mfma_f32_16x16x32_bf16 v[192:195], a[84:87], a[4:7], v[192:195]
    v_exp_f32 v205, v205
    v_mfma_f32_16x16x32_bf16 v[192:195], a[88:91], a[8:11], v[192:195]
    v_exp_f32 v206, v206
    v_mfma_f32_16x16x32_bf16 v[192:195], a[92:95], a[12:15], v[192:195]
    v_exp_f32 v207, v207
    v_mfma_f32_16x16x32_bf16 v[96:99], a[112:115], v[128:131], v[96:99]
    v_cvt_pk_bf16_f32 v188, v204, v205
    v_cvt_pk_bf16_f32 v189, v206, v207
    v_mfma_f32_16x16x32_bf16 v[96:99], a[116:119], v[144:147], v[96:99]
    ds_read_b64_tr_b16 a[96:97], v212 offset:16384
    ds_read_b64_tr_b16 a[98:99], v212 offset:20480
    v_mfma_f32_16x16x32_bf16 v[100:103], a[116:119], v[148:151], v[100:103]
    ds_read_b128 a[64:67], v208 offset:32768
    ds_read_b128 a[68:71], v209 offset:32768
    v_mfma_f32_16x16x32_bf16 v[100:103], a[112:115], v[132:135], v[100:103]
    v_add_u32 v250, 1, v250
    v_mfma_f32_16x16x32_bf16 v[196:199], a[80:83], a[16:19], 0
    v_exp_f32 v192, v192
    v_mfma_f32_16x16x32_bf16 v[196:199], a[84:87], a[20:23], v[196:199]
    v_exp_f32 v193, v193
    v_mfma_f32_16x16x32_bf16 v[196:199], a[88:91], a[24:27], v[196:199]
    v_exp_f32 v194, v194
    v_mfma_f32_16x16x32_bf16 v[196:199], a[92:95], a[28:31], v[196:199]
    v_exp_f32 v195, v195
    v_mfma_f32_16x16x32_bf16 v[104:107], a[112:115], v[136:139], v[104:107]
    v_cvt_pk_bf16_f32 v178, v192, v193
    v_cvt_pk_bf16_f32 v179, v194, v195
    v_mfma_f32_16x16x32_bf16 v[104:107], a[116:119], v[152:155], v[104:107]
    ds_read_b64_tr_b16 a[100:101], v212 offset:24576
    ds_read_b64_tr_b16 a[102:103], v212 offset:28672
    v_mfma_f32_16x16x32_bf16 v[108:111], a[116:119], v[156:159], v[108:111]
    ds_read_b128 a[72:75], v210 offset:32768
    ds_read_b128 a[76:79], v211 offset:32768
    v_mfma_f32_16x16x32_bf16 v[108:111], a[112:115], v[140:143], v[108:111]
    s_waitcnt lgkmcnt(8)
    ds_write_b32 v251, v250
    v_mfma_f32_16x16x32_bf16 v[200:203], a[80:83], a[32:35], 0
    v_exp_f32 v196, v196
    v_mfma_f32_16x16x32_bf16 v[200:203], a[84:87], a[36:39], v[200:203]
    v_exp_f32 v197, v197
    v_mfma_f32_16x16x32_bf16 v[200:203], a[88:91], a[40:43], v[200:203]
    v_exp_f32 v198, v198
    v_mfma_f32_16x16x32_bf16 v[200:203], a[92:95], a[44:47], v[200:203]
    v_exp_f32 v199, v199
    v_mfma_f32_16x16x32_bf16 v[112:115], a[120:123], v[128:131], v[112:115]
    v_cvt_pk_bf16_f32 v182, v196, v197
    v_cvt_pk_bf16_f32 v183, v198, v199
    v_mfma_f32_16x16x32_bf16 v[112:115], a[124:127], v[144:147], v[112:115]
    ds_read_b64_tr_b16 a[104:105], v213 offset:16384
    ds_read_b64_tr_b16 a[106:107], v213 offset:20480
    v_mfma_f32_16x16x32_bf16 v[116:119], a[124:127], v[148:151], v[116:119]
    s_cmp_eq_u32 s27, s89
    s_cselect_b32 s27, s88, s27
    v_mfma_f32_16x16x32_bf16 v[116:119], a[120:123], v[132:135], v[116:119]
    s_cmp_eq_u32 s27, s90
    s_cselect_b32 s27, s89, s27
    v_mfma_f32_16x16x32_bf16 v[204:207], a[80:83], a[48:51], 0
    v_exp_f32 v200, v200
    v_mfma_f32_16x16x32_bf16 v[204:207], a[84:87], a[52:55], v[204:207]
    v_exp_f32 v201, v201
    v_mfma_f32_16x16x32_bf16 v[204:207], a[88:91], a[56:59], v[204:207]
    v_exp_f32 v202, v202
    v_mfma_f32_16x16x32_bf16 v[204:207], a[92:95], a[60:63], v[204:207]
    v_exp_f32 v203, v203
    v_mfma_f32_16x16x32_bf16 v[120:123], a[120:123], v[136:139], v[120:123]
    v_cvt_pk_bf16_f32 v186, v200, v201
    v_cvt_pk_bf16_f32 v187, v202, v203
    v_mfma_f32_16x16x32_bf16 v[120:123], a[124:127], v[152:155], v[120:123]
    ds_read_b64_tr_b16 a[108:109], v213 offset:24576
    ds_read_b64_tr_b16 a[110:111], v213 offset:28672
    v_mfma_f32_16x16x32_bf16 v[124:127], a[124:127], v[156:159], v[124:127]
    s_cmp_eq_u32 s32, 7
    v_mfma_f32_16x16x32_bf16 v[124:127], a[120:123], v[140:143], v[124:127]
    s_waitcnt lgkmcnt(5)
    s_cbranch_scc1 L2_hk0
L2_body1:
    v_mfma_f32_16x16x32_bf16 v[192:195], a[64:67], a[0:3], 0
    v_exp_f32 v204, v204
    v_mfma_f32_16x16x32_bf16 v[192:195], a[68:71], a[4:7], v[192:195]
    v_exp_f32 v205, v205
    v_mfma_f32_16x16x32_bf16 v[192:195], a[72:75], a[8:11], v[192:195]
    v_exp_f32 v206, v206
    v_mfma_f32_16x16x32_bf16 v[192:195], a[76:79], a[12:15], v[192:195]
    v_exp_f32 v207, v207
    v_mfma_f32_16x16x32_bf16 v[0:3], a[96:99], v[160:163], v[0:3]
    v_cvt_pk_bf16_f32 v190, v204, v205
    v_cvt_pk_bf16_f32 v191, v206, v207
    v_mfma_f32_16x16x32_bf16 v[0:3], a[100:103], v[176:179], v[0:3]
    ds_read_b64_tr_b16 a[112:113], v214 offset:16384
    ds_read_b64_tr_b16 a[114:115], v214 offset:20480
    v_mfma_f32_16x16x32_bf16 v[4:7], a[100:103], v[180:183], v[4:7]
    ds_read_b128 a[80:83], v208 offset:36864
    ds_read_b128 a[84:87], v209 offset:36864
    v_mfma_f32_16x16x32_bf16 v[4:7], a[96:99], v[164:167], v[4:7]
    ds_read_b32 v255, v254
    v_mfma_f32_16x16x32_bf16 v[196:199], a[64:67], a[16:19], 0
    v_exp_f32 v192, v192
    v_mfma_f32_16x16x32_bf16 v[196:199], a[68:71], a[20:23], v[196:199]
    v_exp_f32 v193, v193
    v_mfma_f32_16x16x32_bf16 v[196:199], a[72:75], a[24:27], v[196:199]
    v_exp_f32 v194, v194
    v_mfma_f32_16x16x32_bf16 v[196:199], a[76:79], a[28:31], v[196:199]
    v_exp_f32 v195, v195
    v_mfma_f32_16x16x32_bf16 v[8:11], a[96:99], v[168:171], v[8:11]
    v_cvt_pk_bf16_f32 v128, v192, v193
    v_cvt_pk_bf16_f32 v129, v194, v195
    v_mfma_f32_16x16x32_bf16 v[8:11], a[100:103], v[184:187], v[8:11]
    ds_read_b64_tr_b16 a[116:117], v214 offset:24576
    ds_read_b64_tr_b16 a[118:119], v214 offset:28672
    v_mfma_f32_16x16x32_bf16 v[12:15], a[100:103], v[188:191], v[12:15]
    ds_read_b128 a[88:91], v210 offset:36864
    ds_read_b128 a[92:95], v211 offset:36864
    v_mfma_f32_16x16x32_bf16 v[12:15], a[96:99], v[172:175], v[12:15]
    s_waitcnt lgkmcnt(9)
    s_mov_b32 m0, s28
    v_mfma_f32_16x16x32_bf16 v[200:203], a[64:67], a[32:35], 0
    v_exp_f32 v196, v196
    v_mfma_f32_16x16x32_bf16 v[200:203], a[68:71], a[36:39], v[200:203]
    v_exp_f32 v197, v197
    v_mfma_f32_16x16x32_bf16 v[200:203], a[72:75], a[40:43], v[200:203]
    v_exp_f32 v198, v198
    v_mfma_f32_16x16x32_bf16 v[200:203], a[76:79], a[44:47], v[200:203]
    v_exp_f32 v199, v199
    v_mfma_f32_16x16x32_bf16 v[16:19], a[104:107], v[160:163], v[16:19]
    v_cvt_pk_bf16_f32 v132, v196, v197
    v_cvt_pk_bf16_f32 v133, v198, v199
    v_mfma_f32_16x16x32_bf16 v[16:19], a[108:111], v[176:179], v[16:19]
    ds_read_b64_tr_b16 a[120:121], v215 offset:16384
    ds_read_b64_tr_b16 a[122:123], v215 offset:20480
    v_mfma_f32_16x16x32_bf16 v[20:23], a[108:111], v[180:183], v[20:23]
    v_mfma_f32_16x16x32_bf16 v[20:23], a[104:107], v[164:167], v[20:23]
    s_waitcnt lgkmcnt(6)
    v_cmp_lt_u32 vcc, v255, v250
    v_mfma_f32_16x16x32_bf16 v[204:207], a[64:67], a[48:51], 0
    v_exp_f32 v200, v200
    v_mfma_f32_16x16x32_bf16 v[204:207], a[68:71], a[52:55], v[204:207]
    v_exp_f32 v201, v201
    v_mfma_f32_16x16x32_bf16 v[204:207], a[72:75], a[56:59], v[204:207]
    v_exp_f32 v202, v202
    v_mfma_f32_16x16x32_bf16 v[204:207], a[76:79], a[60:63], v[204:207]
    v_exp_f32 v203, v203
    v_mfma_f32_16x16x32_bf16 v[24:27], a[104:107], v[168:171], v[24:27]
    v_cvt_pk_bf16_f32 v136, v200, v201
    v_cvt_pk_bf16_f32 v137, v202, v203
    v_mfma_f32_16x16x32_bf16 v[24:27], a[108:111], v[184:187], v[24:27]
    ds_read_b64_tr_b16 a[124:125], v215 offset:24576
    ds_read_b64_tr_b16 a[126:127], v215 offset:28672
    v_mfma_f32_16x16x32_bf16 v[28:31], a[108:111], v[188:191], v[28:31]
    s_cbranch_vccnz L2_spp1F
L2_sprp1F:
    v_mfma_f32_16x16x32_bf16 v[28:31], a[104:107], v[172:175], v[28:31]
    s_waitcnt lgkmcnt(4)
    v_mfma_f32_16x16x32_bf16 v[192:195], a[80:83], a[0:3], 0
    v_exp_f32 v204, v204
    v_mfma_f32_16x16x32_bf16 v[192:195], a[84:87], a[4:7], v[192:195]
    v_exp_f32 v205, v205
    v_mfma_f32_16x16x32_bf16 v[192:195], a[88:91], a[8:11], v[192:195]
    v_exp_f32 v206, v206
    v_mfma_f32_16x16x32_bf16 v[192:195], a[92:95], a[12:15], v[192:195]
    v_exp_f32 v207, v207
    v_mfma_f32_16x16x32_bf16 v[32:35], a[112:115], v[160:163], v[32:35]
    v_cvt_pk_bf16_f32 v140, v204, v205
    v_cvt_pk_bf16_f32 v141, v206, v207
    v_mfma_f32_16x16x32_bf16 v[32:35], a[116:119], v[176:179], v[32:35]
    ds_read_b64_tr_b16 a[96:97], v216 offset:16384
    ds_read_b64_tr_b16 a[98:99], v216 offset:20480
    v_mfma_f32_16x16x32_bf16 v[36:39], a[116:119], v[180:183], v[36:39]
    ds_read_b128 a[64:67], v208 offset:40960
    ds_read_b128 a[68:71], v209 offset:40960
    v_mfma_f32_16x16x32_bf16 v[36:39], a[112:115], v[164:167], v[36:39]
    buffer_load_dwordx4 v220, s[8:11], s27 offen offset:0 sc1 lds
    v_mfma_f32_16x16x32_bf16 v[196:199], a[80:83], a[16:19], 0
    v_exp_f32 v192, v192
    v_mfma_f32_16x16x32_bf16 v[196:199], a[84:87], a[20:23], v[196:199]
    v_exp_f32 v193, v193
    v_mfma_f32_16x16x32_bf16 v[196:199], a[88:91], a[24:27], v[196:199]
    v_exp_f32 v194, v194
    v_mfma_f32_16x16x32_bf16 v[196:199], a[92:95], a[28:31], v[196:199]
    v_exp_f32 v195, v195
    v_mfma_f32_16x16x32_bf16 v[40:43], a[112:115], v[168:171], v[40:43]
    v_cvt_pk_bf16_f32 v130, v192, v193
    v_cvt_pk_bf16_f32 v131, v194, v195
    v_mfma_f32_16x16x32_bf16 v[40:43], a[116:119], v[184:187], v[40:43]
    ds_read_b64_tr_b16 a[100:101], v216 offset:24576
    ds_read_b64_tr_b16 a[102:103], v216 offset:28672
    v_mfma_f32_16x16x32_bf16 v[44:47], a[116:119], v[188:191], v[44:47]
    ds_read_b128 a[72:75], v210 offset:40960
    ds_read_b128 a[76:79], v211 offset:40960
    v_mfma_f32_16x16x32_bf16 v[44:47], a[112:115], v[172:175], v[44:47]
    s_waitcnt lgkmcnt(8)
    v_add_u32 v250, 1, v250
    v_mfma_f32_16x16x32_bf16 v[200:203], a[80:83], a[32:35], 0
    v_exp_f32 v196, v196
    v_mfma_f32_16x16x32_bf16 v[200:203], a[84:87], a[36:39], v[200:203]
    v_exp_f32 v197, v197
    v_mfma_f32_16x16x32_bf16 v[200:203], a[88:91], a[40:43], v[200:203]
    v_exp_f32 v198, v198
    v_mfma_f32_16x16x32_bf16 v[200:203], a[92:95], a[44:47], v[200:203]
    v_exp_f32 v199, v199
    v_mfma_f32_16x16x32_bf16 v[48:51], a[120:123], v[160:163], v[48:51]
    v_cvt_pk_bf16_f32 v134, v196, v197
    v_cvt_pk_bf16_f32 v135, v198, v199
    v_mfma_f32_16x16x32_bf16 v[48:51], a[124:127], v[176:179], v[48:51]
    ds_read_b64_tr_b16 a[104:105], v217 offset:16384
    ds_read_b64_tr_b16 a[106:107], v217 offset:20480
    v_mfma_f32_16x16x32_bf16 v[52:55], a[124:127], v[180:183], v[52:55]
    buffer_load_dwordx4 v220, s[8:11], s27 offen offset:1024 sc1 lds
    v_mfma_f32_16x16x32_bf16 v[52:55], a[120:123], v[164:167], v[52:55]
    buffer_load_dwordx4 v220, s[8:11], s27 offen offset:2048 sc1 lds
    v_mfma_f32_16x16x32_bf16 v[204:207], a[80:83], a[48:51], 0
    v_exp_f32 v200, v200
    v_mfma_f32_16x16x32_bf16 v[204:207], a[84:87], a[52:55], v[204:207]
    v_exp_f32 v201, v201
    v_mfma_f32_16x16x32_bf16 v[204:207], a[88:91], a[56:59], v[204:207]
    v_exp_f32 v202, v202
    v_mfma_f32_16x16x32_bf16 v[204:207], a[92:95], a[60:63], v[204:207]
    v_exp_f32 v203, v203
    v_mfma_f32_16x16x32_bf16 v[56:59], a[120:123], v[168:171], v[56:59]
    v_cvt_pk_bf16_f32 v138, v200, v201
    v_cvt_pk_bf16_f32 v139, v202, v203
    v_mfma_f32_16x16x32_bf16 v[56:59], a[124:127], v[184:187], v[56:59]
    ds_read_b64_tr_b16 a[108:109], v217 offset:24576
    ds_read_b64_tr_b16 a[110:111], v217 offset:28672
    v_mfma_f32_16x16x32_bf16 v[60:63], a[124:127], v[188:191], v[60:63]
    buffer_load_dwordx4 v220, s[8:11], s27 offen offset:3072 sc1 lds
    v_mfma_f32_16x16x32_bf16 v[60:63], a[120:123], v[172:175], v[60:63]
    s_waitcnt lgkmcnt(4)
    s_waitcnt vmcnt(4)
    v_mfma_f32_16x16x32_bf16 v[192:195], a[64:67], a[0:3], 0
    v_exp_f32 v204, v204
    v_mfma_f32_16x16x32_bf16 v[192:195], a[68:71], a[4:7], v[192:195]
    v_exp_f32 v205, v205
    v_mfma_f32_16x16x32_bf16 v[192:195], a[72:75], a[8:11], v[192:195]
    v_exp_f32 v206, v206
    v_mfma_f32_16x16x32_bf16 v[192:195], a[76:79], a[12:15], v[192:195]
    v_exp_f32 v207, v207
    v_mfma_f32_16x16x32_bf16 v[64:67], a[96:99], v[160:163], v[64:67]
    v_cvt_pk_bf16_f32 v142, v204, v205
    v_cvt_pk_bf16_f32 v143, v206, v207
    v_mfma_f32_16x16x32_bf16 v[64:67], a[100:103], v[176:179], v[64:67]
    ds_read_b64_tr_b16 a[112:113], v218 offset:16384
    ds_read_b64_tr_b16 a[114:115], v218 offset:20480
    v_mfma_f32_16x16x32_bf16 v[68:71], a[100:103], v[180:183], v[68:71]
    ds_read_b128 a[80:83], v208 offset:45056
    ds_read_b128 a[84:87], v209 offset:45056
    v_mfma_f32_16x16x32_bf16 v[68:71], a[96:99], v[164:167], v[68:71]
    ds_write_b32 v251, v250
    v_mfma_f32_16x16x32_bf16 v[196:199], a[64:67], a[16:19], 0
    v_exp_f32 v192, v192
    v_mfma_f32_16x16x32_bf16 v[196:199], a[68:71], a[20:23], v[196:199]
    v_exp_f32 v193, v193
    v_mfma_f32_16x16x32_bf16 v[196:199], a[72:75], a[24:27], v[196:199]
    v_exp_f32 v194, v194
    v_mfma_f32_16x16x32_bf16 v[196:199], a[76:79], a[28:31], v[196:199]
    v_exp_f32 v195, v195
    v_mfma_f32_16x16x32_bf16 v[72:75], a[96:99], v[168:171], v[72:75]
    v_cvt_pk_bf16_f32 v144, v192, v193
    v_cvt_pk_bf16_f32 v145, v194, v195
    v_mfma_f32_16x16x32_bf16 v[72:75], a[100:103], v[184:187], v[72:75]
    ds_read_b64_tr_b16 a[116:117], v218 offset:24576
    ds_read_b64_tr_b16 a[118:119], v218 offset:28672
    v_mfma_f32_16x16x32_bf16 v[76:79], a[100:103], v[188:191], v[76:79]
    ds_read_b128 a[88:91], v210 offset:45056
    ds_read_b128 a[92:95], v211 offset:45056
    v_mfma_f32_16x16x32_bf16 v[76:79], a[96:99], v[172:175], v[76:79]
    s_waitcnt lgkmcnt(9)
    v_mfma_f32_16x16x32_bf16 v[200:203], a[64:67], a[32:35], 0
    v_exp_f32 v196, v196
    v_mfma_f32_16x16x32_bf16 v[200:203], a[68:71], a[36:39], v[200:203]
    v_exp_f32 v197, v197
    v_mfma_f32_16x16x32_bf16 v[200:203], a[72:75], a[40:43], v[200:203]
    v_exp_f32 v198, v198
    v_mfma_f32_16x16x32_bf16 v[200:203], a[76:79], a[44:47], v[200:203]
    v_exp_f32 v199, v199
    v_mfma_f32_16x16x32_bf16 v[80:83], a[104:107], v[160:163], v[80:83]
    v_cvt_pk_bf16_f32 v148, v196, v197
    v_cvt_pk_bf16_f32 v149, v198, v199
    v_mfma_f32_16x16x32_bf16 v[80:83], a[108:111], v[176:179], v[80:83]
    ds_read_b64_tr_b16 a[120:121], v219 offset:16384
    ds_read_b64_tr_b16 a[122:123], v219 offset:20480
    v_mfma_f32_16x16x32_bf16 v[84:87], a[108:111], v[180:183], v[84:87]
    ds_read_b32 v255, v254
    v_mfma_f32_16x16x32_bf16 v[84:87], a[104:107], v[164:167], v[84:87]
    s_add_u32 s27, s27, 16384
    v_mfma_f32_16x16x32_bf16 v[204:207], a[64:67], a[48:51], 0
    v_exp_f32 v200, v200
    v_mfma_f32_16x16x32_bf16 v[204:207], a[68:71], a[52:55], v[204:207]
    v_exp_f32 v201, v201
    v_mfma_f32_16x16x32_bf16 v[204:207], a[72:75], a[56:59], v[204:207]
    v_exp_f32 v202, v202
    v_mfma_f32_16x16x32_bf16 v[204:207], a[76:79], a[60:63], v[204:207]
    v_exp_f32 v203, v203
    v_mfma_f32_16x16x32_bf16 v[88:91], a[104:107], v[168:171], v[88:91]
    v_cvt_pk_bf16_f32 v152, v200, v201
    v_cvt_pk_bf16_f32 v153, v202, v203
    v_mfma_f32_16x16x32_bf16 v[88:91], a[108:111], v[184:187], v[88:91]
    ds_read_b64_tr_b16 a[124:125], v219 offset:24576
    ds_read_b64_tr_b16 a[126:127], v219 offset:28672
    v_mfma_f32_16x16x32_bf16 v[92:95], a[108:111], v[188:191], v[92:95]
    s_waitcnt lgkmcnt(2)
    v_cmp_lt_u32 vcc, v255, v250
    v_mfma_f32_16x16x32_bf16 v[92:95], a[104:107], v[172:175], v[92:95]
    s_cbranch_vccnz L2_spp1L
L2_sprp1L:
    v_mfma_f32_16x16x32_bf16 v[192:195], a[80:83], a[0:3], 0
    v_exp_f32 v204, v204
    v_mfma_f32_16x16x32_bf16 v[192:195], a[84:87], a[4:7], v[192:195]
    v_exp_f32 v205, v205
    v_mfma_f32_16x16x32_bf16 v[192:195], a[88:91], a[8:11], v[192:195]
    v_exp_f32 v206, v206
    v_mfma_f32_16x16x32_bf16 v[192:195], a[92:95], a[12:15], v[192:195]
    v_exp_f32 v207, v207
    v_mfma_f32_16x16x32_bf16 v[96:99], a[112:115], v[160:163], v[96:99]
    v_cvt_pk_bf16_f32 v156, v204, v205
    v_cvt_pk_bf16_f32 v157, v206, v207
    v_mfma_f32_16x16x32_bf16 v[96:99], a[116:119], v[176:179], v[96:99]
    ds_read_b64_tr_b16 a[96:97], v212 offset:32768
    ds_read_b64_tr_b16 a[98:99], v212 offset:36864
    v_mfma_f32_16x16x32_bf16 v[100:103], a[116:119], v[180:183], v[100:103]
    ds_read_b128 a[64:67], v208 offset:49152
    ds_read_b128 a[68:71], v209 offset:49152
    v_mfma_f32_16x16x32_bf16 v[100:103], a[112:115], v[164:167], v[100:103]
    v_add_u32 v250, 1, v250
    v_mfma_f32_16x16x32_bf16 v[196:199], a[80:83], a[16:19], 0
    v_exp_f32 v192, v192
    v_mfma_f32_16x16x32_bf16 v[196:199], a[84:87], a[20:23], v[196:199]
    v_exp_f32 v193, v193
    v_mfma_f32_16x16x32_bf16 v[196:199], a[88:91], a[24:27], v[196:199]
    v_exp_f32 v194, v194
    v_mfma_f32_16x16x32_bf16 v[196:199], a[92:95], a[28:31], v[196:199]
    v_exp_f32 v195, v195
    v_mfma_f32_16x16x32_bf16 v[104:107], a[112:115], v[168:171], v[104:107]
    v_cvt_pk_bf16_f32 v146, v192, v193
    v_cvt_pk_bf16_f32 v147, v194, v195
    v_mfma_f32_16x16x32_bf16 v[104:107], a[116:119], v[184:187], v[104:107]
    ds_read_b64_tr_b16 a[100:101], v212 offset:40960
    ds_read_b64_tr_b16 a[102:103], v212 offset:45056
    v_mfma_f32_16x16x32_bf16 v[108:111], a[116:119], v[188:191], v[108:111]
    ds_read_b128 a[72:75], v210 offset:49152
    ds_read_b128 a[76:79], v211 offset:49152
    v_mfma_f32_16x16x32_bf16 v[108:111], a[112:115], v[172:175], v[108:111]
    s_waitcnt lgkmcnt(8)
    ds_write_b32 v251, v250
    v_mfma_f32_16x16x32_bf16 v[200:203], a[80:83], a[32:35], 0
    v_exp_f32 v196, v196
    v_mfma_f32_16x16x32_bf16 v[200:203], a[84:87], a[36:39], v[200:203]
    v_exp_f32 v197, v197
    v_mfma_f32_16x16x32_bf16 v[200:203], a[88:91], a[40:43], v[200:203]
    v_exp_f32 v198, v198
    v_mfma_f32_16x16x32_bf16 v[200:203], a[92:95], a[44:47], v[200:203]
    v_exp_f32 v199, v199
    v_mfma_f32_16x16x32_bf16 v[112:115], a[120:123], v[160:163], v[112:115]
    v_cvt_pk_bf16_f32 v150, v196, v197
    v_cvt_pk_bf16_f32 v151, v198, v199
    v_mfma_f32_16x16x32_bf16 v[112:115], a[124:127], v[176:179], v[112:115]
    ds_read_b64_tr_b16 a[104:105], v213 offset:32768
    ds_read_b64_tr_b16 a[106:107], v213 offset:36864
    v_mfma_f32_16x16x32_bf16 v[116:119], a[124:127], v[180:183], v[116:119]
    s_cmp_eq_u32 s27, s89
    s_cselect_b32 s27, s88, s27
    v_mfma_f32_16x16x32_bf16 v[116:119], a[120:123], v[164:167], v[116:119]
    s_cmp_eq_u32 s27, s90
    s_cselect_b32 s27, s89, s27
    v_mfma_f32_16x16x32_bf16 v[204:207], a[80:83], a[48:51], 0
    v_exp_f32 v200, v200
    v_mfma_f32_16x16x32_bf16 v[204:207], a[84:87], a[52:55], v[204:207]
    v_exp_f32 v201, v201
    v_mfma_f32_16x16x32_bf16 v[204:207], a[88:91], a[56:59], v[204:207]
    v_exp_f32 v202, v202
    v_mfma_f32_16x16x32_bf16 v[204:207], a[92:95], a[60:63], v[204:207]
    v_exp_f32 v203, v203
    v_mfma_f32_16x16x32_bf16 v[120:123], a[120:123], v[168:171], v[120:123]
    v_cvt_pk_bf16_f32 v154, v200, v201
    v_cvt_pk_bf16_f32 v155, v202, v203
    v_mfma_f32_16x16x32_bf16 v[120:123], a[124:127], v[184:187], v[120:123]
    ds_read_b64_tr_b16 a[108:109], v213 offset:40960
    ds_read_b64_tr_b16 a[110:111], v213 offset:45056
    v_mfma_f32_16x16x32_bf16 v[124:127], a[124:127], v[188:191], v[124:127]
    s_cmp_eq_u32 s32, 7
    v_mfma_f32_16x16x32_bf16 v[124:127], a[120:123], v[172:175], v[124:127]
    s_waitcnt lgkmcnt(5)
    s_cbranch_scc1 L2_hk1
    s_cmp_eq_u32 s32, s83
    s_cbranch_scc1 L2_post2
L2_body2:
    v_mfma_f32_16x16x32_bf16 v[192:195], a[64:67], a[0:3], 0
    v_exp_f32 v204, v204
    v_mfma_f32_16x16x32_bf16 v[192:195], a[68:71], a[4:7], v[192:195]
    v_exp_f32 v205, v205
    v_mfma_f32_16x16x32_bf16 v[192:195], a[72:75], a[8:11], v[192:195]
    v_exp_f32 v206, v206
    v_mfma_f32_16x16x32_bf16 v[192:195], a[76:79], a[12:15], v[192:195]
    v_exp_f32 v207, v207
    v_mfma_f32_16x16x32_bf16 v[0:3], a[96:99], v[128:131], v[0:3]
    v_cvt_pk_bf16_f32 v158, v204, v205
    v_cvt_pk_bf16_f32 v159, v206, v207
    v_mfma_f32_16x16x32_bf16 v[0:3], a[100:103], v[144:147], v[0:3]
    ds_read_b64_tr_b16 a[112:113], v214 offset:32768
    ds_read_b64_tr_b16 a[114:115], v214 offset:36864
    v_mfma_f32_16x16x32_bf16 v[4:7], a[100:103], v[148:151], v[4:7]
    ds_read_b128 a[80:83], v208 offset:53248
    ds_read_b128 a[84:87], v209 offset:53248
    v_mfma_f32_16x16x32_bf16 v[4:7], a[96:99], v[132:135], v[4:7]
    ds_read_b32 v255, v254
    v_mfma_f32_16x16x32_bf16 v[196:199], a[64:67], a[16:19], 0
    v_exp_f32 v192, v192
    v_mfma_f32_16x16x32_bf16 v[196:199], a[68:71], a[20:23], v[196:199]
    v_exp_f32 v193, v193
    v_mfma_f32_16x16x32_bf16 v[196:199], a[72:75], a[24:27], v[196:199]
    v_exp_f32 v194, v194
    v_mfma_f32_16x16x32_bf16 v[196:199], a[76:79], a[28:31], v[196:199]
    v_exp_f32 v195, v195
    v_mfma_f32_16x16x32_bf16 v[8:11], a[96:99], v[136:139], v[8:11]
    v_cvt_pk_bf16_f32 v160, v192, v193
    v_cvt_pk_bf16_f32 v161, v194, v195
    v_mfma_f32_16x16x32_bf16 v[8:11], a[100:103], v[152:155], v[8:11]
    ds_read_b64_tr_b16 a[116:117], v214 offset:40960
    ds_read_b64_tr_b16 a[118:119], v214 offset:45056
    v_mfma_f32_16x16x32_bf16 v[12:15], a[100:103], v[156:159], v[12:15]
    ds_read_b128 a[88:91], v210 offset:53248
    ds_read_b128 a[92:95], v211 offset:53248
    v_mfma_f32_16x16x32_bf16 v[12:15], a[96:99], v[140:143], v[12:15]
    s_waitcnt lgkmcnt(9)
    s_mov_b32 m0, s29
    v_mfma_f32_16x16x32_bf16 v[200:203], a[64:67], a[32:35], 0
    v_exp_f32 v196, v196
    v_mfma_f32_16x16x32_bf16 v[200:203], a[68:71], a[36:39], v[200:203]
    v_exp_f32 v197, v197
    v_mfma_f32_16x16x32_bf16 v[200:203], a[72:75], a[40:43], v[200:203]
    v_exp_f32 v198, v198
    v_mfma_f32_16x16x32_bf16 v[200:203], a[76:79], a[44:47], v[200:203]
    v_exp_f32 v199, v199
    v_mfma_f32_16x16x32_bf16 v[16:19], a[104:107], v[128:131], v[16:19]
    v_cvt_pk_bf16_f32 v164, v196, v197
    v_cvt_pk_bf16_f32 v165, v198, v199
    v_mfma_f32_16x16x32_bf16 v[16:19], a[108:111], v[144:147], v[16:19]
    ds_read_b64_tr_b16 a[120:121], v215 offset:32768
    ds_read_b64_tr_b16 a[122:123], v215 offset:36864
    v_mfma_f32_16x16x32_bf16 v[20:23], a[108:111], v[148:151], v[20:23]
    v_mfma_f32_16x16x32_bf16 v[20:23], a[104:107], v[132:135], v[20:23]
    s_waitcnt lgkmcnt(6)
    v_cmp_lt_u32 vcc, v255, v250
    v_mfma_f32_16x16x32_bf16 v[204:207], a[64:67], a[48:51], 0
    v_exp_f32 v200, v200
    v_mfma_f32_16x16x32_bf16 v[204:207], a[68:71], a[52:55], v[204:207]
    v_exp_f32 v201, v201
    v_mfma_f32_16x16x32_bf16 v[204:207], a[72:75], a[56:59], v[204:207]
    v_exp_f32 v202, v202
    v_mfma_f32_16x16x32_bf16 v[204:207], a[76:79], a[60:63], v[204:207]
    v_exp_f32 v203, v203
    v_mfma_f32_16x16x32_bf16 v[24:27], a[104:107], v[136:139], v[24:27]
    v_cvt_pk_bf16_f32 v168, v200, v201
    v_cvt_pk_bf16_f32 v169, v202, v203
    v_mfma_f32_16x16x32_bf16 v[24:27], a[108:111], v[152:155], v[24:27]
    ds_read_b64_tr_b16 a[124:125], v215 offset:40960
    ds_read_b64_tr_b16 a[126:127], v215 offset:45056
    v_mfma_f32_16x16x32_bf16 v[28:31], a[108:111], v[156:159], v[28:31]
    s_cbranch_vccnz L2_spp2F
L2_sprp2F:
    v_mfma_f32_16x16x32_bf16 v[28:31], a[104:107], v[140:143], v[28:31]
    s_waitcnt lgkmcnt(4)
    v_mfma_f32_16x16x32_bf16 v[192:195], a[80:83], a[0:3], 0
    v_exp_f32 v204, v204
    v_mfma_f32_16x16x32_bf16 v[192:195], a[84:87], a[4:7], v[192:195]
    v_exp_f32 v205, v205
    v_mfma_f32_16x16x32_bf16 v[192:195], a[88:91], a[8:11], v[192:195]
    v_exp_f32 v206, v206
    v_mfma_f32_16x16x32_bf16 v[192:195], a[92:95], a[12:15], v[192:195]
    v_exp_f32 v207, v207
    v_mfma_f32_16x16x32_bf16 v[32:35], a[112:115], v[128:131], v[32:35]
    v_cvt_pk_bf16_f32 v172, v204, v205
    v_cvt_pk_bf16_f32 v173, v206, v207
    v_mfma_f32_16x16x32_bf16 v[32:35], a[116:119], v[144:147], v[32:35]
    ds_read_b64_tr_b16 a[96:97], v216 offset:32768
    ds_read_b64_tr_b16 a[98:99], v216 offset:36864
    v_mfma_f32_16x16x32_bf16 v[36:39], a[116:119], v[148:151], v[36:39]
    ds_read_b128 a[64:67], v208 offset:57344
    ds_read_b128 a[68:71], v209 offset:57344
    v_mfma_f32_16x16x32_bf16 v[36:39], a[112:115], v[132:135], v[36:39]
    buffer_load_dwordx4 v220, s[8:11], s27 offen offset:0 sc1 lds
    v_mfma_f32_16x16x32_bf16 v[196:199], a[80:83], a[16:19], 0
    v_exp_f32 v192, v192
    v_mfma_f32_16x16x32_bf16 v[196:199], a[84:87], a[20:23], v[196:199]
    v_exp_f32 v193, v193
    v_mfma_f32_16x16x32_bf16 v[196:199], a[88:91], a[24:27], v[196:199]
    v_exp_f32 v194, v194
    v_mfma_f32_16x16x32_bf16 v[196:199], a[92:95], a[28:31], v[196:199]
    v_exp_f32 v195, v195
    v_mfma_f32_16x16x32_bf16 v[40:43], a[112:115], v[136:139], v[40:43]
    v_cvt_pk_bf16_f32 v162, v192, v193
    v_cvt_pk_bf16_f32 v163, v194, v195
    v_mfma_f32_16x16x32_bf16 v[40:43], a[116:119], v[152:155], v[40:43]
    ds_read_b64_tr_b16 a[100:101], v216 offset:40960
    ds_read_b64_tr_b16 a[102:103], v216 offset:45056
    v_mfma_f32_16x16x32_bf16 v[44:47], a[116:119], v[156:159], v[44:47]
    ds_read_b128 a[72:75], v210 offset:57344
    ds_read_b128 a[76:79], v211 offset:57344
    v_mfma_f32_16x16x32_bf16 v[44:47], a[112:115], v[140:143], v[44:47]
    s_waitcnt lgkmcnt(8)
    v_add_u32 v250, 1, v250
    v_mfma_f32_16x16x32_bf16 v[200:203], a[80:83], a[32:35], 0
    v_exp_f32 v196, v196
    v_mfma_f32_16x16x32_bf16 v[200:203], a[84:87], a[36:39], v[200:203]
    v_exp_f32 v197, v197
    v_mfma_f32_16x16x32_bf16 v[200:203], a[88:91], a[40:43], v[200:203]
    v_exp_f32 v198, v198
    v_mfma_f32_16x16x32_bf16 v[200:203], a[92:95], a[44:47], v[200:203]
    v_exp_f32 v199, v199
    v_mfma_f32_16x16x32_bf16 v[48:51], a[120:123], v[128:131], v[48:51]
    v_cvt_pk_bf16_f32 v166, v196, v197
    v_cvt_pk_bf16_f32 v167, v198, v199
    v_mfma_f32_16x16x32_bf16 v[48:51], a[124:127], v[144:147], v[48:51]
    ds_read_b64_tr_b16 a[104:105], v217 offset:32768
    ds_read_b64_tr_b16 a[106:107], v217 offset:36864
    v_mfma_f32_16x16x32_bf16 v[52:55], a[124:127], v[148:151], v[52:55]
    buffer_load_dwordx4 v220, s[8:11], s27 offen offset:1024 sc1 lds
    v_mfma_f32_16x16x32_bf16 v[52:55], a[120:123], v[132:135], v[52:55]
    buffer_load_dwordx4 v220, s[8:11], s27 offen offset:2048 sc1 lds
    v_mfma_f32_16x16x32_bf16 v[204:207], a[80:83], a[48:51], 0
    v_exp_f32 v200, v200
    v_mfma_f32_16x16x32_bf16 v[204:207], a[84:87], a[52:55], v[204:207]
    v_exp_f32 v201, v201
    v_mfma_f32_16x16x32_bf16 v[204:207], a[88:91], a[56:59], v[204:207]
    v_exp_f32 v202, v202
    v_mfma_f32_16x16x32_bf16 v[204:207], a[92:95], a[60:63], v[204:207]
    v_exp_f32 v203, v203
    v_mfma_f32_16x16x32_bf16 v[56:59], a[120:123], v[136:139], v[56:59]
    v_cvt_pk_bf16_f32 v170, v200, v201
    v_cvt_pk_bf16_f32 v171, v202, v203
    v_mfma_f32_16x16x32_bf16 v[56:59], a[124:127], v[152:155], v[56:59]
    ds_read_b64_tr_b16 a[108:109], v217 offset:40960
    ds_read_b64_tr_b16 a[110:111], v217 offset:45056
    v_mfma_f32_16x16x32_bf16 v[60:63], a[124:127], v[156:159], v[60:63]
    buffer_load_dwordx4 v220, s[8:11], s27 offen offset:3072 sc1 lds
    v_mfma_f32_16x16x32_bf16 v[60:63], a[120:123], v[140:143], v[60:63]
    s_waitcnt lgkmcnt(4)
    s_waitcnt vmcnt(4)
    v_mfma_f32_16x16x32_bf16 v[192:195], a[64:67], a[0:3], 0
    v_exp_f32 v204, v204
    v_mfma_f32_16x16x32_bf16 v[192:195], a[68:71], a[4:7], v[192:195]
    v_exp_f32 v205, v205
    v_mfma_f32_16x16x32_bf16 v[192:195], a[72:75], a[8:11], v[192:195]
    v_exp_f32 v206, v206
    v_mfma_f32_16x16x32_bf16 v[192:195], a[76:79], a[12:15], v[192:195]
    v_exp_f32 v207, v207
    v_mfma_f32_16x16x32_bf16 v[64:67], a[96:99], v[128:131], v[64:67]
    v_cvt_pk_bf16_f32 v174, v204, v205
    v_cvt_pk_bf16_f32 v175, v206, v207
    v_mfma_f32_16x16x32_bf16 v[64:67], a[100:103], v[144:147], v[64:67]
    ds_read_b64_tr_b16 a[112:113], v218 offset:32768
    ds_read_b64_tr_b16 a[114:115], v218 offset:36864
    v_mfma_f32_16x16x32_bf16 v[68:71], a[100:103], v[148:151], v[68:71]
    ds_read_b128 a[80:83], v208 offset:61440
    ds_read_b128 a[84:87], v209 offset:61440
    v_mfma_f32_16x16x32_bf16 v[68:71], a[96:99], v[132:135], v[68:71]
    ds_write_b32 v251, v250
    v_mfma_f32_16x16x32_bf16 v[196:199], a[64:67], a[16:19], 0
    v_exp_f32 v192, v192
    v_mfma_f32_16x16x32_bf16 v[196:199], a[68:71], a[20:23], v[196:199]
    v_exp_f32 v193, v193
    v_mfma_f32_16x16x32_bf16 v[196:199], a[72:75], a[24:27], v[196:199]
    v_exp_f32 v194, v194
    v_mfma_f32_16x16x32_bf16 v[196:199], a[76:79], a[28:31], v[196:199]
    v_exp_f32 v195, v195
    v_mfma_f32_16x16x32_bf16 v[72:75], a[96:99], v[136:139], v[72:75]
    v_cvt_pk_bf16_f32 v176, v192, v193
    v_cvt_pk_bf16_f32 v177, v194, v195
    v_mfma_f32_16x16x32_bf16 v[72:75], a[100:103], v[152:155], v[72:75]
    ds_read_b64_tr_b16 a[116:117], v218 offset:40960
    ds_read_b64_tr_b16 a[118:119], v218 offset:45056
    v_mfma_f32_16x16x32_bf16 v[76:79], a[100:103], v[156:159], v[76:79]
    ds_read_b128 a[88:91], v210 offset:61440
    ds_read_b128 a[92:95], v211 offset:61440
    v_mfma_f32_16x16x32_bf16 v[76:79], a[96:99], v[140:143], v[76:79]
    s_waitcnt lgkmcnt(9)
    v_mfma_f32_16x16x32_bf16 v[200:203], a[64:67], a[32:35], 0
    v_exp_f32 v196, v196
    v_mfma_f32_16x16x32_bf16 v[200:203], a[68:71], a[36:39], v[200:203]
    v_exp_f32 v197, v197
    v_mfma_f32_16x16x32_bf16 v[200:203], a[72:75], a[40:43], v[200:203]
    v_exp_f32 v198, v198
    v_mfma_f32_16x16x32_bf16 v[200:203], a[76:79], a[44:47], v[200:203]
    v_exp_f32 v199, v199
    v_mfma_f32_16x16x32_bf16 v[80:83], a[104:107], v[128:131], v[80:83]
    v_cvt_pk_bf16_f32 v180, v196, v197
    v_cvt_pk_bf16_f32 v181, v198, v199
    v_mfma_f32_16x16x32_bf16 v[80:83], a[108:111], v[144:147], v[80:83]
    ds_read_b64_tr_b16 a[120:121], v219 offset:32768
    ds_read_b64_tr_b16 a[122:123], v219 offset:36864
    v_mfma_f32_16x16x32_bf16 v[84:87], a[108:111], v[148:151], v[84:87]
    ds_read_b32 v255, v254
    v_mfma_f32_16x16x32_bf16 v[84:87], a[104:107], v[132:135], v[84:87]
    s_add_u32 s27, s27, 16384
    v_mfma_f32_16x16x32_bf16 v[204:207], a[64:67], a[48:51], 0
    v_exp_f32 v200, v200
    v_mfma_f32_16x16x32_bf16 v[204:207], a[68:71], a[52:55], v[204:207]
    v_exp_f32 v201, v201
    v_mfma_f32_16x16x32_bf16 v[204:207], a[72:75], a[56:59], v[204:207]
    v_exp_f32 v202, v202
    v_mfma_f32_16x16x32_bf16 v[204:207], a[76:79], a[60:63], v[204:207]
    v_exp_f32 v203, v203
    v_mfma_f32_16x16x32_bf16 v[88:91], a[104:107], v[136:139], v[88:91]
    v_cvt_pk_bf16_f32 v184, v200, v201
    v_cvt_pk_bf16_f32 v185, v202, v203
    v_mfma_f32_16x16x32_bf16 v[88:91], a[108:111], v[152:155], v[88:91]
    ds_read_b64_tr_b16 a[124:125], v219 offset:40960
    ds_read_b64_tr_b16 a[126:127], v219 offset:45056
    v_mfma_f32_16x16x32_bf16 v[92:95], a[108:111], v[156:159], v[92:95]
    s_waitcnt lgkmcnt(2)
    v_cmp_lt_u32 vcc, v255, v250
    v_mfma_f32_16x16x32_bf16 v[92:95], a[104:107], v[140:143], v[92:95]
    s_cbranch_vccnz L2_spp2L
L2_sprp2L:
    v_mfma_f32_16x16x32_bf16 v[192:195], a[80:83], a[0:3], 0
    v_exp_f32 v204, v204
    v_mfma_f32_16x16x32_bf16 v[192:195], a[84:87], a[4:7], v[192:195]
    v_exp_f32 v205, v205
    v_mfma_f32_16x16x32_bf16 v[192:195], a[88:91], a[8:11], v[192:195]
    v_exp_f32 v206, v206
    v_mfma_f32_16x16x32_bf16 v[192:195], a[92:95], a[12:15], v[192:195]
    v_exp_f32 v207, v207
    v_mfma_f32_16x16x32_bf16 v[96:99], a[112:115], v[128:131], v[96:99]
    v_cvt_pk_bf16_f32 v188, v204, v205
    v_cvt_pk_bf16_f32 v189, v206, v207
    v_mfma_f32_16x16x32_bf16 v[96:99], a[116:119], v[144:147], v[96:99]
    ds_read_b64_tr_b16 a[96:97], v212 offset:49152
    ds_read_b64_tr_b16 a[98:99], v212 offset:53248
    v_mfma_f32_16x16x32_bf16 v[100:103], a[116:119], v[148:151], v[100:103]
    ds_read_b128 a[64:67], v208 offset:0
    ds_read_b128 a[68:71], v209 offset:0
    v_mfma_f32_16x16x32_bf16 v[100:103], a[112:115], v[132:135], v[100:103]
    v_add_u32 v250, 1, v250
    v_mfma_f32_16x16x32_bf16 v[196:199], a[80:83], a[16:19], 0
    v_exp_f32 v192, v192
    v_mfma_f32_16x16x32_bf16 v[196:199], a[84:87], a[20:23], v[196:199]
    v_exp_f32 v193, v193
    v_mfma_f32_16x16x32_bf16 v[196:199], a[88:91], a[24:27], v[196:199]
    v_exp_f32 v194, v194
    v_mfma_f32_16x16x32_bf16 v[196:199], a[92:95], a[28:31], v[196:199]
    v_exp_f32 v195, v195
    v_mfma_f32_16x16x32_bf16 v[104:107], a[112:115], v[136:139], v[104:107]
    v_cvt_pk_bf16_f32 v178, v192, v193
    v_cvt_pk_bf16_f32 v179, v194, v195
    v_mfma_f32_16x16x32_bf16 v[104:107], a[116:119], v[152:155], v[104:107]
    ds_read_b64_tr_b16 a[100:101], v212 offset:57344
    ds_read_b64_tr_b16 a[102:103], v212 offset:61440
    v_mfma_f32_16x16x32_bf16 v[108:111], a[116:119], v[156:159], v[108:111]
    ds_read_b128 a[72:75], v210 offset:0
    ds_read_b128 a[76:79], v211 offset:0
    v_mfma_f32_16x16x32_bf16 v[108:111], a[112:115], v[140:143], v[108:111]
    s_waitcnt lgkmcnt(8)
    ds_write_b32 v251, v250
    v_mfma_f32_16x16x32_bf16 v[200:203], a[80:83], a[32:35], 0
    v_exp_f32 v196, v196
    v_mfma_f32_16x16x32_bf16 v[200:203], a[84:87], a[36:39], v[200:203]
    v_exp_f32 v197, v197
    v_mfma_f32_16x16x32_bf16 v[200:203], a[88:91], a[40:43], v[200:203]
    v_exp_f32 v198, v198
    v_mfma_f32_16x16x32_bf16 v[200:203], a[92:95], a[44:47], v[200:203]
    v_exp_f32 v199, v199
    v_mfma_f32_16x16x32_bf16 v[112:115], a[120:123], v[128:131], v[112:115]
    v_cvt_pk_bf16_f32 v182, v196, v197
    v_cvt_pk_bf16_f32 v183, v198, v199
    v_mfma_f32_16x16x32_bf16 v[112:115], a[124:127], v[144:147], v[112:115]
    ds_read_b64_tr_b16 a[104:105], v213 offset:49152
    ds_read_b64_tr_b16 a[106:107], v213 offset:53248
    v_mfma_f32_16x16x32_bf16 v[116:119], a[124:127], v[148:151], v[116:119]
    s_cmp_eq_u32 s27, s89
    s_cselect_b32 s27, s88, s27
    v_mfma_f32_16x16x32_bf16 v[116:119], a[120:123], v[132:135], v[116:119]
    s_cmp_eq_u32 s27, s90
    s_cselect_b32 s27, s89, s27
    v_mfma_f32_16x16x32_bf16 v[204:207], a[80:83], a[48:51], 0
    v_exp_f32 v200, v200
    v_mfma_f32_16x16x32_bf16 v[204:207], a[84:87], a[52:55], v[204:207]
    v_exp_f32 v201, v201
    v_mfma_f32_16x16x32_bf16 v[204:207], a[88:91], a[56:59], v[204:207]
    v_exp_f32 v202, v202
    v_mfma_f32_16x16x32_bf16 v[204:207], a[92:95], a[60:63], v[204:207]
    v_exp_f32 v203, v203
    v_mfma_f32_16x16x32_bf16 v[120:123], a[120:123], v[136:139], v[120:123]
    v_cvt_pk_bf16_f32 v186, v200, v201
    v_cvt_pk_bf16_f32 v187, v202, v203
    v_mfma_f32_16x16x32_bf16 v[120:123], a[124:127], v[152:155], v[120:123]
    ds_read_b64_tr_b16 a[108:109], v213 offset:57344
    ds_read_b64_tr_b16 a[110:111], v213 offset:61440
    v_mfma_f32_16x16x32_bf16 v[124:127], a[124:127], v[156:159], v[124:127]
    s_cmp_eq_u32 s32, 7
    v_mfma_f32_16x16x32_bf16 v[124:127], a[120:123], v[140:143], v[124:127]
    s_waitcnt lgkmcnt(5)
    s_cbranch_scc1 L2_hk2
L2_body3:
    v_mfma_f32_16x16x32_bf16 v[192:195], a[64:67], a[0:3], 0
    v_exp_f32 v204, v204
    v_mfma_f32_16x16x32_bf16 v[192:195], a[68:71], a[4:7], v[192:195]
    v_exp_f32 v205, v205
    v_mfma_f32_16x16x32_bf16 v[192:195], a[72:75], a[8:11], v[192:195]
    v_exp_f32 v206, v206
    v_mfma_f32_16x16x32_bf16 v[192:195], a[76:79], a[12:15], v[192:195]
    v_exp_f32 v207, v207
    v_mfma_f32_16x16x32_bf16 v[0:3], a[96:99], v[160:163], v[0:3]
    v_cvt_pk_bf16_f32 v190, v204, v205
    v_cvt_pk_bf16_f32 v191, v206, v207
    v_mfma_f32_16x16x32_bf16 v[0:3], a[100:103], v[176:179], v[0:3]
    ds_read_b64_tr_b16 a[112:113], v214 offset:49152
    ds_read_b64_tr_b16 a[114:115], v214 offset:53248
    v_mfma_f32_16x16x32_bf16 v[4:7], a[100:103], v[180:183], v[4:7]
    ds_read_b128 a[80:83], v208 offset:4096
    ds_read_b128 a[84:87], v209 offset:4096
    v_mfma_f32_16x16x32_bf16 v[4:7], a[96:99], v[164:167], v[4:7]
    ds_read_b32 v255, v254
    v_mfma_f32_16x16x32_bf16 v[196:199], a[64:67], a[16:19], 0
    v_exp_f32 v192, v192
    v_mfma_f32_16x16x32_bf16 v[196:199], a[68:71], a[20:23], v[196:199]
    v_exp_f32 v193, v193
    v_mfma_f32_16x16x32_bf16 v[196:199], a[72:75], a[24:27], v[196:199]
    v_exp_f32 v194, v194
    v_mfma_f32_16x16x32_bf16 v[196:199], a[76:79], a[28:31], v[196:199]
    v_exp_f32 v195, v195
    v_mfma_f32_16x16x32_bf16 v[8:11], a[96:99], v[168:171], v[8:11]
    v_cvt_pk_bf16_f32 v128, v192, v193
    v_cvt_pk_bf16_f32 v129, v194, v195
    v_mfma_f32_16x16x32_bf16 v[8:11], a[100:103], v[184:187], v[8:11]
    ds_read_b64_tr_b16 a[116:117], v214 offset:57344
    ds_read_b64_tr_b16 a[118:119], v214 offset:61440
    v_mfma_f32_16x16x32_bf16 v[12:15], a[100:103], v[188:191], v[12:15]
    ds_read_b128 a[88:91], v210 offset:4096
    ds_read_b128 a[92:95], v211 offset:4096
    v_mfma_f32_16x16x32_bf16 v[12:15], a[96:99], v[172:175], v[12:15]
    s_waitcnt lgkmcnt(9)
    s_mov_b32 m0, s30
    v_mfma_f32_16x16x32_bf16 v[200:203], a[64:67], a[32:35], 0
    v_exp_f32 v196, v196
    v_mfma_f32_16x16x32_bf16 v[200:203], a[68:71], a[36:39], v[200:203]
    v_exp_f32 v197, v197
    v_mfma_f32_16x16x32_bf16 v[200:203], a[72:75], a[40:43], v[200:203]
    v_exp_f32 v198, v198
    v_mfma_f32_16x16x32_bf16 v[200:203], a[76:79], a[44:47], v[200:203]
    v_exp_f32 v199, v199
    v_mfma_f32_16x16x32_bf16 v[16:19], a[104:107], v[160:163], v[16:19]
    v_cvt_pk_bf16_f32 v132, v196, v197
    v_cvt_pk_bf16_f32 v133, v198, v199
    v_mfma_f32_16x16x32_bf16 v[16:19], a[108:111], v[176:179], v[16:19]
    ds_read_b64_tr_b16 a[120:121], v215 offset:49152
    ds_read_b64_tr_b16 a[122:123], v215 offset:53248
    v_mfma_f32_16x16x32_bf16 v[20:23], a[108:111], v[180:183], v[20:23]
    v_mfma_f32_16x16x32_bf16 v[20:23], a[104:107], v[164:167], v[20:23]
    s_waitcnt lgkmcnt(6)
    v_cmp_lt_u32 vcc, v255, v250
    v_mfma_f32_16x16x32_bf16 v[204:207], a[64:67], a[48:51], 0
    v_exp_f32 v200, v200
    v_mfma_f32_16x16x32_bf16 v[204:207], a[68:71], a[52:55], v[204:207]
    v_exp_f32 v201, v201
    v_mfma_f32_16x16x32_bf16 v[204:207], a[72:75], a[56:59], v[204:207]
    v_exp_f32 v202, v202
    v_mfma_f32_16x16x32_bf16 v[204:207], a[76:79], a[60:63], v[204:207]
    v_exp_f32 v203, v203
    v_mfma_f32_16x16x32_bf16 v[24:27], a[104:107], v[168:171], v[24:27]
    v_cvt_pk_bf16_f32 v136, v200, v201
    v_cvt_pk_bf16_f32 v137, v202, v203
    v_mfma_f32_16x16x32_bf16 v[24:27], a[108:111], v[184:187], v[24:27]
    ds_read_b64_tr_b16 a[124:125], v215 offset:57344
    ds_read_b64_tr_b16 a[126:127], v215 offset:61440
    v_mfma_f32_16x16x32_bf16 v[28:31], a[108:111], v[188:191], v[28:31]
    s_cbranch_vccnz L2_spp3F
L2_sprp3F:
    v_mfma_f32_16x16x32_bf16 v[28:31], a[104:107], v[172:175], v[28:31]
    s_waitcnt lgkmcnt(4)
    v_mfma_f32_16x16x32_bf16 v[192:195], a[80:83], a[0:3], 0
    v_exp_f32 v204, v204
    v_mfma_f32_16x16x32_bf16 v[192:195], a[84:87], a[4:7], v[192:195]
    v_exp_f32 v205, v205
    v_mfma_f32_16x16x32_bf16 v[192:195], a[88:91], a[8:11], v[192:195]
    v_exp_f32 v206, v206
    v_mfma_f32_16x16x32_bf16 v[192:195], a[92:95], a[12:15], v[192:195]
    v_exp_f32 v207, v207
    v_mfma_f32_16x16x32_bf16 v[32:35], a[112:115], v[160:163], v[32:35]
    v_cvt_pk_bf16_f32 v140, v204, v205
    v_cvt_pk_bf16_f32 v141, v206, v207
    v_mfma_f32_16x16x32_bf16 v[32:35], a[116:119], v[176:179], v[32:35]
    ds_read_b64_tr_b16 a[96:97], v216 offset:49152
    ds_read_b64_tr_b16 a[98:99], v216 offset:53248
    v_mfma_f32_16x16x32_bf16 v[36:39], a[116:119], v[180:183], v[36:39]
    ds_read_b128 a[64:67], v208 offset:8192
    ds_read_b128 a[68:71], v209 offset:8192
    v_mfma_f32_16x16x32_bf16 v[36:39], a[112:115], v[164:167], v[36:39]
    buffer_load_dwordx4 v220, s[8:11], s27 offen offset:0 sc1 lds
    v_mfma_f32_16x16x32_bf16 v[196:199], a[80:83], a[16:19], 0
    v_exp_f32 v192, v192
    v_mfma_f32_16x16x32_bf16 v[196:199], a[84:87], a[20:23], v[196:199]
    v_exp_f32 v193, v193
    v_mfma_f32_16x16x32_bf16 v[196:199], a[88:91], a[24:27], v[196:199]
    v_exp_f32 v194, v194
    v_mfma_f32_16x16x32_bf16 v[196:199], a[92:95], a[28:31], v[196:199]
    v_exp_f32 v195, v195
    v_mfma_f32_16x16x32_bf16 v[40:43], a[112:115], v[168:171], v[40:43]
    v_cvt_pk_bf16_f32 v130, v192, v193
    v_cvt_pk_bf16_f32 v131, v194, v195
    v_mfma_f32_16x16x32_bf16 v[40:43], a[116:119], v[184:187], v[40:43]
    ds_read_b64_tr_b16 a[100:101], v216 offset:57344
    ds_read_b64_tr_b16 a[102:103], v216 offset:61440
    v_mfma_f32_16x16x32_bf16 v[44:47], a[116:119], v[188:191], v[44:47]
    ds_read_b128 a[72:75], v210 offset:8192
    ds_read_b128 a[76:79], v211 offset:8192
    v_mfma_f32_16x16x32_bf16 v[44:47], a[112:115], v[172:175], v[44:47]
    s_waitcnt lgkmcnt(8)
    v_add_u32 v250, 1, v250
    v_mfma_f32_16x16x32_bf16 v[200:203], a[80:83], a[32:35], 0
    v_exp_f32 v196, v196
    v_mfma_f32_16x16x32_bf16 v[200:203], a[84:87], a[36:39], v[200:203]
    v_exp_f32 v197, v197
    v_mfma_f32_16x16x32_bf16 v[200:203], a[88:91], a[40:43], v[200:203]
    v_exp_f32 v198, v198
    v_mfma_f32_16x16x32_bf16 v[200:203], a[92:95], a[44:47], v[200:203]
    v_exp_f32 v199, v199
    v_mfma_f32_16x16x32_bf16 v[48:51], a[120:123], v[160:163], v[48:51]
    v_cvt_pk_bf16_f32 v134, v196, v197
    v_cvt_pk_bf16_f32 v135, v198, v199
    v_mfma_f32_16x16x32_bf16 v[48:51], a[124:127], v[176:179], v[48:51]
    ds_read_b64_tr_b16 a[104:105], v217 offset:49152
    ds_read_b64_tr_b16 a[106:107], v217 offset:53248
    v_mfma_f32_16x16x32_bf16 v[52:55], a[124:127], v[180:183], v[52:55]
    buffer_load_dwordx4 v220, s[8:11], s27 offen offset:1024 sc1 lds
    v_mfma_f32_16x16x32_bf16 v[52:55], a[120:123], v[164:167], v[52:55]
    buffer_load_dwordx4 v220, s[8:11], s27 offen offset:2048 sc1 lds
    v_mfma_f32_16x16x32_bf16 v[204:207], a[80:83], a[48:51], 0
    v_exp_f32 v200, v200
    v_mfma_f32_16x16x32_bf16 v[204:207], a[84:87], a[52:55], v[204:207]
    v_exp_f32 v201, v201
    v_mfma_f32_16x16x32_bf16 v[204:207], a[88:91], a[56:59], v[204:207]
    v_exp_f32 v202, v202
    v_mfma_f32_16x16x32_bf16 v[204:207], a[92:95], a[60:63], v[204:207]
    v_exp_f32 v203, v203
    v_mfma_f32_16x16x32_bf16 v[56:59], a[120:123], v[168:171], v[56:59]
    v_cvt_pk_bf16_f32 v138, v200, v201
    v_cvt_pk_bf16_f32 v139, v202, v203
    v_mfma_f32_16x16x32_bf16 v[56:59], a[124:127], v[184:187], v[56:59]
    ds_read_b64_tr_b16 a[108:109], v217 offset:57344
    ds_read_b64_tr_b16 a[110:111], v217 offset:61440
    v_mfma_f32_16x16x32_bf16 v[60:63], a[124:127], v[188:191], v[60:63]
    buffer_load_dwordx4 v220, s[8:11], s27 offen offset:3072 sc1 lds
    v_mfma_f32_16x16x32_bf16 v[60:63], a[120:123], v[172:175], v[60:63]
    s_waitcnt lgkmcnt(4)
    s_waitcnt vmcnt(4)
    v_mfma_f32_16x16x32_bf16 v[192:195], a[64:67], a[0:3], 0
    v_exp_f32 v204, v204
    v_mfma_f32_16x16x32_bf16 v[192:195], a[68:71], a[4:7], v[192:195]
    v_exp_f32 v205, v205
    v_mfma_f32_16x16x32_bf16 v[192:195], a[72:75], a[8:11], v[192:195]
    v_exp_f32 v206, v206
    v_mfma_f32_16x16x32_bf16 v[192:195], a[76:79], a[12:15], v[192:195]
    v_exp_f32 v207, v207
    v_mfma_f32_16x16x32_bf16 v[64:67], a[96:99], v[160:163], v[64:67]
    v_cvt_pk_bf16_f32 v142, v204, v205
    v_cvt_pk_bf16_f32 v143, v206, v207
    v_mfma_f32_16x16x32_bf16 v[64:67], a[100:103], v[176:179], v[64:67]
    ds_read_b64_tr_b16 a[112:113], v218 offset:49152
    ds_read_b64_tr_b16 a[114:115], v218 offset:53248
    v_mfma_f32_16x16x32_bf16 v[68:71], a[100:103], v[180:183], v[68:71]
    ds_read_b128 a[80:83], v208 offset:12288
    ds_read_b128 a[84:87], v209 offset:12288
    v_mfma_f32_16x16x32_bf16 v[68:71], a[96:99], v[164:167], v[68:71]
    ds_write_b32 v251, v250
    v_mfma_f32_16x16x32_bf16 v[196:199], a[64:67], a[16:19], 0
    v_exp_f32 v192, v192
    v_mfma_f32_16x16x32_bf16 v[196:199], a[68:71], a[20:23], v[196:199]
    v_exp_f32 v193, v193
    v_mfma_f32_16x16x32_bf16 v[196:199], a[72:75], a[24:27], v[196:199]
    v_exp_f32 v194, v194
    v_mfma_f32_16x16x32_bf16 v[196:199], a[76:79], a[28:31], v[196:199]
    v_exp_f32 v195, v195
    v_mfma_f32_16x16x32_bf16 v[72:75], a[96:99], v[168:171], v[72:75]
    v_cvt_pk_bf16_f32 v144, v192, v193
    v_cvt_pk_bf16_f32 v145, v194, v195
    v_mfma_f32_16x16x32_bf16 v[72:75], a[100:103], v[184:187], v[72:75]
    ds_read_b64_tr_b16 a[116:117], v218 offset:57344
    ds_read_b64_tr_b16 a[118:119], v218 offset:61440
    v_mfma_f32_16x16x32_bf16 v[76:79], a[100:103], v[188:191], v[76:79]
    ds_read_b128 a[88:91], v210 offset:12288
    ds_read_b128 a[92:95], v211 offset:12288
    v_mfma_f32_16x16x32_bf16 v[76:79], a[96:99], v[172:175], v[76:79]
    s_waitcnt lgkmcnt(9)
    v_mfma_f32_16x16x32_bf16 v[200:203], a[64:67], a[32:35], 0
    v_exp_f32 v196, v196
    v_mfma_f32_16x16x32_bf16 v[200:203], a[68:71], a[36:39], v[200:203]
    v_exp_f32 v197, v197
    v_mfma_f32_16x16x32_bf16 v[200:203], a[72:75], a[40:43], v[200:203]
    v_exp_f32 v198, v198
    v_mfma_f32_16x16x32_bf16 v[200:203], a[76:79], a[44:47], v[200:203]
    v_exp_f32 v199, v199
    v_mfma_f32_16x16x32_bf16 v[80:83], a[104:107], v[160:163], v[80:83]
    v_cvt_pk_bf16_f32 v148, v196, v197
    v_cvt_pk_bf16_f32 v149, v198, v199
    v_mfma_f32_16x16x32_bf16 v[80:83], a[108:111], v[176:179], v[80:83]
    ds_read_b64_tr_b16 a[120:121], v219 offset:49152
    ds_read_b64_tr_b16 a[122:123], v219 offset:53248
    v_mfma_f32_16x16x32_bf16 v[84:87], a[108:111], v[180:183], v[84:87]
    ds_read_b32 v255, v254
    v_mfma_f32_16x16x32_bf16 v[84:87], a[104:107], v[164:167], v[84:87]
    s_add_u32 s27, s27, 16384
    v_mfma_f32_16x16x32_bf16 v[204:207], a[64:67], a[48:51], 0
    v_exp_f32 v200, v200
    v_mfma_f32_16x16x32_bf16 v[204:207], a[68:71], a[52:55], v[204:207]
    v_exp_f32 v201, v201
    v_mfma_f32_16x16x32_bf16 v[204:207], a[72:75], a[56:59], v[204:207]
    v_exp_f32 v202, v202
    v_mfma_f32_16x16x32_bf16 v[204:207], a[76:79], a[60:63], v[204:207]
    v_exp_f32 v203, v203
    v_mfma_f32_16x16x32_bf16 v[88:91], a[104:107], v[168:171], v[88:91]
    v_cvt_pk_bf16_f32 v152, v200, v201
    v_cvt_pk_bf16_f32 v153, v202, v203
    v_mfma_f32_16x16x32_bf16 v[88:91], a[108:111], v[184:187], v[88:91]
    ds_read_b64_tr_b16 a[124:125], v219 offset:57344
    ds_read_b64_tr_b16 a[126:127], v219 offset:61440
    v_mfma_f32_16x16x32_bf16 v[92:95], a[108:111], v[188:191], v[92:95]
    s_waitcnt lgkmcnt(2)
    v_cmp_lt_u32 vcc, v255, v250
    v_mfma_f32_16x16x32_bf16 v[92:95], a[104:107], v[172:175], v[92:95]
    s_cbranch_vccnz L2_spp3L
L2_sprp3L:
    v_mfma_f32_16x16x32_bf16 v[192:195], a[80:83], a[0:3], 0
    v_exp_f32 v204, v204
    v_mfma_f32_16x16x32_bf16 v[192:195], a[84:87], a[4:7], v[192:195]
    v_exp_f32 v205, v205
    v_mfma_f32_16x16x32_bf16 v[192:195], a[88:91], a[8:11], v[192:195]
    v_exp_f32 v206, v206
    v_mfma_f32_16x16x32_bf16 v[192:195], a[92:95], a[12:15], v[192:195]
    v_exp_f32 v207, v207
    v_mfma_f32_16x16x32_bf16 v[96:99], a[112:115], v[160:163], v[96:99]
    v_cvt_pk_bf16_f32 v156, v204, v205
    v_cvt_pk_bf16_f32 v157, v206, v207
    v_mfma_f32_16x16x32_bf16 v[96:99], a[116:119], v[176:179], v[96:99]
    ds_read_b64_tr_b16 a[96:97], v212 offset:0
    ds_read_b64_tr_b16 a[98:99], v212 offset:4096
    v_mfma_f32_16x16x32_bf16 v[100:103], a[116:119], v[180:183], v[100:103]
    ds_read_b128 a[64:67], v208 offset:16384
    ds_read_b128 a[68:71], v209 offset:16384
    v_mfma_f32_16x16x32_bf16 v[100:103], a[112:115], v[164:167], v[100:103]
    v_add_u32 v250, 1, v250
    v_mfma_f32_16x16x32_bf16 v[196:199], a[80:83], a[16:19], 0
    v_exp_f32 v192, v192
    v_mfma_f32_16x16x32_bf16 v[196:199], a[84:87], a[20:23], v[196:199]
    v_exp_f32 v193, v193
    v_mfma_f32_16x16x32_bf16 v[196:199], a[88:91], a[24:27], v[196:199]
    v_exp_f32 v194, v194
    v_mfma_f32_16x16x32_bf16 v[196:199], a[92:95], a[28:31], v[196:199]
    v_exp_f32 v195, v195
    v_mfma_f32_16x16x32_bf16 v[104:107], a[112:115], v[168:171], v[104:107]
    v_cvt_pk_bf16_f32 v146, v192, v193
    v_cvt_pk_bf16_f32 v147, v194, v195
    v_mfma_f32_16x16x32_bf16 v[104:107], a[116:119], v[184:187], v[104:107]
    ds_read_b64_tr_b16 a[100:101], v212 offset:8192
    ds_read_b64_tr_b16 a[102:103], v212 offset:12288
    v_mfma_f32_16x16x32_bf16 v[108:111], a[116:119], v[188:191], v[108:111]
    ds_read_b128 a[72:75], v210 offset:16384
    ds_read_b128 a[76:79], v211 offset:16384
    v_mfma_f32_16x16x32_bf16 v[108:111], a[112:115], v[172:175], v[108:111]
    s_waitcnt lgkmcnt(8)
    ds_write_b32 v251, v250
    v_mfma_f32_16x16x32_bf16 v[200:203], a[80:83], a[32:35], 0
    v_exp_f32 v196, v196
    v_mfma_f32_16x16x32_bf16 v[200:203], a[84:87], a[36:39], v[200:203]
    v_exp_f32 v197, v197
    v_mfma_f32_16x16x32_bf16 v[200:203], a[88:91], a[40:43], v[200:203]
    v_exp_f32 v198, v198
    v_mfma_f32_16x16x32_bf16 v[200:203], a[92:95], a[44:47], v[200:203]
    v_exp_f32 v199, v199
    v_mfma_f32_16x16x32_bf16 v[112:115], a[120:123], v[160:163], v[112:115]
    v_cvt_pk_bf16_f32 v150, v196, v197
    v_cvt_pk_bf16_f32 v151, v198, v199
    v_mfma_f32_16x16x32_bf16 v[112:115], a[124:127], v[176:179], v[112:115]
    ds_read_b64_tr_b16 a[104:105], v213 offset:0
    ds_read_b64_tr_b16 a[106:107], v213 offset:4096
    v_mfma_f32_16x16x32_bf16 v[116:119], a[124:127], v[180:183], v[116:119]
    s_cmp_eq_u32 s27, s89
    s_cselect_b32 s27, s88, s27
    v_mfma_f32_16x16x32_bf16 v[116:119], a[120:123], v[164:167], v[116:119]
    s_cmp_eq_u32 s27, s90
    s_cselect_b32 s27, s89, s27
    v_mfma_f32_16x16x32_bf16 v[204:207], a[80:83], a[48:51], 0
    v_exp_f32 v200, v200
    v_mfma_f32_16x16x32_bf16 v[204:207], a[84:87], a[52:55], v[204:207]
    v_exp_f32 v201, v201
    v_mfma_f32_16x16x32_bf16 v[204:207], a[88:91], a[56:59], v[204:207]
    v_exp_f32 v202, v202
    v_mfma_f32_16x16x32_bf16 v[204:207], a[92:95], a[60:63], v[204:207]
    v_exp_f32 v203, v203
    v_mfma_f32_16x16x32_bf16 v[120:123], a[120:123], v[168:171], v[120:123]
    v_cvt_pk_bf16_f32 v154, v200, v201
    v_cvt_pk_bf16_f32 v155, v202, v203
    v_mfma_f32_16x16x32_bf16 v[120:123], a[124:127], v[184:187], v[120:123]
    ds_read_b64_tr_b16 a[108:109], v213 offset:8192
    ds_read_b64_tr_b16 a[110:111], v213 offset:12288
    v_mfma_f32_16x16x32_bf16 v[124:127], a[124:127], v[188:191], v[124:127]
    v_mfma_f32_16x16x32_bf16 v[124:127], a[120:123], v[172:175], v[124:127]
    s_waitcnt lgkmcnt(5)
    s_sub_u32 s32, s32, 1
    s_cmp_lg_u32 s32, 0
    s_cbranch_scc1 L2_head
    s_branch L2_post
.p2align 6
L2_gbody:
    v_mfma_f32_16x16x32_bf16 v[192:195], a[64:67], a[0:3], 0
    v_exp_f32 v204, v204
    v_mfma_f32_16x16x32_bf16 v[192:195], a[68:71], a[4:7], v[192:195]
    v_exp_f32 v205, v205
    v_mfma_f32_16x16x32_bf16 v[192:195], a[72:75], a[8:11], v[192:195]
    v_exp_f32 v206, v206
    v_mfma_f32_16x16x32_bf16 v[192:195], a[76:79], a[12:15], v[192:195]
    v_exp_f32 v207, v207
    v_mfma_f32_16x16x32_bf16 v[0:3], a[96:99], v[128:131], v[0:3]
    v_cvt_pk_bf16_f32 v158, v204, v205
    v_cvt_pk_bf16_f32 v159, v206, v207
    v_mfma_f32_16x16x32_bf16 v[0:3], a[100:103], v[144:147], v[0:3]
    ds_read_b64_tr_b16 a[112:113], v214 offset:0
    ds_read_b64_tr_b16 a[114:115], v214 offset:4096
    v_mfma_f32_16x16x32_bf16 v[4:7], a[100:103], v[148:151], v[4:7]
    ds_read_b128 a[80:83], v208 offset:20480
    ds_read_b128 a[84:87], v209 offset:20480
    v_mfma_f32_16x16x32_bf16 v[4:7], a[96:99], v[132:135], v[4:7]
    ds_read_b32 v255, v254
    ds_read_b32 v245, v241 offset:0
    v_mfma_f32_16x16x32_bf16 v[196:199], a[64:67], a[16:19], 0
    v_exp_f32 v192, v192
    v_mfma_f32_16x16x32_bf16 v[196:199], a[68:71], a[20:23], v[196:199]
    v_exp_f32 v193, v193
    v_mfma_f32_16x16x32_bf16 v[196:199], a[72:75], a[24:27], v[196:199]
    v_exp_f32 v194, v194
    v_mfma_f32_16x16x32_bf16 v[196:199], a[76:79], a[28:31], v[196:199]
    v_exp_f32 v195, v195
    v_mfma_f32_16x16x32_bf16 v[8:11], a[96:99], v[136:139], v[8:11]
    v_cvt_pk_bf16_f32 v160, v192, v193
    v_cvt_pk_bf16_f32 v161, v194, v195
    v_mfma_f32_16x16x32_bf16 v[8:11], a[100:103], v[152:155], v[8:11]
    ds_read_b64_tr_b16 a[116:117], v214 offset:8192
    ds_read_b64_tr_b16 a[118:119], v214 offset:12288
    v_mfma_f32_16x16x32_bf16 v[12:15], a[100:103], v[156:159], v[12:15]
    ds_read_b128 a[88:91], v210 offset:20480
    ds_read_b128 a[92:95], v211 offset:20480
    v_mfma_f32_16x16x32_bf16 v[12:15], a[96:99], v[140:143], v[12:15]
    s_waitcnt lgkmcnt(10)
    s_mov_b32 m0, s31
    v_mfma_f32_16x16x32_bf16 v[200:203], a[64:67], a[32:35], 0
    v_exp_f32 v196, v196
    v_mfma_f32_16x16x32_bf16 v[200:203], a[68:71], a[36:39], v[200:203]
    v_exp_f32 v197, v197
    v_mfma_f32_16x16x32_bf16 v[200:203], a[72:75], a[40:43], v[200:203]
    v_exp_f32 v198, v198
    v_mfma_f32_16x16x32_bf16 v[200:203], a[76:79], a[44:47], v[200:203]
    v_exp_f32 v199, v199
    v_mfma_f32_16x16x32_bf16 v[16:19], a[104:107], v[128:131], v[16:19]
    v_cvt_pk_bf16_f32 v164, v196, v197
    v_cvt_pk_bf16_f32 v165, v198, v199
    v_mfma_f32_16x16x32_bf16 v[16:19], a[108:111], v[144:147], v[16:19]
    ds_read_b64_tr_b16 a[120:121], v215 offset:0
    ds_read_b64_tr_b16 a[122:123], v215 offset:4096
    v_mfma_f32_16x16x32_bf16 v[20:23], a[108:111], v[148:151], v[20:23]
    ds_write_b128 v243, a[196:199]
    ds_read2_b32 v[222:223], v240 offset0:32 offset1:36
    v_mfma_f32_16x16x32_bf16 v[20:23], a[104:107], v[132:135], v[20:23]
    s_waitcnt lgkmcnt(9)
    v_cmp_lt_u32 vcc, v255, v250
    v_mfma_f32_16x16x32_bf16 v[204:207], a[64:67], a[48:51], 0
    v_exp_f32 v200, v200
    v_mfma_f32_16x16x32_bf16 v[204:207], a[68:71], a[52:55], v[204:207]
    v_exp_f32 v201, v201
    v_mfma_f32_16x16x32_bf16 v[204:207], a[72:75], a[56:59], v[204:207]
    v_exp_f32 v202, v202
    v_mfma_f32_16x16x32_bf16 v[204:207], a[76:79], a[60:63], v[204:207]
    v_exp_f32 v203, v203
    v_mfma_f32_16x16x32_bf16 v[24:27], a[104:107], v[136:139], v[24:27]
    v_cvt_pk_bf16_f32 v168, v200, v201
    v_cvt_pk_bf16_f32 v169, v202, v203
    v_mfma_f32_16x16x32_bf16 v[24:27], a[108:111], v[152:155], v[24:27]
    ds_read_b64_tr_b16 a[124:125], v215 offset:8192
    ds_read_b64_tr_b16 a[126:127], v215 offset:12288
    v_mfma_f32_16x16x32_bf16 v[28:31], a[108:111], v[156:159], v[28:31]
    s_cbranch_vccnz L2_spg0F
L2_sprg0F:
    ds_read2_b32 v[224:225], v240 offset0:40 offset1:44
    v_mfma_f32_16x16x32_bf16 v[28:31], a[104:107], v[140:143], v[28:31]
    s_waitcnt lgkmcnt(7)
    ds_read2_b32 v[226:227], v240 offset0:48 offset1:52
    v_mfma_f32_16x16x32_bf16 v[192:195], a[80:83], a[0:3], 0
    v_exp_f32 v204, v204
    v_mfma_f32_16x16x32_bf16 v[192:195], a[84:87], a[4:7], v[192:195]
    v_exp_f32 v205, v205
    v_mfma_f32_16x16x32_bf16 v[192:195], a[88:91], a[8:11], v[192:195]
    v_exp_f32 v206, v206
    v_mfma_f32_16x16x32_bf16 v[192:195], a[92:95], a[12:15], v[192:195]
    v_exp_f32 v207, v207
    v_and_b32 v245, 31, v245
    v_lshl_add_u32 v245, v245, 6, v242
    v_mfma_f32_16x16x32_bf16 v[32:35], a[112:115], v[128:131], v[32:35]
    v_cvt_pk_bf16_f32 v172, v204, v205
    v_cvt_pk_bf16_f32 v173, v206, v207
    v_mfma_f32_16x16x32_bf16 v[32:35], a[116:119], v[144:147], v[32:35]
    ds_read_b64_tr_b16 a[96:97], v216 offset:0
    ds_read_b64_tr_b16 a[98:99], v216 offset:4096
    v_mfma_f32_16x16x32_bf16 v[36:39], a[116:119], v[148:151], v[36:39]
    ds_read_b128 a[64:67], v208 offset:24576
    ds_read_b128 a[68:71], v209 offset:24576
    v_mfma_f32_16x16x32_bf16 v[36:39], a[112:115], v[132:135], v[36:39]
    buffer_load_dwordx4 v220, s[8:11], s27 offen offset:0 sc1 lds
    ds_write_b16 v245, v244
    v_mfma_f32_16x16x32_bf16 v[196:199], a[80:83], a[16:19], 0
    v_exp_f32 v192, v192
    v_mfma_f32_16x16x32_bf16 v[196:199], a[84:87], a[20:23], v[196:199]
    v_exp_f32 v193, v193
    v_mfma_f32_16x16x32_bf16 v[196:199], a[88:91], a[24:27], v[196:199]
    v_exp_f32 v194, v194
    v_mfma_f32_16x16x32_bf16 v[196:199], a[92:95], a[28:31], v[196:199]
    v_exp_f32 v195, v195
    v_mfma_f32_16x16x32_bf16 v[40:43], a[112:115], v[136:139], v[40:43]
    v_cvt_pk_bf16_f32 v162, v192, v193
    v_cvt_pk_bf16_f32 v163, v194, v195
    s_waitcnt vmcnt(1)
    v_mfma_f32_16x16x32_bf16 v[40:43], a[116:119], v[152:155], v[40:43]
    ds_read_b64_tr_b16 a[100:101], v216 offset:8192
    ds_read_b64_tr_b16 a[102:103], v216 offset:12288
    ds_read_b64_tr_b16 a[160:161], v230 offset:0
    ds_read_b64_tr_b16 a[162:163], v230 offset:4096
    v_mfma_f32_16x16x32_bf16 v[44:47], a[116:119], v[156:159], v[44:47]
    ds_read_b128 a[72:75], v210 offset:24576
    ds_read_b128 a[76:79], v211 offset:24576
    ds_read_b64_tr_b16 a[164:165], v231 offset:0
    ds_read_b64_tr_b16 a[166:167], v231 offset:4096
    ds_read_b128 a[192:195], v243
    v_mfma_f32_16x16x32_bf16 v[44:47], a[112:115], v[140:143], v[44:47]
    s_waitcnt lgkmcnt(15)
    buffer_load_dwordx4 v220, s[8:11], s27 offen offset:1024 sc1 lds
    v_add_u32 v250, 1, v250
    v_mfma_f32_16x16x32_bf16 v[200:203], a[80:83], a[32:35], 0
    v_exp_f32 v196, v196
    v_mfma_f32_16x16x32_bf16 v[200:203], a[84:87], a[36:39], v[200:203]
    v_exp_f32 v197, v197
    v_mfma_f32_16x16x32_bf16 v[200:203], a[88:91], a[40:43], v[200:203]
    v_exp_f32 v198, v198
    v_mfma_f32_16x16x32_bf16 v[200:203], a[92:95], a[44:47], v[200:203]
    v_exp_f32 v199, v199
    v_mfma_f32_16x16x32_bf16 v[48:51], a[120:123], v[128:131], v[48:51]
    v_cvt_pk_bf16_f32 v166, v196, v197
    v_cvt_pk_bf16_f32 v167, v198, v199
    v_mfma_f32_16x16x32_bf16 v[48:51], a[124:127], v[144:147], v[48:51]
    ds_read_b64_tr_b16 a[104:105], v217 offset:0
    ds_read_b64_tr_b16 a[106:107], v217 offset:4096
    ds_read_b64_tr_b16 a[172:173], v233 offset:0
    ds_read_b64_tr_b16 a[174:175], v233 offset:4096
    v_mfma_f32_16x16x32_bf16 v[52:55], a[124:127], v[148:151], v[52:55]
    ds_read_b64_tr_b16 a[168:169], v232 offset:0
    ds_read_b64_tr_b16 a[170:171], v232 offset:4096
    v_mfma_f32_16x16x32_bf16 v[52:55], a[120:123], v[132:135], v[52:55]
    buffer_load_dwordx4 v220, s[8:11], s27 offen offset:2048 sc1 lds
    v_mfma_f32_16x16x32_bf16 v[204:207], a[80:83], a[48:51], 0
    v_exp_f32 v200, v200
    v_mfma_f32_16x16x32_bf16 v[204:207], a[84:87], a[52:55], v[204:207]
    v_exp_f32 v201, v201
    v_mfma_f32_16x16x32_bf16 v[204:207], a[88:91], a[56:59], v[204:207]
    v_exp_f32 v202, v202
    v_mfma_f32_16x16x32_bf16 v[204:207], a[92:95], a[60:63], v[204:207]
    v_exp_f32 v203, v203
    v_mfma_f32_16x16x32_bf16 v[56:59], a[120:123], v[136:139], v[56:59]
    v_cvt_pk_bf16_f32 v170, v200, v201
    v_cvt_pk_bf16_f32 v171, v202, v203
    v_mfma_f32_16x16x32_bf16 v[56:59], a[124:127], v[152:155], v[56:59]
    ds_read_b64_tr_b16 a[108:109], v217 offset:8192
    ds_read_b64_tr_b16 a[110:111], v217 offset:12288
    v_mfma_f32_16x16x32_bf16 v[60:63], a[124:127], v[156:159], v[60:63]
    buffer_load_dwordx4 v220, s[8:11], s27 offen offset:3072 sc1 lds
    v_mfma_f32_16x16x32_bf16 v[60:63], a[120:123], v[140:143], v[60:63]
    s_waitcnt lgkmcnt(11)
    s_waitcnt vmcnt(12)
    s_mov_b32 m0, s75
    v_mfma_f32_16x16x32_bf16 v[192:195], a[64:67], a[0:3], 0
    v_exp_f32 v204, v204
    v_mfma_f32_16x16x32_bf16 v[192:195], a[68:71], a[4:7], v[192:195]
    v_exp_f32 v205, v205
    v_mfma_f32_16x16x32_bf16 v[192:195], a[72:75], a[8:11], v[192:195]
    v_exp_f32 v206, v206
    v_mfma_f32_16x16x32_bf16 v[192:195], a[76:79], a[12:15], v[192:195]
    v_exp_f32 v207, v207
    v_bitop3_b32 v222, v222, -16, v238 bitop3:0x6a
    s_waitcnt lgkmcnt(8)
    v_mfma_f32_16x16x32_bf16 a[128:131], a[160:163], a[192:195], a[128:131]
    buffer_load_dwordx4 v222, s[92:95], s36 offen offset:0 sc1 lds
    ds_read_b64_tr_b16 a[176:177], v234 offset:0
    v_mfma_f32_16x16x32_bf16 v[64:67], a[96:99], v[128:131], v[64:67]
    v_cvt_pk_bf16_f32 v174, v204, v205
    v_cvt_pk_bf16_f32 v175, v206, v207
    v_mfma_f32_16x16x32_bf16 v[64:67], a[100:103], v[144:147], v[64:67]
    ds_read_b64_tr_b16 a[112:113], v218 offset:0
    ds_read_b64_tr_b16 a[114:115], v218 offset:4096
    v_mfma_f32_16x16x32_bf16 v[68:71], a[100:103], v[148:151], v[68:71]
    ds_read_b128 a[80:83], v208 offset:28672
    ds_read_b128 a[84:87], v209 offset:28672
    v_mfma_f32_16x16x32_bf16 v[68:71], a[96:99], v[132:135], v[68:71]
    ds_write_b32 v251, v250
    ds_read2_b32 v[228:229], v240 offset0:56 offset1:60
    v_mfma_f32_16x16x32_bf16 v[196:199], a[64:67], a[16:19], 0
    v_exp_f32 v192, v192
    v_mfma_f32_16x16x32_bf16 v[196:199], a[68:71], a[20:23], v[196:199]
    v_exp_f32 v193, v193
    v_mfma_f32_16x16x32_bf16 v[196:199], a[72:75], a[24:27], v[196:199]
    v_exp_f32 v194, v194
    v_mfma_f32_16x16x32_bf16 v[196:199], a[76:79], a[28:31], v[196:199]
    v_exp_f32 v195, v195
    v_bitop3_b32 v223, v223, -16, v239 bitop3:0x6a
    v_mfma_f32_16x16x32_bf16 a[132:135], a[164:167], a[192:195], a[132:135]
    buffer_load_dwordx4 v223, s[92:95], s37 offen offset:1024 sc1 lds
    ds_read_b64_tr_b16 a[178:179], v234 offset:4096
    v_mfma_f32_16x16x32_bf16 v[72:75], a[96:99], v[136:139], v[72:75]
    v_cvt_pk_bf16_f32 v176, v192, v193
    v_cvt_pk_bf16_f32 v177, v194, v195
    v_mfma_f32_16x16x32_bf16 v[72:75], a[100:103], v[152:155], v[72:75]
    ds_read_b64_tr_b16 a[116:117], v218 offset:8192
    ds_read_b64_tr_b16 a[118:119], v218 offset:12288
    v_mfma_f32_16x16x32_bf16 v[76:79], a[100:103], v[156:159], v[76:79]
    ds_read_b128 a[88:91], v210 offset:28672
    ds_read_b128 a[92:95], v211 offset:28672
    v_mfma_f32_16x16x32_bf16 v[76:79], a[96:99], v[140:143], v[76:79]
    s_waitcnt lgkmcnt(12)
    ds_read_b64_tr_b16 a[182:183], v235 offset:4096
    v_mfma_f32_16x16x32_bf16 v[200:203], a[64:67], a[32:35], 0
    v_exp_f32 v196, v196
    v_mfma_f32_16x16x32_bf16 v[200:203], a[68:71], a[36:39], v[200:203]
    v_exp_f32 v197, v197
    v_mfma_f32_16x16x32_bf16 v[200:203], a[72:75], a[40:43], v[200:203]
    v_exp_f32 v198, v198
    v_mfma_f32_16x16x32_bf16 v[200:203], a[76:79], a[44:47], v[200:203]
    v_exp_f32 v199, v199
    v_bitop3_b32 v224, v224, -16, v238 bitop3:0x6a
    v_mfma_f32_16x16x32_bf16 a[136:139], a[168:171], a[192:195], a[136:139]
    buffer_load_dwordx4 v224, s[92:95], s38 offen offset:2048 sc1 lds
    ds_read_b64_tr_b16 a[180:181], v235 offset:0
    v_mfma_f32_16x16x32_bf16 v[80:83], a[104:107], v[128:131], v[80:83]
    v_cvt_pk_bf16_f32 v180, v196, v197
    v_cvt_pk_bf16_f32 v181, v198, v199
    v_mfma_f32_16x16x32_bf16 v[80:83], a[108:111], v[144:147], v[80:83]
    ds_read_b64_tr_b16 a[120:121], v219 offset:0
    ds_read_b64_tr_b16 a[122:123], v219 offset:4096
    ds_read_b64_tr_b16 a[190:191], v237 offset:4096
    v_mfma_f32_16x16x32_bf16 v[84:87], a[108:111], v[148:151], v[84:87]
    ds_read_b32 v255, v254
    ds_read_b64_tr_b16 a[184:185], v236 offset:0
    v_mfma_f32_16x16x32_bf16 v[84:87], a[104:107], v[132:135], v[84:87]
    s_add_u32 s27, s27, 16384
    ds_read_b64_tr_b16 a[186:187], v236 offset:4096
    v_mfma_f32_16x16x32_bf16 v[204:207], a[64:67], a[48:51], 0
    v_exp_f32 v200, v200
    v_mfma_f32_16x16x32_bf16 v[204:207], a[68:71], a[52:55], v[204:207]
    v_exp_f32 v201, v201
    v_mfma_f32_16x16x32_bf16 v[204:207], a[72:75], a[56:59], v[204:207]
    v_exp_f32 v202, v202
    v_mfma_f32_16x16x32_bf16 v[204:207], a[76:79], a[60:63], v[204:207]
    v_exp_f32 v203, v203
    v_bitop3_b32 v225, v225, -16, v239 bitop3:0x6a
    v_mfma_f32_16x16x32_bf16 a[140:143], a[172:175], a[192:195], a[140:143]
    buffer_load_dwordx4 v225, s[92:95], 0 offen offset:3072 sc1 lds
    ds_read_b64_tr_b16 a[188:189], v237 offset:0
    v_mfma_f32_16x16x32_bf16 v[88:91], a[104:107], v[136:139], v[88:91]
    v_cvt_pk_bf16_f32 v184, v200, v201
    v_cvt_pk_bf16_f32 v185, v202, v203
    v_mfma_f32_16x16x32_bf16 v[88:91], a[108:111], v[152:155], v[88:91]
    ds_read_b64_tr_b16 a[124:125], v219 offset:8192
    ds_read_b64_tr_b16 a[126:127], v219 offset:12288
    v_mfma_f32_16x16x32_bf16 v[92:95], a[108:111], v[156:159], v[92:95]
    s_waitcnt lgkmcnt(5)
    v_cmp_lt_u32 vcc, v255, v250
    v_mfma_f32_16x16x32_bf16 v[92:95], a[104:107], v[140:143], v[92:95]
    s_cbranch_vccnz L2_spg0L
L2_sprg0L:
    s_add_u32 m0, s75, 4096
    v_mfma_f32_16x16x32_bf16 v[192:195], a[80:83], a[0:3], 0
    v_exp_f32 v204, v204
    v_mfma_f32_16x16x32_bf16 v[192:195], a[84:87], a[4:7], v[192:195]
    v_exp_f32 v205, v205
    v_mfma_f32_16x16x32_bf16 v[192:195], a[88:91], a[8:11], v[192:195]
    v_exp_f32 v206, v206
    v_mfma_f32_16x16x32_bf16 v[192:195], a[92:95], a[12:15], v[192:195]
    v_exp_f32 v207, v207
    v_bitop3_b32 v226, v226, -16, v238 bitop3:0x6a
    v_mfma_f32_16x16x32_bf16 a[144:147], a[176:179], a[192:195], a[144:147]
    buffer_load_dwordx4 v226, s[92:95], s36 offen offset:0 sc1 lds
    v_mfma_f32_16x16x32_bf16 v[96:99], a[112:115], v[128:131], v[96:99]
    v_cvt_pk_bf16_f32 v188, v204, v205
    v_cvt_pk_bf16_f32 v189, v206, v207
    v_mfma_f32_16x16x32_bf16 v[96:99], a[116:119], v[144:147], v[96:99]
    ds_read_b64_tr_b16 a[96:97], v212 offset:16384
    ds_read_b64_tr_b16 a[98:99], v212 offset:20480
    v_mfma_f32_16x16x32_bf16 v[100:103], a[116:119], v[148:151], v[100:103]
    ds_read_b128 a[64:67], v208 offset:32768
    ds_read_b128 a[68:71], v209 offset:32768
    v_mfma_f32_16x16x32_bf16 v[100:103], a[112:115], v[132:135], v[100:103]
    v_add_u32 v250, 1, v250
    v_mfma_f32_16x16x32_bf16 v[196:199], a[80:83], a[16:19], 0
    v_exp_f32 v192, v192
    v_mfma_f32_16x16x32_bf16 v[196:199], a[84:87], a[20:23], v[196:199]
    v_exp_f32 v193, v193
    v_mfma_f32_16x16x32_bf16 v[196:199], a[88:91], a[24:27], v[196:199]
    v_exp_f32 v194, v194
    v_mfma_f32_16x16x32_bf16 v[196:199], a[92:95], a[28:31], v[196:199]
    v_exp_f32 v195, v195
    v_bitop3_b32 v227, v227, -16, v239 bitop3:0x6a
    v_mfma_f32_16x16x32_bf16 a[148:151], a[180:183], a[192:195], a[148:151]
    buffer_load_dwordx4 v227, s[92:95], s37 offen offset:1024 sc1 lds
    v_mfma_f32_16x16x32_bf16 v[104:107], a[112:115], v[136:139], v[104:107]
    v_cvt_pk_bf16_f32 v178, v192, v193
    v_cvt_pk_bf16_f32 v179, v194, v195
    v_mfma_f32_16x16x32_bf16 v[104:107], a[116:119], v[152:155], v[104:107]
    ds_read_b64_tr_b16 a[100:101], v212 offset:24576
    ds_read_b64_tr_b16 a[102:103], v212 offset:28672
    v_mfma_f32_16x16x32_bf16 v[108:111], a[116:119], v[156:159], v[108:111]
    ds_read_b128 a[72:75], v210 offset:32768
    ds_read_b128 a[76:79], v211 offset:32768
    v_mfma_f32_16x16x32_bf16 v[108:111], a[112:115], v[140:143], v[108:111]
    s_waitcnt lgkmcnt(8)
    ds_write_b32 v251, v250
    v_mfma_f32_16x16x32_bf16 v[200:203], a[80:83], a[32:35], 0
    v_exp_f32 v196, v196
    v_mfma_f32_16x16x32_bf16 v[200:203], a[84:87], a[36:39], v[200:203]
    v_exp_f32 v197, v197
    v_mfma_f32_16x16x32_bf16 v[200:203], a[88:91], a[40:43], v[200:203]
    v_exp_f32 v198, v198
    v_mfma_f32_16x16x32_bf16 v[200:203], a[92:95], a[44:47], v[200:203]
    v_exp_f32 v199, v199
    v_bitop3_b32 v228, v228, -16, v238 bitop3:0x6a
    v_mfma_f32_16x16x32_bf16 a[152:155], a[184:187], a[192:195], a[152:155]
    buffer_load_dwordx4 v228, s[92:95], s38 offen offset:2048 sc1 lds
    v_mfma_f32_16x16x32_bf16 v[112:115], a[120:123], v[128:131], v[112:115]
    v_cvt_pk_bf16_f32 v182, v196, v197
    v_cvt_pk_bf16_f32 v183, v198, v199
    v_mfma_f32_16x16x32_bf16 v[112:115], a[124:127], v[144:147], v[112:115]
    ds_read_b64_tr_b16 a[104:105], v213 offset:16384
    ds_read_b64_tr_b16 a[106:107], v213 offset:20480
    v_mfma_f32_16x16x32_bf16 v[116:119], a[124:127], v[148:151], v[116:119]
    s_cmp_eq_u32 s27, s89
    s_cselect_b32 s27, s88, s27
    v_mfma_f32_16x16x32_bf16 v[116:119], a[120:123], v[132:135], v[116:119]
    s_cmp_eq_u32 s27, s90
    s_cselect_b32 s27, s89, s27
    v_mfma_f32_16x16x32_bf16 v[204:207], a[80:83], a[48:51], 0
    v_exp_f32 v200, v200
    v_mfma_f32_16x16x32_bf16 v[204:207], a[84:87], a[52:55], v[204:207]
    v_exp_f32 v201, v201
    v_mfma_f32_16x16x32_bf16 v[204:207], a[88:91], a[56:59], v[204:207]
    v_exp_f32 v202, v202
    v_mfma_f32_16x16x32_bf16 v[204:207], a[92:95], a[60:63], v[204:207]
    v_exp_f32 v203, v203
    v_bitop3_b32 v229, v229, -16, v239 bitop3:0x6a
    v_mfma_f32_16x16x32_bf16 a[156:159], a[188:191], a[192:195], a[156:159]
    buffer_load_dwordx4 v229, s[92:95], 0 offen offset:3072 sc1 lds
    v_mfma_f32_16x16x32_bf16 v[120:123], a[120:123], v[136:139], v[120:123]
    v_cvt_pk_bf16_f32 v186, v200, v201
    v_cvt_pk_bf16_f32 v187, v202, v203
    v_mfma_f32_16x16x32_bf16 v[120:123], a[124:127], v[152:155], v[120:123]
    ds_read_b64_tr_b16 a[108:109], v213 offset:24576
    ds_read_b64_tr_b16 a[110:111], v213 offset:28672
    v_mfma_f32_16x16x32_bf16 v[124:127], a[124:127], v[156:159], v[124:127]
    s_add_u32 s78, s78, 1
    s_cmp_ge_u32 s78, s3
    v_mfma_f32_16x16x32_bf16 v[124:127], a[120:123], v[140:143], v[124:127]
    s_waitcnt lgkmcnt(5)
    s_cbranch_scc1 L2_body1
    v_mfma_f32_16x16x32_bf16 v[192:195], a[64:67], a[0:3], 0
    v_exp_f32 v204, v204
    v_mfma_f32_16x16x32_bf16 v[192:195], a[68:71], a[4:7], v[192:195]
    v_exp_f32 v205, v205
    v_mfma_f32_16x16x32_bf16 v[192:195], a[72:75], a[8:11], v[192:195]
    v_exp_f32 v206, v206
    v_mfma_f32_16x16x32_bf16 v[192:195], a[76:79], a[12:15], v[192:195]
    v_exp_f32 v207, v207
    v_mfma_f32_16x16x32_bf16 v[0:3], a[96:99], v[160:163], v[0:3]
    v_cvt_pk_bf16_f32 v190, v204, v205
    v_cvt_pk_bf16_f32 v191, v206, v207
    v_mfma_f32_16x16x32_bf16 v[0:3], a[100:103], v[176:179], v[0:3]
    ds_read_b64_tr_b16 a[112:113], v214 offset:16384
    ds_read_b64_tr_b16 a[114:115], v214 offset:20480
    v_mfma_f32_16x16x32_bf16 v[4:7], a[100:103], v[180:183], v[4:7]
    ds_read_b128 a[80:83], v208 offset:36864
    ds_read_b128 a[84:87], v209 offset:36864
    v_mfma_f32_16x16x32_bf16 v[4:7], a[96:99], v[164:167], v[4:7]
    ds_read_b32 v255, v254
    ds_read_b32 v245, v241 offset:128
    v_mfma_f32_16x16x32_bf16 v[196:199], a[64:67], a[16:19], 0
    v_exp_f32 v192, v192
    v_mfma_f32_16x16x32_bf16 v[196:199], a[68:71], a[20:23], v[196:199]
    v_exp_f32 v193, v193
    v_mfma_f32_16x16x32_bf16 v[196:199], a[72:75], a[24:27], v[196:199]
    v_exp_f32 v194, v194
    v_mfma_f32_16x16x32_bf16 v[196:199], a[76:79], a[28:31], v[196:199]
    v_exp_f32 v195, v195
    v_mfma_f32_16x16x32_bf16 v[8:11], a[96:99], v[168:171], v[8:11]
    v_cvt_pk_bf16_f32 v128, v192, v193
    v_cvt_pk_bf16_f32 v129, v194, v195
    v_mfma_f32_16x16x32_bf16 v[8:11], a[100:103], v[184:187], v[8:11]
    ds_read_b64_tr_b16 a[116:117], v214 offset:24576
    ds_read_b64_tr_b16 a[118:119], v214 offset:28672
    v_mfma_f32_16x16x32_bf16 v[12:15], a[100:103], v[188:191], v[12:15]
    ds_read_b128 a[88:91], v210 offset:36864
    ds_read_b128 a[92:95], v211 offset:36864
    v_mfma_f32_16x16x32_bf16 v[12:15], a[96:99], v[172:175], v[12:15]
    s_waitcnt lgkmcnt(10)
    s_mov_b32 m0, s28
    v_mfma_f32_16x16x32_bf16 v[200:203], a[64:67], a[32:35], 0
    v_exp_f32 v196, v196
    v_mfma_f32_16x16x32_bf16 v[200:203], a[68:71], a[36:39], v[200:203]
    v_exp_f32 v197, v197
    v_mfma_f32_16x16x32_bf16 v[200:203], a[72:75], a[40:43], v[200:203]
    v_exp_f32 v198, v198
    v_mfma_f32_16x16x32_bf16 v[200:203], a[76:79], a[44:47], v[200:203]
    v_exp_f32 v199, v199
    v_mfma_f32_16x16x32_bf16 v[16:19], a[104:107], v[160:163], v[16:19]
    v_cvt_pk_bf16_f32 v132, v196, v197
    v_cvt_pk_bf16_f32 v133, v198, v199
    v_mfma_f32_16x16x32_bf16 v[16:19], a[108:111], v[176:179], v[16:19]
    ds_read_b64_tr_b16 a[120:121], v215 offset:16384
    ds_read_b64_tr_b16 a[122:123], v215 offset:20480
    v_mfma_f32_16x16x32_bf16 v[20:23], a[108:111], v[180:183], v[20:23]
    ds_write_b128 v243, a[196:199]
    ds_read2_b32 v[222:223], v240 offset0:64 offset1:68
    v_mfma_f32_16x16x32_bf16 v[20:23], a[104:107], v[164:167], v[20:23]
    s_waitcnt lgkmcnt(9)
    v_cmp_lt_u32 vcc, v255, v250
    v_mfma_f32_16x16x32_bf16 v[204:207], a[64:67], a[48:51], 0
    v_exp_f32 v200, v200
    v_mfma_f32_16x16x32_bf16 v[204:207], a[68:71], a[52:55], v[204:207]
    v_exp_f32 v201, v201
    v_mfma_f32_16x16x32_bf16 v[204:207], a[72:75], a[56:59], v[204:207]
    v_exp_f32 v202, v202
    v_mfma_f32_16x16x32_bf16 v[204:207], a[76:79], a[60:63], v[204:207]
    v_exp_f32 v203, v203
    v_mfma_f32_16x16x32_bf16 v[24:27], a[104:107], v[168:171], v[24:27]
    v_cvt_pk_bf16_f32 v136, v200, v201
    v_cvt_pk_bf16_f32 v137, v202, v203
    v_mfma_f32_16x16x32_bf16 v[24:27], a[108:111], v[184:187], v[24:27]
    ds_read_b64_tr_b16 a[124:125], v215 offset:24576
    ds_read_b64_tr_b16 a[126:127], v215 offset:28672
    v_mfma_f32_16x16x32_bf16 v[28:31], a[108:111], v[188:191], v[28:31]
    s_cbranch_vccnz L2_spg1F
L2_sprg1F:
    ds_read2_b32 v[224:225], v240 offset0:72 offset1:76
    v_mfma_f32_16x16x32_bf16 v[28:31], a[104:107], v[172:175], v[28:31]
    s_waitcnt lgkmcnt(7)
    ds_read2_b32 v[226:227], v240 offset0:80 offset1:84
    v_mfma_f32_16x16x32_bf16 v[192:195], a[80:83], a[0:3], 0
    v_exp_f32 v204, v204
    v_mfma_f32_16x16x32_bf16 v[192:195], a[84:87], a[4:7], v[192:195]
    v_exp_f32 v205, v205
    v_mfma_f32_16x16x32_bf16 v[192:195], a[88:91], a[8:11], v[192:195]
    v_exp_f32 v206, v206
    v_mfma_f32_16x16x32_bf16 v[192:195], a[92:95], a[12:15], v[192:195]
    v_exp_f32 v207, v207
    v_and_b32 v245, 31, v245
    v_lshl_add_u32 v245, v245, 6, v242
    v_mfma_f32_16x16x32_bf16 v[32:35], a[112:115], v[160:163], v[32:35]
    v_cvt_pk_bf16_f32 v140, v204, v205
    v_cvt_pk_bf16_f32 v141, v206, v207
    v_mfma_f32_16x16x32_bf16 v[32:35], a[116:119], v[176:179], v[32:35]
    ds_read_b64_tr_b16 a[96:97], v216 offset:16384
    ds_read_b64_tr_b16 a[98:99], v216 offset:20480
    v_mfma_f32_16x16x32_bf16 v[36:39], a[116:119], v[180:183], v[36:39]
    ds_read_b128 a[64:67], v208 offset:40960
    ds_read_b128 a[68:71], v209 offset:40960
    v_mfma_f32_16x16x32_bf16 v[36:39], a[112:115], v[164:167], v[36:39]
    buffer_load_dwordx4 v220, s[8:11], s27 offen offset:0 sc1 lds
    ds_write_b16 v245, v244
    v_mfma_f32_16x16x32_bf16 v[196:199], a[80:83], a[16:19], 0
    v_exp_f32 v192, v192
    v_mfma_f32_16x16x32_bf16 v[196:199], a[84:87], a[20:23], v[196:199]
    v_exp_f32 v193, v193
    v_mfma_f32_16x16x32_bf16 v[196:199], a[88:91], a[24:27], v[196:199]
    v_exp_f32 v194, v194
    v_mfma_f32_16x16x32_bf16 v[196:199], a[92:95], a[28:31], v[196:199]
    v_exp_f32 v195, v195
    v_mfma_f32_16x16x32_bf16 v[40:43], a[112:115], v[168:171], v[40:43]
    v_cvt_pk_bf16_f32 v130, v192, v193
    v_cvt_pk_bf16_f32 v131, v194, v195
    s_waitcnt vmcnt(1)
    v_mfma_f32_16x16x32_bf16 v[40:43], a[116:119], v[184:187], v[40:43]
    ds_read_b64_tr_b16 a[100:101], v216 offset:24576
    ds_read_b64_tr_b16 a[102:103], v216 offset:28672
    ds_read_b64_tr_b16 a[160:161], v230 offset:8192
    ds_read_b64_tr_b16 a[162:163], v230 offset:12288
    v_mfma_f32_16x16x32_bf16 v[44:47], a[116:119], v[188:191], v[44:47]
    ds_read_b128 a[72:75], v210 offset:40960
    ds_read_b128 a[76:79], v211 offset:40960
    ds_read_b64_tr_b16 a[164:165], v231 offset:8192
    ds_read_b64_tr_b16 a[166:167], v231 offset:12288
    ds_read_b128 a[192:195], v243
    v_mfma_f32_16x16x32_bf16 v[44:47], a[112:115], v[172:175], v[44:47]
    s_waitcnt lgkmcnt(15)
    buffer_load_dwordx4 v220, s[8:11], s27 offen offset:1024 sc1 lds
    v_add_u32 v250, 1, v250
    v_mfma_f32_16x16x32_bf16 v[200:203], a[80:83], a[32:35], 0
    v_exp_f32 v196, v196
    v_mfma_f32_16x16x32_bf16 v[200:203], a[84:87], a[36:39], v[200:203]
    v_exp_f32 v197, v197
    v_mfma_f32_16x16x32_bf16 v[200:203], a[88:91], a[40:43], v[200:203]
    v_exp_f32 v198, v198
    v_mfma_f32_16x16x32_bf16 v[200:203], a[92:95], a[44:47], v[200:203]
    v_exp_f32 v199, v199
    v_mfma_f32_16x16x32_bf16 v[48:51], a[120:123], v[160:163], v[48:51]
    v_cvt_pk_bf16_f32 v134, v196, v197
    v_cvt_pk_bf16_f32 v135, v198, v199
    v_mfma_f32_16x16x32_bf16 v[48:51], a[124:127], v[176:179], v[48:51]
    ds_read_b64_tr_b16 a[104:105], v217 offset:16384
    ds_read_b64_tr_b16 a[106:107], v217 offset:20480
    ds_read_b64_tr_b16 a[172:173], v233 offset:8192
    ds_read_b64_tr_b16 a[174:175], v233 offset:12288
    v_mfma_f32_16x16x32_bf16 v[52:55], a[124:127], v[180:183], v[52:55]
    ds_read_b64_tr_b16 a[168:169], v232 offset:8192
    ds_read_b64_tr_b16 a[170:171], v232 offset:12288
    v_mfma_f32_16x16x32_bf16 v[52:55], a[120:123], v[164:167], v[52:55]
    buffer_load_dwordx4 v220, s[8:11], s27 offen offset:2048 sc1 lds
    v_mfma_f32_16x16x32_bf16 v[204:207], a[80:83], a[48:51], 0
    v_exp_f32 v200, v200
    v_mfma_f32_16x16x32_bf16 v[204:207], a[84:87], a[52:55], v[204:207]
    v_exp_f32 v201, v201
    v_mfma_f32_16x16x32_bf16 v[204:207], a[88:91], a[56:59], v[204:207]
    v_exp_f32 v202, v202
    v_mfma_f32_16x16x32_bf16 v[204:207], a[92:95], a[60:63], v[204:207]
    v_exp_f32 v203, v203
    v_mfma_f32_16x16x32_bf16 v[56:59], a[120:123], v[168:171], v[56:59]
    v_cvt_pk_bf16_f32 v138, v200, v201
    v_cvt_pk_bf16_f32 v139, v202, v203
    v_mfma_f32_16x16x32_bf16 v[56:59], a[124:127], v[184:187], v[56:59]
    ds_read_b64_tr_b16 a[108:109], v217 offset:24576
    ds_read_b64_tr_b16 a[110:111], v217 offset:28672
    v_mfma_f32_16x16x32_bf16 v[60:63], a[124:127], v[188:191], v[60:63]
    buffer_load_dwordx4 v220, s[8:11], s27 offen offset:3072 sc1 lds
    v_mfma_f32_16x16x32_bf16 v[60:63], a[120:123], v[172:175], v[60:63]
    s_waitcnt lgkmcnt(11)
    s_waitcnt vmcnt(12)
    s_mov_b32 m0, s74
    v_mfma_f32_16x16x32_bf16 v[192:195], a[64:67], a[0:3], 0
    v_exp_f32 v204, v204
    v_mfma_f32_16x16x32_bf16 v[192:195], a[68:71], a[4:7], v[192:195]
    v_exp_f32 v205, v205
    v_mfma_f32_16x16x32_bf16 v[192:195], a[72:75], a[8:11], v[192:195]
    v_exp_f32 v206, v206
    v_mfma_f32_16x16x32_bf16 v[192:195], a[76:79], a[12:15], v[192:195]
    v_exp_f32 v207, v207
    v_bitop3_b32 v222, v222, -16, v238 bitop3:0x6a
    s_waitcnt lgkmcnt(8)
    v_mfma_f32_16x16x32_bf16 a[128:131], a[160:163], a[192:195], a[128:131]
    buffer_load_dwordx4 v222, s[92:95], s36 offen offset:0 sc1 lds
    ds_read_b64_tr_b16 a[176:177], v234 offset:8192
    v_mfma_f32_16x16x32_bf16 v[64:67], a[96:99], v[160:163], v[64:67]
    v_cvt_pk_bf16_f32 v142, v204, v205
    v_cvt_pk_bf16_f32 v143, v206, v207
    v_mfma_f32_16x16x32_bf16 v[64:67], a[100:103], v[176:179], v[64:67]
    ds_read_b64_tr_b16 a[112:113], v218 offset:16384
    ds_read_b64_tr_b16 a[114:115], v218 offset:20480
    v_mfma_f32_16x16x32_bf16 v[68:71], a[100:103], v[180:183], v[68:71]
    ds_read_b128 a[80:83], v208 offset:45056
    ds_read_b128 a[84:87], v209 offset:45056
    v_mfma_f32_16x16x32_bf16 v[68:71], a[96:99], v[164:167], v[68:71]
    ds_write_b32 v251, v250
    ds_read2_b32 v[228:229], v240 offset0:88 offset1:92
    v_mfma_f32_16x16x32_bf16 v[196:199], a[64:67], a[16:19], 0
    v_exp_f32 v192, v192
    v_mfma_f32_16x16x32_bf16 v[196:199], a[68:71], a[20:23], v[196:199]
    v_exp_f32 v193, v193
    v_mfma_f32_16x16x32_bf16 v[196:199], a[72:75], a[24:27], v[196:199]
    v_exp_f32 v194, v194
    v_mfma_f32_16x16x32_bf16 v[196:199], a[76:79], a[28:31], v[196:199]
    v_exp_f32 v195, v195
    v_bitop3_b32 v223, v223, -16, v239 bitop3:0x6a
    v_mfma_f32_16x16x32_bf16 a[132:135], a[164:167], a[192:195], a[132:135]
    buffer_load_dwordx4 v223, s[92:95], s37 offen offset:1024 sc1 lds
    ds_read_b64_tr_b16 a[178:179], v234 offset:12288
    v_mfma_f32_16x16x32_bf16 v[72:75], a[96:99], v[168:171], v[72:75]
    v_cvt_pk_bf16_f32 v144, v192, v193
    v_cvt_pk_bf16_f32 v145, v194, v195
    v_mfma_f32_16x16x32_bf16 v[72:75], a[100:103], v[184:187], v[72:75]
    ds_read_b64_tr_b16 a[116:117], v218 offset:24576
    ds_read_b64_tr_b16 a[118:119], v218 offset:28672
    v_mfma_f32_16x16x32_bf16 v[76:79], a[100:103], v[188:191], v[76:79]
    ds_read_b128 a[88:91], v210 offset:45056
    ds_read_b128 a[92:95], v211 offset:45056
    v_mfma_f32_16x16x32_bf16 v[76:79], a[96:99], v[172:175], v[76:79]
    s_waitcnt lgkmcnt(12)
    ds_read_b64_tr_b16 a[182:183], v235 offset:12288
    v_mfma_f32_16x16x32_bf16 v[200:203], a[64:67], a[32:35], 0
    v_exp_f32 v196, v196
    v_mfma_f32_16x16x32_bf16 v[200:203], a[68:71], a[36:39], v[200:203]
    v_exp_f32 v197, v197
    v_mfma_f32_16x16x32_bf16 v[200:203], a[72:75], a[40:43], v[200:203]
    v_exp_f32 v198, v198
    v_mfma_f32_16x16x32_bf16 v[200:203], a[76:79], a[44:47], v[200:203]
    v_exp_f32 v199, v199
    v_bitop3_b32 v224, v224, -16, v238 bitop3:0x6a
    v_mfma_f32_16x16x32_bf16 a[136:139], a[168:171], a[192:195], a[136:139]
    buffer_load_dwordx4 v224, s[92:95], s38 offen offset:2048 sc1 lds
    ds_read_b64_tr_b16 a[180:181], v235 offset:8192
    v_mfma_f32_16x16x32_bf16 v[80:83], a[104:107], v[160:163], v[80:83]
    v_cvt_pk_bf16_f32 v148, v196, v197
    v_cvt_pk_bf16_f32 v149, v198, v199
    v_mfma_f32_16x16x32_bf16 v[80:83], a[108:111], v[176:179], v[80:83]
    ds_read_b64_tr_b16 a[120:121], v219 offset:16384
    ds_read_b64_tr_b16 a[122:123], v219 offset:20480
    ds_read_b64_tr_b16 a[190:191], v237 offset:12288
    v_mfma_f32_16x16x32_bf16 v[84:87], a[108:111], v[180:183], v[84:87]
    ds_read_b32 v255, v254
    ds_read_b64_tr_b16 a[184:185], v236 offset:8192
    v_mfma_f32_16x16x32_bf16 v[84:87], a[104:107], v[164:167], v[84:87]
    s_add_u32 s27, s27, 16384
    ds_read_b64_tr_b16 a[186:187], v236 offset:12288
    v_mfma_f32_16x16x32_bf16 v[204:207], a[64:67], a[48:51], 0
    v_exp_f32 v200, v200
    v_mfma_f32_16x16x32_bf16 v[204:207], a[68:71], a[52:55], v[204:207]
    v_exp_f32 v201, v201
    v_mfma_f32_16x16x32_bf16 v[204:207], a[72:75], a[56:59], v[204:207]
    v_exp_f32 v202, v202
    v_mfma_f32_16x16x32_bf16 v[204:207], a[76:79], a[60:63], v[204:207]
    v_exp_f32 v203, v203
    v_bitop3_b32 v225, v225, -16, v239 bitop3:0x6a
    v_mfma_f32_16x16x32_bf16 a[140:143], a[172:175], a[192:195], a[140:143]
    buffer_load_dwordx4 v225, s[92:95], 0 offen offset:3072 sc1 lds
    ds_read_b64_tr_b16 a[188:189], v237 offset:8192
    v_mfma_f32_16x16x32_bf16 v[88:91], a[104:107], v[168:171], v[88:91]
    v_cvt_pk_bf16_f32 v152, v200, v201
    v_cvt_pk_bf16_f32 v153, v202, v203
    v_mfma_f32_16x16x32_bf16 v[88:91], a[108:111], v[184:187], v[88:91]
    ds_read_b64_tr_b16 a[124:125], v219 offset:24576
    ds_read_b64_tr_b16 a[126:127], v219 offset:28672
    v_mfma_f32_16x16x32_bf16 v[92:95], a[108:111], v[188:191], v[92:95]
    s_waitcnt lgkmcnt(5)
    v_cmp_lt_u32 vcc, v255, v250
    v_mfma_f32_16x16x32_bf16 v[92:95], a[104:107], v[172:175], v[92:95]
    s_cbranch_vccnz L2_spg1L
L2_sprg1L:
    s_add_u32 m0, s74, 4096
    v_mfma_f32_16x16x32_bf16 v[192:195], a[80:83], a[0:3], 0
    v_exp_f32 v204, v204
    v_mfma_f32_16x16x32_bf16 v[192:195], a[84:87], a[4:7], v[192:195]
    v_exp_f32 v205, v205
    v_mfma_f32_16x16x32_bf16 v[192:195], a[88:91], a[8:11], v[192:195]
    v_exp_f32 v206, v206
    v_mfma_f32_16x16x32_bf16 v[192:195], a[92:95], a[12:15], v[192:195]
    v_exp_f32 v207, v207
    v_bitop3_b32 v226, v226, -16, v238 bitop3:0x6a
    v_mfma_f32_16x16x32_bf16 a[144:147], a[176:179], a[192:195], a[144:147]
    buffer_load_dwordx4 v226, s[92:95], s36 offen offset:0 sc1 lds
    v_mfma_f32_16x16x32_bf16 v[96:99], a[112:115], v[160:163], v[96:99]
    v_cvt_pk_bf16_f32 v156, v204, v205
    v_cvt_pk_bf16_f32 v157, v206, v207
    v_mfma_f32_16x16x32_bf16 v[96:99], a[116:119], v[176:179], v[96:99]
    ds_read_b64_tr_b16 a[96:97], v212 offset:32768
    ds_read_b64_tr_b16 a[98:99], v212 offset:36864
    v_mfma_f32_16x16x32_bf16 v[100:103], a[116:119], v[180:183], v[100:103]
    ds_read_b128 a[64:67], v208 offset:49152
    ds_read_b128 a[68:71], v209 offset:49152
    v_mfma_f32_16x16x32_bf16 v[100:103], a[112:115], v[164:167], v[100:103]
    v_add_u32 v250, 1, v250
    v_mfma_f32_16x16x32_bf16 v[196:199], a[80:83], a[16:19], 0
    v_exp_f32 v192, v192
    v_mfma_f32_16x16x32_bf16 v[196:199], a[84:87], a[20:23], v[196:199]
    v_exp_f32 v193, v193
    v_mfma_f32_16x16x32_bf16 v[196:199], a[88:91], a[24:27], v[196:199]
    v_exp_f32 v194, v194
    v_mfma_f32_16x16x32_bf16 v[196:199], a[92:95], a[28:31], v[196:199]
    v_exp_f32 v195, v195
    v_bitop3_b32 v227, v227, -16, v239 bitop3:0x6a
    v_mfma_f32_16x16x32_bf16 a[148:151], a[180:183], a[192:195], a[148:151]
    buffer_load_dwordx4 v227, s[92:95], s37 offen offset:1024 sc1 lds
    v_mfma_f32_16x16x32_bf16 v[104:107], a[112:115], v[168:171], v[104:107]
    v_cvt_pk_bf16_f32 v146, v192, v193
    v_cvt_pk_bf16_f32 v147, v194, v195
    v_mfma_f32_16x16x32_bf16 v[104:107], a[116:119], v[184:187], v[104:107]
    ds_read_b64_tr_b16 a[100:101], v212 offset:40960
    ds_read_b64_tr_b16 a[102:103], v212 offset:45056
    v_mfma_f32_16x16x32_bf16 v[108:111], a[116:119], v[188:191], v[108:111]
    ds_read_b128 a[72:75], v210 offset:49152
    ds_read_b128 a[76:79], v211 offset:49152
    v_mfma_f32_16x16x32_bf16 v[108:111], a[112:115], v[172:175], v[108:111]
    s_waitcnt lgkmcnt(8)
    ds_write_b32 v251, v250
    v_mfma_f32_16x16x32_bf16 v[200:203], a[80:83], a[32:35], 0
    v_exp_f32 v196, v196
    v_mfma_f32_16x16x32_bf16 v[200:203], a[84:87], a[36:39], v[200:203]
    v_exp_f32 v197, v197
    v_mfma_f32_16x16x32_bf16 v[200:203], a[88:91], a[40:43], v[200:203]
    v_exp_f32 v198, v198
    v_mfma_f32_16x16x32_bf16 v[200:203], a[92:95], a[44:47], v[200:203]
    v_exp_f32 v199, v199
    v_bitop3_b32 v228, v228, -16, v238 bitop3:0x6a
    v_mfma_f32_16x16x32_bf16 a[152:155], a[184:187], a[192:195], a[152:155]
    buffer_load_dwordx4 v228, s[92:95], s38 offen offset:2048 sc1 lds
    v_mfma_f32_16x16x32_bf16 v[112:115], a[120:123], v[160:163], v[112:115]
    v_cvt_pk_bf16_f32 v150, v196, v197
    v_cvt_pk_bf16_f32 v151, v198, v199
    v_mfma_f32_16x16x32_bf16 v[112:115], a[124:127], v[176:179], v[112:115]
    ds_read_b64_tr_b16 a[104:105], v213 offset:32768
    ds_read_b64_tr_b16 a[106:107], v213 offset:36864
    v_mfma_f32_16x16x32_bf16 v[116:119], a[124:127], v[180:183], v[116:119]
    s_cmp_eq_u32 s27, s89
    s_cselect_b32 s27, s88, s27
    v_mfma_f32_16x16x32_bf16 v[116:119], a[120:123], v[164:167], v[116:119]
    s_cmp_eq_u32 s27, s90
    s_cselect_b32 s27, s89, s27
    v_mfma_f32_16x16x32_bf16 v[204:207], a[80:83], a[48:51], 0
    v_exp_f32 v200, v200
    v_mfma_f32_16x16x32_bf16 v[204:207], a[84:87], a[52:55], v[204:207]
    v_exp_f32 v201, v201
    v_mfma_f32_16x16x32_bf16 v[204:207], a[88:91], a[56:59], v[204:207]
    v_exp_f32 v202, v202
    v_mfma_f32_16x16x32_bf16 v[204:207], a[92:95], a[60:63], v[204:207]
    v_exp_f32 v203, v203
    v_bitop3_b32 v229, v229, -16, v239 bitop3:0x6a
    v_mfma_f32_16x16x32_bf16 a[156:159], a[188:191], a[192:195], a[156:159]
    buffer_load_dwordx4 v229, s[92:95], 0 offen offset:3072 sc1 lds
    v_mfma_f32_16x16x32_bf16 v[120:123], a[120:123], v[168:171], v[120:123]
    v_cvt_pk_bf16_f32 v154, v200, v201
    v_cvt_pk_bf16_f32 v155, v202, v203
    v_mfma_f32_16x16x32_bf16 v[120:123], a[124:127], v[184:187], v[120:123]
    ds_read_b64_tr_b16 a[108:109], v213 offset:40960
    ds_read_b64_tr_b16 a[110:111], v213 offset:45056
    v_mfma_f32_16x16x32_bf16 v[124:127], a[124:127], v[188:191], v[124:127]
    s_add_u32 s78, s78, 1
    s_cmp_ge_u32 s78, s3
    v_mfma_f32_16x16x32_bf16 v[124:127], a[120:123], v[172:175], v[124:127]
    s_waitcnt lgkmcnt(5)
    s_cbranch_scc1 L2_body2
    v_mfma_f32_16x16x32_bf16 v[192:195], a[64:67], a[0:3], 0
    v_exp_f32 v204, v204
    v_mfma_f32_16x16x32_bf16 v[192:195], a[68:71], a[4:7], v[192:195]
    v_exp_f32 v205, v205
    v_mfma_f32_16x16x32_bf16 v[192:195], a[72:75], a[8:11], v[192:195]
    v_exp_f32 v206, v206
    v_mfma_f32_16x16x32_bf16 v[192:195], a[76:79], a[12:15], v[192:195]
    v_exp_f32 v207, v207
    v_mfma_f32_16x16x32_bf16 v[0:3], a[96:99], v[128:131], v[0:3]
    v_cvt_pk_bf16_f32 v158, v204, v205
    v_cvt_pk_bf16_f32 v159, v206, v207
    v_mfma_f32_16x16x32_bf16 v[0:3], a[100:103], v[144:147], v[0:3]
    ds_read_b64_tr_b16 a[112:113], v214 offset:32768
    ds_read_b64_tr_b16 a[114:115], v214 offset:36864
    v_mfma_f32_16x16x32_bf16 v[4:7], a[100:103], v[148:151], v[4:7]
    ds_read_b128 a[80:83], v208 offset:53248
    ds_read_b128 a[84:87], v209 offset:53248
    v_mfma_f32_16x16x32_bf16 v[4:7], a[96:99], v[132:135], v[4:7]
    ds_read_b32 v255, v254
    ds_read_b32 v245, v241 offset:256
    v_mfma_f32_16x16x32_bf16 v[196:199], a[64:67], a[16:19], 0
    v_exp_f32 v192, v192
    v_mfma_f32_16x16x32_bf16 v[196:199], a[68:71], a[20:23], v[196:199]
    v_exp_f32 v193, v193
    v_mfma_f32_16x16x32_bf16 v[196:199], a[72:75], a[24:27], v[196:199]
    v_exp_f32 v194, v194
    v_mfma_f32_16x16x32_bf16 v[196:199], a[76:79], a[28:31], v[196:199]
    v_exp_f32 v195, v195
    v_mfma_f32_16x16x32_bf16 v[8:11], a[96:99], v[136:139], v[8:11]
    v_cvt_pk_bf16_f32 v160, v192, v193
    v_cvt_pk_bf16_f32 v161, v194, v195
    v_mfma_f32_16x16x32_bf16 v[8:11], a[100:103], v[152:155], v[8:11]
    ds_read_b64_tr_b16 a[116:117], v214 offset:40960
    ds_read_b64_tr_b16 a[118:119], v214 offset:45056
    v_mfma_f32_16x16x32_bf16 v[12:15], a[100:103], v[156:159], v[12:15]
    ds_read_b128 a[88:91], v210 offset:53248
    ds_read_b128 a[92:95], v211 offset:53248
    v_mfma_f32_16x16x32_bf16 v[12:15], a[96:99], v[140:143], v[12:15]
    s_waitcnt lgkmcnt(10)
    s_mov_b32 m0, s29
    v_mfma_f32_16x16x32_bf16 v[200:203], a[64:67], a[32:35], 0
    v_exp_f32 v196, v196
    v_mfma_f32_16x16x32_bf16 v[200:203], a[68:71], a[36:39], v[200:203]
    v_exp_f32 v197, v197
    v_mfma_f32_16x16x32_bf16 v[200:203], a[72:75], a[40:43], v[200:203]
    v_exp_f32 v198, v198
    v_mfma_f32_16x16x32_bf16 v[200:203], a[76:79], a[44:47], v[200:203]
    v_exp_f32 v199, v199
    v_mfma_f32_16x16x32_bf16 v[16:19], a[104:107], v[128:131], v[16:19]
    v_cvt_pk_bf16_f32 v164, v196, v197
    v_cvt_pk_bf16_f32 v165, v198, v199
    v_mfma_f32_16x16x32_bf16 v[16:19], a[108:111], v[144:147], v[16:19]
    ds_read_b64_tr_b16 a[120:121], v215 offset:32768
    ds_read_b64_tr_b16 a[122:123], v215 offset:36864
    v_mfma_f32_16x16x32_bf16 v[20:23], a[108:111], v[148:151], v[20:23]
    ds_write_b128 v243, a[196:199]
    ds_read2_b32 v[222:223], v240 offset0:96 offset1:100
    v_mfma_f32_16x16x32_bf16 v[20:23], a[104:107], v[132:135], v[20:23]
    s_waitcnt lgkmcnt(9)
    v_cmp_lt_u32 vcc, v255, v250
    v_mfma_f32_16x16x32_bf16 v[204:207], a[64:67], a[48:51], 0
    v_exp_f32 v200, v200
    v_mfma_f32_16x16x32_bf16 v[204:207], a[68:71], a[52:55], v[204:207]
    v_exp_f32 v201, v201
    v_mfma_f32_16x16x32_bf16 v[204:207], a[72:75], a[56:59], v[204:207]
    v_exp_f32 v202, v202
    v_mfma_f32_16x16x32_bf16 v[204:207], a[76:79], a[60:63], v[204:207]
    v_exp_f32 v203, v203
    v_mfma_f32_16x16x32_bf16 v[24:27], a[104:107], v[136:139], v[24:27]
    v_cvt_pk_bf16_f32 v168, v200, v201
    v_cvt_pk_bf16_f32 v169, v202, v203
    v_mfma_f32_16x16x32_bf16 v[24:27], a[108:111], v[152:155], v[24:27]
    ds_read_b64_tr_b16 a[124:125], v215 offset:40960
    ds_read_b64_tr_b16 a[126:127], v215 offset:45056
    v_mfma_f32_16x16x32_bf16 v[28:31], a[108:111], v[156:159], v[28:31]
    s_cbranch_vccnz L2_spg2F
L2_sprg2F:
    ds_read2_b32 v[224:225], v240 offset0:104 offset1:108
    v_mfma_f32_16x16x32_bf16 v[28:31], a[104:107], v[140:143], v[28:31]
    s_waitcnt lgkmcnt(7)
    ds_read2_b32 v[226:227], v240 offset0:112 offset1:116
    v_mfma_f32_16x16x32_bf16 v[192:195], a[80:83], a[0:3], 0
    v_exp_f32 v204, v204
    v_mfma_f32_16x16x32_bf16 v[192:195], a[84:87], a[4:7], v[192:195]
    v_exp_f32 v205, v205
    v_mfma_f32_16x16x32_bf16 v[192:195], a[88:91], a[8:11], v[192:195]
    v_exp_f32 v206, v206
    v_mfma_f32_16x16x32_bf16 v[192:195], a[92:95], a[12:15], v[192:195]
    v_exp_f32 v207, v207
    v_and_b32 v245, 31, v245
    v_lshl_add_u32 v245, v245, 6, v242
    v_mfma_f32_16x16x32_bf16 v[32:35], a[112:115], v[128:131], v[32:35]
    v_cvt_pk_bf16_f32 v172, v204, v205
    v_cvt_pk_bf16_f32 v173, v206, v207
    v_mfma_f32_16x16x32_bf16 v[32:35], a[116:119], v[144:147], v[32:35]
    ds_read_b64_tr_b16 a[96:97], v216 offset:32768
    ds_read_b64_tr_b16 a[98:99], v216 offset:36864
    v_mfma_f32_16x16x32_bf16 v[36:39], a[116:119], v[148:151], v[36:39]
    ds_read_b128 a[64:67], v208 offset:57344
    ds_read_b128 a[68:71], v209 offset:57344
    v_mfma_f32_16x16x32_bf16 v[36:39], a[112:115], v[132:135], v[36:39]
    buffer_load_dwordx4 v220, s[8:11], s27 offen offset:0 sc1 lds
    ds_write_b16 v245, v244
    v_mfma_f32_16x16x32_bf16 v[196:199], a[80:83], a[16:19], 0
    v_exp_f32 v192, v192
    v_mfma_f32_16x16x32_bf16 v[196:199], a[84:87], a[20:23], v[196:199]
    v_exp_f32 v193, v193
    v_mfma_f32_16x16x32_bf16 v[196:199], a[88:91], a[24:27], v[196:199]
    v_exp_f32 v194, v194
    v_mfma_f32_16x16x32_bf16 v[196:199], a[92:95], a[28:31], v[196:199]
    v_exp_f32 v195, v195
    v_mfma_f32_16x16x32_bf16 v[40:43], a[112:115], v[136:139], v[40:43]
    v_cvt_pk_bf16_f32 v162, v192, v193
    v_cvt_pk_bf16_f32 v163, v194, v195
    s_waitcnt vmcnt(1)
    v_mfma_f32_16x16x32_bf16 v[40:43], a[116:119], v[152:155], v[40:43]
    ds_read_b64_tr_b16 a[100:101], v216 offset:40960
    ds_read_b64_tr_b16 a[102:103], v216 offset:45056
    ds_read_b64_tr_b16 a[160:161], v230 offset:0
    ds_read_b64_tr_b16 a[162:163], v230 offset:4096
    v_mfma_f32_16x16x32_bf16 v[44:47], a[116:119], v[156:159], v[44:47]
    ds_read_b128 a[72:75], v210 offset:57344
    ds_read_b128 a[76:79], v211 offset:57344
    ds_read_b64_tr_b16 a[164:165], v231 offset:0
    ds_read_b64_tr_b16 a[166:167], v231 offset:4096
    ds_read_b128 a[192:195], v243
    v_mfma_f32_16x16x32_bf16 v[44:47], a[112:115], v[140:143], v[44:47]
    s_waitcnt lgkmcnt(15)
    buffer_load_dwordx4 v220, s[8:11], s27 offen offset:1024 sc1 lds
    v_add_u32 v250, 1, v250
    v_mfma_f32_16x16x32_bf16 v[200:203], a[80:83], a[32:35], 0
    v_exp_f32 v196, v196
    v_mfma_f32_16x16x32_bf16 v[200:203], a[84:87], a[36:39], v[200:203]
    v_exp_f32 v197, v197
    v_mfma_f32_16x16x32_bf16 v[200:203], a[88:91], a[40:43], v[200:203]
    v_exp_f32 v198, v198
    v_mfma_f32_16x16x32_bf16 v[200:203], a[92:95], a[44:47], v[200:203]
    v_exp_f32 v199, v199
    v_mfma_f32_16x16x32_bf16 v[48:51], a[120:123], v[128:131], v[48:51]
    v_cvt_pk_bf16_f32 v166, v196, v197
    v_cvt_pk_bf16_f32 v167, v198, v199
    v_mfma_f32_16x16x32_bf16 v[48:51], a[124:127], v[144:147], v[48:51]
    ds_read_b64_tr_b16 a[104:105], v217 offset:32768
    ds_read_b64_tr_b16 a[106:107], v217 offset:36864
    ds_read_b64_tr_b16 a[172:173], v233 offset:0
    ds_read_b64_tr_b16 a[174:175], v233 offset:4096
    v_mfma_f32_16x16x32_bf16 v[52:55], a[124:127], v[148:151], v[52:55]
    ds_read_b64_tr_b16 a[168:169], v232 offset:0
    ds_read_b64_tr_b16 a[170:171], v232 offset:4096
    v_mfma_f32_16x16x32_bf16 v[52:55], a[120:123], v[132:135], v[52:55]
    buffer_load_dwordx4 v220, s[8:11], s27 offen offset:2048 sc1 lds
    v_mfma_f32_16x16x32_bf16 v[204:207], a[80:83], a[48:51], 0
    v_exp_f32 v200, v200
    v_mfma_f32_16x16x32_bf16 v[204:207], a[84:87], a[52:55], v[204:207]
    v_exp_f32 v201, v201
    v_mfma_f32_16x16x32_bf16 v[204:207], a[88:91], a[56:59], v[204:207]
    v_exp_f32 v202, v202
    v_mfma_f32_16x16x32_bf16 v[204:207], a[92:95], a[60:63], v[204:207]
    v_exp_f32 v203, v203
    v_mfma_f32_16x16x32_bf16 v[56:59], a[120:123], v[136:139], v[56:59]
    v_cvt_pk_bf16_f32 v170, v200, v201
    v_cvt_pk_bf16_f32 v171, v202, v203
    v_mfma_f32_16x16x32_bf16 v[56:59], a[124:127], v[152:155], v[56:59]
    ds_read_b64_tr_b16 a[108:109], v217 offset:40960
    ds_read_b64_tr_b16 a[110:111], v217 offset:45056
    v_mfma_f32_16x16x32_bf16 v[60:63], a[124:127], v[156:159], v[60:63]
    buffer_load_dwordx4 v220, s[8:11], s27 offen offset:3072 sc1 lds
    v_mfma_f32_16x16x32_bf16 v[60:63], a[120:123], v[140:143], v[60:63]
    s_waitcnt lgkmcnt(11)
    s_waitcnt vmcnt(12)
    s_mov_b32 m0, s75
    v_mfma_f32_16x16x32_bf16 v[192:195], a[64:67], a[0:3], 0
    v_exp_f32 v204, v204
    v_mfma_f32_16x16x32_bf16 v[192:195], a[68:71], a[4:7], v[192:195]
    v_exp_f32 v205, v205
    v_mfma_f32_16x16x32_bf16 v[192:195], a[72:75], a[8:11], v[192:195]
    v_exp_f32 v206, v206
    v_mfma_f32_16x16x32_bf16 v[192:195], a[76:79], a[12:15], v[192:195]
    v_exp_f32 v207, v207
    v_bitop3_b32 v222, v222, -16, v238 bitop3:0x6a
    s_waitcnt lgkmcnt(8)
    v_mfma_f32_16x16x32_bf16 a[128:131], a[160:163], a[192:195], a[128:131]
    buffer_load_dwordx4 v222, s[92:95], s36 offen offset:0 sc1 lds
    ds_read_b64_tr_b16 a[176:177], v234 offset:0
    v_mfma_f32_16x16x32_bf16 v[64:67], a[96:99], v[128:131], v[64:67]
    v_cvt_pk_bf16_f32 v174, v204, v205
    v_cvt_pk_bf16_f32 v175, v206, v207
    v_mfma_f32_16x16x32_bf16 v[64:67], a[100:103], v[144:147], v[64:67]
    ds_read_b64_tr_b16 a[112:113], v218 offset:32768
    ds_read_b64_tr_b16 a[114:115], v218 offset:36864
    v_mfma_f32_16x16x32_bf16 v[68:71], a[100:103], v[148:151], v[68:71]
    ds_read_b128 a[80:83], v208 offset:61440
    ds_read_b128 a[84:87], v209 offset:61440
    v_mfma_f32_16x16x32_bf16 v[68:71], a[96:99], v[132:135], v[68:71]
    ds_write_b32 v251, v250
    ds_read2_b32 v[228:229], v240 offset0:120 offset1:124
    v_mfma_f32_16x16x32_bf16 v[196:199], a[64:67], a[16:19], 0
    v_exp_f32 v192, v192
    v_mfma_f32_16x16x32_bf16 v[196:199], a[68:71], a[20:23], v[196:199]
    v_exp_f32 v193, v193
    v_mfma_f32_16x16x32_bf16 v[196:199], a[72:75], a[24:27], v[196:199]
    v_exp_f32 v194, v194
    v_mfma_f32_16x16x32_bf16 v[196:199], a[76:79], a[28:31], v[196:199]
    v_exp_f32 v195, v195
    v_bitop3_b32 v223, v223, -16, v239 bitop3:0x6a
    v_mfma_f32_16x16x32_bf16 a[132:135], a[164:167], a[192:195], a[132:135]
    buffer_load_dwordx4 v223, s[92:95], s37 offen offset:1024 sc1 lds
    ds_read_b64_tr_b16 a[178:179], v234 offset:4096
    v_mfma_f32_16x16x32_bf16 v[72:75], a[96:99], v[136:139], v[72:75]
    v_cvt_pk_bf16_f32 v176, v192, v193
    v_cvt_pk_bf16_f32 v177, v194, v195
    v_mfma_f32_16x16x32_bf16 v[72:75], a[100:103], v[152:155], v[72:75]
    ds_read_b64_tr_b16 a[116:117], v218 offset:40960
    ds_read_b64_tr_b16 a[118:119], v218 offset:45056
    v_mfma_f32_16x16x32_bf16 v[76:79], a[100:103], v[156:159], v[76:79]
    ds_read_b128 a[88:91], v210 offset:61440
    ds_read_b128 a[92:95], v211 offset:61440
    v_mfma_f32_16x16x32_bf16 v[76:79], a[96:99], v[140:143], v[76:79]
    s_waitcnt lgkmcnt(12)
    ds_read_b64_tr_b16 a[182:183], v235 offset:4096
    v_mfma_f32_16x16x32_bf16 v[200:203], a[64:67], a[32:35], 0
    v_exp_f32 v196, v196
    v_mfma_f32_16x16x32_bf16 v[200:203], a[68:71], a[36:39], v[200:203]
    v_exp_f32 v197, v197
    v_mfma_f32_16x16x32_bf16 v[200:203], a[72:75], a[40:43], v[200:203]
    v_exp_f32 v198, v198
    v_mfma_f32_16x16x32_bf16 v[200:203], a[76:79], a[44:47], v[200:203]
    v_exp_f32 v199, v199
    v_bitop3_b32 v224, v224, -16, v238 bitop3:0x6a
    v_mfma_f32_16x16x32_bf16 a[136:139], a[168:171], a[192:195], a[136:139]
    buffer_load_dwordx4 v224, s[92:95], s38 offen offset:2048 sc1 lds
    ds_read_b64_tr_b16 a[180:181], v235 offset:0
    v_mfma_f32_16x16x32_bf16 v[80:83], a[104:107], v[128:131], v[80:83]
    v_cvt_pk_bf16_f32 v180, v196, v197
    v_cvt_pk_bf16_f32 v181, v198, v199
    v_mfma_f32_16x16x32_bf16 v[80:83], a[108:111], v[144:147], v[80:83]
    ds_read_b64_tr_b16 a[120:121], v219 offset:32768
    ds_read_b64_tr_b16 a[122:123], v219 offset:36864
    ds_read_b64_tr_b16 a[190:191], v237 offset:4096
    v_mfma_f32_16x16x32_bf16 v[84:87], a[108:111], v[148:151], v[84:87]
    ds_read_b32 v255, v254
    ds_read_b64_tr_b16 a[184:185], v236 offset:0
    v_mfma_f32_16x16x32_bf16 v[84:87], a[104:107], v[132:135], v[84:87]
    s_add_u32 s27, s27, 16384
    ds_read_b64_tr_b16 a[186:187], v236 offset:4096
    v_mfma_f32_16x16x32_bf16 v[204:207], a[64:67], a[48:51], 0
    v_exp_f32 v200, v200
    v_mfma_f32_16x16x32_bf16 v[204:207], a[68:71], a[52:55], v[204:207]
    v_exp_f32 v201, v201
    v_mfma_f32_16x16x32_bf16 v[204:207], a[72:75], a[56:59], v[204:207]
    v_exp_f32 v202, v202
    v_mfma_f32_16x16x32_bf16 v[204:207], a[76:79], a[60:63], v[204:207]
    v_exp_f32 v203, v203
    v_bitop3_b32 v225, v225, -16, v239 bitop3:0x6a
    v_mfma_f32_16x16x32_bf16 a[140:143], a[172:175], a[192:195], a[140:143]
    buffer_load_dwordx4 v225, s[92:95], 0 offen offset:3072 sc1 lds
    ds_read_b64_tr_b16 a[188:189], v237 offset:0
    v_mfma_f32_16x16x32_bf16 v[88:91], a[104:107], v[136:139], v[88:91]
    v_cvt_pk_bf16_f32 v184, v200, v201
    v_cvt_pk_bf16_f32 v185, v202, v203
    v_mfma_f32_16x16x32_bf16 v[88:91], a[108:111], v[152:155], v[88:91]
    ds_read_b64_tr_b16 a[124:125], v219 offset:40960
    ds_read_b64_tr_b16 a[126:127], v219 offset:45056
    v_mfma_f32_16x16x32_bf16 v[92:95], a[108:111], v[156:159], v[92:95]
    s_waitcnt lgkmcnt(5)
    v_cmp_lt_u32 vcc, v255, v250
    v_mfma_f32_16x16x32_bf16 v[92:95], a[104:107], v[140:143], v[92:95]
    s_cbranch_vccnz L2_spg2L
L2_sprg2L:
    s_add_u32 m0, s75, 4096
    v_mfma_f32_16x16x32_bf16 v[192:195], a[80:83], a[0:3], 0
    v_exp_f32 v204, v204
    v_mfma_f32_16x16x32_bf16 v[192:195], a[84:87], a[4:7], v[192:195]
    v_exp_f32 v205, v205
    v_mfma_f32_16x16x32_bf16 v[192:195], a[88:91], a[8:11], v[192:195]
    v_exp_f32 v206, v206
    v_mfma_f32_16x16x32_bf16 v[192:195], a[92:95], a[12:15], v[192:195]
    v_exp_f32 v207, v207
    v_bitop3_b32 v226, v226, -16, v238 bitop3:0x6a
    v_mfma_f32_16x16x32_bf16 a[144:147], a[176:179], a[192:195], a[144:147]
    buffer_load_dwordx4 v226, s[92:95], s36 offen offset:0 sc1 lds
    v_mfma_f32_16x16x32_bf16 v[96:99], a[112:115], v[128:131], v[96:99]
    v_cvt_pk_bf16_f32 v188, v204, v205
    v_cvt_pk_bf16_f32 v189, v206, v207
    v_mfma_f32_16x16x32_bf16 v[96:99], a[116:119], v[144:147], v[96:99]
    ds_read_b64_tr_b16 a[96:97], v212 offset:49152
    ds_read_b64_tr_b16 a[98:99], v212 offset:53248
    v_mfma_f32_16x16x32_bf16 v[100:103], a[116:119], v[148:151], v[100:103]
    ds_read_b128 a[64:67], v208 offset:0
    ds_read_b128 a[68:71], v209 offset:0
    v_mfma_f32_16x16x32_bf16 v[100:103], a[112:115], v[132:135], v[100:103]
    v_add_u32 v250, 1, v250
    v_mfma_f32_16x16x32_bf16 v[196:199], a[80:83], a[16:19], 0
    v_exp_f32 v192, v192
    v_mfma_f32_16x16x32_bf16 v[196:199], a[84:87], a[20:23], v[196:199]
    v_exp_f32 v193, v193
    v_mfma_f32_16x16x32_bf16 v[196:199], a[88:91], a[24:27], v[196:199]
    v_exp_f32 v194, v194
    v_mfma_f32_16x16x32_bf16 v[196:199], a[92:95], a[28:31], v[196:199]
    v_exp_f32 v195, v195
    v_bitop3_b32 v227, v227, -16, v239 bitop3:0x6a
    v_mfma_f32_16x16x32_bf16 a[148:151], a[180:183], a[192:195], a[148:151]
    buffer_load_dwordx4 v227, s[92:95], s37 offen offset:1024 sc1 lds
    v_mfma_f32_16x16x32_bf16 v[104:107], a[112:115], v[136:139], v[104:107]
    v_cvt_pk_bf16_f32 v178, v192, v193
    v_cvt_pk_bf16_f32 v179, v194, v195
    v_mfma_f32_16x16x32_bf16 v[104:107], a[116:119], v[152:155], v[104:107]
    ds_read_b64_tr_b16 a[100:101], v212 offset:57344
    ds_read_b64_tr_b16 a[102:103], v212 offset:61440
    v_mfma_f32_16x16x32_bf16 v[108:111], a[116:119], v[156:159], v[108:111]
    ds_read_b128 a[72:75], v210 offset:0
    ds_read_b128 a[76:79], v211 offset:0
    v_mfma_f32_16x16x32_bf16 v[108:111], a[112:115], v[140:143], v[108:111]
    s_waitcnt lgkmcnt(8)
    ds_write_b32 v251, v250
    v_mfma_f32_16x16x32_bf16 v[200:203], a[80:83], a[32:35], 0
    v_exp_f32 v196, v196
    v_mfma_f32_16x16x32_bf16 v[200:203], a[84:87], a[36:39], v[200:203]
    v_exp_f32 v197, v197
    v_mfma_f32_16x16x32_bf16 v[200:203], a[88:91], a[40:43], v[200:203]
    v_exp_f32 v198, v198
    v_mfma_f32_16x16x32_bf16 v[200:203], a[92:95], a[44:47], v[200:203]
    v_exp_f32 v199, v199
    v_bitop3_b32 v228, v228, -16, v238 bitop3:0x6a
    v_mfma_f32_16x16x32_bf16 a[152:155], a[184:187], a[192:195], a[152:155]
    buffer_load_dwordx4 v228, s[92:95], s38 offen offset:2048 sc1 lds
    v_mfma_f32_16x16x32_bf16 v[112:115], a[120:123], v[128:131], v[112:115]
    v_cvt_pk_bf16_f32 v182, v196, v197
    v_cvt_pk_bf16_f32 v183, v198, v199
    v_mfma_f32_16x16x32_bf16 v[112:115], a[124:127], v[144:147], v[112:115]
    ds_read_b64_tr_b16 a[104:105], v213 offset:49152
    ds_read_b64_tr_b16 a[106:107], v213 offset:53248
    v_mfma_f32_16x16x32_bf16 v[116:119], a[124:127], v[148:151], v[116:119]
    s_cmp_eq_u32 s27, s89
    s_cselect_b32 s27, s88, s27
    v_mfma_f32_16x16x32_bf16 v[116:119], a[120:123], v[132:135], v[116:119]
    s_cmp_eq_u32 s27, s90
    s_cselect_b32 s27, s89, s27
    v_mfma_f32_16x16x32_bf16 v[204:207], a[80:83], a[48:51], 0
    v_exp_f32 v200, v200
    v_mfma_f32_16x16x32_bf16 v[204:207], a[84:87], a[52:55], v[204:207]
    v_exp_f32 v201, v201
    v_mfma_f32_16x16x32_bf16 v[204:207], a[88:91], a[56:59], v[204:207]
    v_exp_f32 v202, v202
    v_mfma_f32_16x16x32_bf16 v[204:207], a[92:95], a[60:63], v[204:207]
    v_exp_f32 v203, v203
    v_bitop3_b32 v229, v229, -16, v239 bitop3:0x6a
    v_mfma_f32_16x16x32_bf16 a[156:159], a[188:191], a[192:195], a[156:159]
    buffer_load_dwordx4 v229, s[92:95], 0 offen offset:3072 sc1 lds
    v_mfma_f32_16x16x32_bf16 v[120:123], a[120:123], v[136:139], v[120:123]
    v_cvt_pk_bf16_f32 v186, v200, v201
    v_cvt_pk_bf16_f32 v187, v202, v203
    v_mfma_f32_16x16x32_bf16 v[120:123], a[124:127], v[152:155], v[120:123]
    ds_read_b64_tr_b16 a[108:109], v213 offset:57344
    ds_read_b64_tr_b16 a[110:111], v213 offset:61440
    v_mfma_f32_16x16x32_bf16 v[124:127], a[124:127], v[156:159], v[124:127]
    s_add_u32 s78, s78, 1
    s_cmp_ge_u32 s78, s3
    v_mfma_f32_16x16x32_bf16 v[124:127], a[120:123], v[140:143], v[124:127]
    s_waitcnt lgkmcnt(5)
    s_cbranch_scc1 L2_body3
    v_mfma_f32_16x16x32_bf16 v[192:195], a[64:67], a[0:3], 0
    v_exp_f32 v204, v204
    v_mfma_f32_16x16x32_bf16 v[192:195], a[68:71], a[4:7], v[192:195]
    v_exp_f32 v205, v205
    v_mfma_f32_16x16x32_bf16 v[192:195], a[72:75], a[8:11], v[192:195]
    v_exp_f32 v206, v206
    v_mfma_f32_16x16x32_bf16 v[192:195], a[76:79], a[12:15], v[192:195]
    v_exp_f32 v207, v207
    v_mfma_f32_16x16x32_bf16 v[0:3], a[96:99], v[160:163], v[0:3]
    v_cvt_pk_bf16_f32 v190, v204, v205
    v_cvt_pk_bf16_f32 v191, v206, v207
    v_mfma_f32_16x16x32_bf16 v[0:3], a[100:103], v[176:179], v[0:3]
    ds_read_b64_tr_b16 a[112:113], v214 offset:49152
    ds_read_b64_tr_b16 a[114:115], v214 offset:53248
    v_mfma_f32_16x16x32_bf16 v[4:7], a[100:103], v[180:183], v[4:7]
    ds_read_b128 a[80:83], v208 offset:4096
    ds_read_b128 a[84:87], v209 offset:4096
    v_mfma_f32_16x16x32_bf16 v[4:7], a[96:99], v[164:167], v[4:7]
    ds_read_b32 v255, v254
    ds_read_b32 v245, v241 offset:384
    v_mfma_f32_16x16x32_bf16 v[196:199], a[64:67], a[16:19], 0
    v_exp_f32 v192, v192
    v_mfma_f32_16x16x32_bf16 v[196:199], a[68:71], a[20:23], v[196:199]
    v_exp_f32 v193, v193
    v_mfma_f32_16x16x32_bf16 v[196:199], a[72:75], a[24:27], v[196:199]
    v_exp_f32 v194, v194
    v_mfma_f32_16x16x32_bf16 v[196:199], a[76:79], a[28:31], v[196:199]
    v_exp_f32 v195, v195
    v_mfma_f32_16x16x32_bf16 v[8:11], a[96:99], v[168:171], v[8:11]
    v_cvt_pk_bf16_f32 v128, v192, v193
    v_cvt_pk_bf16_f32 v129, v194, v195
    v_mfma_f32_16x16x32_bf16 v[8:11], a[100:103], v[184:187], v[8:11]
    ds_read_b64_tr_b16 a[116:117], v214 offset:57344
    ds_read_b64_tr_b16 a[118:119], v214 offset:61440
    v_mfma_f32_16x16x32_bf16 v[12:15], a[100:103], v[188:191], v[12:15]
    ds_read_b128 a[88:91], v210 offset:4096
    ds_read_b128 a[92:95], v211 offset:4096
    v_mfma_f32_16x16x32_bf16 v[12:15], a[96:99], v[172:175], v[12:15]
    s_waitcnt lgkmcnt(10)
    s_mov_b32 m0, s30
    v_mfma_f32_16x16x32_bf16 v[200:203], a[64:67], a[32:35], 0
    v_exp_f32 v196, v196
    v_mfma_f32_16x16x32_bf16 v[200:203], a[68:71], a[36:39], v[200:203]
    v_exp_f32 v197, v197
    v_mfma_f32_16x16x32_bf16 v[200:203], a[72:75], a[40:43], v[200:203]
    v_exp_f32 v198, v198
    v_mfma_f32_16x16x32_bf16 v[200:203], a[76:79], a[44:47], v[200:203]
    v_exp_f32 v199, v199
    v_mfma_f32_16x16x32_bf16 v[16:19], a[104:107], v[160:163], v[16:19]
    v_cvt_pk_bf16_f32 v132, v196, v197
    v_cvt_pk_bf16_f32 v133, v198, v199
    v_mfma_f32_16x16x32_bf16 v[16:19], a[108:111], v[176:179], v[16:19]
    ds_read_b64_tr_b16 a[120:121], v215 offset:49152
    ds_read_b64_tr_b16 a[122:123], v215 offset:53248
    v_mfma_f32_16x16x32_bf16 v[20:23], a[108:111], v[180:183], v[20:23]
    ds_write_b128 v243, a[196:199]
    ds_read2_b32 v[222:223], v240 offset0:128 offset1:132
    v_mfma_f32_16x16x32_bf16 v[20:23], a[104:107], v[164:167], v[20:23]
    s_waitcnt lgkmcnt(9)
    v_cmp_lt_u32 vcc, v255, v250
    v_mfma_f32_16x16x32_bf16 v[204:207], a[64:67], a[48:51], 0
    v_exp_f32 v200, v200
    v_mfma_f32_16x16x32_bf16 v[204:207], a[68:71], a[52:55], v[204:207]
    v_exp_f32 v201, v201
    v_mfma_f32_16x16x32_bf16 v[204:207], a[72:75], a[56:59], v[204:207]
    v_exp_f32 v202, v202
    v_mfma_f32_16x16x32_bf16 v[204:207], a[76:79], a[60:63], v[204:207]
    v_exp_f32 v203, v203
    v_mfma_f32_16x16x32_bf16 v[24:27], a[104:107], v[168:171], v[24:27]
    v_cvt_pk_bf16_f32 v136, v200, v201
    v_cvt_pk_bf16_f32 v137, v202, v203
    v_mfma_f32_16x16x32_bf16 v[24:27], a[108:111], v[184:187], v[24:27]
    ds_read_b64_tr_b16 a[124:125], v215 offset:57344
    ds_read_b64_tr_b16 a[126:127], v215 offset:61440
    v_mfma_f32_16x16x32_bf16 v[28:31], a[108:111], v[188:191], v[28:31]
    s_cbranch_vccnz L2_spg3F
L2_sprg3F:
    ds_read2_b32 v[224:225], v240 offset0:136 offset1:140
    v_mfma_f32_16x16x32_bf16 v[28:31], a[104:107], v[172:175], v[28:31]
    s_waitcnt lgkmcnt(7)
    ds_read2_b32 v[226:227], v240 offset0:144 offset1:148
    v_mfma_f32_16x16x32_bf16 v[192:195], a[80:83], a[0:3], 0
    v_exp_f32 v204, v204
    v_mfma_f32_16x16x32_bf16 v[192:195], a[84:87], a[4:7], v[192:195]
    v_exp_f32 v205, v205
    v_mfma_f32_16x16x32_bf16 v[192:195], a[88:91], a[8:11], v[192:195]
    v_exp_f32 v206, v206
    v_mfma_f32_16x16x32_bf16 v[192:195], a[92:95], a[12:15], v[192:195]
    v_exp_f32 v207, v207
    v_and_b32 v245, 31, v245
    v_lshl_add_u32 v245, v245, 6, v242
    v_mfma_f32_16x16x32_bf16 v[32:35], a[112:115], v[160:163], v[32:35]
    v_cvt_pk_bf16_f32 v140, v204, v205
    v_cvt_pk_bf16_f32 v141, v206, v207
    v_mfma_f32_16x16x32_bf16 v[32:35], a[116:119], v[176:179], v[32:35]
    ds_read_b64_tr_b16 a[96:97], v216 offset:49152
    ds_read_b64_tr_b16 a[98:99], v216 offset:53248
    v_mfma_f32_16x16x32_bf16 v[36:39], a[116:119], v[180:183], v[36:39]
    ds_read_b128 a[64:67], v208 offset:8192
    ds_read_b128 a[68:71], v209 offset:8192
    v_mfma_f32_16x16x32_bf16 v[36:39], a[112:115], v[164:167], v[36:39]
    buffer_load_dwordx4 v220, s[8:11], s27 offen offset:0 sc1 lds
    ds_write_b16 v245, v244
    v_mfma_f32_16x16x32_bf16 v[196:199], a[80:83], a[16:19], 0
    v_exp_f32 v192, v192
    v_mfma_f32_16x16x32_bf16 v[196:199], a[84:87], a[20:23], v[196:199]
    v_exp_f32 v193, v193
    v_mfma_f32_16x16x32_bf16 v[196:199], a[88:91], a[24:27], v[196:199]
    v_exp_f32 v194, v194
    v_mfma_f32_16x16x32_bf16 v[196:199], a[92:95], a[28:31], v[196:199]
    v_exp_f32 v195, v195
    v_mfma_f32_16x16x32_bf16 v[40:43], a[112:115], v[168:171], v[40:43]
    v_cvt_pk_bf16_f32 v130, v192, v193
    v_cvt_pk_bf16_f32 v131, v194, v195
    s_waitcnt vmcnt(1)
    v_mfma_f32_16x16x32_bf16 v[40:43], a[116:119], v[184:187], v[40:43]
    ds_read_b64_tr_b16 a[100:101], v216 offset:57344
    ds_read_b64_tr_b16 a[102:103], v216 offset:61440
    ds_read_b64_tr_b16 a[160:161], v230 offset:8192
    ds_read_b64_tr_b16 a[162:163], v230 offset:12288
    v_mfma_f32_16x16x32_bf16 v[44:47], a[116:119], v[188:191], v[44:47]
    ds_read_b128 a[72:75], v210 offset:8192
    ds_read_b128 a[76:79], v211 offset:8192
    ds_read_b64_tr_b16 a[164:165], v231 offset:8192
    ds_read_b64_tr_b16 a[166:167], v231 offset:12288
    ds_read_b128 a[192:195], v243
    v_mfma_f32_16x16x32_bf16 v[44:47], a[112:115], v[172:175], v[44:47]
    s_waitcnt lgkmcnt(15)
    buffer_load_dwordx4 v220, s[8:11], s27 offen offset:1024 sc1 lds
    v_add_u32 v250, 1, v250
    v_mfma_f32_16x16x32_bf16 v[200:203], a[80:83], a[32:35], 0
    v_exp_f32 v196, v196
    v_mfma_f32_16x16x32_bf16 v[200:203], a[84:87], a[36:39], v[200:203]
    v_exp_f32 v197, v197
    v_mfma_f32_16x16x32_bf16 v[200:203], a[88:91], a[40:43], v[200:203]
    v_exp_f32 v198, v198
    v_mfma_f32_16x16x32_bf16 v[200:203], a[92:95], a[44:47], v[200:203]
    v_exp_f32 v199, v199
    v_mfma_f32_16x16x32_bf16 v[48:51], a[120:123], v[160:163], v[48:51]
    v_cvt_pk_bf16_f32 v134, v196, v197
    v_cvt_pk_bf16_f32 v135, v198, v199
    v_mfma_f32_16x16x32_bf16 v[48:51], a[124:127], v[176:179], v[48:51]
    ds_read_b64_tr_b16 a[104:105], v217 offset:49152
    ds_read_b64_tr_b16 a[106:107], v217 offset:53248
    ds_read_b64_tr_b16 a[172:173], v233 offset:8192
    ds_read_b64_tr_b16 a[174:175], v233 offset:12288
    v_mfma_f32_16x16x32_bf16 v[52:55], a[124:127], v[180:183], v[52:55]
    ds_read_b64_tr_b16 a[168:169], v232 offset:8192
    ds_read_b64_tr_b16 a[170:171], v232 offset:12288
    v_mfma_f32_16x16x32_bf16 v[52:55], a[120:123], v[164:167], v[52:55]
    buffer_load_dwordx4 v220, s[8:11], s27 offen offset:2048 sc1 lds
    v_mfma_f32_16x16x32_bf16 v[204:207], a[80:83], a[48:51], 0
    v_exp_f32 v200, v200
    v_mfma_f32_16x16x32_bf16 v[204:207], a[84:87], a[52:55], v[204:207]
    v_exp_f32 v201, v201
    v_mfma_f32_16x16x32_bf16 v[204:207], a[88:91], a[56:59], v[204:207]
    v_exp_f32 v202, v202
    v_mfma_f32_16x16x32_bf16 v[204:207], a[92:95], a[60:63], v[204:207]
    v_exp_f32 v203, v203
    v_mfma_f32_16x16x32_bf16 v[56:59], a[120:123], v[168:171], v[56:59]
    v_cvt_pk_bf16_f32 v138, v200, v201
    v_cvt_pk_bf16_f32 v139, v202, v203
    v_mfma_f32_16x16x32_bf16 v[56:59], a[124:127], v[184:187], v[56:59]
    ds_read_b64_tr_b16 a[108:109], v217 offset:57344
    ds_read_b64_tr_b16 a[110:111], v217 offset:61440
    v_mfma_f32_16x16x32_bf16 v[60:63], a[124:127], v[188:191], v[60:63]
    buffer_load_dwordx4 v220, s[8:11], s27 offen offset:3072 sc1 lds
    v_mfma_f32_16x16x32_bf16 v[60:63], a[120:123], v[172:175], v[60:63]
    s_waitcnt lgkmcnt(11)
    s_waitcnt vmcnt(12)
    s_mov_b32 m0, s74
    v_mfma_f32_16x16x32_bf16 v[192:195], a[64:67], a[0:3], 0
    v_exp_f32 v204, v204
    v_mfma_f32_16x16x32_bf16 v[192:195], a[68:71], a[4:7], v[192:195]
    v_exp_f32 v205, v205
    v_mfma_f32_16x16x32_bf16 v[192:195], a[72:75], a[8:11], v[192:195]
    v_exp_f32 v206, v206
    v_mfma_f32_16x16x32_bf16 v[192:195], a[76:79], a[12:15], v[192:195]
    v_exp_f32 v207, v207
    v_bitop3_b32 v222, v222, -16, v238 bitop3:0x6a
    s_waitcnt lgkmcnt(8)
    v_mfma_f32_16x16x32_bf16 a[128:131], a[160:163], a[192:195], a[128:131]
    buffer_load_dwordx4 v222, s[92:95], s36 offen offset:0 sc1 lds
    ds_read_b64_tr_b16 a[176:177], v234 offset:8192
    v_mfma_f32_16x16x32_bf16 v[64:67], a[96:99], v[160:163], v[64:67]
    v_cvt_pk_bf16_f32 v142, v204, v205
    v_cvt_pk_bf16_f32 v143, v206, v207
    v_mfma_f32_16x16x32_bf16 v[64:67], a[100:103], v[176:179], v[64:67]
    ds_read_b64_tr_b16 a[112:113], v218 offset:49152
    ds_read_b64_tr_b16 a[114:115], v218 offset:53248
    v_mfma_f32_16x16x32_bf16 v[68:71], a[100:103], v[180:183], v[68:71]
    ds_read_b128 a[80:83], v208 offset:12288
    ds_read_b128 a[84:87], v209 offset:12288
    v_mfma_f32_16x16x32_bf16 v[68:71], a[96:99], v[164:167], v[68:71]
    ds_write_b32 v251, v250
    ds_read2_b32 v[228:229], v240 offset0:152 offset1:156
    v_mfma_f32_16x16x32_bf16 v[196:199], a[64:67], a[16:19], 0
    v_exp_f32 v192, v192
    v_mfma_f32_16x16x32_bf16 v[196:199], a[68:71], a[20:23], v[196:199]
    v_exp_f32 v193, v193
    v_mfma_f32_16x16x32_bf16 v[196:199], a[72:75], a[24:27], v[196:199]
    v_exp_f32 v194, v194
    v_mfma_f32_16x16x32_bf16 v[196:199], a[76:79], a[28:31], v[196:199]
    v_exp_f32 v195, v195
    v_bitop3_b32 v223, v223, -16, v239 bitop3:0x6a
    v_mfma_f32_16x16x32_bf16 a[132:135], a[164:167], a[192:195], a[132:135]
    buffer_load_dwordx4 v223, s[92:95], s37 offen offset:1024 sc1 lds
    ds_read_b64_tr_b16 a[178:179], v234 offset:12288
    v_mfma_f32_16x16x32_bf16 v[72:75], a[96:99], v[168:171], v[72:75]
    v_cvt_pk_bf16_f32 v144, v192, v193
    v_cvt_pk_bf16_f32 v145, v194, v195
    v_mfma_f32_16x16x32_bf16 v[72:75], a[100:103], v[184:187], v[72:75]
    ds_read_b64_tr_b16 a[116:117], v218 offset:57344
    ds_read_b64_tr_b16 a[118:119], v218 offset:61440
    v_mfma_f32_16x16x32_bf16 v[76:79], a[100:103], v[188:191], v[76:79]
    ds_read_b128 a[88:91], v210 offset:12288
    ds_read_b128 a[92:95], v211 offset:12288
    v_mfma_f32_16x16x32_bf16 v[76:79], a[96:99], v[172:175], v[76:79]
    s_waitcnt lgkmcnt(12)
    ds_read_b64_tr_b16 a[182:183], v235 offset:12288
    v_mfma_f32_16x16x32_bf16 v[200:203], a[64:67], a[32:35], 0
    v_exp_f32 v196, v196
    v_mfma_f32_16x16x32_bf16 v[200:203], a[68:71], a[36:39], v[200:203]
    v_exp_f32 v197, v197
    v_mfma_f32_16x16x32_bf16 v[200:203], a[72:75], a[40:43], v[200:203]
    v_exp_f32 v198, v198
    v_mfma_f32_16x16x32_bf16 v[200:203], a[76:79], a[44:47], v[200:203]
    v_exp_f32 v199, v199
    v_bitop3_b32 v224, v224, -16, v238 bitop3:0x6a
    v_mfma_f32_16x16x32_bf16 a[136:139], a[168:171], a[192:195], a[136:139]
    buffer_load_dwordx4 v224, s[92:95], s38 offen offset:2048 sc1 lds
    ds_read_b64_tr_b16 a[180:181], v235 offset:8192
    v_mfma_f32_16x16x32_bf16 v[80:83], a[104:107], v[160:163], v[80:83]
    v_cvt_pk_bf16_f32 v148, v196, v197
    v_cvt_pk_bf16_f32 v149, v198, v199
    v_mfma_f32_16x16x32_bf16 v[80:83], a[108:111], v[176:179], v[80:83]
    ds_read_b64_tr_b16 a[120:121], v219 offset:49152
    ds_read_b64_tr_b16 a[122:123], v219 offset:53248
    ds_read_b64_tr_b16 a[190:191], v237 offset:12288
    v_mfma_f32_16x16x32_bf16 v[84:87], a[108:111], v[180:183], v[84:87]
    ds_read_b32 v255, v254
    ds_read_b64_tr_b16 a[184:185], v236 offset:8192
    v_mfma_f32_16x16x32_bf16 v[84:87], a[104:107], v[164:167], v[84:87]
    s_add_u32 s27, s27, 16384
    ds_read_b64_tr_b16 a[186:187], v236 offset:12288
    v_mfma_f32_16x16x32_bf16 v[204:207], a[64:67], a[48:51], 0
    v_exp_f32 v200, v200
    v_mfma_f32_16x16x32_bf16 v[204:207], a[68:71], a[52:55], v[204:207]
    v_exp_f32 v201, v201
    v_mfma_f32_16x16x32_bf16 v[204:207], a[72:75], a[56:59], v[204:207]
    v_exp_f32 v202, v202
    v_mfma_f32_16x16x32_bf16 v[204:207], a[76:79], a[60:63], v[204:207]
    v_exp_f32 v203, v203
    v_bitop3_b32 v225, v225, -16, v239 bitop3:0x6a
    v_mfma_f32_16x16x32_bf16 a[140:143], a[172:175], a[192:195], a[140:143]
    buffer_load_dwordx4 v225, s[92:95], 0 offen offset:3072 sc1 lds
    ds_read_b64_tr_b16 a[188:189], v237 offset:8192
    v_mfma_f32_16x16x32_bf16 v[88:91], a[104:107], v[168:171], v[88:91]
    v_cvt_pk_bf16_f32 v152, v200, v201
    v_cvt_pk_bf16_f32 v153, v202, v203
    v_mfma_f32_16x16x32_bf16 v[88:91], a[108:111], v[184:187], v[88:91]
    ds_read_b64_tr_b16 a[124:125], v219 offset:57344
    ds_read_b64_tr_b16 a[126:127], v219 offset:61440
    v_mfma_f32_16x16x32_bf16 v[92:95], a[108:111], v[188:191], v[92:95]
    s_waitcnt lgkmcnt(5)
    v_cmp_lt_u32 vcc, v255, v250
    v_mfma_f32_16x16x32_bf16 v[92:95], a[104:107], v[172:175], v[92:95]
    s_cbranch_vccnz L2_spg3L
L2_sprg3L:
    s_add_u32 m0, s74, 4096
    v_mfma_f32_16x16x32_bf16 v[192:195], a[80:83], a[0:3], 0
    v_exp_f32 v204, v204
    v_mfma_f32_16x16x32_bf16 v[192:195], a[84:87], a[4:7], v[192:195]
    v_exp_f32 v205, v205
    v_mfma_f32_16x16x32_bf16 v[192:195], a[88:91], a[8:11], v[192:195]
    v_exp_f32 v206, v206
    v_mfma_f32_16x16x32_bf16 v[192:195], a[92:95], a[12:15], v[192:195]
    v_exp_f32 v207, v207
    v_bitop3_b32 v226, v226, -16, v238 bitop3:0x6a
    v_mfma_f32_16x16x32_bf16 a[144:147], a[176:179], a[192:195], a[144:147]
    buffer_load_dwordx4 v226, s[92:95], s36 offen offset:0 sc1 lds
    v_mfma_f32_16x16x32_bf16 v[96:99], a[112:115], v[160:163], v[96:99]
    v_cvt_pk_bf16_f32 v156, v204, v205
    v_cvt_pk_bf16_f32 v157, v206, v207
    v_mfma_f32_16x16x32_bf16 v[96:99], a[116:119], v[176:179], v[96:99]
    ds_read_b64_tr_b16 a[96:97], v212 offset:0
    ds_read_b64_tr_b16 a[98:99], v212 offset:4096
    v_mfma_f32_16x16x32_bf16 v[100:103], a[116:119], v[180:183], v[100:103]
    ds_read_b128 a[64:67], v208 offset:16384
    ds_read_b128 a[68:71], v209 offset:16384
    v_mfma_f32_16x16x32_bf16 v[100:103], a[112:115], v[164:167], v[100:103]
    v_add_u32 v250, 1, v250
    v_mfma_f32_16x16x32_bf16 v[196:199], a[80:83], a[16:19], 0
    v_exp_f32 v192, v192
    v_mfma_f32_16x16x32_bf16 v[196:199], a[84:87], a[20:23], v[196:199]
    v_exp_f32 v193, v193
    v_mfma_f32_16x16x32_bf16 v[196:199], a[88:91], a[24:27], v[196:199]
    v_exp_f32 v194, v194
    v_mfma_f32_16x16x32_bf16 v[196:199], a[92:95], a[28:31], v[196:199]
    v_exp_f32 v195, v195
    v_bitop3_b32 v227, v227, -16, v239 bitop3:0x6a
    v_mfma_f32_16x16x32_bf16 a[148:151], a[180:183], a[192:195], a[148:151]
    buffer_load_dwordx4 v227, s[92:95], s37 offen offset:1024 sc1 lds
    v_mfma_f32_16x16x32_bf16 v[104:107], a[112:115], v[168:171], v[104:107]
    v_cvt_pk_bf16_f32 v146, v192, v193
    v_cvt_pk_bf16_f32 v147, v194, v195
    v_mfma_f32_16x16x32_bf16 v[104:107], a[116:119], v[184:187], v[104:107]
    ds_read_b64_tr_b16 a[100:101], v212 offset:8192
    ds_read_b64_tr_b16 a[102:103], v212 offset:12288
    v_mfma_f32_16x16x32_bf16 v[108:111], a[116:119], v[188:191], v[108:111]
    ds_read_b128 a[72:75], v210 offset:16384
    ds_read_b128 a[76:79], v211 offset:16384
    v_mfma_f32_16x16x32_bf16 v[108:111], a[112:115], v[172:175], v[108:111]
    s_waitcnt lgkmcnt(8)
    ds_write_b32 v251, v250
    v_mfma_f32_16x16x32_bf16 v[200:203], a[80:83], a[32:35], 0
    v_exp_f32 v196, v196
    v_mfma_f32_16x16x32_bf16 v[200:203], a[84:87], a[36:39], v[200:203]
    v_exp_f32 v197, v197
    v_mfma_f32_16x16x32_bf16 v[200:203], a[88:91], a[40:43], v[200:203]
    v_exp_f32 v198, v198
    v_mfma_f32_16x16x32_bf16 v[200:203], a[92:95], a[44:47], v[200:203]
    v_exp_f32 v199, v199
    v_bitop3_b32 v228, v228, -16, v238 bitop3:0x6a
    v_mfma_f32_16x16x32_bf16 a[152:155], a[184:187], a[192:195], a[152:155]
    buffer_load_dwordx4 v228, s[92:95], s38 offen offset:2048 sc1 lds
    v_mfma_f32_16x16x32_bf16 v[112:115], a[120:123], v[160:163], v[112:115]
    v_cvt_pk_bf16_f32 v150, v196, v197
    v_cvt_pk_bf16_f32 v151, v198, v199
    v_mfma_f32_16x16x32_bf16 v[112:115], a[124:127], v[176:179], v[112:115]
    ds_read_b64_tr_b16 a[104:105], v213 offset:0
    ds_read_b64_tr_b16 a[106:107], v213 offset:4096
    v_mfma_f32_16x16x32_bf16 v[116:119], a[124:127], v[180:183], v[116:119]
    s_cmp_eq_u32 s27, s89
    s_cselect_b32 s27, s88, s27
    v_mfma_f32_16x16x32_bf16 v[116:119], a[120:123], v[164:167], v[116:119]
    s_cmp_eq_u32 s27, s90
    s_cselect_b32 s27, s89, s27
    v_mfma_f32_16x16x32_bf16 v[204:207], a[80:83], a[48:51], 0
    v_exp_f32 v200, v200
    v_mfma_f32_16x16x32_bf16 v[204:207], a[84:87], a[52:55], v[204:207]
    v_exp_f32 v201, v201
    v_mfma_f32_16x16x32_bf16 v[204:207], a[88:91], a[56:59], v[204:207]
    v_exp_f32 v202, v202
    v_mfma_f32_16x16x32_bf16 v[204:207], a[92:95], a[60:63], v[204:207]
    v_exp_f32 v203, v203
    v_bitop3_b32 v229, v229, -16, v239 bitop3:0x6a
    v_mfma_f32_16x16x32_bf16 a[156:159], a[188:191], a[192:195], a[156:159]
    buffer_load_dwordx4 v229, s[92:95], 0 offen offset:3072 sc1 lds
    v_mfma_f32_16x16x32_bf16 v[120:123], a[120:123], v[168:171], v[120:123]
    v_cvt_pk_bf16_f32 v154, v200, v201
    v_cvt_pk_bf16_f32 v155, v202, v203
    v_mfma_f32_16x16x32_bf16 v[120:123], a[124:127], v[184:187], v[120:123]
    ds_read_b64_tr_b16 a[108:109], v213 offset:8192
    ds_read_b64_tr_b16 a[110:111], v213 offset:12288
    v_mfma_f32_16x16x32_bf16 v[124:127], a[124:127], v[188:191], v[124:127]
    s_add_u32 s78, s78, 1
    s_cmp_ge_u32 s78, s3
    v_mfma_f32_16x16x32_bf16 v[124:127], a[120:123], v[172:175], v[124:127]
    s_waitcnt lgkmcnt(5)
    v_add_u32 v240, 512, v240
    v_add_u32 v241, 512, v241
    s_sub_u32 s32, s32, 1
    s_cmp_lg_u32 s32, 0
    s_cbranch_scc1 L2_head
L2_post:
    s_lshl_b32 s33, s78, 7
    s_add_u32 s33, s33, s73
    v_lshrrev_b32 v240, 4, v221
    v_lshl_add_u32 v240, v240, 2, s33
    v_and_b32 v241, 31, v221
    v_lshl_add_u32 v241, v241, 2, s33

    s_mov_b32 s41, 0x20000
L2_hfw38:
    v_cmp_ne_u32 vcc, 1, v247
    s_cbranch_vccz L2_hfokw38
    s_sub_u32 s41, s41, 1
    s_cmp_eq_u32 s41, 0
    s_cbranch_scc1 L2_hfokw38
    s_sleep 2
    buffer_load_dword v247, v248, s[20:23], s39 offen sc1
    s_waitcnt vmcnt(0)
    s_branch L2_hfw38

L2_hfokw38:
    s_add_u32 s12, s4, 9502720
    s_addc_u32 s13, s5, 0
    s_mov_b32 s14, 65536
    s_mov_b32 s15, 0x20000
    s_lshl_b32 s33, s26, 13
    s_add_u32 s33, s33, 4096
    s_add_u32 s1, s33, 32768
    v_lshlrev_b32 v249, 4, v221
    s_mul_i32 s40, s25, 3211264
    s_add_u32 s40, s40, s35
    s_xor_b32 s41, s40, 4096
    s_xor_b32 s42, s40, 8192
    s_xor_b32 s43, s40, 12288
    s_cmp_eq_u32 s82, 1
    s_cselect_b32 s40, 0x7ff00000, s40

    s_mov_b32 s88, s28
    s_mov_b32 s89, s29
    s_mov_b32 s90, 32768
    v_mfma_f32_16x16x32_bf16 v[192:195], a[64:67], a[0:3], 0
    v_exp_f32 v204, v204
    v_mfma_f32_16x16x32_bf16 v[192:195], a[68:71], a[4:7], v[192:195]
    v_exp_f32 v205, v205
    v_mfma_f32_16x16x32_bf16 v[192:195], a[72:75], a[8:11], v[192:195]
    v_exp_f32 v206, v206
    v_mfma_f32_16x16x32_bf16 v[192:195], a[76:79], a[12:15], v[192:195]
    v_exp_f32 v207, v207
    v_mfma_f32_16x16x32_bf16 v[0:3], a[96:99], v[128:131], v[0:3]
    v_cvt_pk_bf16_f32 v158, v204, v205
    v_cvt_pk_bf16_f32 v159, v206, v207
    v_mfma_f32_16x16x32_bf16 v[0:3], a[100:103], v[144:147], v[0:3]
    ds_read_b64_tr_b16 a[112:113], v214 offset:0
    ds_read_b64_tr_b16 a[114:115], v214 offset:4096
    v_mfma_f32_16x16x32_bf16 v[4:7], a[100:103], v[148:151], v[4:7]
    ds_read_b128 a[80:83], v208 offset:20480
    ds_read_b128 a[84:87], v209 offset:20480
    v_mfma_f32_16x16x32_bf16 v[4:7], a[96:99], v[132:135], v[4:7]
    ds_read2_b32 v[222:223], v240 offset0:32 offset1:36
    ds_read2_b32 v[224:225], v240 offset0:40 offset1:44
    v_mfma_f32_16x16x32_bf16 v[196:199], a[64:67], a[16:19], 0
    v_exp_f32 v192, v192
    v_mfma_f32_16x16x32_bf16 v[196:199], a[68:71], a[20:23], v[196:199]
    v_exp_f32 v193, v193
    v_mfma_f32_16x16x32_bf16 v[196:199], a[72:75], a[24:27], v[196:199]
    v_exp_f32 v194, v194
    v_mfma_f32_16x16x32_bf16 v[196:199], a[76:79], a[28:31], v[196:199]
    v_exp_f32 v195, v195
    v_mfma_f32_16x16x32_bf16 v[8:11], a[96:99], v[136:139], v[8:11]
    v_cvt_pk_bf16_f32 v160, v192, v193
    v_cvt_pk_bf16_f32 v161, v194, v195
    v_mfma_f32_16x16x32_bf16 v[8:11], a[100:103], v[152:155], v[8:11]
    ds_read_b64_tr_b16 a[116:117], v214 offset:8192
    ds_read_b64_tr_b16 a[118:119], v214 offset:12288
    v_mfma_f32_16x16x32_bf16 v[12:15], a[100:103], v[156:159], v[12:15]
    ds_read_b128 a[88:91], v210 offset:20480
    ds_read_b128 a[92:95], v211 offset:20480
    v_mfma_f32_16x16x32_bf16 v[12:15], a[96:99], v[140:143], v[12:15]
    s_waitcnt lgkmcnt(10)
    ds_read2_b32 v[226:227], v240 offset0:48 offset1:52
    v_mfma_f32_16x16x32_bf16 v[200:203], a[64:67], a[32:35], 0
    v_exp_f32 v196, v196
    v_mfma_f32_16x16x32_bf16 v[200:203], a[68:71], a[36:39], v[200:203]
    v_exp_f32 v197, v197
    v_mfma_f32_16x16x32_bf16 v[200:203], a[72:75], a[40:43], v[200:203]
    v_exp_f32 v198, v198
    v_mfma_f32_16x16x32_bf16 v[200:203], a[76:79], a[44:47], v[200:203]
    v_exp_f32 v199, v199
    v_mfma_f32_16x16x32_bf16 v[16:19], a[104:107], v[128:131], v[16:19]
    v_cvt_pk_bf16_f32 v164, v196, v197
    v_cvt_pk_bf16_f32 v165, v198, v199
    v_mfma_f32_16x16x32_bf16 v[16:19], a[108:111], v[144:147], v[16:19]
    ds_read_b64_tr_b16 a[120:121], v215 offset:0
    ds_read_b64_tr_b16 a[122:123], v215 offset:4096
    ds_read2_b32 v[228:229], v240 offset0:56 offset1:60
    v_mfma_f32_16x16x32_bf16 v[20:23], a[108:111], v[148:151], v[20:23]
    s_mov_b32 m0, s75
    s_waitcnt lgkmcnt(9)
    v_bitop3_b32 v222, v222, -16, v238 bitop3:0x6a
    v_mfma_f32_16x16x32_bf16 v[20:23], a[104:107], v[132:135], v[20:23]
    buffer_load_dwordx4 v222, s[8:11], 0 offen sc1 lds
    v_mfma_f32_16x16x32_bf16 v[204:207], a[64:67], a[48:51], 0
    v_exp_f32 v200, v200
    v_mfma_f32_16x16x32_bf16 v[204:207], a[68:71], a[52:55], v[204:207]
    v_exp_f32 v201, v201
    v_mfma_f32_16x16x32_bf16 v[204:207], a[72:75], a[56:59], v[204:207]
    v_exp_f32 v202, v202
    v_mfma_f32_16x16x32_bf16 v[204:207], a[76:79], a[60:63], v[204:207]
    v_exp_f32 v203, v203
    v_mfma_f32_16x16x32_bf16 v[24:27], a[104:107], v[136:139], v[24:27]
    v_cvt_pk_bf16_f32 v168, v200, v201
    v_cvt_pk_bf16_f32 v169, v202, v203
    v_mfma_f32_16x16x32_bf16 v[24:27], a[108:111], v[152:155], v[24:27]
    ds_read_b64_tr_b16 a[124:125], v215 offset:8192
    ds_read_b64_tr_b16 a[126:127], v215 offset:12288
    v_mfma_f32_16x16x32_bf16 v[28:31], a[108:111], v[156:159], v[28:31]
    s_add_u32 m0, s75, 1024
    v_bitop3_b32 v223, v223, -16, v239 bitop3:0x6a
    v_mfma_f32_16x16x32_bf16 v[28:31], a[104:107], v[140:143], v[28:31]
    s_waitcnt lgkmcnt(6)
    buffer_load_dwordx4 v223, s[8:11], 0 offen sc1 lds
    v_mfma_f32_16x16x32_bf16 v[192:195], a[80:83], a[0:3], 0
    v_exp_f32 v204, v204
    v_mfma_f32_16x16x32_bf16 v[192:195], a[84:87], a[4:7], v[192:195]
    v_exp_f32 v205, v205
    v_mfma_f32_16x16x32_bf16 v[192:195], a[88:91], a[8:11], v[192:195]
    v_exp_f32 v206, v206
    v_mfma_f32_16x16x32_bf16 v[192:195], a[92:95], a[12:15], v[192:195]
    v_exp_f32 v207, v207
    v_mfma_f32_16x16x32_bf16 v[32:35], a[112:115], v[128:131], v[32:35]
    v_cvt_pk_bf16_f32 v172, v204, v205
    v_cvt_pk_bf16_f32 v173, v206, v207
    v_mfma_f32_16x16x32_bf16 v[32:35], a[116:119], v[144:147], v[32:35]
    ds_read_b64_tr_b16 a[96:97], v216 offset:0
    ds_read_b64_tr_b16 a[98:99], v216 offset:4096
    ds_read_b32 v255, v254
    v_mfma_f32_16x16x32_bf16 v[36:39], a[116:119], v[148:151], v[36:39]
    s_add_u32 m0, s75, 2048
    v_bitop3_b32 v224, v224, -16, v238 bitop3:0x6a
    v_mfma_f32_16x16x32_bf16 v[36:39], a[112:115], v[132:135], v[36:39]
    buffer_load_dwordx4 v224, s[8:11], 0 offen sc1 lds
    v_mfma_f32_16x16x32_bf16 v[196:199], a[80:83], a[16:19], 0
    v_exp_f32 v192, v192
    v_mfma_f32_16x16x32_bf16 v[196:199], a[84:87], a[20:23], v[196:199]
    v_exp_f32 v193, v193
    v_mfma_f32_16x16x32_bf16 v[196:199], a[88:91], a[24:27], v[196:199]
    v_exp_f32 v194, v194
    v_mfma_f32_16x16x32_bf16 v[196:199], a[92:95], a[28:31], v[196:199]
    v_exp_f32 v195, v195
    v_mfma_f32_16x16x32_bf16 v[40:43], a[112:115], v[136:139], v[40:43]
    v_cvt_pk_bf16_f32 v162, v192, v193
    v_cvt_pk_bf16_f32 v163, v194, v195
    v_mfma_f32_16x16x32_bf16 v[40:43], a[116:119], v[152:155], v[40:43]
    ds_read_b64_tr_b16 a[100:101], v216 offset:8192
    ds_read_b64_tr_b16 a[102:103], v216 offset:12288
    v_mfma_f32_16x16x32_bf16 v[44:47], a[116:119], v[156:159], v[44:47]
    s_add_u32 m0, s75, 3072
    v_bitop3_b32 v225, v225, -16, v239 bitop3:0x6a
    v_mfma_f32_16x16x32_bf16 v[44:47], a[112:115], v[140:143], v[44:47]
    s_waitcnt lgkmcnt(5)
    buffer_load_dwordx4 v225, s[8:11], 0 offen sc1 lds
    v_mfma_f32_16x16x32_bf16 v[200:203], a[80:83], a[32:35], 0
    v_exp_f32 v196, v196
    v_mfma_f32_16x16x32_bf16 v[200:203], a[84:87], a[36:39], v[200:203]
    v_exp_f32 v197, v197
    v_mfma_f32_16x16x32_bf16 v[200:203], a[88:91], a[40:43], v[200:203]
    v_exp_f32 v198, v198
    v_mfma_f32_16x16x32_bf16 v[200:203], a[92:95], a[44:47], v[200:203]
    v_exp_f32 v199, v199
    v_mfma_f32_16x16x32_bf16 v[48:51], a[120:123], v[128:131], v[48:51]
    v_cvt_pk_bf16_f32 v166, v196, v197
    v_cvt_pk_bf16_f32 v167, v198, v199
    v_mfma_f32_16x16x32_bf16 v[48:51], a[124:127], v[144:147], v[48:51]
    ds_read_b64_tr_b16 a[104:105], v217 offset:0
    ds_read_b64_tr_b16 a[106:107], v217 offset:4096
    v_mfma_f32_16x16x32_bf16 v[52:55], a[124:127], v[148:151], v[52:55]
    s_add_u32 m0, s75, 4096
    v_bitop3_b32 v226, v226, -16, v238 bitop3:0x6a
    v_mfma_f32_16x16x32_bf16 v[52:55], a[120:123], v[132:135], v[52:55]
    buffer_load_dwordx4 v226, s[8:11], 0 offen sc1 lds
    v_mfma_f32_16x16x32_bf16 v[204:207], a[80:83], a[48:51], 0
    v_exp_f32 v200, v200
    v_mfma_f32_16x16x32_bf16 v[204:207], a[84:87], a[52:55], v[204:207]
    v_exp_f32 v201, v201
    v_mfma_f32_16x16x32_bf16 v[204:207], a[88:91], a[56:59], v[204:207]
    v_exp_f32 v202, v202
    v_mfma_f32_16x16x32_bf16 v[204:207], a[92:95], a[60:63], v[204:207]
    v_exp_f32 v203, v203
    v_mfma_f32_16x16x32_bf16 v[56:59], a[120:123], v[136:139], v[56:59]
    v_cvt_pk_bf16_f32 v170, v200, v201
    v_cvt_pk_bf16_f32 v171, v202, v203
    v_mfma_f32_16x16x32_bf16 v[56:59], a[124:127], v[152:155], v[56:59]
    ds_read_b64_tr_b16 a[108:109], v217 offset:8192
    ds_read_b64_tr_b16 a[110:111], v217 offset:12288
    v_mfma_f32_16x16x32_bf16 v[60:63], a[124:127], v[156:159], v[60:63]
    s_add_u32 m0, s75, 5120
    v_bitop3_b32 v227, v227, -16, v239 bitop3:0x6a
    v_mfma_f32_16x16x32_bf16 v[60:63], a[120:123], v[140:143], v[60:63]
    s_waitcnt lgkmcnt(4)
    buffer_load_dwordx4 v227, s[8:11], 0 offen sc1 lds
    v_exp_f32 v204, v204
    v_exp_f32 v205, v205
    v_exp_f32 v206, v206
    v_exp_f32 v207, v207
    v_mfma_f32_16x16x32_bf16 v[64:67], a[96:99], v[128:131], v[64:67]
    v_cvt_pk_bf16_f32 v174, v204, v205
    v_cvt_pk_bf16_f32 v175, v206, v207
    v_cmp_lt_u32 vcc, v255, v250
    v_mfma_f32_16x16x32_bf16 v[64:67], a[100:103], v[144:147], v[64:67]
    ds_read_b64_tr_b16 a[112:113], v218 offset:0
    ds_read_b64_tr_b16 a[114:115], v218 offset:4096
    v_mfma_f32_16x16x32_bf16 v[68:71], a[100:103], v[148:151], v[68:71]
    s_add_u32 m0, s75, 6144
    v_bitop3_b32 v228, v228, -16, v238 bitop3:0x6a
    v_mfma_f32_16x16x32_bf16 v[68:71], a[96:99], v[132:135], v[68:71]
    buffer_load_dwordx4 v228, s[8:11], 0 offen sc1 lds
    v_mfma_f32_16x16x32_bf16 v[72:75], a[96:99], v[136:139], v[72:75]
    s_cbranch_vccnz L2_spe38
L2_spre38:
    v_mfma_f32_16x16x32_bf16 v[72:75], a[100:103], v[152:155], v[72:75]
    ds_read_b64_tr_b16 a[116:117], v218 offset:8192
    ds_read_b64_tr_b16 a[118:119], v218 offset:12288
    v_mfma_f32_16x16x32_bf16 v[76:79], a[100:103], v[156:159], v[76:79]
    s_add_u32 m0, s75, 7168
    v_bitop3_b32 v229, v229, -16, v239 bitop3:0x6a
    v_mfma_f32_16x16x32_bf16 v[76:79], a[96:99], v[140:143], v[76:79]
    s_waitcnt lgkmcnt(4)
    buffer_load_dwordx4 v229, s[8:11], 0 offen sc1 lds
    v_mfma_f32_16x16x32_bf16 v[80:83], a[104:107], v[128:131], v[80:83]
    s_waitcnt vmcnt(8)
    v_mfma_f32_16x16x32_bf16 v[80:83], a[108:111], v[144:147], v[80:83]
    ds_read_b64_tr_b16 a[120:121], v219 offset:0
    ds_read_b64_tr_b16 a[122:123], v219 offset:4096
    v_mfma_f32_16x16x32_bf16 v[84:87], a[108:111], v[148:151], v[84:87]
    s_mov_b32 m0, s30
    v_mfma_f32_16x16x32_bf16 v[84:87], a[104:107], v[132:135], v[84:87]
    buffer_load_dwordx4 v249, s[12:15], s33 offen offset:0 sc1 lds
    v_mfma_f32_16x16x32_bf16 v[88:91], a[104:107], v[136:139], v[88:91]
    v_mfma_f32_16x16x32_bf16 v[88:91], a[108:111], v[152:155], v[88:91]
    ds_read_b64_tr_b16 a[124:125], v219 offset:8192
    ds_read_b64_tr_b16 a[126:127], v219 offset:12288
    v_mfma_f32_16x16x32_bf16 v[92:95], a[108:111], v[156:159], v[92:95]
    v_mfma_f32_16x16x32_bf16 v[92:95], a[104:107], v[140:143], v[92:95]
    s_waitcnt lgkmcnt(4)
    buffer_load_dwordx4 v249, s[12:15], s33 offen offset:1024 sc1 lds
    v_mfma_f32_16x16x32_bf16 v[96:99], a[112:115], v[128:131], v[96:99]
    buffer_load_dwordx4 v249, s[12:15], s33 offen offset:2048 sc1 lds
    v_mfma_f32_16x16x32_bf16 v[96:99], a[116:119], v[144:147], v[96:99]
    ds_read_b64_tr_b16 a[96:97], v212 offset:16384
    ds_read_b64_tr_b16 a[98:99], v212 offset:20480
    v_mfma_f32_16x16x32_bf16 v[100:103], a[116:119], v[148:151], v[100:103]
    v_mfma_f32_16x16x32_bf16 v[100:103], a[112:115], v[132:135], v[100:103]
    buffer_load_dwordx4 v249, s[12:15], s33 offen offset:3072 sc1 lds
    v_mfma_f32_16x16x32_bf16 v[104:107], a[112:115], v[136:139], v[104:107]
    s_mov_b32 m0, s31
    v_mfma_f32_16x16x32_bf16 v[104:107], a[116:119], v[152:155], v[104:107]
    buffer_load_dwordx4 v249, s[12:15], s1 offen offset:0 sc1 lds
    v_mfma_f32_16x16x32_bf16 v[108:111], a[116:119], v[156:159], v[108:111]
    v_mfma_f32_16x16x32_bf16 v[108:111], a[112:115], v[140:143], v[108:111]
    s_waitcnt lgkmcnt(2)
    buffer_load_dwordx4 v249, s[12:15], s1 offen offset:1024 sc1 lds
    v_mfma_f32_16x16x32_bf16 v[112:115], a[120:123], v[128:131], v[112:115]
    v_mfma_f32_16x16x32_bf16 v[112:115], a[124:127], v[144:147], v[112:115]
    ds_read_b64_tr_b16 a[104:105], v213 offset:16384
    ds_read_b64_tr_b16 a[106:107], v213 offset:20480
    v_mfma_f32_16x16x32_bf16 v[116:119], a[124:127], v[148:151], v[116:119]
    v_mfma_f32_16x16x32_bf16 v[116:119], a[120:123], v[132:135], v[116:119]
    buffer_load_dwordx4 v249, s[12:15], s1 offen offset:2048 sc1 lds
    v_mfma_f32_16x16x32_bf16 v[120:123], a[120:123], v[136:139], v[120:123]
    v_mfma_f32_16x16x32_bf16 v[120:123], a[124:127], v[152:155], v[120:123]
    buffer_load_dwordx4 v249, s[12:15], s1 offen offset:3072 sc1 lds
    v_mfma_f32_16x16x32_bf16 v[124:127], a[124:127], v[156:159], v[124:127]
    v_mfma_f32_16x16x32_bf16 v[124:127], a[120:123], v[140:143], v[124:127]
    s_waitcnt lgkmcnt(2)
    v_mfma_f32_16x16x32_bf16 v[0:3], a[96:99], v[160:163], v[0:3]
    ds_read_b64_tr_b16 a[112:113], v214 offset:16384
    ds_read_b64_tr_b16 a[114:115], v214 offset:20480
    v_mfma_f32_16x16x32_bf16 v[4:7], a[96:99], v[164:167], v[4:7]
    v_mfma_f32_16x16x32_bf16 v[8:11], a[96:99], v[168:171], v[8:11]
    v_mfma_f32_16x16x32_bf16 v[12:15], a[96:99], v[172:175], v[12:15]
    s_waitcnt lgkmcnt(2)
    v_mfma_f32_16x16x32_bf16 v[16:19], a[104:107], v[160:163], v[16:19]
    ds_read_b64_tr_b16 a[120:121], v215 offset:16384
    ds_read_b64_tr_b16 a[122:123], v215 offset:20480
    v_mfma_f32_16x16x32_bf16 v[20:23], a[104:107], v[164:167], v[20:23]
    v_mfma_f32_16x16x32_bf16 v[24:27], a[104:107], v[168:171], v[24:27]
    v_mfma_f32_16x16x32_bf16 v[28:31], a[104:107], v[172:175], v[28:31]
    s_waitcnt lgkmcnt(2)
    v_mfma_f32_16x16x32_bf16 v[32:35], a[112:115], v[160:163], v[32:35]
    ds_read_b64_tr_b16 a[96:97], v216 offset:16384
    ds_read_b64_tr_b16 a[98:99], v216 offset:20480
    v_mfma_f32_16x16x32_bf16 v[36:39], a[112:115], v[164:167], v[36:39]
    v_cvt_pk_bf16_f32 v128, v0, v1
    v_cvt_pk_bf16_f32 v129, v2, v3
    v_cvt_pk_bf16_f32 v130, v16, v17
    v_cvt_pk_bf16_f32 v131, v18, v19
    buffer_store_dwordx4 v[128:131], v249, s[16:19], s40 offen offset:0 sc1
    v_mfma_f32_16x16x32_bf16 v[40:43], a[112:115], v[168:171], v[40:43]
    v_mfma_f32_16x16x32_bf16 v[44:47], a[112:115], v[172:175], v[44:47]
    v_cvt_pk_bf16_f32 v132, v4, v5
    v_cvt_pk_bf16_f32 v133, v6, v7
    v_cvt_pk_bf16_f32 v134, v20, v21
    v_cvt_pk_bf16_f32 v135, v22, v23
    buffer_store_dwordx4 v[132:135], v249, s[16:19], s41 offen offset:0 sc1
    s_waitcnt lgkmcnt(2)
    v_mfma_f32_16x16x32_bf16 v[48:51], a[120:123], v[160:163], v[48:51]
    ds_read_b64_tr_b16 a[104:105], v217 offset:16384
    ds_read_b64_tr_b16 a[106:107], v217 offset:20480
    v_mfma_f32_16x16x32_bf16 v[52:55], a[120:123], v[164:167], v[52:55]
    v_cvt_pk_bf16_f32 v136, v8, v9
    v_cvt_pk_bf16_f32 v137, v10, v11
    v_cvt_pk_bf16_f32 v138, v24, v25
    v_cvt_pk_bf16_f32 v139, v26, v27
    buffer_store_dwordx4 v[136:139], v249, s[16:19], s42 offen offset:0 sc1
    v_mfma_f32_16x16x32_bf16 v[56:59], a[120:123], v[168:171], v[56:59]
    v_mfma_f32_16x16x32_bf16 v[60:63], a[120:123], v[172:175], v[60:63]
    v_cvt_pk_bf16_f32 v140, v12, v13
    v_cvt_pk_bf16_f32 v141, v14, v15
    v_cvt_pk_bf16_f32 v142, v28, v29
    v_cvt_pk_bf16_f32 v143, v30, v31
    buffer_store_dwordx4 v[140:143], v249, s[16:19], s43 offen offset:0 sc1
    s_waitcnt lgkmcnt(2)
    v_mfma_f32_16x16x32_bf16 v[64:67], a[96:99], v[160:163], v[64:67]
    ds_read_b64_tr_b16 a[112:113], v218 offset:16384
    ds_read_b64_tr_b16 a[114:115], v218 offset:20480
    v_mfma_f32_16x16x32_bf16 v[68:71], a[96:99], v[164:167], v[68:71]
    v_cvt_pk_bf16_f32 v144, v32, v33
    v_cvt_pk_bf16_f32 v145, v34, v35
    v_cvt_pk_bf16_f32 v146, v48, v49
    v_cvt_pk_bf16_f32 v147, v50, v51
    buffer_store_dwordx4 v[144:147], v249, s[16:19], s40 offen offset:1024 sc1
    v_mfma_f32_16x16x32_bf16 v[72:75], a[96:99], v[168:171], v[72:75]
    v_mfma_f32_16x16x32_bf16 v[76:79], a[96:99], v[172:175], v[76:79]
    v_cvt_pk_bf16_f32 v148, v36, v37
    v_cvt_pk_bf16_f32 v149, v38, v39
    v_cvt_pk_bf16_f32 v150, v52, v53
    v_cvt_pk_bf16_f32 v151, v54, v55
    buffer_store_dwordx4 v[148:151], v249, s[16:19], s41 offen offset:1024 sc1
    s_waitcnt lgkmcnt(2)
    v_mfma_f32_16x16x32_bf16 v[80:83], a[104:107], v[160:163], v[80:83]
    ds_read_b64_tr_b16 a[120:121], v219 offset:16384
    ds_read_b64_tr_b16 a[122:123], v219 offset:20480
    v_mfma_f32_16x16x32_bf16 v[84:87], a[104:107], v[164:167], v[84:87]
    v_cvt_pk_bf16_f32 v152, v40, v41
    v_cvt_pk_bf16_f32 v153, v42, v43
    v_cvt_pk_bf16_f32 v154, v56, v57
    v_cvt_pk_bf16_f32 v155, v58, v59
    buffer_store_dwordx4 v[152:155], v249, s[16:19], s42 offen offset:1024 sc1
    v_mfma_f32_16x16x32_bf16 v[88:91], a[104:107], v[168:171], v[88:91]
    v_mfma_f32_16x16x32_bf16 v[92:95], a[104:107], v[172:175], v[92:95]
    v_cvt_pk_bf16_f32 v156, v44, v45
    v_cvt_pk_bf16_f32 v157, v46, v47
    v_cvt_pk_bf16_f32 v158, v60, v61
    v_cvt_pk_bf16_f32 v159, v62, v63
    buffer_store_dwordx4 v[156:159], v249, s[16:19], s43 offen offset:1024 sc1
    s_waitcnt lgkmcnt(2)
    v_mfma_f32_16x16x32_bf16 v[96:99], a[112:115], v[160:163], v[96:99]
    v_mfma_f32_16x16x32_bf16 v[100:103], a[112:115], v[164:167], v[100:103]
    v_cvt_pk_bf16_f32 v128, v64, v65
    v_cvt_pk_bf16_f32 v129, v66, v67
    v_cvt_pk_bf16_f32 v130, v80, v81
    v_cvt_pk_bf16_f32 v131, v82, v83
    buffer_store_dwordx4 v[128:131], v249, s[16:19], s40 offen offset:2048 sc1
    v_mfma_f32_16x16x32_bf16 v[104:107], a[112:115], v[168:171], v[104:107]
    v_mfma_f32_16x16x32_bf16 v[108:111], a[112:115], v[172:175], v[108:111]
    v_cvt_pk_bf16_f32 v132, v68, v69
    v_cvt_pk_bf16_f32 v133, v70, v71
    v_cvt_pk_bf16_f32 v134, v84, v85
    v_cvt_pk_bf16_f32 v135, v86, v87
    buffer_store_dwordx4 v[132:135], v249, s[16:19], s41 offen offset:2048 sc1
    s_waitcnt lgkmcnt(0)
    v_mfma_f32_16x16x32_bf16 v[112:115], a[120:123], v[160:163], v[112:115]
    v_mfma_f32_16x16x32_bf16 v[116:119], a[120:123], v[164:167], v[116:119]
    v_cvt_pk_bf16_f32 v136, v72, v73
    v_cvt_pk_bf16_f32 v137, v74, v75
    v_cvt_pk_bf16_f32 v138, v88, v89
    v_cvt_pk_bf16_f32 v139, v90, v91
    buffer_store_dwordx4 v[136:139], v249, s[16:19], s42 offen offset:2048 sc1
    v_mfma_f32_16x16x32_bf16 v[120:123], a[120:123], v[168:171], v[120:123]
    v_mfma_f32_16x16x32_bf16 v[124:127], a[120:123], v[172:175], v[124:127]
    v_cvt_pk_bf16_f32 v140, v76, v77
    v_cvt_pk_bf16_f32 v141, v78, v79
    v_cvt_pk_bf16_f32 v142, v92, v93
    v_cvt_pk_bf16_f32 v143, v94, v95
    buffer_store_dwordx4 v[140:143], v249, s[16:19], s43 offen offset:2048 sc1
    v_cvt_pk_bf16_f32 v144, v96, v97
    v_cvt_pk_bf16_f32 v145, v98, v99
    v_cvt_pk_bf16_f32 v146, v112, v113
    v_cvt_pk_bf16_f32 v147, v114, v115
    buffer_store_dwordx4 v[144:147], v249, s[16:19], s40 offen offset:3072 sc1
    v_cvt_pk_bf16_f32 v148, v100, v101
    v_cvt_pk_bf16_f32 v149, v102, v103
    v_cvt_pk_bf16_f32 v150, v116, v117
    v_cvt_pk_bf16_f32 v151, v118, v119
    buffer_store_dwordx4 v[148:151], v249, s[16:19], s41 offen offset:3072 sc1
    v_cvt_pk_bf16_f32 v152, v104, v105
    v_cvt_pk_bf16_f32 v153, v106, v107
    v_cvt_pk_bf16_f32 v154, v120, v121
    v_cvt_pk_bf16_f32 v155, v122, v123
    buffer_store_dwordx4 v[152:155], v249, s[16:19], s42 offen offset:3072 sc1
    v_cvt_pk_bf16_f32 v156, v108, v109
    v_cvt_pk_bf16_f32 v157, v110, v111
    v_cvt_pk_bf16_f32 v158, v124, v125
    v_cvt_pk_bf16_f32 v159, v126, v127
    buffer_store_dwordx4 v[156:159], v249, s[16:19], s43 offen offset:3072 sc1
    v_mov_b32 v250, 0
    v_mov_b32 v251, 0
    v_mov_b32 v252, 0
    v_mov_b32 v253, 0
    s_branch L2_lm
L2_post2:
    s_lshl_b32 s33, s78, 7
    s_add_u32 s33, s33, s73
    v_lshrrev_b32 v240, 4, v221
    v_lshl_add_u32 v240, v240, 2, s33
    v_and_b32 v241, 31, v221
    v_lshl_add_u32 v241, v241, 2, s33

    s_mov_b32 s41, 0x20000
L2_hfw36:
    v_cmp_ne_u32 vcc, 1, v247
    s_cbranch_vccz L2_hfokw36
    s_sub_u32 s41, s41, 1
    s_cmp_eq_u32 s41, 0
    s_cbranch_scc1 L2_hfokw36
    s_sleep 2
    buffer_load_dword v247, v248, s[20:23], s39 offen sc1
    s_waitcnt vmcnt(0)
    s_branch L2_hfw36

L2_hfokw36:
    s_add_u32 s12, s4, 9502720
    s_addc_u32 s13, s5, 0
    s_mov_b32 s14, 65536
    s_mov_b32 s15, 0x20000
    s_lshl_b32 s33, s26, 13
    s_add_u32 s33, s33, 4096
    s_add_u32 s1, s33, 32768
    v_lshlrev_b32 v249, 4, v221
    s_mul_i32 s40, s25, 3211264
    s_add_u32 s40, s40, s35
    s_xor_b32 s41, s40, 4096
    s_xor_b32 s42, s40, 8192
    s_xor_b32 s43, s40, 12288
    s_cmp_eq_u32 s82, 1
    s_cselect_b32 s40, 0x7ff00000, s40

    s_mov_b32 s88, s30
    s_mov_b32 s89, s31
    s_mov_b32 s90, 0
    v_mfma_f32_16x16x32_bf16 v[192:195], a[64:67], a[0:3], 0
    v_exp_f32 v204, v204
    v_mfma_f32_16x16x32_bf16 v[192:195], a[68:71], a[4:7], v[192:195]
    v_exp_f32 v205, v205
    v_mfma_f32_16x16x32_bf16 v[192:195], a[72:75], a[8:11], v[192:195]
    v_exp_f32 v206, v206
    v_mfma_f32_16x16x32_bf16 v[192:195], a[76:79], a[12:15], v[192:195]
    v_exp_f32 v207, v207
    v_mfma_f32_16x16x32_bf16 v[0:3], a[96:99], v[128:131], v[0:3]
    v_cvt_pk_bf16_f32 v158, v204, v205
    v_cvt_pk_bf16_f32 v159, v206, v207
    v_mfma_f32_16x16x32_bf16 v[0:3], a[100:103], v[144:147], v[0:3]
    ds_read_b64_tr_b16 a[112:113], v214 offset:32768
    ds_read_b64_tr_b16 a[114:115], v214 offset:36864
    v_mfma_f32_16x16x32_bf16 v[4:7], a[100:103], v[148:151], v[4:7]
    ds_read_b128 a[80:83], v208 offset:53248
    ds_read_b128 a[84:87], v209 offset:53248
    v_mfma_f32_16x16x32_bf16 v[4:7], a[96:99], v[132:135], v[4:7]
    ds_read2_b32 v[222:223], v240 offset0:32 offset1:36
    ds_read2_b32 v[224:225], v240 offset0:40 offset1:44
    v_mfma_f32_16x16x32_bf16 v[196:199], a[64:67], a[16:19], 0
    v_exp_f32 v192, v192
    v_mfma_f32_16x16x32_bf16 v[196:199], a[68:71], a[20:23], v[196:199]
    v_exp_f32 v193, v193
    v_mfma_f32_16x16x32_bf16 v[196:199], a[72:75], a[24:27], v[196:199]
    v_exp_f32 v194, v194
    v_mfma_f32_16x16x32_bf16 v[196:199], a[76:79], a[28:31], v[196:199]
    v_exp_f32 v195, v195
    v_mfma_f32_16x16x32_bf16 v[8:11], a[96:99], v[136:139], v[8:11]
    v_cvt_pk_bf16_f32 v160, v192, v193
    v_cvt_pk_bf16_f32 v161, v194, v195
    v_mfma_f32_16x16x32_bf16 v[8:11], a[100:103], v[152:155], v[8:11]
    ds_read_b64_tr_b16 a[116:117], v214 offset:40960
    ds_read_b64_tr_b16 a[118:119], v214 offset:45056
    v_mfma_f32_16x16x32_bf16 v[12:15], a[100:103], v[156:159], v[12:15]
    ds_read_b128 a[88:91], v210 offset:53248
    ds_read_b128 a[92:95], v211 offset:53248
    v_mfma_f32_16x16x32_bf16 v[12:15], a[96:99], v[140:143], v[12:15]
    s_waitcnt lgkmcnt(10)
    ds_read2_b32 v[226:227], v240 offset0:48 offset1:52
    v_mfma_f32_16x16x32_bf16 v[200:203], a[64:67], a[32:35], 0
    v_exp_f32 v196, v196
    v_mfma_f32_16x16x32_bf16 v[200:203], a[68:71], a[36:39], v[200:203]
    v_exp_f32 v197, v197
    v_mfma_f32_16x16x32_bf16 v[200:203], a[72:75], a[40:43], v[200:203]
    v_exp_f32 v198, v198
    v_mfma_f32_16x16x32_bf16 v[200:203], a[76:79], a[44:47], v[200:203]
    v_exp_f32 v199, v199
    v_mfma_f32_16x16x32_bf16 v[16:19], a[104:107], v[128:131], v[16:19]
    v_cvt_pk_bf16_f32 v164, v196, v197
    v_cvt_pk_bf16_f32 v165, v198, v199
    v_mfma_f32_16x16x32_bf16 v[16:19], a[108:111], v[144:147], v[16:19]
    ds_read_b64_tr_b16 a[120:121], v215 offset:32768
    ds_read_b64_tr_b16 a[122:123], v215 offset:36864
    ds_read2_b32 v[228:229], v240 offset0:56 offset1:60
    v_mfma_f32_16x16x32_bf16 v[20:23], a[108:111], v[148:151], v[20:23]
    s_mov_b32 m0, s75
    s_waitcnt lgkmcnt(9)
    v_bitop3_b32 v222, v222, -16, v238 bitop3:0x6a
    v_mfma_f32_16x16x32_bf16 v[20:23], a[104:107], v[132:135], v[20:23]
    buffer_load_dwordx4 v222, s[8:11], 0 offen sc1 lds
    v_mfma_f32_16x16x32_bf16 v[204:207], a[64:67], a[48:51], 0
    v_exp_f32 v200, v200
    v_mfma_f32_16x16x32_bf16 v[204:207], a[68:71], a[52:55], v[204:207]
    v_exp_f32 v201, v201
    v_mfma_f32_16x16x32_bf16 v[204:207], a[72:75], a[56:59], v[204:207]
    v_exp_f32 v202, v202
    v_mfma_f32_16x16x32_bf16 v[204:207], a[76:79], a[60:63], v[204:207]
    v_exp_f32 v203, v203
    v_mfma_f32_16x16x32_bf16 v[24:27], a[104:107], v[136:139], v[24:27]
    v_cvt_pk_bf16_f32 v168, v200, v201
    v_cvt_pk_bf16_f32 v169, v202, v203
    v_mfma_f32_16x16x32_bf16 v[24:27], a[108:111], v[152:155], v[24:27]
    ds_read_b64_tr_b16 a[124:125], v215 offset:40960
    ds_read_b64_tr_b16 a[126:127], v215 offset:45056
    v_mfma_f32_16x16x32_bf16 v[28:31], a[108:111], v[156:159], v[28:31]
    s_add_u32 m0, s75, 1024
    v_bitop3_b32 v223, v223, -16, v239 bitop3:0x6a
    v_mfma_f32_16x16x32_bf16 v[28:31], a[104:107], v[140:143], v[28:31]
    s_waitcnt lgkmcnt(6)
    buffer_load_dwordx4 v223, s[8:11], 0 offen sc1 lds
    v_mfma_f32_16x16x32_bf16 v[192:195], a[80:83], a[0:3], 0
    v_exp_f32 v204, v204
    v_mfma_f32_16x16x32_bf16 v[192:195], a[84:87], a[4:7], v[192:195]
    v_exp_f32 v205, v205
    v_mfma_f32_16x16x32_bf16 v[192:195], a[88:91], a[8:11], v[192:195]
    v_exp_f32 v206, v206
    v_mfma_f32_16x16x32_bf16 v[192:195], a[92:95], a[12:15], v[192:195]
    v_exp_f32 v207, v207
    v_mfma_f32_16x16x32_bf16 v[32:35], a[112:115], v[128:131], v[32:35]
    v_cvt_pk_bf16_f32 v172, v204, v205
    v_cvt_pk_bf16_f32 v173, v206, v207
    v_mfma_f32_16x16x32_bf16 v[32:35], a[116:119], v[144:147], v[32:35]
    ds_read_b64_tr_b16 a[96:97], v216 offset:32768
    ds_read_b64_tr_b16 a[98:99], v216 offset:36864
    ds_read_b32 v255, v254
    v_mfma_f32_16x16x32_bf16 v[36:39], a[116:119], v[148:151], v[36:39]
    s_add_u32 m0, s75, 2048
    v_bitop3_b32 v224, v224, -16, v238 bitop3:0x6a
    v_mfma_f32_16x16x32_bf16 v[36:39], a[112:115], v[132:135], v[36:39]
    buffer_load_dwordx4 v224, s[8:11], 0 offen sc1 lds
    v_mfma_f32_16x16x32_bf16 v[196:199], a[80:83], a[16:19], 0
    v_exp_f32 v192, v192
    v_mfma_f32_16x16x32_bf16 v[196:199], a[84:87], a[20:23], v[196:199]
    v_exp_f32 v193, v193
    v_mfma_f32_16x16x32_bf16 v[196:199], a[88:91], a[24:27], v[196:199]
    v_exp_f32 v194, v194
    v_mfma_f32_16x16x32_bf16 v[196:199], a[92:95], a[28:31], v[196:199]
    v_exp_f32 v195, v195
    v_mfma_f32_16x16x32_bf16 v[40:43], a[112:115], v[136:139], v[40:43]
    v_cvt_pk_bf16_f32 v162, v192, v193
    v_cvt_pk_bf16_f32 v163, v194, v195
    v_mfma_f32_16x16x32_bf16 v[40:43], a[116:119], v[152:155], v[40:43]
    ds_read_b64_tr_b16 a[100:101], v216 offset:40960
    ds_read_b64_tr_b16 a[102:103], v216 offset:45056
    v_mfma_f32_16x16x32_bf16 v[44:47], a[116:119], v[156:159], v[44:47]
    s_add_u32 m0, s75, 3072
    v_bitop3_b32 v225, v225, -16, v239 bitop3:0x6a
    v_mfma_f32_16x16x32_bf16 v[44:47], a[112:115], v[140:143], v[44:47]
    s_waitcnt lgkmcnt(5)
    buffer_load_dwordx4 v225, s[8:11], 0 offen sc1 lds
    v_mfma_f32_16x16x32_bf16 v[200:203], a[80:83], a[32:35], 0
    v_exp_f32 v196, v196
    v_mfma_f32_16x16x32_bf16 v[200:203], a[84:87], a[36:39], v[200:203]
    v_exp_f32 v197, v197
    v_mfma_f32_16x16x32_bf16 v[200:203], a[88:91], a[40:43], v[200:203]
    v_exp_f32 v198, v198
    v_mfma_f32_16x16x32_bf16 v[200:203], a[92:95], a[44:47], v[200:203]
    v_exp_f32 v199, v199
    v_mfma_f32_16x16x32_bf16 v[48:51], a[120:123], v[128:131], v[48:51]
    v_cvt_pk_bf16_f32 v166, v196, v197
    v_cvt_pk_bf16_f32 v167, v198, v199
    v_mfma_f32_16x16x32_bf16 v[48:51], a[124:127], v[144:147], v[48:51]
    ds_read_b64_tr_b16 a[104:105], v217 offset:32768
    ds_read_b64_tr_b16 a[106:107], v217 offset:36864
    v_mfma_f32_16x16x32_bf16 v[52:55], a[124:127], v[148:151], v[52:55]
    s_add_u32 m0, s75, 4096
    v_bitop3_b32 v226, v226, -16, v238 bitop3:0x6a
    v_mfma_f32_16x16x32_bf16 v[52:55], a[120:123], v[132:135], v[52:55]
    buffer_load_dwordx4 v226, s[8:11], 0 offen sc1 lds
    v_mfma_f32_16x16x32_bf16 v[204:207], a[80:83], a[48:51], 0
    v_exp_f32 v200, v200
    v_mfma_f32_16x16x32_bf16 v[204:207], a[84:87], a[52:55], v[204:207]
    v_exp_f32 v201, v201
    v_mfma_f32_16x16x32_bf16 v[204:207], a[88:91], a[56:59], v[204:207]
    v_exp_f32 v202, v202
    v_mfma_f32_16x16x32_bf16 v[204:207], a[92:95], a[60:63], v[204:207]
    v_exp_f32 v203, v203
    v_mfma_f32_16x16x32_bf16 v[56:59], a[120:123], v[136:139], v[56:59]
    v_cvt_pk_bf16_f32 v170, v200, v201
    v_cvt_pk_bf16_f32 v171, v202, v203
    v_mfma_f32_16x16x32_bf16 v[56:59], a[124:127], v[152:155], v[56:59]
    ds_read_b64_tr_b16 a[108:109], v217 offset:40960
    ds_read_b64_tr_b16 a[110:111], v217 offset:45056
    v_mfma_f32_16x16x32_bf16 v[60:63], a[124:127], v[156:159], v[60:63]
    s_add_u32 m0, s75, 5120
    v_bitop3_b32 v227, v227, -16, v239 bitop3:0x6a
    v_mfma_f32_16x16x32_bf16 v[60:63], a[120:123], v[140:143], v[60:63]
    s_waitcnt lgkmcnt(4)
    buffer_load_dwordx4 v227, s[8:11], 0 offen sc1 lds
    v_exp_f32 v204, v204
    v_exp_f32 v205, v205
    v_exp_f32 v206, v206
    v_exp_f32 v207, v207
    v_mfma_f32_16x16x32_bf16 v[64:67], a[96:99], v[128:131], v[64:67]
    v_cvt_pk_bf16_f32 v174, v204, v205
    v_cvt_pk_bf16_f32 v175, v206, v207
    v_cmp_lt_u32 vcc, v255, v250
    v_mfma_f32_16x16x32_bf16 v[64:67], a[100:103], v[144:147], v[64:67]
    ds_read_b64_tr_b16 a[112:113], v218 offset:32768
    ds_read_b64_tr_b16 a[114:115], v218 offset:36864
    v_mfma_f32_16x16x32_bf16 v[68:71], a[100:103], v[148:151], v[68:71]
    s_add_u32 m0, s75, 6144
    v_bitop3_b32 v228, v228, -16, v238 bitop3:0x6a
    v_mfma_f32_16x16x32_bf16 v[68:71], a[96:99], v[132:135], v[68:71]
    buffer_load_dwordx4 v228, s[8:11], 0 offen sc1 lds
    v_mfma_f32_16x16x32_bf16 v[72:75], a[96:99], v[136:139], v[72:75]
    s_cbranch_vccnz L2_spe36
L2_spre36:
    v_mfma_f32_16x16x32_bf16 v[72:75], a[100:103], v[152:155], v[72:75]
    ds_read_b64_tr_b16 a[116:117], v218 offset:40960
    ds_read_b64_tr_b16 a[118:119], v218 offset:45056
    v_mfma_f32_16x16x32_bf16 v[76:79], a[100:103], v[156:159], v[76:79]
    s_add_u32 m0, s75, 7168
    v_bitop3_b32 v229, v229, -16, v239 bitop3:0x6a
    v_mfma_f32_16x16x32_bf16 v[76:79], a[96:99], v[140:143], v[76:79]
    s_waitcnt lgkmcnt(4)
    buffer_load_dwordx4 v229, s[8:11], 0 offen sc1 lds
    v_mfma_f32_16x16x32_bf16 v[80:83], a[104:107], v[128:131], v[80:83]
    s_waitcnt vmcnt(8)
    v_mfma_f32_16x16x32_bf16 v[80:83], a[108:111], v[144:147], v[80:83]
    ds_read_b64_tr_b16 a[120:121], v219 offset:32768
    ds_read_b64_tr_b16 a[122:123], v219 offset:36864
    v_mfma_f32_16x16x32_bf16 v[84:87], a[108:111], v[148:151], v[84:87]
    s_mov_b32 m0, s28
    v_mfma_f32_16x16x32_bf16 v[84:87], a[104:107], v[132:135], v[84:87]
    buffer_load_dwordx4 v249, s[12:15], s33 offen offset:0 sc1 lds
    v_mfma_f32_16x16x32_bf16 v[88:91], a[104:107], v[136:139], v[88:91]
    v_mfma_f32_16x16x32_bf16 v[88:91], a[108:111], v[152:155], v[88:91]
    ds_read_b64_tr_b16 a[124:125], v219 offset:40960
    ds_read_b64_tr_b16 a[126:127], v219 offset:45056
    v_mfma_f32_16x16x32_bf16 v[92:95], a[108:111], v[156:159], v[92:95]
    v_mfma_f32_16x16x32_bf16 v[92:95], a[104:107], v[140:143], v[92:95]
    s_waitcnt lgkmcnt(4)
    buffer_load_dwordx4 v249, s[12:15], s33 offen offset:1024 sc1 lds
    v_mfma_f32_16x16x32_bf16 v[96:99], a[112:115], v[128:131], v[96:99]
    buffer_load_dwordx4 v249, s[12:15], s33 offen offset:2048 sc1 lds
    v_mfma_f32_16x16x32_bf16 v[96:99], a[116:119], v[144:147], v[96:99]
    ds_read_b64_tr_b16 a[96:97], v212 offset:49152
    ds_read_b64_tr_b16 a[98:99], v212 offset:53248
    v_mfma_f32_16x16x32_bf16 v[100:103], a[116:119], v[148:151], v[100:103]
    v_mfma_f32_16x16x32_bf16 v[100:103], a[112:115], v[132:135], v[100:103]
    buffer_load_dwordx4 v249, s[12:15], s33 offen offset:3072 sc1 lds
    v_mfma_f32_16x16x32_bf16 v[104:107], a[112:115], v[136:139], v[104:107]
    s_mov_b32 m0, s29
    v_mfma_f32_16x16x32_bf16 v[104:107], a[116:119], v[152:155], v[104:107]
    buffer_load_dwordx4 v249, s[12:15], s1 offen offset:0 sc1 lds
    v_mfma_f32_16x16x32_bf16 v[108:111], a[116:119], v[156:159], v[108:111]
    v_mfma_f32_16x16x32_bf16 v[108:111], a[112:115], v[140:143], v[108:111]
    s_waitcnt lgkmcnt(2)
    buffer_load_dwordx4 v249, s[12:15], s1 offen offset:1024 sc1 lds
    v_mfma_f32_16x16x32_bf16 v[112:115], a[120:123], v[128:131], v[112:115]
    v_mfma_f32_16x16x32_bf16 v[112:115], a[124:127], v[144:147], v[112:115]
    ds_read_b64_tr_b16 a[104:105], v213 offset:49152
    ds_read_b64_tr_b16 a[106:107], v213 offset:53248
    v_mfma_f32_16x16x32_bf16 v[116:119], a[124:127], v[148:151], v[116:119]
    v_mfma_f32_16x16x32_bf16 v[116:119], a[120:123], v[132:135], v[116:119]
    buffer_load_dwordx4 v249, s[12:15], s1 offen offset:2048 sc1 lds
    v_mfma_f32_16x16x32_bf16 v[120:123], a[120:123], v[136:139], v[120:123]
    v_mfma_f32_16x16x32_bf16 v[120:123], a[124:127], v[152:155], v[120:123]
    buffer_load_dwordx4 v249, s[12:15], s1 offen offset:3072 sc1 lds
    v_mfma_f32_16x16x32_bf16 v[124:127], a[124:127], v[156:159], v[124:127]
    v_mfma_f32_16x16x32_bf16 v[124:127], a[120:123], v[140:143], v[124:127]
    s_waitcnt lgkmcnt(2)
    v_mfma_f32_16x16x32_bf16 v[0:3], a[96:99], v[160:163], v[0:3]
    ds_read_b64_tr_b16 a[112:113], v214 offset:49152
    ds_read_b64_tr_b16 a[114:115], v214 offset:53248
    v_mfma_f32_16x16x32_bf16 v[4:7], a[96:99], v[164:167], v[4:7]
    v_mfma_f32_16x16x32_bf16 v[8:11], a[96:99], v[168:171], v[8:11]
    v_mfma_f32_16x16x32_bf16 v[12:15], a[96:99], v[172:175], v[12:15]
    s_waitcnt lgkmcnt(2)
    v_mfma_f32_16x16x32_bf16 v[16:19], a[104:107], v[160:163], v[16:19]
    ds_read_b64_tr_b16 a[120:121], v215 offset:49152
    ds_read_b64_tr_b16 a[122:123], v215 offset:53248
    v_mfma_f32_16x16x32_bf16 v[20:23], a[104:107], v[164:167], v[20:23]
    v_mfma_f32_16x16x32_bf16 v[24:27], a[104:107], v[168:171], v[24:27]
    v_mfma_f32_16x16x32_bf16 v[28:31], a[104:107], v[172:175], v[28:31]
    s_waitcnt lgkmcnt(2)
    v_mfma_f32_16x16x32_bf16 v[32:35], a[112:115], v[160:163], v[32:35]
    ds_read_b64_tr_b16 a[96:97], v216 offset:49152
    ds_read_b64_tr_b16 a[98:99], v216 offset:53248
    v_mfma_f32_16x16x32_bf16 v[36:39], a[112:115], v[164:167], v[36:39]
    v_cvt_pk_bf16_f32 v128, v0, v1
    v_cvt_pk_bf16_f32 v129, v2, v3
    v_cvt_pk_bf16_f32 v130, v16, v17
    v_cvt_pk_bf16_f32 v131, v18, v19
    buffer_store_dwordx4 v[128:131], v249, s[16:19], s40 offen offset:0 sc1
    v_mfma_f32_16x16x32_bf16 v[40:43], a[112:115], v[168:171], v[40:43]
    v_mfma_f32_16x16x32_bf16 v[44:47], a[112:115], v[172:175], v[44:47]
    v_cvt_pk_bf16_f32 v132, v4, v5
    v_cvt_pk_bf16_f32 v133, v6, v7
    v_cvt_pk_bf16_f32 v134, v20, v21
    v_cvt_pk_bf16_f32 v135, v22, v23
    buffer_store_dwordx4 v[132:135], v249, s[16:19], s41 offen offset:0 sc1
    s_waitcnt lgkmcnt(2)
    v_mfma_f32_16x16x32_bf16 v[48:51], a[120:123], v[160:163], v[48:51]
    ds_read_b64_tr_b16 a[104:105], v217 offset:49152
    ds_read_b64_tr_b16 a[106:107], v217 offset:53248
    v_mfma_f32_16x16x32_bf16 v[52:55], a[120:123], v[164:167], v[52:55]
    v_cvt_pk_bf16_f32 v136, v8, v9
    v_cvt_pk_bf16_f32 v137, v10, v11
    v_cvt_pk_bf16_f32 v138, v24, v25
    v_cvt_pk_bf16_f32 v139, v26, v27
    buffer_store_dwordx4 v[136:139], v249, s[16:19], s42 offen offset:0 sc1
    v_mfma_f32_16x16x32_bf16 v[56:59], a[120:123], v[168:171], v[56:59]
    v_mfma_f32_16x16x32_bf16 v[60:63], a[120:123], v[172:175], v[60:63]
    v_cvt_pk_bf16_f32 v140, v12, v13
    v_cvt_pk_bf16_f32 v141, v14, v15
    v_cvt_pk_bf16_f32 v142, v28, v29
    v_cvt_pk_bf16_f32 v143, v30, v31
    buffer_store_dwordx4 v[140:143], v249, s[16:19], s43 offen offset:0 sc1
    s_waitcnt lgkmcnt(2)
    v_mfma_f32_16x16x32_bf16 v[64:67], a[96:99], v[160:163], v[64:67]
    ds_read_b64_tr_b16 a[112:113], v218 offset:49152
    ds_read_b64_tr_b16 a[114:115], v218 offset:53248
    v_mfma_f32_16x16x32_bf16 v[68:71], a[96:99], v[164:167], v[68:71]
    v_cvt_pk_bf16_f32 v144, v32, v33
    v_cvt_pk_bf16_f32 v145, v34, v35
    v_cvt_pk_bf16_f32 v146, v48, v49
    v_cvt_pk_bf16_f32 v147, v50, v51
    buffer_store_dwordx4 v[144:147], v249, s[16:19], s40 offen offset:1024 sc1
    v_mfma_f32_16x16x32_bf16 v[72:75], a[96:99], v[168:171], v[72:75]
    v_mfma_f32_16x16x32_bf16 v[76:79], a[96:99], v[172:175], v[76:79]
    v_cvt_pk_bf16_f32 v148, v36, v37
    v_cvt_pk_bf16_f32 v149, v38, v39
    v_cvt_pk_bf16_f32 v150, v52, v53
    v_cvt_pk_bf16_f32 v151, v54, v55
    buffer_store_dwordx4 v[148:151], v249, s[16:19], s41 offen offset:1024 sc1
    s_waitcnt lgkmcnt(2)
    v_mfma_f32_16x16x32_bf16 v[80:83], a[104:107], v[160:163], v[80:83]
    ds_read_b64_tr_b16 a[120:121], v219 offset:49152
    ds_read_b64_tr_b16 a[122:123], v219 offset:53248
    v_mfma_f32_16x16x32_bf16 v[84:87], a[104:107], v[164:167], v[84:87]
    v_cvt_pk_bf16_f32 v152, v40, v41
    v_cvt_pk_bf16_f32 v153, v42, v43
    v_cvt_pk_bf16_f32 v154, v56, v57
    v_cvt_pk_bf16_f32 v155, v58, v59
    buffer_store_dwordx4 v[152:155], v249, s[16:19], s42 offen offset:1024 sc1
    v_mfma_f32_16x16x32_bf16 v[88:91], a[104:107], v[168:171], v[88:91]
    v_mfma_f32_16x16x32_bf16 v[92:95], a[104:107], v[172:175], v[92:95]
    v_cvt_pk_bf16_f32 v156, v44, v45
    v_cvt_pk_bf16_f32 v157, v46, v47
    v_cvt_pk_bf16_f32 v158, v60, v61
    v_cvt_pk_bf16_f32 v159, v62, v63
    buffer_store_dwordx4 v[156:159], v249, s[16:19], s43 offen offset:1024 sc1
    s_waitcnt lgkmcnt(2)
    v_mfma_f32_16x16x32_bf16 v[96:99], a[112:115], v[160:163], v[96:99]
    v_mfma_f32_16x16x32_bf16 v[100:103], a[112:115], v[164:167], v[100:103]
    v_cvt_pk_bf16_f32 v128, v64, v65
    v_cvt_pk_bf16_f32 v129, v66, v67
    v_cvt_pk_bf16_f32 v130, v80, v81
    v_cvt_pk_bf16_f32 v131, v82, v83
    buffer_store_dwordx4 v[128:131], v249, s[16:19], s40 offen offset:2048 sc1
    v_mfma_f32_16x16x32_bf16 v[104:107], a[112:115], v[168:171], v[104:107]
    v_mfma_f32_16x16x32_bf16 v[108:111], a[112:115], v[172:175], v[108:111]
    v_cvt_pk_bf16_f32 v132, v68, v69
    v_cvt_pk_bf16_f32 v133, v70, v71
    v_cvt_pk_bf16_f32 v134, v84, v85
    v_cvt_pk_bf16_f32 v135, v86, v87
    buffer_store_dwordx4 v[132:135], v249, s[16:19], s41 offen offset:2048 sc1
    s_waitcnt lgkmcnt(0)
    v_mfma_f32_16x16x32_bf16 v[112:115], a[120:123], v[160:163], v[112:115]
    v_mfma_f32_16x16x32_bf16 v[116:119], a[120:123], v[164:167], v[116:119]
    v_cvt_pk_bf16_f32 v136, v72, v73
    v_cvt_pk_bf16_f32 v137, v74, v75
    v_cvt_pk_bf16_f32 v138, v88, v89
    v_cvt_pk_bf16_f32 v139, v90, v91
    buffer_store_dwordx4 v[136:139], v249, s[16:19], s42 offen offset:2048 sc1
    v_mfma_f32_16x16x32_bf16 v[120:123], a[120:123], v[168:171], v[120:123]
    v_mfma_f32_16x16x32_bf16 v[124:127], a[120:123], v[172:175], v[124:127]
    v_cvt_pk_bf16_f32 v140, v76, v77
    v_cvt_pk_bf16_f32 v141, v78, v79
    v_cvt_pk_bf16_f32 v142, v92, v93
    v_cvt_pk_bf16_f32 v143, v94, v95
    buffer_store_dwordx4 v[140:143], v249, s[16:19], s43 offen offset:2048 sc1
    v_cvt_pk_bf16_f32 v144, v96, v97
    v_cvt_pk_bf16_f32 v145, v98, v99
    v_cvt_pk_bf16_f32 v146, v112, v113
    v_cvt_pk_bf16_f32 v147, v114, v115
    buffer_store_dwordx4 v[144:147], v249, s[16:19], s40 offen offset:3072 sc1
    v_cvt_pk_bf16_f32 v148, v100, v101
    v_cvt_pk_bf16_f32 v149, v102, v103
    v_cvt_pk_bf16_f32 v150, v116, v117
    v_cvt_pk_bf16_f32 v151, v118, v119
    buffer_store_dwordx4 v[148:151], v249, s[16:19], s41 offen offset:3072 sc1
    v_cvt_pk_bf16_f32 v152, v104, v105
    v_cvt_pk_bf16_f32 v153, v106, v107
    v_cvt_pk_bf16_f32 v154, v120, v121
    v_cvt_pk_bf16_f32 v155, v122, v123
    buffer_store_dwordx4 v[152:155], v249, s[16:19], s42 offen offset:3072 sc1
    v_cvt_pk_bf16_f32 v156, v108, v109
    v_cvt_pk_bf16_f32 v157, v110, v111
    v_cvt_pk_bf16_f32 v158, v124, v125
    v_cvt_pk_bf16_f32 v159, v126, v127
    buffer_store_dwordx4 v[156:159], v249, s[16:19], s43 offen offset:3072 sc1
    v_mov_b32 v250, 0
    v_mov_b32 v251, 0
    v_mov_b32 v252, 0
    v_mov_b32 v253, 0
    s_branch L2_lm
L2_store:
L2_lefts:
    s_cmp_ge_u32 s78, s3
    s_cbranch_scc1 L2_leftdones
    ds_read2_b32 v[222:223], v240 offset0:0 offset1:4
    ds_read2_b32 v[224:225], v240 offset0:8 offset1:12
    ds_read2_b32 v[226:227], v240 offset0:16 offset1:20
    ds_read2_b32 v[228:229], v240 offset0:24 offset1:28
    s_mov_b32 m0, s74
    s_waitcnt lgkmcnt(3)
    v_bitop3_b32 v222, v222, -16, v238 bitop3:0x6a
    buffer_load_dwordx4 v222, s[8:11], 0 offen sc1 lds
    s_add_u32 m0, s74, 1024
    v_bitop3_b32 v223, v223, -16, v239 bitop3:0x6a
    buffer_load_dwordx4 v223, s[8:11], 0 offen sc1 lds
    s_add_u32 m0, s74, 2048
    s_waitcnt lgkmcnt(2)
    v_bitop3_b32 v224, v224, -16, v238 bitop3:0x6a
    buffer_load_dwordx4 v224, s[8:11], 0 offen sc1 lds
    s_add_u32 m0, s74, 3072
    v_bitop3_b32 v225, v225, -16, v239 bitop3:0x6a
    buffer_load_dwordx4 v225, s[8:11], 0 offen sc1 lds
    s_add_u32 m0, s74, 4096
    s_waitcnt lgkmcnt(1)
    v_bitop3_b32 v226, v226, -16, v238 bitop3:0x6a
    buffer_load_dwordx4 v226, s[8:11], 0 offen sc1 lds
    s_add_u32 m0, s74, 5120
    v_bitop3_b32 v227, v227, -16, v239 bitop3:0x6a
    buffer_load_dwordx4 v227, s[8:11], 0 offen sc1 lds
    s_add_u32 m0, s74, 6144
    s_waitcnt lgkmcnt(0)
    v_bitop3_b32 v228, v228, -16, v238 bitop3:0x6a
    buffer_load_dwordx4 v228, s[8:11], 0 offen sc1 lds
    s_add_u32 m0, s74, 7168
    v_bitop3_b32 v229, v229, -16, v239 bitop3:0x6a
    buffer_load_dwordx4 v229, s[8:11], 0 offen sc1 lds
    ds_read_b32 v245, v241 offset:0
    ds_write_b128 v243, a[196:199]
    s_waitcnt lgkmcnt(1)
    v_and_b32 v245, 31, v245
    v_lshl_add_u32 v245, v245, 6, v242
    ds_write_b16 v245, v244
    ds_read_b128 a[192:195], v243
    s_waitcnt vmcnt(0)
    ds_read_b64_tr_b16 a[160:161], v230 offset:0
    ds_read_b64_tr_b16 a[162:163], v230 offset:4096
    ds_read_b64_tr_b16 a[164:165], v231 offset:0
    ds_read_b64_tr_b16 a[166:167], v231 offset:4096
    ds_read_b64_tr_b16 a[168:169], v232 offset:0
    ds_read_b64_tr_b16 a[170:171], v232 offset:4096
    ds_read_b64_tr_b16 a[172:173], v233 offset:0
    ds_read_b64_tr_b16 a[174:175], v233 offset:4096
    ds_read_b64_tr_b16 a[176:177], v234 offset:0
    ds_read_b64_tr_b16 a[178:179], v234 offset:4096
    ds_read_b64_tr_b16 a[180:181], v235 offset:0
    ds_read_b64_tr_b16 a[182:183], v235 offset:4096
    ds_read_b64_tr_b16 a[184:185], v236 offset:0
    ds_read_b64_tr_b16 a[186:187], v236 offset:4096
    ds_read_b64_tr_b16 a[188:189], v237 offset:0
    ds_read_b64_tr_b16 a[190:191], v237 offset:4096
    s_waitcnt lgkmcnt(14)
    v_mfma_f32_16x16x32_bf16 a[128:131], a[160:163], a[192:195], a[128:131]
    s_waitcnt lgkmcnt(12)
    v_mfma_f32_16x16x32_bf16 a[132:135], a[164:167], a[192:195], a[132:135]
    s_waitcnt lgkmcnt(10)
    v_mfma_f32_16x16x32_bf16 a[136:139], a[168:171], a[192:195], a[136:139]
    s_waitcnt lgkmcnt(8)
    v_mfma_f32_16x16x32_bf16 a[140:143], a[172:175], a[192:195], a[140:143]
    s_waitcnt lgkmcnt(6)
    v_mfma_f32_16x16x32_bf16 a[144:147], a[176:179], a[192:195], a[144:147]
    s_waitcnt lgkmcnt(4)
    v_mfma_f32_16x16x32_bf16 a[148:151], a[180:183], a[192:195], a[148:151]
    s_waitcnt lgkmcnt(2)
    v_mfma_f32_16x16x32_bf16 a[152:155], a[184:187], a[192:195], a[152:155]
    s_waitcnt lgkmcnt(0)
    v_mfma_f32_16x16x32_bf16 a[156:159], a[188:191], a[192:195], a[156:159]
    v_add_u32 v240, 128, v240
    v_add_u32 v241, 128, v241
    s_add_u32 s78, s78, 1
    s_branch L2_lefts
L2_leftdones:
    ds_read2_b32 v[222:223], v240 offset0:0 offset1:4
    ds_read2_b32 v[224:225], v240 offset0:8 offset1:12
    ds_read2_b32 v[226:227], v240 offset0:16 offset1:20
    ds_read2_b32 v[228:229], v240 offset0:24 offset1:28
    s_mov_b32 m0, s74
    s_waitcnt lgkmcnt(3)
    v_bitop3_b32 v222, v222, -16, v238 bitop3:0x6a
    buffer_load_dwordx4 v222, s[8:11], 0 offen sc1 lds
    s_add_u32 m0, s74, 1024
    v_bitop3_b32 v223, v223, -16, v239 bitop3:0x6a
    buffer_load_dwordx4 v223, s[8:11], 0 offen sc1 lds
    s_add_u32 m0, s74, 2048
    s_waitcnt lgkmcnt(2)
    v_bitop3_b32 v224, v224, -16, v238 bitop3:0x6a
    buffer_load_dwordx4 v224, s[8:11], 0 offen sc1 lds
    s_add_u32 m0, s74, 3072
    v_bitop3_b32 v225, v225, -16, v239 bitop3:0x6a
    buffer_load_dwordx4 v225, s[8:11], 0 offen sc1 lds
    s_add_u32 m0, s74, 4096
    s_waitcnt lgkmcnt(1)
    v_bitop3_b32 v226, v226, -16, v238 bitop3:0x6a
    buffer_load_dwordx4 v226, s[8:11], 0 offen sc1 lds
    s_add_u32 m0, s74, 5120
    v_bitop3_b32 v227, v227, -16, v239 bitop3:0x6a
    buffer_load_dwordx4 v227, s[8:11], 0 offen sc1 lds
    s_add_u32 m0, s74, 6144
    s_waitcnt lgkmcnt(0)
    v_bitop3_b32 v228, v228, -16, v238 bitop3:0x6a
    buffer_load_dwordx4 v228, s[8:11], 0 offen sc1 lds
    s_add_u32 m0, s74, 7168
    v_bitop3_b32 v229, v229, -16, v239 bitop3:0x6a
    buffer_load_dwordx4 v229, s[8:11], 0 offen sc1 lds
    ds_read2_b32 v[222:223], v240 offset0:32 offset1:36
    ds_read2_b32 v[224:225], v240 offset0:40 offset1:44
    ds_read2_b32 v[226:227], v240 offset0:48 offset1:52
    ds_read2_b32 v[228:229], v240 offset0:56 offset1:60
    s_mov_b32 m0, s75
    s_waitcnt lgkmcnt(3)
    v_bitop3_b32 v222, v222, -16, v238 bitop3:0x6a
    buffer_load_dwordx4 v222, s[8:11], 0 offen sc1 lds
    s_add_u32 m0, s75, 1024
    v_bitop3_b32 v223, v223, -16, v239 bitop3:0x6a
    buffer_load_dwordx4 v223, s[8:11], 0 offen sc1 lds
    s_add_u32 m0, s75, 2048
    s_waitcnt lgkmcnt(2)
    v_bitop3_b32 v224, v224, -16, v238 bitop3:0x6a
    buffer_load_dwordx4 v224, s[8:11], 0 offen sc1 lds
    s_add_u32 m0, s75, 3072
    v_bitop3_b32 v225, v225, -16, v239 bitop3:0x6a
    buffer_load_dwordx4 v225, s[8:11], 0 offen sc1 lds
    s_add_u32 m0, s75, 4096
    s_waitcnt lgkmcnt(1)
    v_bitop3_b32 v226, v226, -16, v238 bitop3:0x6a
    buffer_load_dwordx4 v226, s[8:11], 0 offen sc1 lds
    s_add_u32 m0, s75, 5120
    v_bitop3_b32 v227, v227, -16, v239 bitop3:0x6a
    buffer_load_dwordx4 v227, s[8:11], 0 offen sc1 lds
    s_add_u32 m0, s75, 6144
    s_waitcnt lgkmcnt(0)
    v_bitop3_b32 v228, v228, -16, v238 bitop3:0x6a
    buffer_load_dwordx4 v228, s[8:11], 0 offen sc1 lds
    s_add_u32 m0, s75, 7168
    v_bitop3_b32 v229, v229, -16, v239 bitop3:0x6a
    buffer_load_dwordx4 v229, s[8:11], 0 offen sc1 lds
    v_min_u32 v248, 3, v221
    v_lshlrev_b32 v248, 2, v248
    s_mov_b32 s39, 1061120
    buffer_load_dword v247, v248, s[20:23], s39 offen sc1
    s_waitcnt vmcnt(0)
    s_mov_b32 s41, 0x20000
L2_hfws:
    v_cmp_ne_u32 vcc, 1, v247
    s_cbranch_vccz L2_hfokws
    s_sub_u32 s41, s41, 1
    s_cmp_eq_u32 s41, 0
    s_cbranch_scc1 L2_hfokws
    s_sleep 2
    buffer_load_dword v247, v248, s[20:23], s39 offen sc1
    s_waitcnt vmcnt(0)
    s_branch L2_hfws

L2_hfokws:
    s_add_u32 s12, s4, 9502720
    s_addc_u32 s13, s5, 0
    s_mov_b32 s14, 65536
    s_mov_b32 s15, 0x20000
    s_lshl_b32 s33, s26, 13
    s_add_u32 s33, s33, 4096
    s_add_u32 s1, s33, 32768
    v_lshlrev_b32 v249, 4, v221
    s_mul_i32 s40, s25, 3211264
    s_add_u32 s40, s40, s35
    s_xor_b32 s41, s40, 4096
    s_xor_b32 s42, s40, 8192
    s_xor_b32 s43, s40, 12288
    s_cmp_eq_u32 s82, 1
    s_cselect_b32 s40, 0x7ff00000, s40

    s_mov_b32 s88, s28
    s_mov_b32 s89, s29
    s_mov_b32 s90, 32768
    s_mov_b32 m0, s30
    s_nop 0
    buffer_load_dwordx4 v249, s[12:15], s33 offen offset:0 sc1 lds
    buffer_load_dwordx4 v249, s[12:15], s33 offen offset:1024 sc1 lds
    buffer_load_dwordx4 v249, s[12:15], s33 offen offset:2048 sc1 lds
    buffer_load_dwordx4 v249, s[12:15], s33 offen offset:3072 sc1 lds
    s_mov_b32 m0, s31
    s_nop 0
    buffer_load_dwordx4 v249, s[12:15], s1 offen offset:0 sc1 lds
    buffer_load_dwordx4 v249, s[12:15], s1 offen offset:1024 sc1 lds
    buffer_load_dwordx4 v249, s[12:15], s1 offen offset:2048 sc1 lds
    buffer_load_dwordx4 v249, s[12:15], s1 offen offset:3072 sc1 lds
    v_cvt_pk_bf16_f32 v128, v0, v1
    v_cvt_pk_bf16_f32 v129, v2, v3
    v_cvt_pk_bf16_f32 v130, v16, v17
    v_cvt_pk_bf16_f32 v131, v18, v19
    buffer_store_dwordx4 v[128:131], v249, s[16:19], s40 offen offset:0 sc1
    v_cvt_pk_bf16_f32 v132, v4, v5
    v_cvt_pk_bf16_f32 v133, v6, v7
    v_cvt_pk_bf16_f32 v134, v20, v21
    v_cvt_pk_bf16_f32 v135, v22, v23
    buffer_store_dwordx4 v[132:135], v249, s[16:19], s41 offen offset:0 sc1
    v_cvt_pk_bf16_f32 v136, v8, v9
    v_cvt_pk_bf16_f32 v137, v10, v11
    v_cvt_pk_bf16_f32 v138, v24, v25
    v_cvt_pk_bf16_f32 v139, v26, v27
    buffer_store_dwordx4 v[136:139], v249, s[16:19], s42 offen offset:0 sc1
    v_cvt_pk_bf16_f32 v140, v12, v13
    v_cvt_pk_bf16_f32 v141, v14, v15
    v_cvt_pk_bf16_f32 v142, v28, v29
    v_cvt_pk_bf16_f32 v143, v30, v31
    buffer_store_dwordx4 v[140:143], v249, s[16:19], s43 offen offset:0 sc1
    v_cvt_pk_bf16_f32 v144, v32, v33
    v_cvt_pk_bf16_f32 v145, v34, v35
    v_cvt_pk_bf16_f32 v146, v48, v49
    v_cvt_pk_bf16_f32 v147, v50, v51
    buffer_store_dwordx4 v[144:147], v249, s[16:19], s40 offen offset:1024 sc1
    v_cvt_pk_bf16_f32 v148, v36, v37
    v_cvt_pk_bf16_f32 v149, v38, v39
    v_cvt_pk_bf16_f32 v150, v52, v53
    v_cvt_pk_bf16_f32 v151, v54, v55
    buffer_store_dwordx4 v[148:151], v249, s[16:19], s41 offen offset:1024 sc1
    v_cvt_pk_bf16_f32 v152, v40, v41
    v_cvt_pk_bf16_f32 v153, v42, v43
    v_cvt_pk_bf16_f32 v154, v56, v57
    v_cvt_pk_bf16_f32 v155, v58, v59
    buffer_store_dwordx4 v[152:155], v249, s[16:19], s42 offen offset:1024 sc1
    v_cvt_pk_bf16_f32 v156, v44, v45
    v_cvt_pk_bf16_f32 v157, v46, v47
    v_cvt_pk_bf16_f32 v158, v60, v61
    v_cvt_pk_bf16_f32 v159, v62, v63
    buffer_store_dwordx4 v[156:159], v249, s[16:19], s43 offen offset:1024 sc1
    v_cvt_pk_bf16_f32 v128, v64, v65
    v_cvt_pk_bf16_f32 v129, v66, v67
    v_cvt_pk_bf16_f32 v130, v80, v81
    v_cvt_pk_bf16_f32 v131, v82, v83
    buffer_store_dwordx4 v[128:131], v249, s[16:19], s40 offen offset:2048 sc1
    v_cvt_pk_bf16_f32 v132, v68, v69
    v_cvt_pk_bf16_f32 v133, v70, v71
    v_cvt_pk_bf16_f32 v134, v84, v85
    v_cvt_pk_bf16_f32 v135, v86, v87
    buffer_store_dwordx4 v[132:135], v249, s[16:19], s41 offen offset:2048 sc1
    v_cvt_pk_bf16_f32 v136, v72, v73
    v_cvt_pk_bf16_f32 v137, v74, v75
    v_cvt_pk_bf16_f32 v138, v88, v89
    v_cvt_pk_bf16_f32 v139, v90, v91
    buffer_store_dwordx4 v[136:139], v249, s[16:19], s42 offen offset:2048 sc1
    v_cvt_pk_bf16_f32 v140, v76, v77
    v_cvt_pk_bf16_f32 v141, v78, v79
    v_cvt_pk_bf16_f32 v142, v92, v93
    v_cvt_pk_bf16_f32 v143, v94, v95
    buffer_store_dwordx4 v[140:143], v249, s[16:19], s43 offen offset:2048 sc1
    v_cvt_pk_bf16_f32 v144, v96, v97
    v_cvt_pk_bf16_f32 v145, v98, v99
    v_cvt_pk_bf16_f32 v146, v112, v113
    v_cvt_pk_bf16_f32 v147, v114, v115
    buffer_store_dwordx4 v[144:147], v249, s[16:19], s40 offen offset:3072 sc1
    v_cvt_pk_bf16_f32 v148, v100, v101
    v_cvt_pk_bf16_f32 v149, v102, v103
    v_cvt_pk_bf16_f32 v150, v116, v117
    v_cvt_pk_bf16_f32 v151, v118, v119
    buffer_store_dwordx4 v[148:151], v249, s[16:19], s41 offen offset:3072 sc1
    v_cvt_pk_bf16_f32 v152, v104, v105
    v_cvt_pk_bf16_f32 v153, v106, v107
    v_cvt_pk_bf16_f32 v154, v120, v121
    v_cvt_pk_bf16_f32 v155, v122, v123
    buffer_store_dwordx4 v[152:155], v249, s[16:19], s42 offen offset:3072 sc1
    v_cvt_pk_bf16_f32 v156, v108, v109
    v_cvt_pk_bf16_f32 v157, v110, v111
    v_cvt_pk_bf16_f32 v158, v124, v125
    v_cvt_pk_bf16_f32 v159, v126, v127
    buffer_store_dwordx4 v[156:159], v249, s[16:19], s43 offen offset:3072 sc1
L2_lm:
    v_mov_b32 v176, v0
    v_mov_b32 v177, v1
    v_mov_b32 v178, v2
    v_mov_b32 v179, v3
    v_mov_b32 v180, v16
    v_mov_b32 v181, v17
    v_mov_b32 v182, v18
    v_mov_b32 v183, v19
    v_mov_b32 v184, v32
    v_mov_b32 v185, v33
    v_mov_b32 v186, v34
    v_mov_b32 v187, v35
    v_mov_b32 v188, v48
    v_mov_b32 v189, v49
    v_mov_b32 v190, v50
    v_mov_b32 v191, v51
    v_mov_b32 v192, v64
    v_mov_b32 v193, v65
    v_mov_b32 v194, v66
    v_mov_b32 v195, v67
    v_mov_b32 v196, v80
    v_mov_b32 v197, v81
    v_mov_b32 v198, v82
    v_mov_b32 v199, v83
    v_mov_b32 v200, v96
    v_mov_b32 v201, v97
    v_mov_b32 v202, v98
    v_mov_b32 v203, v99
    v_mov_b32 v204, v112
    v_mov_b32 v205, v113
    v_mov_b32 v206, v114
    v_mov_b32 v207, v115
    v_and_b32 v254, 15, v221
    v_lshlrev_b32 v254, 3, v254
    s_mul_i32 s36, s25, 100352
    s_lshr_b32 s37, s35, 5
    s_add_u32 s36, s36, s37
    s_add_u32 s36, s36, 65536
    s_xor_b32 s37, s36, 128
    s_xor_b32 s38, s36, 256
    s_xor_b32 s39, s36, 384

    v_mov_b32 v114, v115
    v_mov_b32 v115, v250
    v_mov_b32 v118, v119
    v_mov_b32 v119, v251
    v_mov_b32 v122, v123
    v_mov_b32 v123, v252
    v_mov_b32 v126, v127
    v_mov_b32 v127, v253
    s_mov_b32 exec_lo, 0
    s_mov_b32 exec_hi, 0xffff0000
    buffer_store_dwordx2 v[114:115], v254, s[20:23], s36 offen sc1
    buffer_store_dwordx2 v[118:119], v254, s[20:23], s37 offen sc1
    buffer_store_dwordx2 v[122:123], v254, s[20:23], s38 offen sc1
    buffer_store_dwordx2 v[126:127], v254, s[20:23], s39 offen sc1
    s_mov_b64 exec, -1
    ds_read_b32 v245, v241 offset:0
    ds_write_b128 v243, a[196:199]
    s_waitcnt lgkmcnt(1)
    v_and_b32 v245, 31, v245
    v_lshl_add_u32 v245, v245, 6, v242
    ds_write_b16 v245, v244
    ds_read_b128 a[192:195], v243
    s_waitcnt vmcnt(20)
    ds_read_b64_tr_b16 a[160:161], v230 offset:0
    ds_read_b64_tr_b16 a[162:163], v230 offset:4096
    ds_read_b64_tr_b16 a[164:165], v231 offset:0
    ds_read_b64_tr_b16 a[166:167], v231 offset:4096
    ds_read_b64_tr_b16 a[168:169], v232 offset:0
    ds_read_b64_tr_b16 a[170:171], v232 offset:4096
    ds_read_b64_tr_b16 a[172:173], v233 offset:0
    ds_read_b64_tr_b16 a[174:175], v233 offset:4096
    ds_read_b64_tr_b16 a[176:177], v234 offset:0
    ds_read_b64_tr_b16 a[178:179], v234 offset:4096
    ds_read_b64_tr_b16 a[180:181], v235 offset:0
    ds_read_b64_tr_b16 a[182:183], v235 offset:4096
    ds_read_b64_tr_b16 a[184:185], v236 offset:0
    ds_read_b64_tr_b16 a[186:187], v236 offset:4096
    ds_read_b64_tr_b16 a[188:189], v237 offset:0
    ds_read_b64_tr_b16 a[190:191], v237 offset:4096
    s_waitcnt lgkmcnt(14)
    v_mfma_f32_16x16x32_bf16 a[128:131], a[160:163], a[192:195], a[128:131]
    s_waitcnt lgkmcnt(12)
    v_mfma_f32_16x16x32_bf16 a[132:135], a[164:167], a[192:195], a[132:135]
    s_waitcnt lgkmcnt(10)
    v_mfma_f32_16x16x32_bf16 a[136:139], a[168:171], a[192:195], a[136:139]
    s_waitcnt lgkmcnt(8)
    v_mfma_f32_16x16x32_bf16 a[140:143], a[172:175], a[192:195], a[140:143]
    s_waitcnt lgkmcnt(6)
    v_mfma_f32_16x16x32_bf16 a[144:147], a[176:179], a[192:195], a[144:147]
    s_waitcnt lgkmcnt(4)
    v_mfma_f32_16x16x32_bf16 a[148:151], a[180:183], a[192:195], a[148:151]
    s_waitcnt lgkmcnt(2)
    v_mfma_f32_16x16x32_bf16 a[152:155], a[184:187], a[192:195], a[152:155]
    s_waitcnt lgkmcnt(0)
    v_mfma_f32_16x16x32_bf16 a[156:159], a[188:191], a[192:195], a[156:159]
    ds_read_b32 v245, v241 offset:128
    ds_write_b128 v243, a[196:199]
    s_waitcnt lgkmcnt(1)
    v_and_b32 v245, 31, v245
    v_lshl_add_u32 v245, v245, 6, v242
    ds_write_b16 v245, v244
    ds_read_b128 a[192:195], v243
    ds_read_b64_tr_b16 a[160:161], v230 offset:8192
    ds_read_b64_tr_b16 a[162:163], v230 offset:12288
    ds_read_b64_tr_b16 a[164:165], v231 offset:8192
    ds_read_b64_tr_b16 a[166:167], v231 offset:12288
    ds_read_b64_tr_b16 a[168:169], v232 offset:8192
    ds_read_b64_tr_b16 a[170:171], v232 offset:12288
    ds_read_b64_tr_b16 a[172:173], v233 offset:8192
    ds_read_b64_tr_b16 a[174:175], v233 offset:12288
    ds_read_b64_tr_b16 a[176:177], v234 offset:8192
    ds_read_b64_tr_b16 a[178:179], v234 offset:12288
    ds_read_b64_tr_b16 a[180:181], v235 offset:8192
    ds_read_b64_tr_b16 a[182:183], v235 offset:12288
    ds_read_b64_tr_b16 a[184:185], v236 offset:8192
    ds_read_b64_tr_b16 a[186:187], v236 offset:12288
    ds_read_b64_tr_b16 a[188:189], v237 offset:8192
    ds_read_b64_tr_b16 a[190:191], v237 offset:12288
    s_waitcnt lgkmcnt(14)
    v_mfma_f32_16x16x32_bf16 a[128:131], a[160:163], a[192:195], a[128:131]
    s_waitcnt lgkmcnt(12)
    v_mfma_f32_16x16x32_bf16 a[132:135], a[164:167], a[192:195], a[132:135]
    s_waitcnt lgkmcnt(10)
    v_mfma_f32_16x16x32_bf16 a[136:139], a[168:171], a[192:195], a[136:139]
    s_waitcnt lgkmcnt(8)
    v_mfma_f32_16x16x32_bf16 a[140:143], a[172:175], a[192:195], a[140:143]
    s_waitcnt lgkmcnt(6)
    v_mfma_f32_16x16x32_bf16 a[144:147], a[176:179], a[192:195], a[144:147]
    s_waitcnt lgkmcnt(4)
    v_mfma_f32_16x16x32_bf16 a[148:151], a[180:183], a[192:195], a[148:151]
    s_waitcnt lgkmcnt(2)
    v_mfma_f32_16x16x32_bf16 a[152:155], a[184:187], a[192:195], a[152:155]
    s_waitcnt lgkmcnt(0)
    v_mfma_f32_16x16x32_bf16 a[156:159], a[188:191], a[192:195], a[156:159]
    s_waitcnt vmcnt(0)
    s_barrier
    s_lshl_b32 s40, s24, 8
    s_add_u32 s40, s40, 1048576
    s_cmp_lg_u32 s26, 0
    s_cbranch_scc1 L2_noflag
    s_lshl_b32 s41, s25, 2
    v_mov_b32 v250, s41
    v_mov_b32 v251, 1
    s_mov_b64 exec, 1
    buffer_store_dword v251, v250, s[20:23], s40 offen sc1
    s_mov_b64 exec, -1

L2_noflag:
    s_sub_u32 s33, s33, 4096
    s_sub_u32 s1, s1, 4096
    s_mov_b32 m0, s88
    s_nop 0
    buffer_load_dwordx4 v249, s[12:15], s33 offen offset:0 sc1 lds
    buffer_load_dwordx4 v249, s[12:15], s33 offen offset:1024 sc1 lds
    buffer_load_dwordx4 v249, s[12:15], s33 offen offset:2048 sc1 lds
    buffer_load_dwordx4 v249, s[12:15], s33 offen offset:3072 sc1 lds
    s_mov_b32 m0, s89
    s_nop 0
    buffer_load_dwordx4 v249, s[12:15], s1 offen offset:0 sc1 lds
    buffer_load_dwordx4 v249, s[12:15], s1 offen offset:1024 sc1 lds
    buffer_load_dwordx4 v249, s[12:15], s1 offen offset:2048 sc1 lds
    buffer_load_dwordx4 v249, s[12:15], s1 offen offset:3072 sc1 lds
    s_cmp_eq_u32 s82, 1
    s_cbranch_scc1 L2_owner
    s_waitcnt vmcnt(0)
    s_barrier
    s_branch L2_exit
L2_owner:
    s_add_u32 s92, s86, 0
    s_addc_u32 s93, s87, 0
    s_mov_b32 s94, 3200000
    s_mov_b32 s95, 0x20000
    v_min_u32 v8, 4, v221
    v_lshlrev_b32 v8, 2, v8
    buffer_load_dword v9, v8, s[20:23], s40 offen sc1
    v_and_b32 v1, 15, v221
    v_lshrrev_b32 v2, 4, v221
    v_lshlrev_b32 v6, 8, v1
    v_lshl_add_u32 v6, v2, 4, v6
    v_mov_b32 v255, v249
    v_add_u32 v10, s90, v249
    v_xor_b32 v11, 0x8000, v10
    v_accvgpr_read_b32 v122, a248

    v_lshlrev_b32 v5, 3, v1
    s_mov_b32 s83, 0

L2_more:
    v_lshrrev_b32 v250, 16, v246
    v_cmp_ne_u32 vcc, 0, v250
    s_cbranch_vccz L2_nomore

    s_mov_b32 s79, 63
L2_retryb:
    v_lshrrev_b32 v222, 16, v246
    v_min_u32 v222, s79, v222
    v_mov_b32 v223, v222

    s_nop 1
    v_add_u32_dpp v223, v223, v223 row_shr:1 row_mask:0xf bank_mask:0xf
    s_nop 1
    v_add_u32_dpp v223, v223, v223 row_shr:2 row_mask:0xf bank_mask:0xf
    s_nop 1
    v_add_u32_dpp v223, v223, v223 row_shr:4 row_mask:0xf bank_mask:0xf
    s_nop 1
    v_add_u32_dpp v223, v223, v223 row_shr:8 row_mask:0xf bank_mask:0xf
    s_nop 0
    v_readlane_b32 s76, v223, 15
    s_cmp_le_u32 s76, 176
    s_cbranch_scc1 L2_okb
    s_mov_b32 s79, 16
    s_branch L2_retryb

L2_okb:
    v_sub_u32 v223, v223, v222
    v_lshl_add_u32 v223, v223, 4, s73
    v_mov_b32 v224, 159744
    v_mul_u32_u24 v224, v224, v221
    v_and_b32 v225, 0xffff, v246
    v_lshl_add_u32 v224, v225, 4, v224
    v_lshlrev_b32 v225, 4, v221
    s_lshl_b32 s76, s76, 2
    s_cbranch_scc0 L2_lbb

    v_readlane_b32 s36, v224, 0
    v_readlane_b32 s37, v224, 1
    v_readlane_b32 s38, v224, 2
    v_readlane_b32 s39, v224, 3
    v_readlane_b32 s33, v223, 0
    v_readlane_b32 s42, v223, 1
    v_readlane_b32 s43, v223, 2
    v_readlane_b32 s79, v223, 3
    v_readlane_b32 s80, v222, 0
    v_readlane_b32 s81, v222, 1
    v_readlane_b32 s91, v222, 2
    v_readlane_b32 s77, v222, 3
    s_mov_b32 m0, s33
    s_bfm_b64 exec, s80, 0
    buffer_load_dwordx4 v225, s[64:67], s36 offen sc1 lds
    s_mov_b32 m0, s42
    s_bfm_b64 exec, s81, 0
    buffer_load_dwordx4 v225, s[64:67], s37 offen sc1 lds
    s_mov_b32 m0, s43
    s_bfm_b64 exec, s91, 0
    buffer_load_dwordx4 v225, s[64:67], s38 offen sc1 lds
    s_mov_b32 m0, s79
    s_bfm_b64 exec, s77, 0
    buffer_load_dwordx4 v225, s[64:67], s39 offen sc1 lds
    v_readlane_b32 s36, v224, 4
    v_readlane_b32 s37, v224, 5
    v_readlane_b32 s38, v224, 6
    v_readlane_b32 s39, v224, 7
    v_readlane_b32 s33, v223, 4
    v_readlane_b32 s42, v223, 5
    v_readlane_b32 s43, v223, 6
    v_readlane_b32 s79, v223, 7
    v_readlane_b32 s80, v222, 4
    v_readlane_b32 s81, v222, 5
    v_readlane_b32 s91, v222, 6
    v_readlane_b32 s77, v222, 7
    s_mov_b32 m0, s33
    s_bfm_b64 exec, s80, 0
    buffer_load_dwordx4 v225, s[64:67], s36 offen sc1 lds
    s_mov_b32 m0, s42
    s_bfm_b64 exec, s81, 0
    buffer_load_dwordx4 v225, s[64:67], s37 offen sc1 lds
    s_mov_b32 m0, s43
    s_bfm_b64 exec, s91, 0
    buffer_load_dwordx4 v225, s[64:67], s38 offen sc1 lds
    s_mov_b32 m0, s79
    s_bfm_b64 exec, s77, 0
    buffer_load_dwordx4 v225, s[64:67], s39 offen sc1 lds
    v_readlane_b32 s36, v224, 8
    v_readlane_b32 s37, v224, 9
    v_readlane_b32 s38, v224, 10
    v_readlane_b32 s33, v223, 8
    v_readlane_b32 s42, v223, 9
    v_readlane_b32 s43, v223, 10
    v_readlane_b32 s80, v222, 8
    v_readlane_b32 s81, v222, 9
    v_readlane_b32 s91, v222, 10
    s_mov_b32 m0, s33
    s_bfm_b64 exec, s80, 0
    buffer_load_dwordx4 v225, s[64:67], s36 offen sc1 lds
    s_mov_b32 m0, s42
    s_bfm_b64 exec, s81, 0
    buffer_load_dwordx4 v225, s[64:67], s37 offen sc1 lds
    s_mov_b32 m0, s43
    s_bfm_b64 exec, s91, 0
    buffer_load_dwordx4 v225, s[64:67], s38 offen sc1 lds
L2_lbb:
    s_mov_b64 exec, -1
    v_add_u32 v223, s76, v221
    v_lshl_add_u32 v223, v223, 2, s73
    v_mov_b32 v224, 0x7ffffff0
    ds_write_b32 v223, v224
    ds_write_b32 v223, v224 offset:256
    ds_write_b32 v223, v224 offset:512
    v_add_u32 v246, v246, v222
    v_lshlrev_b32 v222, 16, v222
    v_sub_u32 v246, v246, v222
    s_add_u32 s77, s76, 31
    s_lshr_b32 s77, s77, 5
    s_mov_b32 s78, 0
    s_max_u32 s3, s77, 1
    s_sub_u32 s3, s3, 1
    s_and_b32 s3, s3, -2
    v_lshrrev_b32 v240, 4, v221
    v_lshl_add_u32 v240, v240, 2, s73
    v_and_b32 v241, 31, v221
    v_lshl_add_u32 v241, v241, 2, s73

    s_waitcnt vmcnt(0) lgkmcnt(0)
L2_leftb:
    s_cmp_ge_u32 s78, s77
    s_cbranch_scc1 L2_leftdoneb
    ds_read2_b32 v[222:223], v240 offset0:0 offset1:4
    ds_read2_b32 v[224:225], v240 offset0:8 offset1:12
    ds_read2_b32 v[226:227], v240 offset0:16 offset1:20
    ds_read2_b32 v[228:229], v240 offset0:24 offset1:28
    s_mov_b32 m0, s74
    s_waitcnt lgkmcnt(3)
    v_bitop3_b32 v222, v222, -16, v238 bitop3:0x6a
    buffer_load_dwordx4 v222, s[8:11], 0 offen sc1 lds
    s_add_u32 m0, s74, 1024
    v_bitop3_b32 v223, v223, -16, v239 bitop3:0x6a
    buffer_load_dwordx4 v223, s[8:11], 0 offen sc1 lds
    s_add_u32 m0, s74, 2048
    s_waitcnt lgkmcnt(2)
    v_bitop3_b32 v224, v224, -16, v238 bitop3:0x6a
    buffer_load_dwordx4 v224, s[8:11], 0 offen sc1 lds
    s_add_u32 m0, s74, 3072
    v_bitop3_b32 v225, v225, -16, v239 bitop3:0x6a
    buffer_load_dwordx4 v225, s[8:11], 0 offen sc1 lds
    s_add_u32 m0, s74, 4096
    s_waitcnt lgkmcnt(1)
    v_bitop3_b32 v226, v226, -16, v238 bitop3:0x6a
    buffer_load_dwordx4 v226, s[8:11], 0 offen sc1 lds
    s_add_u32 m0, s74, 5120
    v_bitop3_b32 v227, v227, -16, v239 bitop3:0x6a
    buffer_load_dwordx4 v227, s[8:11], 0 offen sc1 lds
    s_add_u32 m0, s74, 6144
    s_waitcnt lgkmcnt(0)
    v_bitop3_b32 v228, v228, -16, v238 bitop3:0x6a
    buffer_load_dwordx4 v228, s[8:11], 0 offen sc1 lds
    s_add_u32 m0, s74, 7168
    v_bitop3_b32 v229, v229, -16, v239 bitop3:0x6a
    buffer_load_dwordx4 v229, s[8:11], 0 offen sc1 lds
    ds_read_b32 v245, v241 offset:0
    ds_write_b128 v243, a[196:199]
    s_waitcnt lgkmcnt(1)
    v_and_b32 v245, 31, v245
    v_lshl_add_u32 v245, v245, 6, v242
    ds_write_b16 v245, v244
    ds_read_b128 a[192:195], v243
    s_waitcnt vmcnt(0)
    ds_read_b64_tr_b16 a[160:161], v230 offset:0
    ds_read_b64_tr_b16 a[162:163], v230 offset:4096
    ds_read_b64_tr_b16 a[164:165], v231 offset:0
    ds_read_b64_tr_b16 a[166:167], v231 offset:4096
    ds_read_b64_tr_b16 a[168:169], v232 offset:0
    ds_read_b64_tr_b16 a[170:171], v232 offset:4096
    ds_read_b64_tr_b16 a[172:173], v233 offset:0
    ds_read_b64_tr_b16 a[174:175], v233 offset:4096
    ds_read_b64_tr_b16 a[176:177], v234 offset:0
    ds_read_b64_tr_b16 a[178:179], v234 offset:4096
    ds_read_b64_tr_b16 a[180:181], v235 offset:0
    ds_read_b64_tr_b16 a[182:183], v235 offset:4096
    ds_read_b64_tr_b16 a[184:185], v236 offset:0
    ds_read_b64_tr_b16 a[186:187], v236 offset:4096
    ds_read_b64_tr_b16 a[188:189], v237 offset:0
    ds_read_b64_tr_b16 a[190:191], v237 offset:4096
    s_waitcnt lgkmcnt(14)
    v_mfma_f32_16x16x32_bf16 a[128:131], a[160:163], a[192:195], a[128:131]
    s_waitcnt lgkmcnt(12)
    v_mfma_f32_16x16x32_bf16 a[132:135], a[164:167], a[192:195], a[132:135]
    s_waitcnt lgkmcnt(10)
    v_mfma_f32_16x16x32_bf16 a[136:139], a[168:171], a[192:195], a[136:139]
    s_waitcnt lgkmcnt(8)
    v_mfma_f32_16x16x32_bf16 a[140:143], a[172:175], a[192:195], a[140:143]
    s_waitcnt lgkmcnt(6)
    v_mfma_f32_16x16x32_bf16 a[144:147], a[176:179], a[192:195], a[144:147]
    s_waitcnt lgkmcnt(4)
    v_mfma_f32_16x16x32_bf16 a[148:151], a[180:183], a[192:195], a[148:151]
    s_waitcnt lgkmcnt(2)
    v_mfma_f32_16x16x32_bf16 a[152:155], a[184:187], a[192:195], a[152:155]
    s_waitcnt lgkmcnt(0)
    v_mfma_f32_16x16x32_bf16 a[156:159], a[188:191], a[192:195], a[156:159]
    v_add_u32 v240, 128, v240
    v_add_u32 v241, 128, v241
    s_add_u32 s78, s78, 1
    s_branch L2_leftb
L2_leftdoneb:
    s_branch L2_more
L2_nomore:
    v_lshlrev_b32 v122, 16, v122
    s_nop 3
    v_accvgpr_read_b32 v80, a128
    v_accvgpr_read_b32 v81, a129
    v_accvgpr_read_b32 v82, a130
    v_accvgpr_read_b32 v83, a131
    v_accvgpr_read_b32 v84, a132
    v_accvgpr_read_b32 v85, a133
    v_accvgpr_read_b32 v86, a134
    v_accvgpr_read_b32 v87, a135
    v_accvgpr_read_b32 v88, a136
    v_accvgpr_read_b32 v89, a137
    v_accvgpr_read_b32 v90, a138
    v_accvgpr_read_b32 v91, a139
    v_accvgpr_read_b32 v92, a140
    v_accvgpr_read_b32 v93, a141
    v_accvgpr_read_b32 v94, a142
    v_accvgpr_read_b32 v95, a143
    v_pk_mul_f32 v[80:81], v[80:81], v[122:123] op_sel_hi:[1,0]
    v_pk_mul_f32 v[82:83], v[82:83], v[122:123] op_sel_hi:[1,0]
    v_pk_mul_f32 v[84:85], v[84:85], v[122:123] op_sel_hi:[1,0]
    v_pk_mul_f32 v[86:87], v[86:87], v[122:123] op_sel_hi:[1,0]
    v_pk_mul_f32 v[88:89], v[88:89], v[122:123] op_sel_hi:[1,0]
    v_pk_mul_f32 v[90:91], v[90:91], v[122:123] op_sel_hi:[1,0]
    v_pk_mul_f32 v[92:93], v[92:93], v[122:123] op_sel_hi:[1,0]
    v_pk_mul_f32 v[94:95], v[94:95], v[122:123] op_sel_hi:[1,0]
    v_cvt_pk_bf16_f32 v144, v80, v81
    v_cvt_pk_bf16_f32 v145, v82, v83
    v_cvt_pk_bf16_f32 v146, v84, v85
    v_cvt_pk_bf16_f32 v147, v86, v87
    v_cvt_pk_bf16_f32 v148, v88, v89
    v_cvt_pk_bf16_f32 v149, v90, v91
    v_cvt_pk_bf16_f32 v150, v92, v93
    v_cvt_pk_bf16_f32 v151, v94, v95
    v_accvgpr_read_b32 v80, a144
    v_accvgpr_read_b32 v81, a145
    v_accvgpr_read_b32 v82, a146
    v_accvgpr_read_b32 v83, a147
    v_accvgpr_read_b32 v84, a148
    v_accvgpr_read_b32 v85, a149
    v_accvgpr_read_b32 v86, a150
    v_accvgpr_read_b32 v87, a151
    v_accvgpr_read_b32 v88, a152
    v_accvgpr_read_b32 v89, a153
    v_accvgpr_read_b32 v90, a154
    v_accvgpr_read_b32 v91, a155
    v_accvgpr_read_b32 v92, a156
    v_accvgpr_read_b32 v93, a157
    v_accvgpr_read_b32 v94, a158
    v_accvgpr_read_b32 v95, a159
    v_pk_mul_f32 v[80:81], v[80:81], v[122:123] op_sel_hi:[1,0]
    v_pk_mul_f32 v[82:83], v[82:83], v[122:123] op_sel_hi:[1,0]
    v_pk_mul_f32 v[84:85], v[84:85], v[122:123] op_sel_hi:[1,0]
    v_pk_mul_f32 v[86:87], v[86:87], v[122:123] op_sel_hi:[1,0]
    v_pk_mul_f32 v[88:89], v[88:89], v[122:123] op_sel_hi:[1,0]
    v_pk_mul_f32 v[90:91], v[90:91], v[122:123] op_sel_hi:[1,0]
    v_pk_mul_f32 v[92:93], v[92:93], v[122:123] op_sel_hi:[1,0]
    v_pk_mul_f32 v[94:95], v[94:95], v[122:123] op_sel_hi:[1,0]
    v_cvt_pk_bf16_f32 v152, v80, v81
    v_cvt_pk_bf16_f32 v153, v82, v83
    v_cvt_pk_bf16_f32 v154, v84, v85
    v_cvt_pk_bf16_f32 v155, v86, v87
    v_cvt_pk_bf16_f32 v156, v88, v89
    v_cvt_pk_bf16_f32 v157, v90, v91
    v_cvt_pk_bf16_f32 v158, v92, v93
    v_cvt_pk_bf16_f32 v159, v94, v95
    v_accvgpr_read_b32 v161, a232
    v_lshlrev_b32 v160, 16, v161
    v_and_b32 v161, 0xffff0000, v161
    v_accvgpr_read_b32 v163, a233
    v_lshlrev_b32 v162, 16, v163
    v_and_b32 v163, 0xffff0000, v163
    v_accvgpr_read_b32 v165, a234
    v_lshlrev_b32 v164, 16, v165
    v_and_b32 v165, 0xffff0000, v165
    v_accvgpr_read_b32 v167, a235
    v_lshlrev_b32 v166, 16, v167
    v_and_b32 v167, 0xffff0000, v167
    v_accvgpr_read_b32 v169, a236
    v_lshlrev_b32 v168, 16, v169
    v_and_b32 v169, 0xffff0000, v169
    v_accvgpr_read_b32 v171, a237
    v_lshlrev_b32 v170, 16, v171
    v_and_b32 v171, 0xffff0000, v171
    v_accvgpr_read_b32 v173, a238
    v_lshlrev_b32 v172, 16, v173
    v_and_b32 v173, 0xffff0000, v173
    v_accvgpr_read_b32 v175, a239
    v_lshlrev_b32 v174, 16, v175
    v_and_b32 v175, 0xffff0000, v175
    v_accvgpr_read_b32 v209, a240
    v_lshlrev_b32 v208, 16, v209
    v_and_b32 v209, 0xffff0000, v209
    v_accvgpr_read_b32 v211, a241
    v_lshlrev_b32 v210, 16, v211
    v_and_b32 v211, 0xffff0000, v211
    v_accvgpr_read_b32 v213, a242
    v_lshlrev_b32 v212, 16, v213
    v_and_b32 v213, 0xffff0000, v213
    v_accvgpr_read_b32 v215, a243
    v_lshlrev_b32 v214, 16, v215
    v_and_b32 v215, 0xffff0000, v215
    v_accvgpr_read_b32 v217, a244
    v_lshlrev_b32 v216, 16, v217
    v_and_b32 v217, 0xffff0000, v217
    v_accvgpr_read_b32 v219, a245
    v_lshlrev_b32 v218, 16, v219
    v_and_b32 v219, 0xffff0000, v219
    v_accvgpr_read_b32 v125, a246
    v_lshlrev_b32 v124, 16, v125
    v_and_b32 v125, 0xffff0000, v125
    v_accvgpr_read_b32 v127, a247
    v_lshlrev_b32 v126, 16, v127
    v_and_b32 v127, 0xffff0000, v127
    s_waitcnt vmcnt(0)
    v_cmp_ne_u32 vcc, 1, v9
    s_cbranch_vccz L2_ckgo1
    buffer_load_dword v9, v8, s[20:23], s40 offen sc1
    s_branch L2_ck1
L2_ckgo1:
    s_lshl_b32 s38, s72, 7
    s_add_u32 s38, s38, 65536
    s_lshl_b32 s36, s72, 12
    s_add_u32 s76, s25, 1
    s_cmp_eq_u32 s76, 5
    s_cselect_b32 s76, 0, s76
    s_add_u32 s77, s76, 1
    s_cmp_eq_u32 s77, 5
    s_cselect_b32 s77, 0, s77
    s_add_u32 s79, s77, 1
    s_cmp_eq_u32 s79, 5
    s_cselect_b32 s79, 0, s79
    s_add_u32 s80, s79, 1
    s_cmp_eq_u32 s80, 5
    s_cselect_b32 s80, 0, s80
    s_mul_i32 s39, s25, 100352
    s_add_u32 s39, s39, s38
    buffer_load_dwordx2 v[96:97], v5, s[20:23], s39 offen sc1
    s_mul_i32 s39, s76, 100352
    s_add_u32 s39, s39, s38
    buffer_load_dwordx2 v[98:99], v5, s[20:23], s39 offen sc1
    s_mul_i32 s39, s77, 100352
    s_add_u32 s39, s39, s38
    buffer_load_dwordx2 v[100:101], v5, s[20:23], s39 offen sc1
    s_mul_i32 s39, s79, 100352
    s_add_u32 s39, s39, s38
    buffer_load_dwordx2 v[102:103], v5, s[20:23], s39 offen sc1
    s_mul_i32 s39, s80, 100352
    s_add_u32 s39, s39, s38
    buffer_load_dwordx2 v[104:105], v5, s[20:23], s39 offen sc1
    s_mul_i32 s39, s76, 3211264
    s_add_u32 s39, s39, s36
    buffer_load_dwordx4 v[16:19], v255, s[16:19], s39 offen offset:0 sc1
    buffer_load_dwordx4 v[20:23], v255, s[16:19], s39 offen offset:1024 sc1
    buffer_load_dwordx4 v[24:27], v255, s[16:19], s39 offen offset:2048 sc1
    buffer_load_dwordx4 v[28:31], v255, s[16:19], s39 offen offset:3072 sc1
    s_mul_i32 s39, s77, 3211264
    s_add_u32 s39, s39, s36
    buffer_load_dwordx4 v[32:35], v255, s[16:19], s39 offen offset:0 sc1
    buffer_load_dwordx4 v[36:39], v255, s[16:19], s39 offen offset:1024 sc1
    buffer_load_dwordx4 v[40:43], v255, s[16:19], s39 offen offset:2048 sc1
    buffer_load_dwordx4 v[44:47], v255, s[16:19], s39 offen offset:3072 sc1
    s_mul_i32 s39, s79, 3211264
    s_add_u32 s39, s39, s36
    buffer_load_dwordx4 v[48:51], v255, s[16:19], s39 offen offset:0 sc1
    buffer_load_dwordx4 v[52:55], v255, s[16:19], s39 offen offset:1024 sc1
    buffer_load_dwordx4 v[56:59], v255, s[16:19], s39 offen offset:2048 sc1
    buffer_load_dwordx4 v[60:63], v255, s[16:19], s39 offen offset:3072 sc1
    s_mul_i32 s39, s80, 3211264
    s_add_u32 s39, s39, s36
    buffer_load_dwordx4 v[64:67], v255, s[16:19], s39 offen offset:0 sc1
    buffer_load_dwordx4 v[68:71], v255, s[16:19], s39 offen offset:1024 sc1
    buffer_load_dwordx4 v[72:75], v255, s[16:19], s39 offen offset:2048 sc1
    buffer_load_dwordx4 v[76:79], v255, s[16:19], s39 offen offset:3072 sc1
    s_mov_b32 s83, 1
L2_ck1:
    ds_read_b128 a[0:3], v10 offset:0
    ds_read_b128 a[4:7], v10 offset:1024
    ds_read_b128 a[8:11], v10 offset:2048
    ds_read_b128 a[12:15], v10 offset:3072
    ds_read_b128 a[16:19], v10 offset:4096
    ds_read_b128 a[20:23], v10 offset:5120
    ds_read_b128 a[24:27], v10 offset:6144
    ds_read_b128 a[28:31], v10 offset:7168
    ds_read_b128 a[32:35], v10 offset:8192
    ds_read_b128 a[36:39], v10 offset:9216
    ds_read_b128 a[40:43], v10 offset:10240
    ds_read_b128 a[44:47], v10 offset:11264
    ds_read_b128 a[48:51], v10 offset:12288
    ds_read_b128 a[52:55], v10 offset:13312
    ds_read_b128 a[56:59], v10 offset:14336
    ds_read_b128 a[60:63], v10 offset:15360
    s_waitcnt lgkmcnt(8)
    v_mfma_f32_16x16x32_bf16 v[160:163], a[0:3], v[144:147], v[160:163]
    v_mfma_f32_16x16x32_bf16 v[160:163], a[4:7], v[148:151], v[160:163]
    v_mfma_f32_16x16x32_bf16 v[160:163], a[8:11], v[152:155], v[160:163]
    v_mfma_f32_16x16x32_bf16 v[160:163], a[12:15], v[156:159], v[160:163]
    v_mfma_f32_16x16x32_bf16 v[164:167], a[16:19], v[144:147], v[164:167]
    v_mfma_f32_16x16x32_bf16 v[164:167], a[20:23], v[148:151], v[164:167]
    v_mfma_f32_16x16x32_bf16 v[164:167], a[24:27], v[152:155], v[164:167]
    v_mfma_f32_16x16x32_bf16 v[164:167], a[28:31], v[156:159], v[164:167]
    ds_read_b128 a[0:3], v10 offset:16384
    ds_read_b128 a[4:7], v10 offset:17408
    ds_read_b128 a[8:11], v10 offset:18432
    ds_read_b128 a[12:15], v10 offset:19456
    ds_read_b128 a[16:19], v10 offset:20480
    ds_read_b128 a[20:23], v10 offset:21504
    ds_read_b128 a[24:27], v10 offset:22528
    ds_read_b128 a[28:31], v10 offset:23552
    s_waitcnt lgkmcnt(8)
    v_mfma_f32_16x16x32_bf16 v[168:171], a[32:35], v[144:147], v[168:171]
    v_mfma_f32_16x16x32_bf16 v[168:171], a[36:39], v[148:151], v[168:171]
    v_mfma_f32_16x16x32_bf16 v[168:171], a[40:43], v[152:155], v[168:171]
    v_mfma_f32_16x16x32_bf16 v[168:171], a[44:47], v[156:159], v[168:171]
    v_mfma_f32_16x16x32_bf16 v[172:175], a[48:51], v[144:147], v[172:175]
    v_mfma_f32_16x16x32_bf16 v[172:175], a[52:55], v[148:151], v[172:175]
    v_mfma_f32_16x16x32_bf16 v[172:175], a[56:59], v[152:155], v[172:175]
    v_mfma_f32_16x16x32_bf16 v[172:175], a[60:63], v[156:159], v[172:175]
    ds_read_b128 a[32:35], v10 offset:24576
    ds_read_b128 a[36:39], v10 offset:25600
    ds_read_b128 a[40:43], v10 offset:26624
    ds_read_b128 a[44:47], v10 offset:27648
    ds_read_b128 a[48:51], v10 offset:28672
    ds_read_b128 a[52:55], v10 offset:29696
    ds_read_b128 a[56:59], v10 offset:30720
    ds_read_b128 a[60:63], v10 offset:31744
    s_waitcnt lgkmcnt(8)
    v_mfma_f32_16x16x32_bf16 v[208:211], a[0:3], v[144:147], v[208:211]
    v_mfma_f32_16x16x32_bf16 v[208:211], a[4:7], v[148:151], v[208:211]
    v_mfma_f32_16x16x32_bf16 v[208:211], a[8:11], v[152:155], v[208:211]
    v_mfma_f32_16x16x32_bf16 v[208:211], a[12:15], v[156:159], v[208:211]
    v_mfma_f32_16x16x32_bf16 v[212:215], a[16:19], v[144:147], v[212:215]
    v_mfma_f32_16x16x32_bf16 v[212:215], a[20:23], v[148:151], v[212:215]
    v_mfma_f32_16x16x32_bf16 v[212:215], a[24:27], v[152:155], v[212:215]
    v_mfma_f32_16x16x32_bf16 v[212:215], a[28:31], v[156:159], v[212:215]
    s_waitcnt lgkmcnt(0)
    v_mfma_f32_16x16x32_bf16 v[216:219], a[32:35], v[144:147], v[216:219]
    v_mfma_f32_16x16x32_bf16 v[216:219], a[36:39], v[148:151], v[216:219]
    v_mfma_f32_16x16x32_bf16 v[216:219], a[40:43], v[152:155], v[216:219]
    v_mfma_f32_16x16x32_bf16 v[216:219], a[44:47], v[156:159], v[216:219]
    v_mfma_f32_16x16x32_bf16 v[124:127], a[48:51], v[144:147], v[124:127]
    v_mfma_f32_16x16x32_bf16 v[124:127], a[52:55], v[148:151], v[124:127]
    v_mfma_f32_16x16x32_bf16 v[124:127], a[56:59], v[152:155], v[124:127]
    v_mfma_f32_16x16x32_bf16 v[124:127], a[60:63], v[156:159], v[124:127]
    s_cmp_eq_u32 s83, 1
    s_cbranch_scc1 L2_comb
    s_mov_b32 s42, 131072
L2_spin:
    s_waitcnt vmcnt(0)
    v_cmp_ne_u32 vcc, 1, v9
    s_cbranch_vccz L2_go
    s_sub_u32 s42, s42, 1
    s_cmp_eq_u32 s42, 0
    s_cbranch_scc1 L2_go
    s_sleep 1

    buffer_load_dword v9, v8, s[20:23], s40 offen sc1
    s_branch L2_spin
L2_go:
    s_lshl_b32 s38, s72, 7
    s_add_u32 s38, s38, 65536
    s_lshl_b32 s36, s72, 12
    s_add_u32 s76, s25, 1
    s_cmp_eq_u32 s76, 5
    s_cselect_b32 s76, 0, s76
    s_add_u32 s77, s76, 1
    s_cmp_eq_u32 s77, 5
    s_cselect_b32 s77, 0, s77
    s_add_u32 s79, s77, 1
    s_cmp_eq_u32 s79, 5
    s_cselect_b32 s79, 0, s79
    s_add_u32 s80, s79, 1
    s_cmp_eq_u32 s80, 5
    s_cselect_b32 s80, 0, s80
    s_mul_i32 s39, s25, 100352
    s_add_u32 s39, s39, s38
    buffer_load_dwordx2 v[96:97], v5, s[20:23], s39 offen sc1
    s_mul_i32 s39, s76, 100352
    s_add_u32 s39, s39, s38
    buffer_load_dwordx2 v[98:99], v5, s[20:23], s39 offen sc1
    s_mul_i32 s39, s77, 100352
    s_add_u32 s39, s39, s38
    buffer_load_dwordx2 v[100:101], v5, s[20:23], s39 offen sc1
    s_mul_i32 s39, s79, 100352
    s_add_u32 s39, s39, s38
    buffer_load_dwordx2 v[102:103], v5, s[20:23], s39 offen sc1
    s_mul_i32 s39, s80, 100352
    s_add_u32 s39, s39, s38
    buffer_load_dwordx2 v[104:105], v5, s[20:23], s39 offen sc1
    s_mul_i32 s39, s76, 3211264
    s_add_u32 s39, s39, s36
    buffer_load_dwordx4 v[16:19], v255, s[16:19], s39 offen offset:0 sc1
    buffer_load_dwordx4 v[20:23], v255, s[16:19], s39 offen offset:1024 sc1
    buffer_load_dwordx4 v[24:27], v255, s[16:19], s39 offen offset:2048 sc1
    buffer_load_dwordx4 v[28:31], v255, s[16:19], s39 offen offset:3072 sc1
    s_mul_i32 s39, s77, 3211264
    s_add_u32 s39, s39, s36
    buffer_load_dwordx4 v[32:35], v255, s[16:19], s39 offen offset:0 sc1
    buffer_load_dwordx4 v[36:39], v255, s[16:19], s39 offen offset:1024 sc1
    buffer_load_dwordx4 v[40:43], v255, s[16:19], s39 offen offset:2048 sc1
    buffer_load_dwordx4 v[44:47], v255, s[16:19], s39 offen offset:3072 sc1
    s_mul_i32 s39, s79, 3211264
    s_add_u32 s39, s39, s36
    buffer_load_dwordx4 v[48:51], v255, s[16:19], s39 offen offset:0 sc1
    buffer_load_dwordx4 v[52:55], v255, s[16:19], s39 offen offset:1024 sc1
    buffer_load_dwordx4 v[56:59], v255, s[16:19], s39 offen offset:2048 sc1
    buffer_load_dwordx4 v[60:63], v255, s[16:19], s39 offen offset:3072 sc1
    s_mul_i32 s39, s80, 3211264
    s_add_u32 s39, s39, s36
    buffer_load_dwordx4 v[64:67], v255, s[16:19], s39 offen offset:0 sc1
    buffer_load_dwordx4 v[68:71], v255, s[16:19], s39 offen offset:1024 sc1
    buffer_load_dwordx4 v[72:75], v255, s[16:19], s39 offen offset:2048 sc1
    buffer_load_dwordx4 v[76:79], v255, s[16:19], s39 offen offset:3072 sc1
    s_mov_b32 s83, 1
L2_comb:
    s_barrier
    ds_read_b128 a[0:3], v11 offset:0
    ds_read_b128 a[4:7], v11 offset:1024
    ds_read_b128 a[8:11], v11 offset:2048
    ds_read_b128 a[12:15], v11 offset:3072
    ds_read_b128 a[16:19], v11 offset:4096
    ds_read_b128 a[20:23], v11 offset:5120
    ds_read_b128 a[24:27], v11 offset:6144
    ds_read_b128 a[28:31], v11 offset:7168
    s_lshl_b32 s36, s72, 12
    s_waitcnt vmcnt(16)
    v_max3_f32 v7, v97, v99, v101
    v_max3_f32 v7, v7, v103, v105
    v_sub_f32 v97, v97, v7
    v_sub_f32 v99, v99, v7
    v_sub_f32 v101, v101, v7
    v_sub_f32 v103, v103, v7
    v_sub_f32 v105, v105, v7
    v_exp_f32 v97, v97
    v_exp_f32 v99, v99
    v_exp_f32 v101, v101
    v_exp_f32 v103, v103
    v_exp_f32 v105, v105
    s_nop 0
    v_mul_f32 v7, v97, v96
    v_fmac_f32 v7, v99, v98
    v_fmac_f32 v7, v101, v100
    v_fmac_f32 v7, v103, v102
    v_fmac_f32 v7, v105, v104
    v_rcp_f32 v7, v7
    v_pk_mul_f32 v[176:177], v[176:177], v[96:97] op_sel:[0,1] op_sel_hi:[1,1]
    v_pk_mul_f32 v[178:179], v[178:179], v[96:97] op_sel:[0,1] op_sel_hi:[1,1]
    v_pk_mul_f32 v[180:181], v[180:181], v[96:97] op_sel:[0,1] op_sel_hi:[1,1]
    v_pk_mul_f32 v[182:183], v[182:183], v[96:97] op_sel:[0,1] op_sel_hi:[1,1]
    v_pk_mul_f32 v[184:185], v[184:185], v[96:97] op_sel:[0,1] op_sel_hi:[1,1]
    v_pk_mul_f32 v[186:187], v[186:187], v[96:97] op_sel:[0,1] op_sel_hi:[1,1]
    v_pk_mul_f32 v[188:189], v[188:189], v[96:97] op_sel:[0,1] op_sel_hi:[1,1]
    v_pk_mul_f32 v[190:191], v[190:191], v[96:97] op_sel:[0,1] op_sel_hi:[1,1]
    v_pk_mul_f32 v[192:193], v[192:193], v[96:97] op_sel:[0,1] op_sel_hi:[1,1]
    v_pk_mul_f32 v[194:195], v[194:195], v[96:97] op_sel:[0,1] op_sel_hi:[1,1]
    v_pk_mul_f32 v[196:197], v[196:197], v[96:97] op_sel:[0,1] op_sel_hi:[1,1]
    v_pk_mul_f32 v[198:199], v[198:199], v[96:97] op_sel:[0,1] op_sel_hi:[1,1]
    v_pk_mul_f32 v[200:201], v[200:201], v[96:97] op_sel:[0,1] op_sel_hi:[1,1]
    v_pk_mul_f32 v[202:203], v[202:203], v[96:97] op_sel:[0,1] op_sel_hi:[1,1]
    v_pk_mul_f32 v[204:205], v[204:205], v[96:97] op_sel:[0,1] op_sel_hi:[1,1]
    v_pk_mul_f32 v[206:207], v[206:207], v[96:97] op_sel:[0,1] op_sel_hi:[1,1]
    v_lshrrev_b32 v98, 16, v99
    v_and_b32 v99, 0xffff0000, v99
    v_lshrrev_b32 v100, 16, v101
    v_and_b32 v101, 0xffff0000, v101
    v_lshrrev_b32 v102, 16, v103
    v_and_b32 v103, 0xffff0000, v103
    v_lshrrev_b32 v104, 16, v105
    v_and_b32 v105, 0xffff0000, v105
    s_waitcnt vmcnt(12)
    v_dot2_f32_bf16 v176, v16, v98, v176
    v_dot2_f32_bf16 v177, v16, v99, v177
    v_dot2_f32_bf16 v178, v17, v98, v178
    v_dot2_f32_bf16 v179, v17, v99, v179
    v_dot2_f32_bf16 v180, v18, v98, v180
    v_dot2_f32_bf16 v181, v18, v99, v181
    v_dot2_f32_bf16 v182, v19, v98, v182
    v_dot2_f32_bf16 v183, v19, v99, v183
    v_dot2_f32_bf16 v184, v20, v98, v184
    v_dot2_f32_bf16 v185, v20, v99, v185
    v_dot2_f32_bf16 v186, v21, v98, v186
    v_dot2_f32_bf16 v187, v21, v99, v187
    v_dot2_f32_bf16 v188, v22, v98, v188
    v_dot2_f32_bf16 v189, v22, v99, v189
    v_dot2_f32_bf16 v190, v23, v98, v190
    v_dot2_f32_bf16 v191, v23, v99, v191
    v_dot2_f32_bf16 v192, v24, v98, v192
    v_dot2_f32_bf16 v193, v24, v99, v193
    v_dot2_f32_bf16 v194, v25, v98, v194
    v_dot2_f32_bf16 v195, v25, v99, v195
    v_dot2_f32_bf16 v196, v26, v98, v196
    v_dot2_f32_bf16 v197, v26, v99, v197
    v_dot2_f32_bf16 v198, v27, v98, v198
    v_dot2_f32_bf16 v199, v27, v99, v199
    v_dot2_f32_bf16 v200, v28, v98, v200
    v_dot2_f32_bf16 v201, v28, v99, v201
    v_dot2_f32_bf16 v202, v29, v98, v202
    v_dot2_f32_bf16 v203, v29, v99, v203
    v_dot2_f32_bf16 v204, v30, v98, v204
    v_dot2_f32_bf16 v205, v30, v99, v205
    v_dot2_f32_bf16 v206, v31, v98, v206
    v_dot2_f32_bf16 v207, v31, v99, v207
    s_waitcnt vmcnt(8)
    v_dot2_f32_bf16 v176, v32, v100, v176
    v_dot2_f32_bf16 v177, v32, v101, v177
    v_dot2_f32_bf16 v178, v33, v100, v178
    v_dot2_f32_bf16 v179, v33, v101, v179
    v_dot2_f32_bf16 v180, v34, v100, v180
    v_dot2_f32_bf16 v181, v34, v101, v181
    v_dot2_f32_bf16 v182, v35, v100, v182
    v_dot2_f32_bf16 v183, v35, v101, v183
    v_dot2_f32_bf16 v184, v36, v100, v184
    v_dot2_f32_bf16 v185, v36, v101, v185
    v_dot2_f32_bf16 v186, v37, v100, v186
    v_dot2_f32_bf16 v187, v37, v101, v187
    v_dot2_f32_bf16 v188, v38, v100, v188
    v_dot2_f32_bf16 v189, v38, v101, v189
    v_dot2_f32_bf16 v190, v39, v100, v190
    v_dot2_f32_bf16 v191, v39, v101, v191
    v_dot2_f32_bf16 v192, v40, v100, v192
    v_dot2_f32_bf16 v193, v40, v101, v193
    v_dot2_f32_bf16 v194, v41, v100, v194
    v_dot2_f32_bf16 v195, v41, v101, v195
    v_dot2_f32_bf16 v196, v42, v100, v196
    v_dot2_f32_bf16 v197, v42, v101, v197
    v_dot2_f32_bf16 v198, v43, v100, v198
    v_dot2_f32_bf16 v199, v43, v101, v199
    v_dot2_f32_bf16 v200, v44, v100, v200
    v_dot2_f32_bf16 v201, v44, v101, v201
    v_dot2_f32_bf16 v202, v45, v100, v202
    v_dot2_f32_bf16 v203, v45, v101, v203
    v_dot2_f32_bf16 v204, v46, v100, v204
    v_dot2_f32_bf16 v205, v46, v101, v205
    v_dot2_f32_bf16 v206, v47, v100, v206
    v_dot2_f32_bf16 v207, v47, v101, v207
    s_waitcnt vmcnt(4)
    v_dot2_f32_bf16 v176, v48, v102, v176
    v_dot2_f32_bf16 v177, v48, v103, v177
    v_dot2_f32_bf16 v178, v49, v102, v178
    v_dot2_f32_bf16 v179, v49, v103, v179
    v_dot2_f32_bf16 v180, v50, v102, v180
    v_dot2_f32_bf16 v181, v50, v103, v181
    v_dot2_f32_bf16 v182, v51, v102, v182
    v_dot2_f32_bf16 v183, v51, v103, v183
    v_dot2_f32_bf16 v184, v52, v102, v184
    v_dot2_f32_bf16 v185, v52, v103, v185
    v_dot2_f32_bf16 v186, v53, v102, v186
    v_dot2_f32_bf16 v187, v53, v103, v187
    v_dot2_f32_bf16 v188, v54, v102, v188
    v_dot2_f32_bf16 v189, v54, v103, v189
    v_dot2_f32_bf16 v190, v55, v102, v190
    v_dot2_f32_bf16 v191, v55, v103, v191
    v_dot2_f32_bf16 v192, v56, v102, v192
    v_dot2_f32_bf16 v193, v56, v103, v193
    v_dot2_f32_bf16 v194, v57, v102, v194
    v_dot2_f32_bf16 v195, v57, v103, v195
    v_dot2_f32_bf16 v196, v58, v102, v196
    v_dot2_f32_bf16 v197, v58, v103, v197
    v_dot2_f32_bf16 v198, v59, v102, v198
    v_dot2_f32_bf16 v199, v59, v103, v199
    v_dot2_f32_bf16 v200, v60, v102, v200
    v_dot2_f32_bf16 v201, v60, v103, v201
    v_dot2_f32_bf16 v202, v61, v102, v202
    v_dot2_f32_bf16 v203, v61, v103, v203
    v_dot2_f32_bf16 v204, v62, v102, v204
    v_dot2_f32_bf16 v205, v62, v103, v205
    v_dot2_f32_bf16 v206, v63, v102, v206
    v_dot2_f32_bf16 v207, v63, v103, v207
    s_waitcnt vmcnt(0)
    v_dot2_f32_bf16 v176, v64, v104, v176
    v_dot2_f32_bf16 v177, v64, v105, v177
    v_dot2_f32_bf16 v178, v65, v104, v178
    v_dot2_f32_bf16 v179, v65, v105, v179
    v_dot2_f32_bf16 v180, v66, v104, v180
    v_dot2_f32_bf16 v181, v66, v105, v181
    v_dot2_f32_bf16 v182, v67, v104, v182
    v_dot2_f32_bf16 v183, v67, v105, v183
    v_dot2_f32_bf16 v184, v68, v104, v184
    v_dot2_f32_bf16 v185, v68, v105, v185
    v_dot2_f32_bf16 v186, v69, v104, v186
    v_dot2_f32_bf16 v187, v69, v105, v187
    v_dot2_f32_bf16 v188, v70, v104, v188
    v_dot2_f32_bf16 v189, v70, v105, v189
    v_dot2_f32_bf16 v190, v71, v104, v190
    v_dot2_f32_bf16 v191, v71, v105, v191
    v_dot2_f32_bf16 v192, v72, v104, v192
    v_dot2_f32_bf16 v193, v72, v105, v193
    v_dot2_f32_bf16 v194, v73, v104, v194
    v_dot2_f32_bf16 v195, v73, v105, v195
    v_dot2_f32_bf16 v196, v74, v104, v196
    v_dot2_f32_bf16 v197, v74, v105, v197
    v_dot2_f32_bf16 v198, v75, v104, v198
    v_dot2_f32_bf16 v199, v75, v105, v199
    v_dot2_f32_bf16 v200, v76, v104, v200
    v_dot2_f32_bf16 v201, v76, v105, v201
    v_dot2_f32_bf16 v202, v77, v104, v202
    v_dot2_f32_bf16 v203, v77, v105, v203
    v_dot2_f32_bf16 v204, v78, v104, v204
    v_dot2_f32_bf16 v205, v78, v105, v205
    v_dot2_f32_bf16 v206, v79, v104, v206
    v_dot2_f32_bf16 v207, v79, v105, v207
    s_nop 2
    v_pk_mul_f32 v[176:177], v[176:177], v[6:7] op_sel:[0,1] op_sel_hi:[1,1]
    v_pk_mul_f32 v[178:179], v[178:179], v[6:7] op_sel:[0,1] op_sel_hi:[1,1]
    v_pk_mul_f32 v[180:181], v[180:181], v[6:7] op_sel:[0,1] op_sel_hi:[1,1]
    v_pk_mul_f32 v[182:183], v[182:183], v[6:7] op_sel:[0,1] op_sel_hi:[1,1]
    v_pk_mul_f32 v[184:185], v[184:185], v[6:7] op_sel:[0,1] op_sel_hi:[1,1]
    v_pk_mul_f32 v[186:187], v[186:187], v[6:7] op_sel:[0,1] op_sel_hi:[1,1]
    v_pk_mul_f32 v[188:189], v[188:189], v[6:7] op_sel:[0,1] op_sel_hi:[1,1]
    v_pk_mul_f32 v[190:191], v[190:191], v[6:7] op_sel:[0,1] op_sel_hi:[1,1]
    v_pk_mul_f32 v[192:193], v[192:193], v[6:7] op_sel:[0,1] op_sel_hi:[1,1]
    v_pk_mul_f32 v[194:195], v[194:195], v[6:7] op_sel:[0,1] op_sel_hi:[1,1]
    v_pk_mul_f32 v[196:197], v[196:197], v[6:7] op_sel:[0,1] op_sel_hi:[1,1]
    v_pk_mul_f32 v[198:199], v[198:199], v[6:7] op_sel:[0,1] op_sel_hi:[1,1]
    v_pk_mul_f32 v[200:201], v[200:201], v[6:7] op_sel:[0,1] op_sel_hi:[1,1]
    v_pk_mul_f32 v[202:203], v[202:203], v[6:7] op_sel:[0,1] op_sel_hi:[1,1]
    v_pk_mul_f32 v[204:205], v[204:205], v[6:7] op_sel:[0,1] op_sel_hi:[1,1]
    v_pk_mul_f32 v[206:207], v[206:207], v[6:7] op_sel:[0,1] op_sel_hi:[1,1]
    v_cvt_pk_bf16_f32 v128, v176, v177
    v_cvt_pk_bf16_f32 v129, v178, v179
    v_cvt_pk_bf16_f32 v130, v180, v181
    v_cvt_pk_bf16_f32 v131, v182, v183
    v_cvt_pk_bf16_f32 v132, v184, v185
    v_cvt_pk_bf16_f32 v133, v186, v187
    v_cvt_pk_bf16_f32 v134, v188, v189
    v_cvt_pk_bf16_f32 v135, v190, v191
    v_cvt_pk_bf16_f32 v136, v192, v193
    v_cvt_pk_bf16_f32 v137, v194, v195
    v_cvt_pk_bf16_f32 v138, v196, v197
    v_cvt_pk_bf16_f32 v139, v198, v199
    v_cvt_pk_bf16_f32 v140, v200, v201
    v_cvt_pk_bf16_f32 v141, v202, v203
    v_cvt_pk_bf16_f32 v142, v204, v205
    v_cvt_pk_bf16_f32 v143, v206, v207
    ds_read_b128 a[32:35], v11 offset:8192
    ds_read_b128 a[36:39], v11 offset:9216
    ds_read_b128 a[40:43], v11 offset:10240
    ds_read_b128 a[44:47], v11 offset:11264
    ds_read_b128 a[48:51], v11 offset:12288
    ds_read_b128 a[52:55], v11 offset:13312
    ds_read_b128 a[56:59], v11 offset:14336
    ds_read_b128 a[60:63], v11 offset:15360
    s_waitcnt lgkmcnt(8)
    v_mfma_f32_16x16x32_bf16 v[160:163], a[0:3], v[128:131], v[160:163]
    v_mfma_f32_16x16x32_bf16 v[160:163], a[4:7], v[132:135], v[160:163]
    v_mfma_f32_16x16x32_bf16 v[160:163], a[8:11], v[136:139], v[160:163]
    v_mfma_f32_16x16x32_bf16 v[160:163], a[12:15], v[140:143], v[160:163]
    v_mfma_f32_16x16x32_bf16 v[164:167], a[16:19], v[128:131], v[164:167]
    v_mfma_f32_16x16x32_bf16 v[164:167], a[20:23], v[132:135], v[164:167]
    v_mfma_f32_16x16x32_bf16 v[164:167], a[24:27], v[136:139], v[164:167]
    v_mfma_f32_16x16x32_bf16 v[164:167], a[28:31], v[140:143], v[164:167]
    ds_read_b128 a[0:3], v11 offset:16384
    ds_read_b128 a[4:7], v11 offset:17408
    ds_read_b128 a[8:11], v11 offset:18432
    ds_read_b128 a[12:15], v11 offset:19456
    ds_read_b128 a[16:19], v11 offset:20480
    ds_read_b128 a[20:23], v11 offset:21504
    ds_read_b128 a[24:27], v11 offset:22528
    ds_read_b128 a[28:31], v11 offset:23552
    s_waitcnt lgkmcnt(8)
    v_mfma_f32_16x16x32_bf16 v[168:171], a[32:35], v[128:131], v[168:171]
    v_mfma_f32_16x16x32_bf16 v[168:171], a[36:39], v[132:135], v[168:171]
    v_mfma_f32_16x16x32_bf16 v[168:171], a[40:43], v[136:139], v[168:171]
    v_mfma_f32_16x16x32_bf16 v[168:171], a[44:47], v[140:143], v[168:171]
    v_mfma_f32_16x16x32_bf16 v[172:175], a[48:51], v[128:131], v[172:175]
    v_mfma_f32_16x16x32_bf16 v[172:175], a[52:55], v[132:135], v[172:175]
    v_mfma_f32_16x16x32_bf16 v[172:175], a[56:59], v[136:139], v[172:175]
    v_mfma_f32_16x16x32_bf16 v[172:175], a[60:63], v[140:143], v[172:175]
    ds_read_b128 a[32:35], v11 offset:24576
    ds_read_b128 a[36:39], v11 offset:25600
    ds_read_b128 a[40:43], v11 offset:26624
    ds_read_b128 a[44:47], v11 offset:27648
    ds_read_b128 a[48:51], v11 offset:28672
    ds_read_b128 a[52:55], v11 offset:29696
    ds_read_b128 a[56:59], v11 offset:30720
    ds_read_b128 a[60:63], v11 offset:31744
    s_waitcnt lgkmcnt(8)
    v_mfma_f32_16x16x32_bf16 v[208:211], a[0:3], v[128:131], v[208:211]
    v_mfma_f32_16x16x32_bf16 v[208:211], a[4:7], v[132:135], v[208:211]
    v_mfma_f32_16x16x32_bf16 v[208:211], a[8:11], v[136:139], v[208:211]
    v_mfma_f32_16x16x32_bf16 v[208:211], a[12:15], v[140:143], v[208:211]
    v_mfma_f32_16x16x32_bf16 v[212:215], a[16:19], v[128:131], v[212:215]
    v_mfma_f32_16x16x32_bf16 v[212:215], a[20:23], v[132:135], v[212:215]
    v_mfma_f32_16x16x32_bf16 v[212:215], a[24:27], v[136:139], v[212:215]
    v_mfma_f32_16x16x32_bf16 v[212:215], a[28:31], v[140:143], v[212:215]
    s_waitcnt lgkmcnt(0)
    v_mfma_f32_16x16x32_bf16 v[216:219], a[32:35], v[128:131], v[216:219]
    v_mfma_f32_16x16x32_bf16 v[216:219], a[36:39], v[132:135], v[216:219]
    v_mfma_f32_16x16x32_bf16 v[216:219], a[40:43], v[136:139], v[216:219]
    v_mfma_f32_16x16x32_bf16 v[216:219], a[44:47], v[140:143], v[216:219]
    v_mfma_f32_16x16x32_bf16 v[124:127], a[48:51], v[128:131], v[124:127]
    v_mfma_f32_16x16x32_bf16 v[124:127], a[52:55], v[132:135], v[124:127]
    v_mfma_f32_16x16x32_bf16 v[124:127], a[56:59], v[136:139], v[124:127]
    v_mfma_f32_16x16x32_bf16 v[124:127], a[60:63], v[140:143], v[124:127]
    s_nop 7
    v_cvt_pk_bf16_f32 v106, v160, v161
    v_cvt_pk_bf16_f32 v107, v162, v163
    v_cvt_pk_bf16_f32 v108, v164, v165
    v_cvt_pk_bf16_f32 v109, v166, v167
    buffer_store_dwordx4 v[106:109], v6, s[92:95], s36 offen offset:0 sc1
    v_cvt_pk_bf16_f32 v110, v168, v169
    v_cvt_pk_bf16_f32 v111, v170, v171
    v_cvt_pk_bf16_f32 v112, v172, v173
    v_cvt_pk_bf16_f32 v113, v174, v175
    buffer_store_dwordx4 v[110:113], v6, s[92:95], s36 offen offset:64 sc1
    v_cvt_pk_bf16_f32 v114, v208, v209
    v_cvt_pk_bf16_f32 v115, v210, v211
    v_cvt_pk_bf16_f32 v116, v212, v213
    v_cvt_pk_bf16_f32 v117, v214, v215
    buffer_store_dwordx4 v[114:117], v6, s[92:95], s36 offen offset:128 sc1
    v_cvt_pk_bf16_f32 v118, v216, v217
    v_cvt_pk_bf16_f32 v119, v218, v219
    v_cvt_pk_bf16_f32 v120, v124, v125
    v_cvt_pk_bf16_f32 v121, v126, v127
    buffer_store_dwordx4 v[118:121], v6, s[92:95], s36 offen offset:192 sc1
L2_exit:
L2_done:
    s_endpgm
L2_spx3F:
    s_mov_b32 s91, 0x40000
L2_splx3F:
    s_sleep 1
    ds_read_b32 v255, v254
    s_sub_u32 s91, s91, 1
    s_cmp_eq_u32 s91, 0
    s_cbranch_scc1 L2_sprx3F
    s_waitcnt lgkmcnt(0)
    v_cmp_lt_u32 vcc, v255, v250
    s_cbranch_vccnz L2_splx3F
    s_branch L2_sprx3F

L2_spx3L:
    s_mov_b32 s91, 0x40000
L2_splx3L:
    s_sleep 1
    ds_read_b32 v255, v254
    s_sub_u32 s91, s91, 1
    s_cmp_eq_u32 s91, 0
    s_cbranch_scc1 L2_sprx3L
    s_waitcnt lgkmcnt(0)
    v_cmp_lt_u32 vcc, v255, v250
    s_cbranch_vccnz L2_splx3L
    s_branch L2_sprx3L

L2_spp0F:
    s_mov_b32 s91, 0x40000
L2_splp0F:
    s_sleep 1
    ds_read_b32 v255, v254
    s_sub_u32 s91, s91, 1
    s_cmp_eq_u32 s91, 0
    s_cbranch_scc1 L2_sprp0F
    s_waitcnt lgkmcnt(0)
    v_cmp_lt_u32 vcc, v255, v250
    s_cbranch_vccnz L2_splp0F
    s_branch L2_sprp0F

L2_spp0L:
    s_mov_b32 s91, 0x40000
L2_splp0L:
    s_sleep 1
    ds_read_b32 v255, v254
    s_sub_u32 s91, s91, 1
    s_cmp_eq_u32 s91, 0
    s_cbranch_scc1 L2_sprp0L
    s_waitcnt lgkmcnt(0)
    v_cmp_lt_u32 vcc, v255, v250
    s_cbranch_vccnz L2_splp0L
    s_branch L2_sprp0L

L2_spp1F:
    s_mov_b32 s91, 0x40000
L2_splp1F:
    s_sleep 1
    ds_read_b32 v255, v254
    s_sub_u32 s91, s91, 1
    s_cmp_eq_u32 s91, 0
    s_cbranch_scc1 L2_sprp1F
    s_waitcnt lgkmcnt(0)
    v_cmp_lt_u32 vcc, v255, v250
    s_cbranch_vccnz L2_splp1F
    s_branch L2_sprp1F

L2_spp1L:
    s_mov_b32 s91, 0x40000
L2_splp1L:
    s_sleep 1
    ds_read_b32 v255, v254
    s_sub_u32 s91, s91, 1
    s_cmp_eq_u32 s91, 0
    s_cbranch_scc1 L2_sprp1L
    s_waitcnt lgkmcnt(0)
    v_cmp_lt_u32 vcc, v255, v250
    s_cbranch_vccnz L2_splp1L
    s_branch L2_sprp1L

L2_spp2F:
    s_mov_b32 s91, 0x40000
L2_splp2F:
    s_sleep 1
    ds_read_b32 v255, v254
    s_sub_u32 s91, s91, 1
    s_cmp_eq_u32 s91, 0
    s_cbranch_scc1 L2_sprp2F
    s_waitcnt lgkmcnt(0)
    v_cmp_lt_u32 vcc, v255, v250
    s_cbranch_vccnz L2_splp2F
    s_branch L2_sprp2F

L2_spp2L:
    s_mov_b32 s91, 0x40000
L2_splp2L:
    s_sleep 1
    ds_read_b32 v255, v254
    s_sub_u32 s91, s91, 1
    s_cmp_eq_u32 s91, 0
    s_cbranch_scc1 L2_sprp2L
    s_waitcnt lgkmcnt(0)
    v_cmp_lt_u32 vcc, v255, v250
    s_cbranch_vccnz L2_splp2L
    s_branch L2_sprp2L

L2_spp3F:
    s_mov_b32 s91, 0x40000
L2_splp3F:
    s_sleep 1
    ds_read_b32 v255, v254
    s_sub_u32 s91, s91, 1
    s_cmp_eq_u32 s91, 0
    s_cbranch_scc1 L2_sprp3F
    s_waitcnt lgkmcnt(0)
    v_cmp_lt_u32 vcc, v255, v250
    s_cbranch_vccnz L2_splp3F
    s_branch L2_sprp3F

L2_spp3L:
    s_mov_b32 s91, 0x40000
L2_splp3L:
    s_sleep 1
    ds_read_b32 v255, v254
    s_sub_u32 s91, s91, 1
    s_cmp_eq_u32 s91, 0
    s_cbranch_scc1 L2_sprp3L
    s_waitcnt lgkmcnt(0)
    v_cmp_lt_u32 vcc, v255, v250
    s_cbranch_vccnz L2_splp3L
    s_branch L2_sprp3L

L2_spg0F:
    s_mov_b32 s91, 0x40000
L2_splg0F:
    s_sleep 1
    ds_read_b32 v255, v254
    s_sub_u32 s91, s91, 1
    s_cmp_eq_u32 s91, 0
    s_cbranch_scc1 L2_sprg0F
    s_waitcnt lgkmcnt(0)
    v_cmp_lt_u32 vcc, v255, v250
    s_cbranch_vccnz L2_splg0F
    s_branch L2_sprg0F

L2_spg0L:
    s_mov_b32 s91, 0x40000
L2_splg0L:
    s_sleep 1
    ds_read_b32 v255, v254
    s_sub_u32 s91, s91, 1
    s_cmp_eq_u32 s91, 0
    s_cbranch_scc1 L2_sprg0L
    s_waitcnt lgkmcnt(0)
    v_cmp_lt_u32 vcc, v255, v250
    s_cbranch_vccnz L2_splg0L
    s_branch L2_sprg0L

L2_spg1F:
    s_mov_b32 s91, 0x40000
L2_splg1F:
    s_sleep 1
    ds_read_b32 v255, v254
    s_sub_u32 s91, s91, 1
    s_cmp_eq_u32 s91, 0
    s_cbranch_scc1 L2_sprg1F
    s_waitcnt lgkmcnt(0)
    v_cmp_lt_u32 vcc, v255, v250
    s_cbranch_vccnz L2_splg1F
    s_branch L2_sprg1F

L2_spg1L:
    s_mov_b32 s91, 0x40000
L2_splg1L:
    s_sleep 1
    ds_read_b32 v255, v254
    s_sub_u32 s91, s91, 1
    s_cmp_eq_u32 s91, 0
    s_cbranch_scc1 L2_sprg1L
    s_waitcnt lgkmcnt(0)
    v_cmp_lt_u32 vcc, v255, v250
    s_cbranch_vccnz L2_splg1L
    s_branch L2_sprg1L

L2_spg2F:
    s_mov_b32 s91, 0x40000
L2_splg2F:
    s_sleep 1
    ds_read_b32 v255, v254
    s_sub_u32 s91, s91, 1
    s_cmp_eq_u32 s91, 0
    s_cbranch_scc1 L2_sprg2F
    s_waitcnt lgkmcnt(0)
    v_cmp_lt_u32 vcc, v255, v250
    s_cbranch_vccnz L2_splg2F
    s_branch L2_sprg2F

L2_spg2L:
    s_mov_b32 s91, 0x40000
L2_splg2L:
    s_sleep 1
    ds_read_b32 v255, v254
    s_sub_u32 s91, s91, 1
    s_cmp_eq_u32 s91, 0
    s_cbranch_scc1 L2_sprg2L
    s_waitcnt lgkmcnt(0)
    v_cmp_lt_u32 vcc, v255, v250
    s_cbranch_vccnz L2_splg2L
    s_branch L2_sprg2L

L2_spg3F:
    s_mov_b32 s91, 0x40000
L2_splg3F:
    s_sleep 1
    ds_read_b32 v255, v254
    s_sub_u32 s91, s91, 1
    s_cmp_eq_u32 s91, 0
    s_cbranch_scc1 L2_sprg3F
    s_waitcnt lgkmcnt(0)
    v_cmp_lt_u32 vcc, v255, v250
    s_cbranch_vccnz L2_splg3F
    s_branch L2_sprg3F

L2_spg3L:
    s_mov_b32 s91, 0x40000
L2_splg3L:
    s_sleep 1
    ds_read_b32 v255, v254
    s_sub_u32 s91, s91, 1
    s_cmp_eq_u32 s91, 0
    s_cbranch_scc1 L2_sprg3L
    s_waitcnt lgkmcnt(0)
    v_cmp_lt_u32 vcc, v255, v250
    s_cbranch_vccnz L2_splg3L
    s_branch L2_sprg3L

L2_spe38:
    s_mov_b32 s91, 0x40000
L2_sple38:
    s_sleep 1
    ds_read_b32 v255, v254
    s_sub_u32 s91, s91, 1
    s_cmp_eq_u32 s91, 0
    s_cbranch_scc1 L2_spre38
    s_waitcnt lgkmcnt(0)
    v_cmp_lt_u32 vcc, v255, v250
    s_cbranch_vccnz L2_sple38
    s_branch L2_spre38

L2_spe36:
    s_mov_b32 s91, 0x40000
L2_sple36:
    s_sleep 1
    ds_read_b32 v255, v254
    s_sub_u32 s91, s91, 1
    s_cmp_eq_u32 s91, 0
    s_cbranch_scc1 L2_spre36
    s_waitcnt lgkmcnt(0)
    v_cmp_lt_u32 vcc, v255, v250
    s_cbranch_vccnz L2_sple36
    s_branch L2_spre36

L2_slow:
    buffer_load_ushort a248, v14, s[92:95], s33 offen
    buffer_load_dwordx4 a[32:35], v255, s[12:15], s37 offen offset:0 sc1
    buffer_load_dwordx4 a[36:39], v255, s[12:15], s37 offen offset:1024 sc1
    buffer_load_dwordx4 a[40:43], v255, s[12:15], s37 offen offset:2048 sc1
    buffer_load_dwordx4 a[44:47], v255, s[12:15], s37 offen offset:3072 sc1
    buffer_load_dwordx4 a[48:51], v255, s[12:15], s38 offen offset:0 sc1
    buffer_load_dwordx4 a[52:55], v255, s[12:15], s38 offen offset:1024 sc1
    buffer_load_dwordx4 a[56:59], v255, s[12:15], s38 offen offset:2048 sc1
    buffer_load_dwordx4 a[60:63], v255, s[12:15], s38 offen offset:3072 sc1
    v_min_u32 v228, 48, v221
    v_lshlrev_b32 v228, 8, v228
    s_mov_b32 s39, 1048608
    buffer_load_dwordx4 v[222:225], v228, s[20:23], s39 offen sc1
    buffer_load_dword v226, v228, s[20:23], s39 offen offset:16 sc1
    s_mov_b32 s41, 0x20000
    s_waitcnt vmcnt(0) lgkmcnt(0)
L2_fss:
    v_and_b32 v222, v222, v223
    v_and_b32 v224, v224, v225
    v_and_b32 v222, v222, v226
    v_and_b32 v222, v222, v224
    v_cmp_ne_u32 vcc, 1, v222
    s_cbranch_vccz L2_fsoks
    s_sub_u32 s41, s41, 1
    s_cmp_eq_u32 s41, 0
    s_cbranch_scc1 L2_fsoks
    s_sleep 1
    buffer_load_dwordx4 v[222:225], v228, s[20:23], s39 offen sc1
    buffer_load_dword v226, v228, s[20:23], s39 offen offset:16 sc1
    s_waitcnt vmcnt(0)
    s_branch L2_fss

L2_fsoks:
    v_min_u32 v223, 10, v221
    v_lshlrev_b32 v223, 2, v223
    s_mov_b32 s39, 1061376
    buffer_load_dword v222, v223, s[20:23], s39 offen sc1
    s_waitcnt vmcnt(0)
    s_mov_b32 s41, 0x20000
L2_hfs:
    v_cmp_ne_u32 vcc, 1, v222
    s_cbranch_vccz L2_hfoks
    s_sub_u32 s41, s41, 1
    s_cmp_eq_u32 s41, 0
    s_cbranch_scc1 L2_hfoks
    s_sleep 2
    buffer_load_dword v222, v223, s[20:23], s39 offen sc1
    s_waitcnt vmcnt(0)
    s_branch L2_hfs

L2_hfoks:
    v_lshlrev_b32 v223, 2, v221
    v_mov_b32 v224, 0x7ffffff0
    v_cmp_gt_u32 vcc, 11, v221
    s_lshl_b32 s80, s72, 6
    s_nop 0
    v_cndmask_b32 v223, v224, v223, vcc
    buffer_load_dword v246, v223, s[68:71], s80 offen sc1

    s_waitcnt vmcnt(0)
    s_mov_b32 s79, 63
L2_retrys:
    v_lshrrev_b32 v222, 16, v246
    v_min_u32 v222, s79, v222
    v_mov_b32 v223, v222

    s_nop 1
    v_add_u32_dpp v223, v223, v223 row_shr:1 row_mask:0xf bank_mask:0xf
    s_nop 1
    v_add_u32_dpp v223, v223, v223 row_shr:2 row_mask:0xf bank_mask:0xf
    s_nop 1
    v_add_u32_dpp v223, v223, v223 row_shr:4 row_mask:0xf bank_mask:0xf
    s_nop 1
    v_add_u32_dpp v223, v223, v223 row_shr:8 row_mask:0xf bank_mask:0xf
    s_nop 0
    v_readlane_b32 s76, v223, 15
    s_cmp_le_u32 s76, 176
    s_cbranch_scc1 L2_oks
    s_mov_b32 s79, 16
    s_branch L2_retrys

L2_oks:
    v_sub_u32 v223, v223, v222
    v_lshl_add_u32 v223, v223, 4, s73
    v_mov_b32 v224, 159744
    v_mul_u32_u24 v224, v224, v221
    v_and_b32 v225, 0xffff, v246
    v_lshl_add_u32 v224, v225, 4, v224
    v_lshlrev_b32 v225, 4, v221
    s_lshl_b32 s76, s76, 2
    s_cbranch_scc0 L2_lbs

    v_readlane_b32 s36, v224, 0
    v_readlane_b32 s37, v224, 1
    v_readlane_b32 s38, v224, 2
    v_readlane_b32 s39, v224, 3
    v_readlane_b32 s33, v223, 0
    v_readlane_b32 s42, v223, 1
    v_readlane_b32 s43, v223, 2
    v_readlane_b32 s79, v223, 3
    v_readlane_b32 s80, v222, 0
    v_readlane_b32 s81, v222, 1
    v_readlane_b32 s91, v222, 2
    v_readlane_b32 s77, v222, 3
    s_mov_b32 m0, s33
    s_bfm_b64 exec, s80, 0
    buffer_load_dwordx4 v225, s[64:67], s36 offen sc1 lds
    s_mov_b32 m0, s42
    s_bfm_b64 exec, s81, 0
    buffer_load_dwordx4 v225, s[64:67], s37 offen sc1 lds
    s_mov_b32 m0, s43
    s_bfm_b64 exec, s91, 0
    buffer_load_dwordx4 v225, s[64:67], s38 offen sc1 lds
    s_mov_b32 m0, s79
    s_bfm_b64 exec, s77, 0
    buffer_load_dwordx4 v225, s[64:67], s39 offen sc1 lds
    v_readlane_b32 s36, v224, 4
    v_readlane_b32 s37, v224, 5
    v_readlane_b32 s38, v224, 6
    v_readlane_b32 s39, v224, 7
    v_readlane_b32 s33, v223, 4
    v_readlane_b32 s42, v223, 5
    v_readlane_b32 s43, v223, 6
    v_readlane_b32 s79, v223, 7
    v_readlane_b32 s80, v222, 4
    v_readlane_b32 s81, v222, 5
    v_readlane_b32 s91, v222, 6
    v_readlane_b32 s77, v222, 7
    s_mov_b32 m0, s33
    s_bfm_b64 exec, s80, 0
    buffer_load_dwordx4 v225, s[64:67], s36 offen sc1 lds
    s_mov_b32 m0, s42
    s_bfm_b64 exec, s81, 0
    buffer_load_dwordx4 v225, s[64:67], s37 offen sc1 lds
    s_mov_b32 m0, s43
    s_bfm_b64 exec, s91, 0
    buffer_load_dwordx4 v225, s[64:67], s38 offen sc1 lds
    s_mov_b32 m0, s79
    s_bfm_b64 exec, s77, 0
    buffer_load_dwordx4 v225, s[64:67], s39 offen sc1 lds
    v_readlane_b32 s36, v224, 8
    v_readlane_b32 s37, v224, 9
    v_readlane_b32 s38, v224, 10
    v_readlane_b32 s33, v223, 8
    v_readlane_b32 s42, v223, 9
    v_readlane_b32 s43, v223, 10
    v_readlane_b32 s80, v222, 8
    v_readlane_b32 s81, v222, 9
    v_readlane_b32 s91, v222, 10
    s_mov_b32 m0, s33
    s_bfm_b64 exec, s80, 0
    buffer_load_dwordx4 v225, s[64:67], s36 offen sc1 lds
    s_mov_b32 m0, s42
    s_bfm_b64 exec, s81, 0
    buffer_load_dwordx4 v225, s[64:67], s37 offen sc1 lds
    s_mov_b32 m0, s43
    s_bfm_b64 exec, s91, 0
    buffer_load_dwordx4 v225, s[64:67], s38 offen sc1 lds
L2_lbs:
    s_mov_b64 exec, -1
    v_add_u32 v223, s76, v221
    v_lshl_add_u32 v223, v223, 2, s73
    v_mov_b32 v224, 0x7ffffff0
    ds_write_b32 v223, v224
    ds_write_b32 v223, v224 offset:256
    ds_write_b32 v223, v224 offset:512
    v_add_u32 v246, v246, v222
    v_lshlrev_b32 v222, 16, v222
    v_sub_u32 v246, v246, v222
    s_add_u32 s77, s76, 31
    s_lshr_b32 s77, s77, 5
    s_mov_b32 s78, 0
    s_max_u32 s3, s77, 1
    s_sub_u32 s3, s3, 1
    s_and_b32 s3, s3, -2
    v_lshrrev_b32 v240, 4, v221
    v_lshl_add_u32 v240, v240, 2, s73
    v_and_b32 v241, 31, v221
    v_lshl_add_u32 v241, v241, 2, s73

    s_waitcnt vmcnt(0) lgkmcnt(0)
    v_mov_b32 v250, 0xf149f2ca
    v_mov_b32 v251, 0xf149f2ca
    v_mov_b32 v252, 0xf149f2ca
    v_mov_b32 v253, 0xf149f2ca
    v_mov_b32 v0, 0
    v_mov_b32 v1, 0
    v_mov_b32 v2, 0
    v_mov_b32 v3, 0
    v_mov_b32 v4, 0
    v_mov_b32 v5, 0
    v_mov_b32 v6, 0
    v_mov_b32 v7, 0
    v_mov_b32 v8, 0
    v_mov_b32 v9, 0
    v_mov_b32 v10, 0
    v_mov_b32 v11, 0
    v_mov_b32 v12, 0
    v_mov_b32 v13, 0
    v_mov_b32 v14, 0
    v_mov_b32 v15, 0
    v_mov_b32 v16, 0
    v_mov_b32 v17, 0
    v_mov_b32 v18, 0
    v_mov_b32 v19, 0
    v_mov_b32 v20, 0
    v_mov_b32 v21, 0
    v_mov_b32 v22, 0
    v_mov_b32 v23, 0
    v_mov_b32 v24, 0
    v_mov_b32 v25, 0
    v_mov_b32 v26, 0
    v_mov_b32 v27, 0
    v_mov_b32 v28, 0
    v_mov_b32 v29, 0
    v_mov_b32 v30, 0
    v_mov_b32 v31, 0
    v_mov_b32 v32, 0
    v_mov_b32 v33, 0
    v_mov_b32 v34, 0
    v_mov_b32 v35, 0
    v_mov_b32 v36, 0
    v_mov_b32 v37, 0
    v_mov_b32 v38, 0
    v_mov_b32 v39, 0
    v_mov_b32 v40, 0
    v_mov_b32 v41, 0
    v_mov_b32 v42, 0
    v_mov_b32 v43, 0
    v_mov_b32 v44, 0
    v_mov_b32 v45, 0
    v_mov_b32 v46, 0
    v_mov_b32 v47, 0
    v_mov_b32 v48, 0
    v_mov_b32 v49, 0
    v_mov_b32 v50, 0
    v_mov_b32 v51, 0
    v_mov_b32 v52, 0
    v_mov_b32 v53, 0
    v_mov_b32 v54, 0
    v_mov_b32 v55, 0
    v_mov_b32 v56, 0
    v_mov_b32 v57, 0
    v_mov_b32 v58, 0
    v_mov_b32 v59, 0
    v_mov_b32 v60, 0
    v_mov_b32 v61, 0
    v_mov_b32 v62, 0
    v_mov_b32 v63, 0
    v_mov_b32 v64, 0
    v_mov_b32 v65, 0
    v_mov_b32 v66, 0
    v_mov_b32 v67, 0
    v_mov_b32 v68, 0
    v_mov_b32 v69, 0
    v_mov_b32 v70, 0
    v_mov_b32 v71, 0
    v_mov_b32 v72, 0
    v_mov_b32 v73, 0
    v_mov_b32 v74, 0
    v_mov_b32 v75, 0
    v_mov_b32 v76, 0
    v_mov_b32 v77, 0
    v_mov_b32 v78, 0
    v_mov_b32 v79, 0
    v_mov_b32 v80, 0
    v_mov_b32 v81, 0
    v_mov_b32 v82, 0
    v_mov_b32 v83, 0
    v_mov_b32 v84, 0
    v_mov_b32 v85, 0
    v_mov_b32 v86, 0
    v_mov_b32 v87, 0
    v_mov_b32 v88, 0
    v_mov_b32 v89, 0
    v_mov_b32 v90, 0
    v_mov_b32 v91, 0
    v_mov_b32 v92, 0
    v_mov_b32 v93, 0
    v_mov_b32 v94, 0
    v_mov_b32 v95, 0
    v_mov_b32 v96, 0
    v_mov_b32 v97, 0
    v_mov_b32 v98, 0
    v_mov_b32 v99, 0
    v_mov_b32 v100, 0
    v_mov_b32 v101, 0
    v_mov_b32 v102, 0
    v_mov_b32 v103, 0
    v_mov_b32 v104, 0
    v_mov_b32 v105, 0
    v_mov_b32 v106, 0
    v_mov_b32 v107, 0
    v_mov_b32 v108, 0
    v_mov_b32 v109, 0
    v_mov_b32 v110, 0
    v_mov_b32 v111, 0
    v_mov_b32 v112, 0
    v_mov_b32 v113, 0
    v_mov_b32 v114, 0
    v_mov_b32 v115, 0
    v_mov_b32 v116, 0
    v_mov_b32 v117, 0
    v_mov_b32 v118, 0
    v_mov_b32 v119, 0
    v_mov_b32 v120, 0
    v_mov_b32 v121, 0
    v_mov_b32 v122, 0
    v_mov_b32 v123, 0
    v_mov_b32 v124, 0
    v_mov_b32 v125, 0
    v_mov_b32 v126, 0
    v_mov_b32 v127, 0
    s_mul_i32 s27, s25, 647168
    s_mul_i32 s40, s25, 2528
    s_add_u32 s41, s40, 2528
    s_min_u32 s41, s41, 12500
    v_lshrrev_b32 v254, 4, v221
    v_lshlrev_b32 v254, 2, v254
    v_add_u32 v254, s40, v254
    s_mov_b32 s32, 40
    v_mov_b32 v255, 0xff800000

L2_sloop:
    s_barrier
    s_mov_b32 m0, s28
    s_nop 0
    buffer_load_dwordx4 v220, s[8:11], s27 offen offset:0 sc1 lds
    buffer_load_dwordx4 v220, s[8:11], s27 offen offset:1024 sc1 lds
    buffer_load_dwordx4 v220, s[8:11], s27 offen offset:2048 sc1 lds
    buffer_load_dwordx4 v220, s[8:11], s27 offen offset:3072 sc1 lds
    s_add_u32 s27, s27, 16384
    s_waitcnt vmcnt(0)
    s_barrier
    ds_read_b128 a[64:67], v208 offset:0
    ds_read_b128 a[68:71], v209 offset:0
    ds_read_b128 a[72:75], v210 offset:0
    ds_read_b128 a[76:79], v211 offset:0
    s_waitcnt lgkmcnt(0)
    v_mfma_f32_16x16x32_bf16 v[128:131], a[64:67], a[0:3], 0
    v_mfma_f32_16x16x32_bf16 v[128:131], a[68:71], a[4:7], v[128:131]
    v_mfma_f32_16x16x32_bf16 v[128:131], a[72:75], a[8:11], v[128:131]
    v_mfma_f32_16x16x32_bf16 v[128:131], a[76:79], a[12:15], v[128:131]
    v_mfma_f32_16x16x32_bf16 v[136:139], a[64:67], a[16:19], 0
    v_mfma_f32_16x16x32_bf16 v[136:139], a[68:71], a[20:23], v[136:139]
    v_mfma_f32_16x16x32_bf16 v[136:139], a[72:75], a[24:27], v[136:139]
    v_mfma_f32_16x16x32_bf16 v[136:139], a[76:79], a[28:31], v[136:139]
    v_mfma_f32_16x16x32_bf16 v[144:147], a[64:67], a[32:35], 0
    v_mfma_f32_16x16x32_bf16 v[144:147], a[68:71], a[36:39], v[144:147]
    v_mfma_f32_16x16x32_bf16 v[144:147], a[72:75], a[40:43], v[144:147]
    v_mfma_f32_16x16x32_bf16 v[144:147], a[76:79], a[44:47], v[144:147]
    v_mfma_f32_16x16x32_bf16 v[152:155], a[64:67], a[48:51], 0
    v_mfma_f32_16x16x32_bf16 v[152:155], a[68:71], a[52:55], v[152:155]
    v_mfma_f32_16x16x32_bf16 v[152:155], a[72:75], a[56:59], v[152:155]
    v_mfma_f32_16x16x32_bf16 v[152:155], a[76:79], a[60:63], v[152:155]
    ds_read_b128 a[64:67], v208 offset:4096
    ds_read_b128 a[68:71], v209 offset:4096
    ds_read_b128 a[72:75], v210 offset:4096
    ds_read_b128 a[76:79], v211 offset:4096
    s_waitcnt lgkmcnt(0)
    v_mfma_f32_16x16x32_bf16 v[132:135], a[64:67], a[0:3], 0
    v_mfma_f32_16x16x32_bf16 v[132:135], a[68:71], a[4:7], v[132:135]
    v_mfma_f32_16x16x32_bf16 v[132:135], a[72:75], a[8:11], v[132:135]
    v_mfma_f32_16x16x32_bf16 v[132:135], a[76:79], a[12:15], v[132:135]
    v_mfma_f32_16x16x32_bf16 v[140:143], a[64:67], a[16:19], 0
    v_mfma_f32_16x16x32_bf16 v[140:143], a[68:71], a[20:23], v[140:143]
    v_mfma_f32_16x16x32_bf16 v[140:143], a[72:75], a[24:27], v[140:143]
    v_mfma_f32_16x16x32_bf16 v[140:143], a[76:79], a[28:31], v[140:143]
    v_mfma_f32_16x16x32_bf16 v[148:151], a[64:67], a[32:35], 0
    v_mfma_f32_16x16x32_bf16 v[148:151], a[68:71], a[36:39], v[148:151]
    v_mfma_f32_16x16x32_bf16 v[148:151], a[72:75], a[40:43], v[148:151]
    v_mfma_f32_16x16x32_bf16 v[148:151], a[76:79], a[44:47], v[148:151]
    v_mfma_f32_16x16x32_bf16 v[156:159], a[64:67], a[48:51], 0
    v_mfma_f32_16x16x32_bf16 v[156:159], a[68:71], a[52:55], v[156:159]
    v_mfma_f32_16x16x32_bf16 v[156:159], a[72:75], a[56:59], v[156:159]
    v_mfma_f32_16x16x32_bf16 v[156:159], a[76:79], a[60:63], v[156:159]
    ds_read_b128 a[64:67], v208 offset:8192
    ds_read_b128 a[68:71], v209 offset:8192
    ds_read_b128 a[72:75], v210 offset:8192
    ds_read_b128 a[76:79], v211 offset:8192
    s_waitcnt lgkmcnt(0)
    v_mfma_f32_16x16x32_bf16 v[160:163], a[64:67], a[0:3], 0
    v_mfma_f32_16x16x32_bf16 v[160:163], a[68:71], a[4:7], v[160:163]
    v_mfma_f32_16x16x32_bf16 v[160:163], a[72:75], a[8:11], v[160:163]
    v_mfma_f32_16x16x32_bf16 v[160:163], a[76:79], a[12:15], v[160:163]
    v_mfma_f32_16x16x32_bf16 v[168:171], a[64:67], a[16:19], 0
    v_mfma_f32_16x16x32_bf16 v[168:171], a[68:71], a[20:23], v[168:171]
    v_mfma_f32_16x16x32_bf16 v[168:171], a[72:75], a[24:27], v[168:171]
    v_mfma_f32_16x16x32_bf16 v[168:171], a[76:79], a[28:31], v[168:171]
    v_mfma_f32_16x16x32_bf16 v[176:179], a[64:67], a[32:35], 0
    v_mfma_f32_16x16x32_bf16 v[176:179], a[68:71], a[36:39], v[176:179]
    v_mfma_f32_16x16x32_bf16 v[176:179], a[72:75], a[40:43], v[176:179]
    v_mfma_f32_16x16x32_bf16 v[176:179], a[76:79], a[44:47], v[176:179]
    v_mfma_f32_16x16x32_bf16 v[184:187], a[64:67], a[48:51], 0
    v_mfma_f32_16x16x32_bf16 v[184:187], a[68:71], a[52:55], v[184:187]
    v_mfma_f32_16x16x32_bf16 v[184:187], a[72:75], a[56:59], v[184:187]
    v_mfma_f32_16x16x32_bf16 v[184:187], a[76:79], a[60:63], v[184:187]
    ds_read_b128 a[64:67], v208 offset:12288
    ds_read_b128 a[68:71], v209 offset:12288
    ds_read_b128 a[72:75], v210 offset:12288
    ds_read_b128 a[76:79], v211 offset:12288
    s_waitcnt lgkmcnt(0)
    v_mfma_f32_16x16x32_bf16 v[164:167], a[64:67], a[0:3], 0
    v_mfma_f32_16x16x32_bf16 v[164:167], a[68:71], a[4:7], v[164:167]
    v_mfma_f32_16x16x32_bf16 v[164:167], a[72:75], a[8:11], v[164:167]
    v_mfma_f32_16x16x32_bf16 v[164:167], a[76:79], a[12:15], v[164:167]
    v_mfma_f32_16x16x32_bf16 v[172:175], a[64:67], a[16:19], 0
    v_mfma_f32_16x16x32_bf16 v[172:175], a[68:71], a[20:23], v[172:175]
    v_mfma_f32_16x16x32_bf16 v[172:175], a[72:75], a[24:27], v[172:175]
    v_mfma_f32_16x16x32_bf16 v[172:175], a[76:79], a[28:31], v[172:175]
    v_mfma_f32_16x16x32_bf16 v[180:183], a[64:67], a[32:35], 0
    v_mfma_f32_16x16x32_bf16 v[180:183], a[68:71], a[36:39], v[180:183]
    v_mfma_f32_16x16x32_bf16 v[180:183], a[72:75], a[40:43], v[180:183]
    v_mfma_f32_16x16x32_bf16 v[180:183], a[76:79], a[44:47], v[180:183]
    v_mfma_f32_16x16x32_bf16 v[188:191], a[64:67], a[48:51], 0
    v_mfma_f32_16x16x32_bf16 v[188:191], a[68:71], a[52:55], v[188:191]
    v_mfma_f32_16x16x32_bf16 v[188:191], a[72:75], a[56:59], v[188:191]
    v_mfma_f32_16x16x32_bf16 v[188:191], a[76:79], a[60:63], v[188:191]
    s_nop 7
    v_add_u32 v192, 0, v254
    v_cmp_gt_u32 vcc, s41, v192
    s_nop 1
    v_cndmask_b32 v128, v255, v128, vcc
    v_cndmask_b32 v136, v255, v136, vcc
    v_cndmask_b32 v144, v255, v144, vcc
    v_cndmask_b32 v152, v255, v152, vcc
    v_add_u32 v192, 1, v254
    v_cmp_gt_u32 vcc, s41, v192
    s_nop 1
    v_cndmask_b32 v129, v255, v129, vcc
    v_cndmask_b32 v137, v255, v137, vcc
    v_cndmask_b32 v145, v255, v145, vcc
    v_cndmask_b32 v153, v255, v153, vcc
    v_add_u32 v192, 2, v254
    v_cmp_gt_u32 vcc, s41, v192
    s_nop 1
    v_cndmask_b32 v130, v255, v130, vcc
    v_cndmask_b32 v138, v255, v138, vcc
    v_cndmask_b32 v146, v255, v146, vcc
    v_cndmask_b32 v154, v255, v154, vcc
    v_add_u32 v192, 3, v254
    v_cmp_gt_u32 vcc, s41, v192
    s_nop 1
    v_cndmask_b32 v131, v255, v131, vcc
    v_cndmask_b32 v139, v255, v139, vcc
    v_cndmask_b32 v147, v255, v147, vcc
    v_cndmask_b32 v155, v255, v155, vcc
    v_add_u32 v192, 16, v254
    v_cmp_gt_u32 vcc, s41, v192
    s_nop 1
    v_cndmask_b32 v132, v255, v132, vcc
    v_cndmask_b32 v140, v255, v140, vcc
    v_cndmask_b32 v148, v255, v148, vcc
    v_cndmask_b32 v156, v255, v156, vcc
    v_add_u32 v192, 17, v254
    v_cmp_gt_u32 vcc, s41, v192
    s_nop 1
    v_cndmask_b32 v133, v255, v133, vcc
    v_cndmask_b32 v141, v255, v141, vcc
    v_cndmask_b32 v149, v255, v149, vcc
    v_cndmask_b32 v157, v255, v157, vcc
    v_add_u32 v192, 18, v254
    v_cmp_gt_u32 vcc, s41, v192
    s_nop 1
    v_cndmask_b32 v134, v255, v134, vcc
    v_cndmask_b32 v142, v255, v142, vcc
    v_cndmask_b32 v150, v255, v150, vcc
    v_cndmask_b32 v158, v255, v158, vcc
    v_add_u32 v192, 19, v254
    v_cmp_gt_u32 vcc, s41, v192
    s_nop 1
    v_cndmask_b32 v135, v255, v135, vcc
    v_cndmask_b32 v143, v255, v143, vcc
    v_cndmask_b32 v151, v255, v151, vcc
    v_cndmask_b32 v159, v255, v159, vcc
    v_add_u32 v192, 32, v254
    v_cmp_gt_u32 vcc, s41, v192
    s_nop 1
    v_cndmask_b32 v160, v255, v160, vcc
    v_cndmask_b32 v168, v255, v168, vcc
    v_cndmask_b32 v176, v255, v176, vcc
    v_cndmask_b32 v184, v255, v184, vcc
    v_add_u32 v192, 33, v254
    v_cmp_gt_u32 vcc, s41, v192
    s_nop 1
    v_cndmask_b32 v161, v255, v161, vcc
    v_cndmask_b32 v169, v255, v169, vcc
    v_cndmask_b32 v177, v255, v177, vcc
    v_cndmask_b32 v185, v255, v185, vcc
    v_add_u32 v192, 34, v254
    v_cmp_gt_u32 vcc, s41, v192
    s_nop 1
    v_cndmask_b32 v162, v255, v162, vcc
    v_cndmask_b32 v170, v255, v170, vcc
    v_cndmask_b32 v178, v255, v178, vcc
    v_cndmask_b32 v186, v255, v186, vcc
    v_add_u32 v192, 35, v254
    v_cmp_gt_u32 vcc, s41, v192
    s_nop 1
    v_cndmask_b32 v163, v255, v163, vcc
    v_cndmask_b32 v171, v255, v171, vcc
    v_cndmask_b32 v179, v255, v179, vcc
    v_cndmask_b32 v187, v255, v187, vcc
    v_add_u32 v192, 48, v254
    v_cmp_gt_u32 vcc, s41, v192
    s_nop 1
    v_cndmask_b32 v164, v255, v164, vcc
    v_cndmask_b32 v172, v255, v172, vcc
    v_cndmask_b32 v180, v255, v180, vcc
    v_cndmask_b32 v188, v255, v188, vcc
    v_add_u32 v192, 49, v254
    v_cmp_gt_u32 vcc, s41, v192
    s_nop 1
    v_cndmask_b32 v165, v255, v165, vcc
    v_cndmask_b32 v173, v255, v173, vcc
    v_cndmask_b32 v181, v255, v181, vcc
    v_cndmask_b32 v189, v255, v189, vcc
    v_add_u32 v192, 50, v254
    v_cmp_gt_u32 vcc, s41, v192
    s_nop 1
    v_cndmask_b32 v166, v255, v166, vcc
    v_cndmask_b32 v174, v255, v174, vcc
    v_cndmask_b32 v182, v255, v182, vcc
    v_cndmask_b32 v190, v255, v190, vcc
    v_add_u32 v192, 51, v254
    v_cmp_gt_u32 vcc, s41, v192
    s_nop 1
    v_cndmask_b32 v167, v255, v167, vcc
    v_cndmask_b32 v175, v255, v175, vcc
    v_cndmask_b32 v183, v255, v183, vcc
    v_cndmask_b32 v191, v255, v191, vcc
    v_add_u32 v254, 64, v254
    v_max_f32 v192, v128, v129
    v_max3_f32 v192, v192, v130, v131
    v_max3_f32 v192, v192, v132, v133
    v_max3_f32 v192, v192, v134, v135
    v_max3_f32 v192, v192, v160, v161
    v_max3_f32 v192, v192, v162, v163
    v_max3_f32 v192, v192, v164, v165
    v_max3_f32 v192, v192, v166, v167
    v_mov_b32 v193, v192
    s_nop 1
    v_permlane16_swap_b32 v192, v193
    v_max_f32 v192, v192, v193
    v_mov_b32 v193, v192
    s_nop 1
    v_permlane32_swap_b32 v192, v193
    v_max_f32 v192, v192, v193
    v_ceil_f32 v192, v192
    v_max_f32 v192, v192, v250
    v_sub_f32 v194, v250, v192
    v_exp_f32 v194, v194
    v_mov_b32 v250, v192

    v_sub_f32 v128, v128, v192
    v_sub_f32 v129, v129, v192
    v_sub_f32 v130, v130, v192
    v_sub_f32 v131, v131, v192
    v_sub_f32 v132, v132, v192
    v_sub_f32 v133, v133, v192
    v_sub_f32 v134, v134, v192
    v_sub_f32 v135, v135, v192
    v_sub_f32 v160, v160, v192
    v_sub_f32 v161, v161, v192
    v_sub_f32 v162, v162, v192
    v_sub_f32 v163, v163, v192
    v_sub_f32 v164, v164, v192
    v_sub_f32 v165, v165, v192
    v_sub_f32 v166, v166, v192
    v_sub_f32 v167, v167, v192
    v_exp_f32 v128, v128
    v_exp_f32 v129, v129
    v_exp_f32 v130, v130
    v_exp_f32 v131, v131
    v_exp_f32 v132, v132
    v_exp_f32 v133, v133
    v_exp_f32 v134, v134
    v_exp_f32 v135, v135
    v_exp_f32 v160, v160
    v_exp_f32 v161, v161
    v_exp_f32 v162, v162
    v_exp_f32 v163, v163
    v_exp_f32 v164, v164
    v_exp_f32 v165, v165
    v_exp_f32 v166, v166
    v_exp_f32 v167, v167
    v_mul_f32 v0, v0, v194
    v_mul_f32 v1, v1, v194
    v_mul_f32 v2, v2, v194
    v_mul_f32 v3, v3, v194
    v_mul_f32 v16, v16, v194
    v_mul_f32 v17, v17, v194
    v_mul_f32 v18, v18, v194
    v_mul_f32 v19, v19, v194
    v_mul_f32 v32, v32, v194
    v_mul_f32 v33, v33, v194
    v_mul_f32 v34, v34, v194
    v_mul_f32 v35, v35, v194
    v_mul_f32 v48, v48, v194
    v_mul_f32 v49, v49, v194
    v_mul_f32 v50, v50, v194
    v_mul_f32 v51, v51, v194
    v_mul_f32 v64, v64, v194
    v_mul_f32 v65, v65, v194
    v_mul_f32 v66, v66, v194
    v_mul_f32 v67, v67, v194
    v_mul_f32 v80, v80, v194
    v_mul_f32 v81, v81, v194
    v_mul_f32 v82, v82, v194
    v_mul_f32 v83, v83, v194
    v_mul_f32 v96, v96, v194
    v_mul_f32 v97, v97, v194
    v_mul_f32 v98, v98, v194
    v_mul_f32 v99, v99, v194
    v_mul_f32 v112, v112, v194
    v_mul_f32 v113, v113, v194
    v_mul_f32 v114, v114, v194
    v_mul_f32 v115, v115, v194
    v_cvt_pk_bf16_f32 v128, v128, v129
    v_cvt_pk_bf16_f32 v129, v130, v131
    v_cvt_pk_bf16_f32 v130, v132, v133
    v_cvt_pk_bf16_f32 v131, v134, v135
    v_cvt_pk_bf16_f32 v160, v160, v161
    v_cvt_pk_bf16_f32 v161, v162, v163
    v_cvt_pk_bf16_f32 v162, v164, v165
    v_cvt_pk_bf16_f32 v163, v166, v167
    v_max_f32 v192, v136, v137
    v_max3_f32 v192, v192, v138, v139
    v_max3_f32 v192, v192, v140, v141
    v_max3_f32 v192, v192, v142, v143
    v_max3_f32 v192, v192, v168, v169
    v_max3_f32 v192, v192, v170, v171
    v_max3_f32 v192, v192, v172, v173
    v_max3_f32 v192, v192, v174, v175
    v_mov_b32 v193, v192
    s_nop 1
    v_permlane16_swap_b32 v192, v193
    v_max_f32 v192, v192, v193
    v_mov_b32 v193, v192
    s_nop 1
    v_permlane32_swap_b32 v192, v193
    v_max_f32 v192, v192, v193
    v_ceil_f32 v192, v192
    v_max_f32 v192, v192, v251
    v_sub_f32 v194, v251, v192
    v_exp_f32 v194, v194
    v_mov_b32 v251, v192

    v_sub_f32 v136, v136, v192
    v_sub_f32 v137, v137, v192
    v_sub_f32 v138, v138, v192
    v_sub_f32 v139, v139, v192
    v_sub_f32 v140, v140, v192
    v_sub_f32 v141, v141, v192
    v_sub_f32 v142, v142, v192
    v_sub_f32 v143, v143, v192
    v_sub_f32 v168, v168, v192
    v_sub_f32 v169, v169, v192
    v_sub_f32 v170, v170, v192
    v_sub_f32 v171, v171, v192
    v_sub_f32 v172, v172, v192
    v_sub_f32 v173, v173, v192
    v_sub_f32 v174, v174, v192
    v_sub_f32 v175, v175, v192
    v_exp_f32 v136, v136
    v_exp_f32 v137, v137
    v_exp_f32 v138, v138
    v_exp_f32 v139, v139
    v_exp_f32 v140, v140
    v_exp_f32 v141, v141
    v_exp_f32 v142, v142
    v_exp_f32 v143, v143
    v_exp_f32 v168, v168
    v_exp_f32 v169, v169
    v_exp_f32 v170, v170
    v_exp_f32 v171, v171
    v_exp_f32 v172, v172
    v_exp_f32 v173, v173
    v_exp_f32 v174, v174
    v_exp_f32 v175, v175
    v_mul_f32 v4, v4, v194
    v_mul_f32 v5, v5, v194
    v_mul_f32 v6, v6, v194
    v_mul_f32 v7, v7, v194
    v_mul_f32 v20, v20, v194
    v_mul_f32 v21, v21, v194
    v_mul_f32 v22, v22, v194
    v_mul_f32 v23, v23, v194
    v_mul_f32 v36, v36, v194
    v_mul_f32 v37, v37, v194
    v_mul_f32 v38, v38, v194
    v_mul_f32 v39, v39, v194
    v_mul_f32 v52, v52, v194
    v_mul_f32 v53, v53, v194
    v_mul_f32 v54, v54, v194
    v_mul_f32 v55, v55, v194
    v_mul_f32 v68, v68, v194
    v_mul_f32 v69, v69, v194
    v_mul_f32 v70, v70, v194
    v_mul_f32 v71, v71, v194
    v_mul_f32 v84, v84, v194
    v_mul_f32 v85, v85, v194
    v_mul_f32 v86, v86, v194
    v_mul_f32 v87, v87, v194
    v_mul_f32 v100, v100, v194
    v_mul_f32 v101, v101, v194
    v_mul_f32 v102, v102, v194
    v_mul_f32 v103, v103, v194
    v_mul_f32 v116, v116, v194
    v_mul_f32 v117, v117, v194
    v_mul_f32 v118, v118, v194
    v_mul_f32 v119, v119, v194
    v_cvt_pk_bf16_f32 v136, v136, v137
    v_cvt_pk_bf16_f32 v137, v138, v139
    v_cvt_pk_bf16_f32 v138, v140, v141
    v_cvt_pk_bf16_f32 v139, v142, v143
    v_cvt_pk_bf16_f32 v168, v168, v169
    v_cvt_pk_bf16_f32 v169, v170, v171
    v_cvt_pk_bf16_f32 v170, v172, v173
    v_cvt_pk_bf16_f32 v171, v174, v175
    v_max_f32 v192, v144, v145
    v_max3_f32 v192, v192, v146, v147
    v_max3_f32 v192, v192, v148, v149
    v_max3_f32 v192, v192, v150, v151
    v_max3_f32 v192, v192, v176, v177
    v_max3_f32 v192, v192, v178, v179
    v_max3_f32 v192, v192, v180, v181
    v_max3_f32 v192, v192, v182, v183
    v_mov_b32 v193, v192
    s_nop 1
    v_permlane16_swap_b32 v192, v193
    v_max_f32 v192, v192, v193
    v_mov_b32 v193, v192
    s_nop 1
    v_permlane32_swap_b32 v192, v193
    v_max_f32 v192, v192, v193
    v_ceil_f32 v192, v192
    v_max_f32 v192, v192, v252
    v_sub_f32 v194, v252, v192
    v_exp_f32 v194, v194
    v_mov_b32 v252, v192

    v_sub_f32 v144, v144, v192
    v_sub_f32 v145, v145, v192
    v_sub_f32 v146, v146, v192
    v_sub_f32 v147, v147, v192
    v_sub_f32 v148, v148, v192
    v_sub_f32 v149, v149, v192
    v_sub_f32 v150, v150, v192
    v_sub_f32 v151, v151, v192
    v_sub_f32 v176, v176, v192
    v_sub_f32 v177, v177, v192
    v_sub_f32 v178, v178, v192
    v_sub_f32 v179, v179, v192
    v_sub_f32 v180, v180, v192
    v_sub_f32 v181, v181, v192
    v_sub_f32 v182, v182, v192
    v_sub_f32 v183, v183, v192
    v_exp_f32 v144, v144
    v_exp_f32 v145, v145
    v_exp_f32 v146, v146
    v_exp_f32 v147, v147
    v_exp_f32 v148, v148
    v_exp_f32 v149, v149
    v_exp_f32 v150, v150
    v_exp_f32 v151, v151
    v_exp_f32 v176, v176
    v_exp_f32 v177, v177
    v_exp_f32 v178, v178
    v_exp_f32 v179, v179
    v_exp_f32 v180, v180
    v_exp_f32 v181, v181
    v_exp_f32 v182, v182
    v_exp_f32 v183, v183
    v_mul_f32 v8, v8, v194
    v_mul_f32 v9, v9, v194
    v_mul_f32 v10, v10, v194
    v_mul_f32 v11, v11, v194
    v_mul_f32 v24, v24, v194
    v_mul_f32 v25, v25, v194
    v_mul_f32 v26, v26, v194
    v_mul_f32 v27, v27, v194
    v_mul_f32 v40, v40, v194
    v_mul_f32 v41, v41, v194
    v_mul_f32 v42, v42, v194
    v_mul_f32 v43, v43, v194
    v_mul_f32 v56, v56, v194
    v_mul_f32 v57, v57, v194
    v_mul_f32 v58, v58, v194
    v_mul_f32 v59, v59, v194
    v_mul_f32 v72, v72, v194
    v_mul_f32 v73, v73, v194
    v_mul_f32 v74, v74, v194
    v_mul_f32 v75, v75, v194
    v_mul_f32 v88, v88, v194
    v_mul_f32 v89, v89, v194
    v_mul_f32 v90, v90, v194
    v_mul_f32 v91, v91, v194
    v_mul_f32 v104, v104, v194
    v_mul_f32 v105, v105, v194
    v_mul_f32 v106, v106, v194
    v_mul_f32 v107, v107, v194
    v_mul_f32 v120, v120, v194
    v_mul_f32 v121, v121, v194
    v_mul_f32 v122, v122, v194
    v_mul_f32 v123, v123, v194
    v_cvt_pk_bf16_f32 v144, v144, v145
    v_cvt_pk_bf16_f32 v145, v146, v147
    v_cvt_pk_bf16_f32 v146, v148, v149
    v_cvt_pk_bf16_f32 v147, v150, v151
    v_cvt_pk_bf16_f32 v176, v176, v177
    v_cvt_pk_bf16_f32 v177, v178, v179
    v_cvt_pk_bf16_f32 v178, v180, v181
    v_cvt_pk_bf16_f32 v179, v182, v183
    v_max_f32 v192, v152, v153
    v_max3_f32 v192, v192, v154, v155
    v_max3_f32 v192, v192, v156, v157
    v_max3_f32 v192, v192, v158, v159
    v_max3_f32 v192, v192, v184, v185
    v_max3_f32 v192, v192, v186, v187
    v_max3_f32 v192, v192, v188, v189
    v_max3_f32 v192, v192, v190, v191
    v_mov_b32 v193, v192
    s_nop 1
    v_permlane16_swap_b32 v192, v193
    v_max_f32 v192, v192, v193
    v_mov_b32 v193, v192
    s_nop 1
    v_permlane32_swap_b32 v192, v193
    v_max_f32 v192, v192, v193
    v_ceil_f32 v192, v192
    v_max_f32 v192, v192, v253
    v_sub_f32 v194, v253, v192
    v_exp_f32 v194, v194
    v_mov_b32 v253, v192

    v_sub_f32 v152, v152, v192
    v_sub_f32 v153, v153, v192
    v_sub_f32 v154, v154, v192
    v_sub_f32 v155, v155, v192
    v_sub_f32 v156, v156, v192
    v_sub_f32 v157, v157, v192
    v_sub_f32 v158, v158, v192
    v_sub_f32 v159, v159, v192
    v_sub_f32 v184, v184, v192
    v_sub_f32 v185, v185, v192
    v_sub_f32 v186, v186, v192
    v_sub_f32 v187, v187, v192
    v_sub_f32 v188, v188, v192
    v_sub_f32 v189, v189, v192
    v_sub_f32 v190, v190, v192
    v_sub_f32 v191, v191, v192
    v_exp_f32 v152, v152
    v_exp_f32 v153, v153
    v_exp_f32 v154, v154
    v_exp_f32 v155, v155
    v_exp_f32 v156, v156
    v_exp_f32 v157, v157
    v_exp_f32 v158, v158
    v_exp_f32 v159, v159
    v_exp_f32 v184, v184
    v_exp_f32 v185, v185
    v_exp_f32 v186, v186
    v_exp_f32 v187, v187
    v_exp_f32 v188, v188
    v_exp_f32 v189, v189
    v_exp_f32 v190, v190
    v_exp_f32 v191, v191
    v_mul_f32 v12, v12, v194
    v_mul_f32 v13, v13, v194
    v_mul_f32 v14, v14, v194
    v_mul_f32 v15, v15, v194
    v_mul_f32 v28, v28, v194
    v_mul_f32 v29, v29, v194
    v_mul_f32 v30, v30, v194
    v_mul_f32 v31, v31, v194
    v_mul_f32 v44, v44, v194
    v_mul_f32 v45, v45, v194
    v_mul_f32 v46, v46, v194
    v_mul_f32 v47, v47, v194
    v_mul_f32 v60, v60, v194
    v_mul_f32 v61, v61, v194
    v_mul_f32 v62, v62, v194
    v_mul_f32 v63, v63, v194
    v_mul_f32 v76, v76, v194
    v_mul_f32 v77, v77, v194
    v_mul_f32 v78, v78, v194
    v_mul_f32 v79, v79, v194
    v_mul_f32 v92, v92, v194
    v_mul_f32 v93, v93, v194
    v_mul_f32 v94, v94, v194
    v_mul_f32 v95, v95, v194
    v_mul_f32 v108, v108, v194
    v_mul_f32 v109, v109, v194
    v_mul_f32 v110, v110, v194
    v_mul_f32 v111, v111, v194
    v_mul_f32 v124, v124, v194
    v_mul_f32 v125, v125, v194
    v_mul_f32 v126, v126, v194
    v_mul_f32 v127, v127, v194
    v_cvt_pk_bf16_f32 v152, v152, v153
    v_cvt_pk_bf16_f32 v153, v154, v155
    v_cvt_pk_bf16_f32 v154, v156, v157
    v_cvt_pk_bf16_f32 v155, v158, v159
    v_cvt_pk_bf16_f32 v184, v184, v185
    v_cvt_pk_bf16_f32 v185, v186, v187
    v_cvt_pk_bf16_f32 v186, v188, v189
    v_cvt_pk_bf16_f32 v187, v190, v191
    ds_read_b64_tr_b16 a[96:97], v212 offset:0
    ds_read_b64_tr_b16 a[98:99], v212 offset:4096
    ds_read_b64_tr_b16 a[100:101], v212 offset:8192
    ds_read_b64_tr_b16 a[102:103], v212 offset:12288
    s_waitcnt lgkmcnt(0)
    v_mfma_f32_16x16x32_bf16 v[0:3], a[96:99], v[128:131], v[0:3]
    v_mfma_f32_16x16x32_bf16 v[0:3], a[100:103], v[160:163], v[0:3]
    v_mfma_f32_16x16x32_bf16 v[4:7], a[96:99], v[136:139], v[4:7]
    v_mfma_f32_16x16x32_bf16 v[4:7], a[100:103], v[168:171], v[4:7]
    v_mfma_f32_16x16x32_bf16 v[8:11], a[96:99], v[144:147], v[8:11]
    v_mfma_f32_16x16x32_bf16 v[8:11], a[100:103], v[176:179], v[8:11]
    v_mfma_f32_16x16x32_bf16 v[12:15], a[96:99], v[152:155], v[12:15]
    v_mfma_f32_16x16x32_bf16 v[12:15], a[100:103], v[184:187], v[12:15]
    ds_read_b64_tr_b16 a[96:97], v213 offset:0
    ds_read_b64_tr_b16 a[98:99], v213 offset:4096
    ds_read_b64_tr_b16 a[100:101], v213 offset:8192
    ds_read_b64_tr_b16 a[102:103], v213 offset:12288
    s_waitcnt lgkmcnt(0)
    v_mfma_f32_16x16x32_bf16 v[16:19], a[96:99], v[128:131], v[16:19]
    v_mfma_f32_16x16x32_bf16 v[16:19], a[100:103], v[160:163], v[16:19]
    v_mfma_f32_16x16x32_bf16 v[20:23], a[96:99], v[136:139], v[20:23]
    v_mfma_f32_16x16x32_bf16 v[20:23], a[100:103], v[168:171], v[20:23]
    v_mfma_f32_16x16x32_bf16 v[24:27], a[96:99], v[144:147], v[24:27]
    v_mfma_f32_16x16x32_bf16 v[24:27], a[100:103], v[176:179], v[24:27]
    v_mfma_f32_16x16x32_bf16 v[28:31], a[96:99], v[152:155], v[28:31]
    v_mfma_f32_16x16x32_bf16 v[28:31], a[100:103], v[184:187], v[28:31]
    ds_read_b64_tr_b16 a[96:97], v214 offset:0
    ds_read_b64_tr_b16 a[98:99], v214 offset:4096
    ds_read_b64_tr_b16 a[100:101], v214 offset:8192
    ds_read_b64_tr_b16 a[102:103], v214 offset:12288
    s_waitcnt lgkmcnt(0)
    v_mfma_f32_16x16x32_bf16 v[32:35], a[96:99], v[128:131], v[32:35]
    v_mfma_f32_16x16x32_bf16 v[32:35], a[100:103], v[160:163], v[32:35]
    v_mfma_f32_16x16x32_bf16 v[36:39], a[96:99], v[136:139], v[36:39]
    v_mfma_f32_16x16x32_bf16 v[36:39], a[100:103], v[168:171], v[36:39]
    v_mfma_f32_16x16x32_bf16 v[40:43], a[96:99], v[144:147], v[40:43]
    v_mfma_f32_16x16x32_bf16 v[40:43], a[100:103], v[176:179], v[40:43]
    v_mfma_f32_16x16x32_bf16 v[44:47], a[96:99], v[152:155], v[44:47]
    v_mfma_f32_16x16x32_bf16 v[44:47], a[100:103], v[184:187], v[44:47]
    ds_read_b64_tr_b16 a[96:97], v215 offset:0
    ds_read_b64_tr_b16 a[98:99], v215 offset:4096
    ds_read_b64_tr_b16 a[100:101], v215 offset:8192
    ds_read_b64_tr_b16 a[102:103], v215 offset:12288
    s_waitcnt lgkmcnt(0)
    v_mfma_f32_16x16x32_bf16 v[48:51], a[96:99], v[128:131], v[48:51]
    v_mfma_f32_16x16x32_bf16 v[48:51], a[100:103], v[160:163], v[48:51]
    v_mfma_f32_16x16x32_bf16 v[52:55], a[96:99], v[136:139], v[52:55]
    v_mfma_f32_16x16x32_bf16 v[52:55], a[100:103], v[168:171], v[52:55]
    v_mfma_f32_16x16x32_bf16 v[56:59], a[96:99], v[144:147], v[56:59]
    v_mfma_f32_16x16x32_bf16 v[56:59], a[100:103], v[176:179], v[56:59]
    v_mfma_f32_16x16x32_bf16 v[60:63], a[96:99], v[152:155], v[60:63]
    v_mfma_f32_16x16x32_bf16 v[60:63], a[100:103], v[184:187], v[60:63]
    ds_read_b64_tr_b16 a[96:97], v216 offset:0
    ds_read_b64_tr_b16 a[98:99], v216 offset:4096
    ds_read_b64_tr_b16 a[100:101], v216 offset:8192
    ds_read_b64_tr_b16 a[102:103], v216 offset:12288
    s_waitcnt lgkmcnt(0)
    v_mfma_f32_16x16x32_bf16 v[64:67], a[96:99], v[128:131], v[64:67]
    v_mfma_f32_16x16x32_bf16 v[64:67], a[100:103], v[160:163], v[64:67]
    v_mfma_f32_16x16x32_bf16 v[68:71], a[96:99], v[136:139], v[68:71]
    v_mfma_f32_16x16x32_bf16 v[68:71], a[100:103], v[168:171], v[68:71]
    v_mfma_f32_16x16x32_bf16 v[72:75], a[96:99], v[144:147], v[72:75]
    v_mfma_f32_16x16x32_bf16 v[72:75], a[100:103], v[176:179], v[72:75]
    v_mfma_f32_16x16x32_bf16 v[76:79], a[96:99], v[152:155], v[76:79]
    v_mfma_f32_16x16x32_bf16 v[76:79], a[100:103], v[184:187], v[76:79]
    ds_read_b64_tr_b16 a[96:97], v217 offset:0
    ds_read_b64_tr_b16 a[98:99], v217 offset:4096
    ds_read_b64_tr_b16 a[100:101], v217 offset:8192
    ds_read_b64_tr_b16 a[102:103], v217 offset:12288
    s_waitcnt lgkmcnt(0)
    v_mfma_f32_16x16x32_bf16 v[80:83], a[96:99], v[128:131], v[80:83]
    v_mfma_f32_16x16x32_bf16 v[80:83], a[100:103], v[160:163], v[80:83]
    v_mfma_f32_16x16x32_bf16 v[84:87], a[96:99], v[136:139], v[84:87]
    v_mfma_f32_16x16x32_bf16 v[84:87], a[100:103], v[168:171], v[84:87]
    v_mfma_f32_16x16x32_bf16 v[88:91], a[96:99], v[144:147], v[88:91]
    v_mfma_f32_16x16x32_bf16 v[88:91], a[100:103], v[176:179], v[88:91]
    v_mfma_f32_16x16x32_bf16 v[92:95], a[96:99], v[152:155], v[92:95]
    v_mfma_f32_16x16x32_bf16 v[92:95], a[100:103], v[184:187], v[92:95]
    ds_read_b64_tr_b16 a[96:97], v218 offset:0
    ds_read_b64_tr_b16 a[98:99], v218 offset:4096
    ds_read_b64_tr_b16 a[100:101], v218 offset:8192
    ds_read_b64_tr_b16 a[102:103], v218 offset:12288
    s_waitcnt lgkmcnt(0)
    v_mfma_f32_16x16x32_bf16 v[96:99], a[96:99], v[128:131], v[96:99]
    v_mfma_f32_16x16x32_bf16 v[96:99], a[100:103], v[160:163], v[96:99]
    v_mfma_f32_16x16x32_bf16 v[100:103], a[96:99], v[136:139], v[100:103]
    v_mfma_f32_16x16x32_bf16 v[100:103], a[100:103], v[168:171], v[100:103]
    v_mfma_f32_16x16x32_bf16 v[104:107], a[96:99], v[144:147], v[104:107]
    v_mfma_f32_16x16x32_bf16 v[104:107], a[100:103], v[176:179], v[104:107]
    v_mfma_f32_16x16x32_bf16 v[108:111], a[96:99], v[152:155], v[108:111]
    v_mfma_f32_16x16x32_bf16 v[108:111], a[100:103], v[184:187], v[108:111]
    ds_read_b64_tr_b16 a[96:97], v219 offset:0
    ds_read_b64_tr_b16 a[98:99], v219 offset:4096
    ds_read_b64_tr_b16 a[100:101], v219 offset:8192
    ds_read_b64_tr_b16 a[102:103], v219 offset:12288
    s_waitcnt lgkmcnt(0)
    v_mfma_f32_16x16x32_bf16 v[112:115], a[96:99], v[128:131], v[112:115]
    v_mfma_f32_16x16x32_bf16 v[112:115], a[100:103], v[160:163], v[112:115]
    v_mfma_f32_16x16x32_bf16 v[116:119], a[96:99], v[136:139], v[116:119]
    v_mfma_f32_16x16x32_bf16 v[116:119], a[100:103], v[168:171], v[116:119]
    v_mfma_f32_16x16x32_bf16 v[120:123], a[96:99], v[144:147], v[120:123]
    v_mfma_f32_16x16x32_bf16 v[120:123], a[100:103], v[176:179], v[120:123]
    v_mfma_f32_16x16x32_bf16 v[124:127], a[96:99], v[152:155], v[124:127]
    v_mfma_f32_16x16x32_bf16 v[124:127], a[100:103], v[184:187], v[124:127]
    s_nop 7
    s_sub_u32 s32, s32, 1
    s_cmp_lg_u32 s32, 0
    s_cbranch_scc1 L2_sloop
    s_branch L2_store
L_helper:
    s_bfm_b32 s34, s2, 0
    s_and_b32 s34, s34, 28927
    s_bcnt1_i32_b32 s34, s34
    v_lshrrev_b32 v1, 6, v0
    v_mov_b32 v30, v0
    v_and_b32 v0, 63, v0
    v_readfirstlane_b32 s3, v1
    v_mov_b32 v8, 0
    s_waitcnt lgkmcnt(0)

    s_add_u32 s96, s100, 0
    s_addc_u32 s97, s101, 0
    s_mov_b32 s98, 256
    s_mov_b32 s99, 0x20000
    s_add_u32 s20, s4, 9437184
    s_addc_u32 s21, s5, 0
    s_mov_b32 s22, 16384
    s_mov_b32 s23, 0x20000
    s_cmp_lg_u32 s2, 0
    s_cbranch_scc1 L_hbin
    v_lshrrev_b32 v9, 2, v30
    v_lshlrev_b32 v9, 8, v9
    v_and_b32 v10, 3, v30
    v_lshl_add_u32 v9, v10, 4, v9
    v_mov_b32 v12, 0
    v_mov_b32 v13, 0
    v_mov_b32 v14, 0
    v_mov_b32 v15, 0
    buffer_store_dwordx4 v[12:15], v9, s[20:23], 0 offen sc1
    s_waitcnt vmcnt(0)
    s_barrier
    s_cmp_lg_u32 s3, 0
    s_cbranch_scc1 L_hbin
    v_mov_b32 v9, 1
    s_mov_b64 exec, 1
    buffer_store_dword v9, v8, s[96:99], 0 offen sc1
    s_mov_b64 exec, -1

L_hbin:
    s_load_dwordx4 s[24:27], s[0:1], 8
    s_mul_i32 s36, s34, 147456
    v_lshlrev_b32 v1, 4, v30
    v_mov_b32 v200, v30
    v_mov_b32 v4, 0
    v_mov_b32 v5, 0
    v_mov_b32 v6, 0
    v_mov_b32 v7, 0
    v_mov_b32 v8, 0x7ffffff0
    v_mov_b32 v9, 0x7ffffff0
    v_mov_b32 v10, 0x7ffffff0
    v_mov_b32 v11, 0x7ffffff0
    s_waitcnt lgkmcnt(0)

    s_add_u32 s8, s24, 0
    s_addc_u32 s9, s25, 0
    s_mov_b32 s10, 1600000
    s_mov_b32 s11, 0x20000
    s_add_u32 s12, s26, 0
    s_addc_u32 s13, s27, 0
    s_mov_b32 s14, 1600000
    s_mov_b32 s15, 0x20000
    s_add_u32 s16, s4, 9699328
    s_addc_u32 s17, s5, 0
    s_mov_b32 s18, 50176
    s_mov_b32 s19, 0x20000
    s_add_u32 s28, s4, 10485760
    s_addc_u32 s29, s5, 0
    s_mov_b32 s30, 1757184
    s_mov_b32 s31, 0x20000
    s_mov_b32 s37, s36
    buffer_load_dwordx4 v[16:19], v1, s[12:15], s37 offen
    s_add_u32 s37, s37, 4096
    buffer_load_dwordx4 v[20:23], v1, s[12:15], s37 offen
    s_add_u32 s37, s37, 4096
    buffer_load_dwordx4 v[24:27], v1, s[12:15], s37 offen
    s_add_u32 s37, s37, 4096
    buffer_load_dwordx4 v[28:31], v1, s[12:15], s37 offen
    s_add_u32 s37, s37, 4096
    buffer_load_dwordx4 v[32:35], v1, s[12:15], s37 offen
    s_add_u32 s37, s37, 4096
    buffer_load_dwordx4 v[36:39], v1, s[12:15], s37 offen
    s_add_u32 s37, s37, 4096
    buffer_load_dwordx4 v[40:43], v1, s[12:15], s37 offen
    s_add_u32 s37, s37, 4096
    buffer_load_dwordx4 v[44:47], v1, s[12:15], s37 offen
    s_add_u32 s37, s37, 4096
    buffer_load_dwordx4 v[48:51], v1, s[12:15], s37 offen
    s_add_u32 s37, s37, 4096
    buffer_load_dwordx4 v[52:55], v1, s[12:15], s37 offen
    s_add_u32 s37, s37, 4096
    buffer_load_dwordx4 v[56:59], v1, s[12:15], s37 offen
    s_add_u32 s37, s37, 4096
    buffer_load_dwordx4 v[60:63], v1, s[12:15], s37 offen
    s_add_u32 s37, s37, 4096
    buffer_load_dwordx4 v[64:67], v1, s[12:15], s37 offen
    s_add_u32 s37, s37, 4096
    buffer_load_dwordx4 v[68:71], v1, s[12:15], s37 offen
    s_add_u32 s37, s37, 4096
    buffer_load_dwordx4 v[72:75], v1, s[12:15], s37 offen
    s_add_u32 s37, s37, 4096
    buffer_load_dwordx4 v[76:79], v1, s[12:15], s37 offen
    s_add_u32 s37, s37, 4096
    buffer_load_dwordx4 v[80:83], v1, s[12:15], s37 offen
    s_add_u32 s37, s37, 4096
    buffer_load_dwordx4 v[84:87], v1, s[12:15], s37 offen
    s_add_u32 s37, s37, 4096
    buffer_load_dwordx4 v[88:91], v1, s[12:15], s37 offen
    s_add_u32 s37, s37, 4096
    buffer_load_dwordx4 v[92:95], v1, s[12:15], s37 offen
    s_add_u32 s37, s37, 4096
    buffer_load_dwordx4 v[96:99], v1, s[12:15], s37 offen
    s_add_u32 s37, s37, 4096
    buffer_load_dwordx4 v[100:103], v1, s[12:15], s37 offen
    s_add_u32 s37, s37, 4096
    buffer_load_dwordx4 v[104:107], v1, s[12:15], s37 offen
    s_add_u32 s37, s37, 4096
    buffer_load_dwordx4 v[108:111], v1, s[12:15], s37 offen
    s_add_u32 s37, s37, 4096
    buffer_load_dwordx4 v[112:115], v1, s[12:15], s37 offen
    s_add_u32 s37, s37, 4096
    buffer_load_dwordx4 v[116:119], v1, s[12:15], s37 offen
    s_add_u32 s37, s37, 4096
    buffer_load_dwordx4 v[120:123], v1, s[12:15], s37 offen
    s_add_u32 s37, s37, 4096
    buffer_load_dwordx4 v[124:127], v1, s[12:15], s37 offen
    s_add_u32 s37, s37, 4096
    buffer_load_dwordx4 v[128:131], v1, s[12:15], s37 offen
    s_add_u32 s37, s37, 4096
    buffer_load_dwordx4 v[132:135], v1, s[12:15], s37 offen
    s_add_u32 s37, s37, 4096
    buffer_load_dwordx4 v[136:139], v1, s[12:15], s37 offen
    s_add_u32 s37, s37, 4096
    buffer_load_dwordx4 v[140:143], v1, s[12:15], s37 offen
    s_add_u32 s37, s37, 4096
    buffer_load_dwordx4 v[144:147], v1, s[12:15], s37 offen
    s_add_u32 s37, s37, 4096
    buffer_load_dwordx4 v[148:151], v1, s[12:15], s37 offen
    s_add_u32 s37, s37, 4096
    buffer_load_dwordx4 v[152:155], v1, s[12:15], s37 offen
    s_add_u32 s37, s37, 4096
    buffer_load_dwordx4 v[156:159], v1, s[12:15], s37 offen
    s_add_u32 s37, s37, 4096
    s_barrier
    ds_write_b128 v1, v[4:7]
    v_add_u32 v2, 65536, v1
    v_add_u32 v3, 131072, v1
    ds_write_b128 v1, v[8:11] offset:4096
    ds_write_b128 v1, v[8:11] offset:8192
    ds_write_b128 v1, v[8:11] offset:12288
    ds_write_b128 v1, v[8:11] offset:16384
    ds_write_b128 v1, v[8:11] offset:20480
    ds_write_b128 v1, v[8:11] offset:24576
    ds_write_b128 v1, v[8:11] offset:28672
    ds_write_b128 v1, v[8:11] offset:32768
    ds_write_b128 v1, v[8:11] offset:36864
    ds_write_b128 v1, v[8:11] offset:40960
    ds_write_b128 v1, v[8:11] offset:45056
    ds_write_b128 v1, v[8:11] offset:49152
    ds_write_b128 v1, v[8:11] offset:53248
    ds_write_b128 v1, v[8:11] offset:57344
    ds_write_b128 v1, v[8:11] offset:61440
    ds_write_b128 v2, v[8:11] offset:0
    ds_write_b128 v2, v[8:11] offset:4096
    ds_write_b128 v2, v[8:11] offset:8192
    ds_write_b128 v2, v[8:11] offset:12288
    ds_write_b128 v2, v[8:11] offset:16384
    ds_write_b128 v2, v[8:11] offset:20480
    ds_write_b128 v2, v[8:11] offset:24576
    ds_write_b128 v2, v[8:11] offset:28672
    ds_write_b128 v2, v[8:11] offset:32768
    ds_write_b128 v2, v[8:11] offset:36864
    ds_write_b128 v2, v[8:11] offset:40960
    ds_write_b128 v2, v[8:11] offset:45056
    ds_write_b128 v2, v[8:11] offset:49152
    ds_write_b128 v2, v[8:11] offset:53248
    ds_write_b128 v2, v[8:11] offset:57344
    ds_write_b128 v2, v[8:11] offset:61440
    ds_write_b128 v3, v[8:11] offset:0
    ds_write_b128 v3, v[8:11] offset:4096
    ds_write_b128 v3, v[8:11] offset:8192
    ds_write_b128 v3, v[8:11] offset:12288
    ds_write_b128 v3, v[8:11] offset:16384
    ds_write_b128 v3, v[8:11] offset:20480
    ds_write_b128 v3, v[8:11] offset:24576
    ds_write_b128 v3, v[8:11] offset:28672
    v_add_u32 v12, s36, v1
    v_lshlrev_b32 v13, 4, v0
    v_add_u32 v13, 12800, v13
    v_mov_b32 v14, 1
    s_waitcnt lgkmcnt(0)
    s_barrier
    s_mov_b32 s37, s36
    s_waitcnt vmcnt(35)
    buffer_load_dwordx4 a[0:3], v1, s[8:11], s37 offen
    s_add_u32 s37, s37, 4096
    v_cmp_gt_u32 vcc, 1600000, v12
    s_nop 1
    v_cndmask_b32 v16, v13, v16, vcc
    v_lshrrev_b32 v160, 4, v16
    v_lshlrev_b32 v160, 2, v160
    ds_add_u32 v160, v14
    v_cndmask_b32 v17, v13, v17, vcc
    v_lshrrev_b32 v161, 4, v17
    v_lshlrev_b32 v161, 2, v161
    ds_add_u32 v161, v14
    v_cndmask_b32 v18, v13, v18, vcc
    v_lshrrev_b32 v162, 4, v18
    v_lshlrev_b32 v162, 2, v162
    ds_add_u32 v162, v14
    v_cndmask_b32 v19, v13, v19, vcc
    v_lshrrev_b32 v163, 4, v19
    v_lshlrev_b32 v163, 2, v163
    ds_add_u32 v163, v14
    s_waitcnt vmcnt(35)
    buffer_load_dwordx4 a[4:7], v1, s[8:11], s37 offen
    s_add_u32 s37, s37, 4096
    v_cmp_gt_u32 vcc, 1595904, v12
    s_nop 1
    v_cndmask_b32 v20, v13, v20, vcc
    v_lshrrev_b32 v160, 4, v20
    v_lshlrev_b32 v160, 2, v160
    ds_add_u32 v160, v14
    v_cndmask_b32 v21, v13, v21, vcc
    v_lshrrev_b32 v161, 4, v21
    v_lshlrev_b32 v161, 2, v161
    ds_add_u32 v161, v14
    v_cndmask_b32 v22, v13, v22, vcc
    v_lshrrev_b32 v162, 4, v22
    v_lshlrev_b32 v162, 2, v162
    ds_add_u32 v162, v14
    v_cndmask_b32 v23, v13, v23, vcc
    v_lshrrev_b32 v163, 4, v23
    v_lshlrev_b32 v163, 2, v163
    ds_add_u32 v163, v14
    s_waitcnt vmcnt(35)
    buffer_load_dwordx4 a[8:11], v1, s[8:11], s37 offen
    s_add_u32 s37, s37, 4096
    v_cmp_gt_u32 vcc, 1591808, v12
    s_nop 1
    v_cndmask_b32 v24, v13, v24, vcc
    v_lshrrev_b32 v160, 4, v24
    v_lshlrev_b32 v160, 2, v160
    ds_add_u32 v160, v14
    v_cndmask_b32 v25, v13, v25, vcc
    v_lshrrev_b32 v161, 4, v25
    v_lshlrev_b32 v161, 2, v161
    ds_add_u32 v161, v14
    v_cndmask_b32 v26, v13, v26, vcc
    v_lshrrev_b32 v162, 4, v26
    v_lshlrev_b32 v162, 2, v162
    ds_add_u32 v162, v14
    v_cndmask_b32 v27, v13, v27, vcc
    v_lshrrev_b32 v163, 4, v27
    v_lshlrev_b32 v163, 2, v163
    ds_add_u32 v163, v14
    s_waitcnt vmcnt(35)
    buffer_load_dwordx4 a[12:15], v1, s[8:11], s37 offen
    s_add_u32 s37, s37, 4096
    v_cmp_gt_u32 vcc, 1587712, v12
    s_nop 1
    v_cndmask_b32 v28, v13, v28, vcc
    v_lshrrev_b32 v160, 4, v28
    v_lshlrev_b32 v160, 2, v160
    ds_add_u32 v160, v14
    v_cndmask_b32 v29, v13, v29, vcc
    v_lshrrev_b32 v161, 4, v29
    v_lshlrev_b32 v161, 2, v161
    ds_add_u32 v161, v14
    v_cndmask_b32 v30, v13, v30, vcc
    v_lshrrev_b32 v162, 4, v30
    v_lshlrev_b32 v162, 2, v162
    ds_add_u32 v162, v14
    v_cndmask_b32 v31, v13, v31, vcc
    v_lshrrev_b32 v163, 4, v31
    v_lshlrev_b32 v163, 2, v163
    ds_add_u32 v163, v14
    s_waitcnt vmcnt(35)
    buffer_load_dwordx4 a[16:19], v1, s[8:11], s37 offen
    s_add_u32 s37, s37, 4096
    v_cmp_gt_u32 vcc, 1583616, v12
    s_nop 1
    v_cndmask_b32 v32, v13, v32, vcc
    v_lshrrev_b32 v160, 4, v32
    v_lshlrev_b32 v160, 2, v160
    ds_add_u32 v160, v14
    v_cndmask_b32 v33, v13, v33, vcc
    v_lshrrev_b32 v161, 4, v33
    v_lshlrev_b32 v161, 2, v161
    ds_add_u32 v161, v14
    v_cndmask_b32 v34, v13, v34, vcc
    v_lshrrev_b32 v162, 4, v34
    v_lshlrev_b32 v162, 2, v162
    ds_add_u32 v162, v14
    v_cndmask_b32 v35, v13, v35, vcc
    v_lshrrev_b32 v163, 4, v35
    v_lshlrev_b32 v163, 2, v163
    ds_add_u32 v163, v14
    s_waitcnt vmcnt(35)
    buffer_load_dwordx4 a[20:23], v1, s[8:11], s37 offen
    s_add_u32 s37, s37, 4096
    v_cmp_gt_u32 vcc, 1579520, v12
    s_nop 1
    v_cndmask_b32 v36, v13, v36, vcc
    v_lshrrev_b32 v160, 4, v36
    v_lshlrev_b32 v160, 2, v160
    ds_add_u32 v160, v14
    v_cndmask_b32 v37, v13, v37, vcc
    v_lshrrev_b32 v161, 4, v37
    v_lshlrev_b32 v161, 2, v161
    ds_add_u32 v161, v14
    v_cndmask_b32 v38, v13, v38, vcc
    v_lshrrev_b32 v162, 4, v38
    v_lshlrev_b32 v162, 2, v162
    ds_add_u32 v162, v14
    v_cndmask_b32 v39, v13, v39, vcc
    v_lshrrev_b32 v163, 4, v39
    v_lshlrev_b32 v163, 2, v163
    ds_add_u32 v163, v14
    s_waitcnt vmcnt(35)
    buffer_load_dwordx4 a[24:27], v1, s[8:11], s37 offen
    s_add_u32 s37, s37, 4096
    v_cmp_gt_u32 vcc, 1575424, v12
    s_nop 1
    v_cndmask_b32 v40, v13, v40, vcc
    v_lshrrev_b32 v160, 4, v40
    v_lshlrev_b32 v160, 2, v160
    ds_add_u32 v160, v14
    v_cndmask_b32 v41, v13, v41, vcc
    v_lshrrev_b32 v161, 4, v41
    v_lshlrev_b32 v161, 2, v161
    ds_add_u32 v161, v14
    v_cndmask_b32 v42, v13, v42, vcc
    v_lshrrev_b32 v162, 4, v42
    v_lshlrev_b32 v162, 2, v162
    ds_add_u32 v162, v14
    v_cndmask_b32 v43, v13, v43, vcc
    v_lshrrev_b32 v163, 4, v43
    v_lshlrev_b32 v163, 2, v163
    ds_add_u32 v163, v14
    s_waitcnt vmcnt(35)
    buffer_load_dwordx4 a[28:31], v1, s[8:11], s37 offen
    s_add_u32 s37, s37, 4096
    v_cmp_gt_u32 vcc, 1571328, v12
    s_nop 1
    v_cndmask_b32 v44, v13, v44, vcc
    v_lshrrev_b32 v160, 4, v44
    v_lshlrev_b32 v160, 2, v160
    ds_add_u32 v160, v14
    v_cndmask_b32 v45, v13, v45, vcc
    v_lshrrev_b32 v161, 4, v45
    v_lshlrev_b32 v161, 2, v161
    ds_add_u32 v161, v14
    v_cndmask_b32 v46, v13, v46, vcc
    v_lshrrev_b32 v162, 4, v46
    v_lshlrev_b32 v162, 2, v162
    ds_add_u32 v162, v14
    v_cndmask_b32 v47, v13, v47, vcc
    v_lshrrev_b32 v163, 4, v47
    v_lshlrev_b32 v163, 2, v163
    ds_add_u32 v163, v14
    s_waitcnt vmcnt(35)
    buffer_load_dwordx4 a[32:35], v1, s[8:11], s37 offen
    s_add_u32 s37, s37, 4096
    v_cmp_gt_u32 vcc, 1567232, v12
    s_nop 1
    v_cndmask_b32 v48, v13, v48, vcc
    v_lshrrev_b32 v160, 4, v48
    v_lshlrev_b32 v160, 2, v160
    ds_add_u32 v160, v14
    v_cndmask_b32 v49, v13, v49, vcc
    v_lshrrev_b32 v161, 4, v49
    v_lshlrev_b32 v161, 2, v161
    ds_add_u32 v161, v14
    v_cndmask_b32 v50, v13, v50, vcc
    v_lshrrev_b32 v162, 4, v50
    v_lshlrev_b32 v162, 2, v162
    ds_add_u32 v162, v14
    v_cndmask_b32 v51, v13, v51, vcc
    v_lshrrev_b32 v163, 4, v51
    v_lshlrev_b32 v163, 2, v163
    ds_add_u32 v163, v14
    s_waitcnt vmcnt(35)
    buffer_load_dwordx4 a[36:39], v1, s[8:11], s37 offen
    s_add_u32 s37, s37, 4096
    v_cmp_gt_u32 vcc, 1563136, v12
    s_nop 1
    v_cndmask_b32 v52, v13, v52, vcc
    v_lshrrev_b32 v160, 4, v52
    v_lshlrev_b32 v160, 2, v160
    ds_add_u32 v160, v14
    v_cndmask_b32 v53, v13, v53, vcc
    v_lshrrev_b32 v161, 4, v53
    v_lshlrev_b32 v161, 2, v161
    ds_add_u32 v161, v14
    v_cndmask_b32 v54, v13, v54, vcc
    v_lshrrev_b32 v162, 4, v54
    v_lshlrev_b32 v162, 2, v162
    ds_add_u32 v162, v14
    v_cndmask_b32 v55, v13, v55, vcc
    v_lshrrev_b32 v163, 4, v55
    v_lshlrev_b32 v163, 2, v163
    ds_add_u32 v163, v14
    s_waitcnt vmcnt(35)
    buffer_load_dwordx4 a[40:43], v1, s[8:11], s37 offen
    s_add_u32 s37, s37, 4096
    v_cmp_gt_u32 vcc, 1559040, v12
    s_nop 1
    v_cndmask_b32 v56, v13, v56, vcc
    v_lshrrev_b32 v160, 4, v56
    v_lshlrev_b32 v160, 2, v160
    ds_add_u32 v160, v14
    v_cndmask_b32 v57, v13, v57, vcc
    v_lshrrev_b32 v161, 4, v57
    v_lshlrev_b32 v161, 2, v161
    ds_add_u32 v161, v14
    v_cndmask_b32 v58, v13, v58, vcc
    v_lshrrev_b32 v162, 4, v58
    v_lshlrev_b32 v162, 2, v162
    ds_add_u32 v162, v14
    v_cndmask_b32 v59, v13, v59, vcc
    v_lshrrev_b32 v163, 4, v59
    v_lshlrev_b32 v163, 2, v163
    ds_add_u32 v163, v14
    s_waitcnt vmcnt(35)
    buffer_load_dwordx4 a[44:47], v1, s[8:11], s37 offen
    s_add_u32 s37, s37, 4096
    v_cmp_gt_u32 vcc, 1554944, v12
    s_nop 1
    v_cndmask_b32 v60, v13, v60, vcc
    v_lshrrev_b32 v160, 4, v60
    v_lshlrev_b32 v160, 2, v160
    ds_add_u32 v160, v14
    v_cndmask_b32 v61, v13, v61, vcc
    v_lshrrev_b32 v161, 4, v61
    v_lshlrev_b32 v161, 2, v161
    ds_add_u32 v161, v14
    v_cndmask_b32 v62, v13, v62, vcc
    v_lshrrev_b32 v162, 4, v62
    v_lshlrev_b32 v162, 2, v162
    ds_add_u32 v162, v14
    v_cndmask_b32 v63, v13, v63, vcc
    v_lshrrev_b32 v163, 4, v63
    v_lshlrev_b32 v163, 2, v163
    ds_add_u32 v163, v14
    s_waitcnt vmcnt(35)
    buffer_load_dwordx4 a[48:51], v1, s[8:11], s37 offen
    s_add_u32 s37, s37, 4096
    v_cmp_gt_u32 vcc, 1550848, v12
    s_nop 1
    v_cndmask_b32 v64, v13, v64, vcc
    v_lshrrev_b32 v160, 4, v64
    v_lshlrev_b32 v160, 2, v160
    ds_add_u32 v160, v14
    v_cndmask_b32 v65, v13, v65, vcc
    v_lshrrev_b32 v161, 4, v65
    v_lshlrev_b32 v161, 2, v161
    ds_add_u32 v161, v14
    v_cndmask_b32 v66, v13, v66, vcc
    v_lshrrev_b32 v162, 4, v66
    v_lshlrev_b32 v162, 2, v162
    ds_add_u32 v162, v14
    v_cndmask_b32 v67, v13, v67, vcc
    v_lshrrev_b32 v163, 4, v67
    v_lshlrev_b32 v163, 2, v163
    ds_add_u32 v163, v14
    s_waitcnt vmcnt(35)
    buffer_load_dwordx4 a[52:55], v1, s[8:11], s37 offen
    s_add_u32 s37, s37, 4096
    v_cmp_gt_u32 vcc, 1546752, v12
    s_nop 1
    v_cndmask_b32 v68, v13, v68, vcc
    v_lshrrev_b32 v160, 4, v68
    v_lshlrev_b32 v160, 2, v160
    ds_add_u32 v160, v14
    v_cndmask_b32 v69, v13, v69, vcc
    v_lshrrev_b32 v161, 4, v69
    v_lshlrev_b32 v161, 2, v161
    ds_add_u32 v161, v14
    v_cndmask_b32 v70, v13, v70, vcc
    v_lshrrev_b32 v162, 4, v70
    v_lshlrev_b32 v162, 2, v162
    ds_add_u32 v162, v14
    v_cndmask_b32 v71, v13, v71, vcc
    v_lshrrev_b32 v163, 4, v71
    v_lshlrev_b32 v163, 2, v163
    ds_add_u32 v163, v14
    s_waitcnt vmcnt(35)
    buffer_load_dwordx4 a[56:59], v1, s[8:11], s37 offen
    s_add_u32 s37, s37, 4096
    v_cmp_gt_u32 vcc, 1542656, v12
    s_nop 1
    v_cndmask_b32 v72, v13, v72, vcc
    v_lshrrev_b32 v160, 4, v72
    v_lshlrev_b32 v160, 2, v160
    ds_add_u32 v160, v14
    v_cndmask_b32 v73, v13, v73, vcc
    v_lshrrev_b32 v161, 4, v73
    v_lshlrev_b32 v161, 2, v161
    ds_add_u32 v161, v14
    v_cndmask_b32 v74, v13, v74, vcc
    v_lshrrev_b32 v162, 4, v74
    v_lshlrev_b32 v162, 2, v162
    ds_add_u32 v162, v14
    v_cndmask_b32 v75, v13, v75, vcc
    v_lshrrev_b32 v163, 4, v75
    v_lshlrev_b32 v163, 2, v163
    ds_add_u32 v163, v14
    s_waitcnt vmcnt(35)
    buffer_load_dwordx4 a[60:63], v1, s[8:11], s37 offen
    s_add_u32 s37, s37, 4096
    v_cmp_gt_u32 vcc, 1538560, v12
    s_nop 1
    v_cndmask_b32 v76, v13, v76, vcc
    v_lshrrev_b32 v160, 4, v76
    v_lshlrev_b32 v160, 2, v160
    ds_add_u32 v160, v14
    v_cndmask_b32 v77, v13, v77, vcc
    v_lshrrev_b32 v161, 4, v77
    v_lshlrev_b32 v161, 2, v161
    ds_add_u32 v161, v14
    v_cndmask_b32 v78, v13, v78, vcc
    v_lshrrev_b32 v162, 4, v78
    v_lshlrev_b32 v162, 2, v162
    ds_add_u32 v162, v14
    v_cndmask_b32 v79, v13, v79, vcc
    v_lshrrev_b32 v163, 4, v79
    v_lshlrev_b32 v163, 2, v163
    ds_add_u32 v163, v14
    s_waitcnt vmcnt(35)
    buffer_load_dwordx4 a[64:67], v1, s[8:11], s37 offen
    s_add_u32 s37, s37, 4096
    v_cmp_gt_u32 vcc, 1534464, v12
    s_nop 1
    v_cndmask_b32 v80, v13, v80, vcc
    v_lshrrev_b32 v160, 4, v80
    v_lshlrev_b32 v160, 2, v160
    ds_add_u32 v160, v14
    v_cndmask_b32 v81, v13, v81, vcc
    v_lshrrev_b32 v161, 4, v81
    v_lshlrev_b32 v161, 2, v161
    ds_add_u32 v161, v14
    v_cndmask_b32 v82, v13, v82, vcc
    v_lshrrev_b32 v162, 4, v82
    v_lshlrev_b32 v162, 2, v162
    ds_add_u32 v162, v14
    v_cndmask_b32 v83, v13, v83, vcc
    v_lshrrev_b32 v163, 4, v83
    v_lshlrev_b32 v163, 2, v163
    ds_add_u32 v163, v14
    s_waitcnt vmcnt(35)
    buffer_load_dwordx4 a[68:71], v1, s[8:11], s37 offen
    s_add_u32 s37, s37, 4096
    v_cmp_gt_u32 vcc, 1530368, v12
    s_nop 1
    v_cndmask_b32 v84, v13, v84, vcc
    v_lshrrev_b32 v160, 4, v84
    v_lshlrev_b32 v160, 2, v160
    ds_add_u32 v160, v14
    v_cndmask_b32 v85, v13, v85, vcc
    v_lshrrev_b32 v161, 4, v85
    v_lshlrev_b32 v161, 2, v161
    ds_add_u32 v161, v14
    v_cndmask_b32 v86, v13, v86, vcc
    v_lshrrev_b32 v162, 4, v86
    v_lshlrev_b32 v162, 2, v162
    ds_add_u32 v162, v14
    v_cndmask_b32 v87, v13, v87, vcc
    v_lshrrev_b32 v163, 4, v87
    v_lshlrev_b32 v163, 2, v163
    ds_add_u32 v163, v14
    s_waitcnt vmcnt(35)
    buffer_load_dwordx4 a[72:75], v1, s[8:11], s37 offen
    s_add_u32 s37, s37, 4096
    v_cmp_gt_u32 vcc, 1526272, v12
    s_nop 1
    v_cndmask_b32 v88, v13, v88, vcc
    v_lshrrev_b32 v160, 4, v88
    v_lshlrev_b32 v160, 2, v160
    ds_add_u32 v160, v14
    v_cndmask_b32 v89, v13, v89, vcc
    v_lshrrev_b32 v161, 4, v89
    v_lshlrev_b32 v161, 2, v161
    ds_add_u32 v161, v14
    v_cndmask_b32 v90, v13, v90, vcc
    v_lshrrev_b32 v162, 4, v90
    v_lshlrev_b32 v162, 2, v162
    ds_add_u32 v162, v14
    v_cndmask_b32 v91, v13, v91, vcc
    v_lshrrev_b32 v163, 4, v91
    v_lshlrev_b32 v163, 2, v163
    ds_add_u32 v163, v14
    s_waitcnt vmcnt(35)
    buffer_load_dwordx4 a[76:79], v1, s[8:11], s37 offen
    s_add_u32 s37, s37, 4096
    v_cmp_gt_u32 vcc, 1522176, v12
    s_nop 1
    v_cndmask_b32 v92, v13, v92, vcc
    v_lshrrev_b32 v160, 4, v92
    v_lshlrev_b32 v160, 2, v160
    ds_add_u32 v160, v14
    v_cndmask_b32 v93, v13, v93, vcc
    v_lshrrev_b32 v161, 4, v93
    v_lshlrev_b32 v161, 2, v161
    ds_add_u32 v161, v14
    v_cndmask_b32 v94, v13, v94, vcc
    v_lshrrev_b32 v162, 4, v94
    v_lshlrev_b32 v162, 2, v162
    ds_add_u32 v162, v14
    v_cndmask_b32 v95, v13, v95, vcc
    v_lshrrev_b32 v163, 4, v95
    v_lshlrev_b32 v163, 2, v163
    ds_add_u32 v163, v14
    s_waitcnt vmcnt(35)
    buffer_load_dwordx4 a[80:83], v1, s[8:11], s37 offen
    s_add_u32 s37, s37, 4096
    v_cmp_gt_u32 vcc, 1518080, v12
    s_nop 1
    v_cndmask_b32 v96, v13, v96, vcc
    v_lshrrev_b32 v160, 4, v96
    v_lshlrev_b32 v160, 2, v160
    ds_add_u32 v160, v14
    v_cndmask_b32 v97, v13, v97, vcc
    v_lshrrev_b32 v161, 4, v97
    v_lshlrev_b32 v161, 2, v161
    ds_add_u32 v161, v14
    v_cndmask_b32 v98, v13, v98, vcc
    v_lshrrev_b32 v162, 4, v98
    v_lshlrev_b32 v162, 2, v162
    ds_add_u32 v162, v14
    v_cndmask_b32 v99, v13, v99, vcc
    v_lshrrev_b32 v163, 4, v99
    v_lshlrev_b32 v163, 2, v163
    ds_add_u32 v163, v14
    s_waitcnt vmcnt(35)
    buffer_load_dwordx4 a[84:87], v1, s[8:11], s37 offen
    s_add_u32 s37, s37, 4096
    v_cmp_gt_u32 vcc, 1513984, v12
    s_nop 1
    v_cndmask_b32 v100, v13, v100, vcc
    v_lshrrev_b32 v160, 4, v100
    v_lshlrev_b32 v160, 2, v160
    ds_add_u32 v160, v14
    v_cndmask_b32 v101, v13, v101, vcc
    v_lshrrev_b32 v161, 4, v101
    v_lshlrev_b32 v161, 2, v161
    ds_add_u32 v161, v14
    v_cndmask_b32 v102, v13, v102, vcc
    v_lshrrev_b32 v162, 4, v102
    v_lshlrev_b32 v162, 2, v162
    ds_add_u32 v162, v14
    v_cndmask_b32 v103, v13, v103, vcc
    v_lshrrev_b32 v163, 4, v103
    v_lshlrev_b32 v163, 2, v163
    ds_add_u32 v163, v14
    s_waitcnt vmcnt(35)
    buffer_load_dwordx4 a[88:91], v1, s[8:11], s37 offen
    s_add_u32 s37, s37, 4096
    v_cmp_gt_u32 vcc, 1509888, v12
    s_nop 1
    v_cndmask_b32 v104, v13, v104, vcc
    v_lshrrev_b32 v160, 4, v104
    v_lshlrev_b32 v160, 2, v160
    ds_add_u32 v160, v14
    v_cndmask_b32 v105, v13, v105, vcc
    v_lshrrev_b32 v161, 4, v105
    v_lshlrev_b32 v161, 2, v161
    ds_add_u32 v161, v14
    v_cndmask_b32 v106, v13, v106, vcc
    v_lshrrev_b32 v162, 4, v106
    v_lshlrev_b32 v162, 2, v162
    ds_add_u32 v162, v14
    v_cndmask_b32 v107, v13, v107, vcc
    v_lshrrev_b32 v163, 4, v107
    v_lshlrev_b32 v163, 2, v163
    ds_add_u32 v163, v14
    s_waitcnt vmcnt(35)
    buffer_load_dwordx4 a[92:95], v1, s[8:11], s37 offen
    s_add_u32 s37, s37, 4096
    v_cmp_gt_u32 vcc, 1505792, v12
    s_nop 1
    v_cndmask_b32 v108, v13, v108, vcc
    v_lshrrev_b32 v160, 4, v108
    v_lshlrev_b32 v160, 2, v160
    ds_add_u32 v160, v14
    v_cndmask_b32 v109, v13, v109, vcc
    v_lshrrev_b32 v161, 4, v109
    v_lshlrev_b32 v161, 2, v161
    ds_add_u32 v161, v14
    v_cndmask_b32 v110, v13, v110, vcc
    v_lshrrev_b32 v162, 4, v110
    v_lshlrev_b32 v162, 2, v162
    ds_add_u32 v162, v14
    v_cndmask_b32 v111, v13, v111, vcc
    v_lshrrev_b32 v163, 4, v111
    v_lshlrev_b32 v163, 2, v163
    ds_add_u32 v163, v14
    s_waitcnt vmcnt(35)
    buffer_load_dwordx4 a[96:99], v1, s[8:11], s37 offen
    s_add_u32 s37, s37, 4096
    v_cmp_gt_u32 vcc, 1501696, v12
    s_nop 1
    v_cndmask_b32 v112, v13, v112, vcc
    v_lshrrev_b32 v160, 4, v112
    v_lshlrev_b32 v160, 2, v160
    ds_add_u32 v160, v14
    v_cndmask_b32 v113, v13, v113, vcc
    v_lshrrev_b32 v161, 4, v113
    v_lshlrev_b32 v161, 2, v161
    ds_add_u32 v161, v14
    v_cndmask_b32 v114, v13, v114, vcc
    v_lshrrev_b32 v162, 4, v114
    v_lshlrev_b32 v162, 2, v162
    ds_add_u32 v162, v14
    v_cndmask_b32 v115, v13, v115, vcc
    v_lshrrev_b32 v163, 4, v115
    v_lshlrev_b32 v163, 2, v163
    ds_add_u32 v163, v14
    s_waitcnt vmcnt(35)
    buffer_load_dwordx4 a[100:103], v1, s[8:11], s37 offen
    s_add_u32 s37, s37, 4096
    v_cmp_gt_u32 vcc, 1497600, v12
    s_nop 1
    v_cndmask_b32 v116, v13, v116, vcc
    v_lshrrev_b32 v160, 4, v116
    v_lshlrev_b32 v160, 2, v160
    ds_add_u32 v160, v14
    v_cndmask_b32 v117, v13, v117, vcc
    v_lshrrev_b32 v161, 4, v117
    v_lshlrev_b32 v161, 2, v161
    ds_add_u32 v161, v14
    v_cndmask_b32 v118, v13, v118, vcc
    v_lshrrev_b32 v162, 4, v118
    v_lshlrev_b32 v162, 2, v162
    ds_add_u32 v162, v14
    v_cndmask_b32 v119, v13, v119, vcc
    v_lshrrev_b32 v163, 4, v119
    v_lshlrev_b32 v163, 2, v163
    ds_add_u32 v163, v14
    s_waitcnt vmcnt(35)
    buffer_load_dwordx4 a[104:107], v1, s[8:11], s37 offen
    s_add_u32 s37, s37, 4096
    v_cmp_gt_u32 vcc, 1493504, v12
    s_nop 1
    v_cndmask_b32 v120, v13, v120, vcc
    v_lshrrev_b32 v160, 4, v120
    v_lshlrev_b32 v160, 2, v160
    ds_add_u32 v160, v14
    v_cndmask_b32 v121, v13, v121, vcc
    v_lshrrev_b32 v161, 4, v121
    v_lshlrev_b32 v161, 2, v161
    ds_add_u32 v161, v14
    v_cndmask_b32 v122, v13, v122, vcc
    v_lshrrev_b32 v162, 4, v122
    v_lshlrev_b32 v162, 2, v162
    ds_add_u32 v162, v14
    v_cndmask_b32 v123, v13, v123, vcc
    v_lshrrev_b32 v163, 4, v123
    v_lshlrev_b32 v163, 2, v163
    ds_add_u32 v163, v14
    s_waitcnt vmcnt(35)
    buffer_load_dwordx4 a[108:111], v1, s[8:11], s37 offen
    s_add_u32 s37, s37, 4096
    v_cmp_gt_u32 vcc, 1489408, v12
    s_nop 1
    v_cndmask_b32 v124, v13, v124, vcc
    v_lshrrev_b32 v160, 4, v124
    v_lshlrev_b32 v160, 2, v160
    ds_add_u32 v160, v14
    v_cndmask_b32 v125, v13, v125, vcc
    v_lshrrev_b32 v161, 4, v125
    v_lshlrev_b32 v161, 2, v161
    ds_add_u32 v161, v14
    v_cndmask_b32 v126, v13, v126, vcc
    v_lshrrev_b32 v162, 4, v126
    v_lshlrev_b32 v162, 2, v162
    ds_add_u32 v162, v14
    v_cndmask_b32 v127, v13, v127, vcc
    v_lshrrev_b32 v163, 4, v127
    v_lshlrev_b32 v163, 2, v163
    ds_add_u32 v163, v14
    s_waitcnt vmcnt(35)
    buffer_load_dwordx4 a[112:115], v1, s[8:11], s37 offen
    s_add_u32 s37, s37, 4096
    v_cmp_gt_u32 vcc, 1485312, v12
    s_nop 1
    v_cndmask_b32 v128, v13, v128, vcc
    v_lshrrev_b32 v160, 4, v128
    v_lshlrev_b32 v160, 2, v160
    ds_add_u32 v160, v14
    v_cndmask_b32 v129, v13, v129, vcc
    v_lshrrev_b32 v161, 4, v129
    v_lshlrev_b32 v161, 2, v161
    ds_add_u32 v161, v14
    v_cndmask_b32 v130, v13, v130, vcc
    v_lshrrev_b32 v162, 4, v130
    v_lshlrev_b32 v162, 2, v162
    ds_add_u32 v162, v14
    v_cndmask_b32 v131, v13, v131, vcc
    v_lshrrev_b32 v163, 4, v131
    v_lshlrev_b32 v163, 2, v163
    ds_add_u32 v163, v14
    s_waitcnt vmcnt(35)
    buffer_load_dwordx4 a[116:119], v1, s[8:11], s37 offen
    s_add_u32 s37, s37, 4096
    v_cmp_gt_u32 vcc, 1481216, v12
    s_nop 1
    v_cndmask_b32 v132, v13, v132, vcc
    v_lshrrev_b32 v160, 4, v132
    v_lshlrev_b32 v160, 2, v160
    ds_add_u32 v160, v14
    v_cndmask_b32 v133, v13, v133, vcc
    v_lshrrev_b32 v161, 4, v133
    v_lshlrev_b32 v161, 2, v161
    ds_add_u32 v161, v14
    v_cndmask_b32 v134, v13, v134, vcc
    v_lshrrev_b32 v162, 4, v134
    v_lshlrev_b32 v162, 2, v162
    ds_add_u32 v162, v14
    v_cndmask_b32 v135, v13, v135, vcc
    v_lshrrev_b32 v163, 4, v135
    v_lshlrev_b32 v163, 2, v163
    ds_add_u32 v163, v14
    s_waitcnt vmcnt(35)
    buffer_load_dwordx4 a[120:123], v1, s[8:11], s37 offen
    s_add_u32 s37, s37, 4096
    v_cmp_gt_u32 vcc, 1477120, v12
    s_nop 1
    v_cndmask_b32 v136, v13, v136, vcc
    v_lshrrev_b32 v160, 4, v136
    v_lshlrev_b32 v160, 2, v160
    ds_add_u32 v160, v14
    v_cndmask_b32 v137, v13, v137, vcc
    v_lshrrev_b32 v161, 4, v137
    v_lshlrev_b32 v161, 2, v161
    ds_add_u32 v161, v14
    v_cndmask_b32 v138, v13, v138, vcc
    v_lshrrev_b32 v162, 4, v138
    v_lshlrev_b32 v162, 2, v162
    ds_add_u32 v162, v14
    v_cndmask_b32 v139, v13, v139, vcc
    v_lshrrev_b32 v163, 4, v139
    v_lshlrev_b32 v163, 2, v163
    ds_add_u32 v163, v14
    s_waitcnt vmcnt(35)
    buffer_load_dwordx4 a[124:127], v1, s[8:11], s37 offen
    s_add_u32 s37, s37, 4096
    v_cmp_gt_u32 vcc, 1473024, v12
    s_nop 1
    v_cndmask_b32 v140, v13, v140, vcc
    v_lshrrev_b32 v160, 4, v140
    v_lshlrev_b32 v160, 2, v160
    ds_add_u32 v160, v14
    v_cndmask_b32 v141, v13, v141, vcc
    v_lshrrev_b32 v161, 4, v141
    v_lshlrev_b32 v161, 2, v161
    ds_add_u32 v161, v14
    v_cndmask_b32 v142, v13, v142, vcc
    v_lshrrev_b32 v162, 4, v142
    v_lshlrev_b32 v162, 2, v162
    ds_add_u32 v162, v14
    v_cndmask_b32 v143, v13, v143, vcc
    v_lshrrev_b32 v163, 4, v143
    v_lshlrev_b32 v163, 2, v163
    ds_add_u32 v163, v14
    s_waitcnt vmcnt(35)
    buffer_load_dwordx4 a[128:131], v1, s[8:11], s37 offen
    s_add_u32 s37, s37, 4096
    v_cmp_gt_u32 vcc, 1468928, v12
    s_nop 1
    v_cndmask_b32 v144, v13, v144, vcc
    v_lshrrev_b32 v160, 4, v144
    v_lshlrev_b32 v160, 2, v160
    ds_add_u32 v160, v14
    v_cndmask_b32 v145, v13, v145, vcc
    v_lshrrev_b32 v161, 4, v145
    v_lshlrev_b32 v161, 2, v161
    ds_add_u32 v161, v14
    v_cndmask_b32 v146, v13, v146, vcc
    v_lshrrev_b32 v162, 4, v146
    v_lshlrev_b32 v162, 2, v162
    ds_add_u32 v162, v14
    v_cndmask_b32 v147, v13, v147, vcc
    v_lshrrev_b32 v163, 4, v147
    v_lshlrev_b32 v163, 2, v163
    ds_add_u32 v163, v14
    s_waitcnt vmcnt(35)
    buffer_load_dwordx4 a[132:135], v1, s[8:11], s37 offen
    s_add_u32 s37, s37, 4096
    v_cmp_gt_u32 vcc, 1464832, v12
    s_nop 1
    v_cndmask_b32 v148, v13, v148, vcc
    v_lshrrev_b32 v160, 4, v148
    v_lshlrev_b32 v160, 2, v160
    ds_add_u32 v160, v14
    v_cndmask_b32 v149, v13, v149, vcc
    v_lshrrev_b32 v161, 4, v149
    v_lshlrev_b32 v161, 2, v161
    ds_add_u32 v161, v14
    v_cndmask_b32 v150, v13, v150, vcc
    v_lshrrev_b32 v162, 4, v150
    v_lshlrev_b32 v162, 2, v162
    ds_add_u32 v162, v14
    v_cndmask_b32 v151, v13, v151, vcc
    v_lshrrev_b32 v163, 4, v151
    v_lshlrev_b32 v163, 2, v163
    ds_add_u32 v163, v14
    s_waitcnt vmcnt(35)
    buffer_load_dwordx4 a[136:139], v1, s[8:11], s37 offen
    s_add_u32 s37, s37, 4096
    v_cmp_gt_u32 vcc, 1460736, v12
    s_nop 1
    v_cndmask_b32 v152, v13, v152, vcc
    v_lshrrev_b32 v160, 4, v152
    v_lshlrev_b32 v160, 2, v160
    ds_add_u32 v160, v14
    v_cndmask_b32 v153, v13, v153, vcc
    v_lshrrev_b32 v161, 4, v153
    v_lshlrev_b32 v161, 2, v161
    ds_add_u32 v161, v14
    v_cndmask_b32 v154, v13, v154, vcc
    v_lshrrev_b32 v162, 4, v154
    v_lshlrev_b32 v162, 2, v162
    ds_add_u32 v162, v14
    v_cndmask_b32 v155, v13, v155, vcc
    v_lshrrev_b32 v163, 4, v155
    v_lshlrev_b32 v163, 2, v163
    ds_add_u32 v163, v14
    s_waitcnt vmcnt(35)
    buffer_load_dwordx4 a[140:143], v1, s[8:11], s37 offen
    s_add_u32 s37, s37, 4096
    v_cmp_gt_u32 vcc, 1456640, v12
    s_nop 1
    v_cndmask_b32 v156, v13, v156, vcc
    v_lshrrev_b32 v160, 4, v156
    v_lshlrev_b32 v160, 2, v160
    ds_add_u32 v160, v14
    v_cndmask_b32 v157, v13, v157, vcc
    v_lshrrev_b32 v161, 4, v157
    v_lshlrev_b32 v161, 2, v161
    ds_add_u32 v161, v14
    v_cndmask_b32 v158, v13, v158, vcc
    v_lshrrev_b32 v162, 4, v158
    v_lshlrev_b32 v162, 2, v162
    ds_add_u32 v162, v14
    v_cndmask_b32 v159, v13, v159, vcc
    v_lshrrev_b32 v163, 4, v159
    v_lshlrev_b32 v163, 2, v163
    ds_add_u32 v163, v14
    s_waitcnt lgkmcnt(0)
    s_barrier
    ds_read_b128 v[160:163], v1
    s_waitcnt lgkmcnt(0)

    v_add_u32 v160, 3, v160
    v_and_b32 v160, -4, v160
    v_add_u32 v161, 3, v161
    v_and_b32 v161, -4, v161
    v_add_u32 v162, 3, v162
    v_and_b32 v162, -4, v162
    v_add_u32 v163, 3, v163
    v_and_b32 v163, -4, v163
    v_add_u32 v164, v160, v161
    v_add_u32 v165, v164, v162
    v_add_u32 v166, v165, v163
    v_mov_b32 v167, v166

    s_nop 1
    v_add_u32_dpp v167, v167, v167 row_shr:1 row_mask:0xf bank_mask:0xf
    s_nop 1
    v_add_u32_dpp v167, v167, v167 row_shr:2 row_mask:0xf bank_mask:0xf
    s_nop 1
    v_add_u32_dpp v167, v167, v167 row_shr:4 row_mask:0xf bank_mask:0xf
    s_nop 1
    v_add_u32_dpp v167, v167, v167 row_shr:8 row_mask:0xf bank_mask:0xf
    s_nop 1
    v_add_u32_dpp v167, v167, v167 row_bcast:15 row_mask:0xa bank_mask:0xf
    s_nop 1
    v_add_u32_dpp v167, v167, v167 row_bcast:31 row_mask:0xc bank_mask:0xf
    s_barrier
    s_lshl_b32 s33, s3, 2
    v_mov_b32 v168, s33
    v_cmp_eq_u32 vcc, 63, v0
    s_and_saveexec_b64 s[38:39], vcc
    ds_write_b32 v168, v167 offset:4080
    s_mov_b64 exec, s[38:39]
    s_waitcnt lgkmcnt(0)
    s_barrier
    v_mov_b32 v168, 0
    ds_read_b128 v[172:175], v168 offset:4080
    v_sub_u32 v167, v167, v166
    s_waitcnt lgkmcnt(0)
    v_readfirstlane_b32 s38, v172
    v_readfirstlane_b32 s39, v173
    v_readfirstlane_b32 s40, v174
    s_cmp_gt_u32 s3, 0
    s_cselect_b32 s38, s38, 0
    s_cmp_gt_u32 s3, 1
    s_cselect_b32 s39, s39, 0
    s_cmp_gt_u32 s3, 2
    s_cselect_b32 s40, s40, 0
    s_add_u32 s38, s38, s39
    s_add_u32 s38, s38, s40
    v_add_u32 v176, s38, v167
    v_add_u32 v177, v176, v160
    v_add_u32 v178, v176, v164
    v_add_u32 v179, v176, v165
    v_cmp_gt_u32 vcc, 252, v200
    s_and_saveexec_b64 s[38:39], vcc
    ds_write_b128 v1, v[176:179]
    s_mov_b64 exec, s[38:39]
    v_lshlrev_b32 v168, 8, v200
    s_lshl_b32 s33, s34, 2

    v_lshrrev_b32 v180, 2, v176
    v_lshl_or_b32 v180, v160, 14, v180
    buffer_store_dword v180, v168, s[16:19], s33 offen offset:0 sc1
    v_lshrrev_b32 v181, 2, v177
    v_lshl_or_b32 v181, v161, 14, v181
    buffer_store_dword v181, v168, s[16:19], s33 offen offset:64 sc1
    v_lshrrev_b32 v182, 2, v178
    v_lshl_or_b32 v182, v162, 14, v182
    buffer_store_dword v182, v168, s[16:19], s33 offen offset:128 sc1
    v_lshrrev_b32 v183, 2, v179
    v_lshl_or_b32 v183, v163, 14, v183
    buffer_store_dword v183, v168, s[16:19], s33 offen offset:192 sc1
    s_waitcnt vmcnt(4) lgkmcnt(0)
    s_barrier
    v_lshrrev_b32 v160, 4, v16
    v_lshlrev_b32 v160, 2, v160
    ds_add_rtn_u32 v160, v160, v14
    v_lshrrev_b32 v161, 4, v17
    v_lshlrev_b32 v161, 2, v161
    ds_add_rtn_u32 v161, v161, v14
    v_lshrrev_b32 v162, 4, v18
    v_lshlrev_b32 v162, 2, v162
    ds_add_rtn_u32 v162, v162, v14
    v_lshrrev_b32 v163, 4, v19
    v_lshlrev_b32 v163, 2, v163
    ds_add_rtn_u32 v163, v163, v14
    v_lshrrev_b32 v164, 4, v20
    v_lshlrev_b32 v164, 2, v164
    ds_add_rtn_u32 v164, v164, v14
    v_lshrrev_b32 v165, 4, v21
    v_lshlrev_b32 v165, 2, v165
    ds_add_rtn_u32 v165, v165, v14
    v_lshrrev_b32 v166, 4, v22
    v_lshlrev_b32 v166, 2, v166
    ds_add_rtn_u32 v166, v166, v14
    v_lshrrev_b32 v167, 4, v23
    v_lshlrev_b32 v167, 2, v167
    ds_add_rtn_u32 v167, v167, v14
    v_accvgpr_read_b32 v168, a0
    v_and_b32 v15, 7, v168
    v_lshlrev_b32 v168, 8, v168
    v_lshl_or_b32 v168, v15, 5, v168
    v_and_or_b32 v168, v16, 15, v168
    v_accvgpr_read_b32 v169, a1
    v_and_b32 v15, 7, v169
    v_lshlrev_b32 v169, 8, v169
    v_lshl_or_b32 v169, v15, 5, v169
    v_and_or_b32 v169, v17, 15, v169
    v_accvgpr_read_b32 v170, a2
    v_and_b32 v15, 7, v170
    v_lshlrev_b32 v170, 8, v170
    v_lshl_or_b32 v170, v15, 5, v170
    v_and_or_b32 v170, v18, 15, v170
    v_accvgpr_read_b32 v171, a3
    v_and_b32 v15, 7, v171
    v_lshlrev_b32 v171, 8, v171
    v_lshl_or_b32 v171, v15, 5, v171
    v_and_or_b32 v171, v19, 15, v171
    v_accvgpr_read_b32 v172, a4
    v_and_b32 v15, 7, v172
    v_lshlrev_b32 v172, 8, v172
    v_lshl_or_b32 v172, v15, 5, v172
    v_and_or_b32 v172, v20, 15, v172
    v_accvgpr_read_b32 v173, a5
    v_and_b32 v15, 7, v173
    v_lshlrev_b32 v173, 8, v173
    v_lshl_or_b32 v173, v15, 5, v173
    v_and_or_b32 v173, v21, 15, v173
    v_accvgpr_read_b32 v174, a6
    v_and_b32 v15, 7, v174
    v_lshlrev_b32 v174, 8, v174
    v_lshl_or_b32 v174, v15, 5, v174
    v_and_or_b32 v174, v22, 15, v174
    v_accvgpr_read_b32 v175, a7
    v_and_b32 v15, 7, v175
    v_lshlrev_b32 v175, 8, v175
    v_lshl_or_b32 v175, v15, 5, v175
    v_and_or_b32 v175, v23, 15, v175
    s_waitcnt lgkmcnt(0)
    v_lshlrev_b32 v160, 2, v160
    ds_write_b32 v160, v168 offset:4096
    v_lshlrev_b32 v161, 2, v161
    ds_write_b32 v161, v169 offset:4096
    v_lshlrev_b32 v162, 2, v162
    ds_write_b32 v162, v170 offset:4096
    v_lshlrev_b32 v163, 2, v163
    ds_write_b32 v163, v171 offset:4096
    v_lshlrev_b32 v164, 2, v164
    ds_write_b32 v164, v172 offset:4096
    v_lshlrev_b32 v165, 2, v165
    ds_write_b32 v165, v173 offset:4096
    v_lshlrev_b32 v166, 2, v166
    ds_write_b32 v166, v174 offset:4096
    v_lshlrev_b32 v167, 2, v167
    ds_write_b32 v167, v175 offset:4096
    v_lshrrev_b32 v160, 4, v24
    v_lshlrev_b32 v160, 2, v160
    ds_add_rtn_u32 v160, v160, v14
    v_lshrrev_b32 v161, 4, v25
    v_lshlrev_b32 v161, 2, v161
    ds_add_rtn_u32 v161, v161, v14
    v_lshrrev_b32 v162, 4, v26
    v_lshlrev_b32 v162, 2, v162
    ds_add_rtn_u32 v162, v162, v14
    v_lshrrev_b32 v163, 4, v27
    v_lshlrev_b32 v163, 2, v163
    ds_add_rtn_u32 v163, v163, v14
    v_lshrrev_b32 v164, 4, v28
    v_lshlrev_b32 v164, 2, v164
    ds_add_rtn_u32 v164, v164, v14
    v_lshrrev_b32 v165, 4, v29
    v_lshlrev_b32 v165, 2, v165
    ds_add_rtn_u32 v165, v165, v14
    v_lshrrev_b32 v166, 4, v30
    v_lshlrev_b32 v166, 2, v166
    ds_add_rtn_u32 v166, v166, v14
    v_lshrrev_b32 v167, 4, v31
    v_lshlrev_b32 v167, 2, v167
    ds_add_rtn_u32 v167, v167, v14
    v_accvgpr_read_b32 v168, a8
    v_and_b32 v15, 7, v168
    v_lshlrev_b32 v168, 8, v168
    v_lshl_or_b32 v168, v15, 5, v168
    v_and_or_b32 v168, v24, 15, v168
    v_accvgpr_read_b32 v169, a9
    v_and_b32 v15, 7, v169
    v_lshlrev_b32 v169, 8, v169
    v_lshl_or_b32 v169, v15, 5, v169
    v_and_or_b32 v169, v25, 15, v169
    v_accvgpr_read_b32 v170, a10
    v_and_b32 v15, 7, v170
    v_lshlrev_b32 v170, 8, v170
    v_lshl_or_b32 v170, v15, 5, v170
    v_and_or_b32 v170, v26, 15, v170
    v_accvgpr_read_b32 v171, a11
    v_and_b32 v15, 7, v171
    v_lshlrev_b32 v171, 8, v171
    v_lshl_or_b32 v171, v15, 5, v171
    v_and_or_b32 v171, v27, 15, v171
    v_accvgpr_read_b32 v172, a12
    v_and_b32 v15, 7, v172
    v_lshlrev_b32 v172, 8, v172
    v_lshl_or_b32 v172, v15, 5, v172
    v_and_or_b32 v172, v28, 15, v172
    v_accvgpr_read_b32 v173, a13
    v_and_b32 v15, 7, v173
    v_lshlrev_b32 v173, 8, v173
    v_lshl_or_b32 v173, v15, 5, v173
    v_and_or_b32 v173, v29, 15, v173
    v_accvgpr_read_b32 v174, a14
    v_and_b32 v15, 7, v174
    v_lshlrev_b32 v174, 8, v174
    v_lshl_or_b32 v174, v15, 5, v174
    v_and_or_b32 v174, v30, 15, v174
    v_accvgpr_read_b32 v175, a15
    v_and_b32 v15, 7, v175
    v_lshlrev_b32 v175, 8, v175
    v_lshl_or_b32 v175, v15, 5, v175
    v_and_or_b32 v175, v31, 15, v175
    s_waitcnt lgkmcnt(0)
    v_lshlrev_b32 v160, 2, v160
    ds_write_b32 v160, v168 offset:4096
    v_lshlrev_b32 v161, 2, v161
    ds_write_b32 v161, v169 offset:4096
    v_lshlrev_b32 v162, 2, v162
    ds_write_b32 v162, v170 offset:4096
    v_lshlrev_b32 v163, 2, v163
    ds_write_b32 v163, v171 offset:4096
    v_lshlrev_b32 v164, 2, v164
    ds_write_b32 v164, v172 offset:4096
    v_lshlrev_b32 v165, 2, v165
    ds_write_b32 v165, v173 offset:4096
    v_lshlrev_b32 v166, 2, v166
    ds_write_b32 v166, v174 offset:4096
    v_lshlrev_b32 v167, 2, v167
    ds_write_b32 v167, v175 offset:4096
    v_lshrrev_b32 v160, 4, v32
    v_lshlrev_b32 v160, 2, v160
    ds_add_rtn_u32 v160, v160, v14
    v_lshrrev_b32 v161, 4, v33
    v_lshlrev_b32 v161, 2, v161
    ds_add_rtn_u32 v161, v161, v14
    v_lshrrev_b32 v162, 4, v34
    v_lshlrev_b32 v162, 2, v162
    ds_add_rtn_u32 v162, v162, v14
    v_lshrrev_b32 v163, 4, v35
    v_lshlrev_b32 v163, 2, v163
    ds_add_rtn_u32 v163, v163, v14
    v_lshrrev_b32 v164, 4, v36
    v_lshlrev_b32 v164, 2, v164
    ds_add_rtn_u32 v164, v164, v14
    v_lshrrev_b32 v165, 4, v37
    v_lshlrev_b32 v165, 2, v165
    ds_add_rtn_u32 v165, v165, v14
    v_lshrrev_b32 v166, 4, v38
    v_lshlrev_b32 v166, 2, v166
    ds_add_rtn_u32 v166, v166, v14
    v_lshrrev_b32 v167, 4, v39
    v_lshlrev_b32 v167, 2, v167
    ds_add_rtn_u32 v167, v167, v14
    v_accvgpr_read_b32 v168, a16
    v_and_b32 v15, 7, v168
    v_lshlrev_b32 v168, 8, v168
    v_lshl_or_b32 v168, v15, 5, v168
    v_and_or_b32 v168, v32, 15, v168
    v_accvgpr_read_b32 v169, a17
    v_and_b32 v15, 7, v169
    v_lshlrev_b32 v169, 8, v169
    v_lshl_or_b32 v169, v15, 5, v169
    v_and_or_b32 v169, v33, 15, v169
    v_accvgpr_read_b32 v170, a18
    v_and_b32 v15, 7, v170
    v_lshlrev_b32 v170, 8, v170
    v_lshl_or_b32 v170, v15, 5, v170
    v_and_or_b32 v170, v34, 15, v170
    v_accvgpr_read_b32 v171, a19
    v_and_b32 v15, 7, v171
    v_lshlrev_b32 v171, 8, v171
    v_lshl_or_b32 v171, v15, 5, v171
    v_and_or_b32 v171, v35, 15, v171
    v_accvgpr_read_b32 v172, a20
    v_and_b32 v15, 7, v172
    v_lshlrev_b32 v172, 8, v172
    v_lshl_or_b32 v172, v15, 5, v172
    v_and_or_b32 v172, v36, 15, v172
    v_accvgpr_read_b32 v173, a21
    v_and_b32 v15, 7, v173
    v_lshlrev_b32 v173, 8, v173
    v_lshl_or_b32 v173, v15, 5, v173
    v_and_or_b32 v173, v37, 15, v173
    v_accvgpr_read_b32 v174, a22
    v_and_b32 v15, 7, v174
    v_lshlrev_b32 v174, 8, v174
    v_lshl_or_b32 v174, v15, 5, v174
    v_and_or_b32 v174, v38, 15, v174
    v_accvgpr_read_b32 v175, a23
    v_and_b32 v15, 7, v175
    v_lshlrev_b32 v175, 8, v175
    v_lshl_or_b32 v175, v15, 5, v175
    v_and_or_b32 v175, v39, 15, v175
    s_waitcnt lgkmcnt(0)
    v_lshlrev_b32 v160, 2, v160
    ds_write_b32 v160, v168 offset:4096
    v_lshlrev_b32 v161, 2, v161
    ds_write_b32 v161, v169 offset:4096
    v_lshlrev_b32 v162, 2, v162
    ds_write_b32 v162, v170 offset:4096
    v_lshlrev_b32 v163, 2, v163
    ds_write_b32 v163, v171 offset:4096
    v_lshlrev_b32 v164, 2, v164
    ds_write_b32 v164, v172 offset:4096
    v_lshlrev_b32 v165, 2, v165
    ds_write_b32 v165, v173 offset:4096
    v_lshlrev_b32 v166, 2, v166
    ds_write_b32 v166, v174 offset:4096
    v_lshlrev_b32 v167, 2, v167
    ds_write_b32 v167, v175 offset:4096
    v_lshrrev_b32 v160, 4, v40
    v_lshlrev_b32 v160, 2, v160
    ds_add_rtn_u32 v160, v160, v14
    v_lshrrev_b32 v161, 4, v41
    v_lshlrev_b32 v161, 2, v161
    ds_add_rtn_u32 v161, v161, v14
    v_lshrrev_b32 v162, 4, v42
    v_lshlrev_b32 v162, 2, v162
    ds_add_rtn_u32 v162, v162, v14
    v_lshrrev_b32 v163, 4, v43
    v_lshlrev_b32 v163, 2, v163
    ds_add_rtn_u32 v163, v163, v14
    v_lshrrev_b32 v164, 4, v44
    v_lshlrev_b32 v164, 2, v164
    ds_add_rtn_u32 v164, v164, v14
    v_lshrrev_b32 v165, 4, v45
    v_lshlrev_b32 v165, 2, v165
    ds_add_rtn_u32 v165, v165, v14
    v_lshrrev_b32 v166, 4, v46
    v_lshlrev_b32 v166, 2, v166
    ds_add_rtn_u32 v166, v166, v14
    v_lshrrev_b32 v167, 4, v47
    v_lshlrev_b32 v167, 2, v167
    ds_add_rtn_u32 v167, v167, v14
    v_accvgpr_read_b32 v168, a24
    v_and_b32 v15, 7, v168
    v_lshlrev_b32 v168, 8, v168
    v_lshl_or_b32 v168, v15, 5, v168
    v_and_or_b32 v168, v40, 15, v168
    v_accvgpr_read_b32 v169, a25
    v_and_b32 v15, 7, v169
    v_lshlrev_b32 v169, 8, v169
    v_lshl_or_b32 v169, v15, 5, v169
    v_and_or_b32 v169, v41, 15, v169
    v_accvgpr_read_b32 v170, a26
    v_and_b32 v15, 7, v170
    v_lshlrev_b32 v170, 8, v170
    v_lshl_or_b32 v170, v15, 5, v170
    v_and_or_b32 v170, v42, 15, v170
    v_accvgpr_read_b32 v171, a27
    v_and_b32 v15, 7, v171
    v_lshlrev_b32 v171, 8, v171
    v_lshl_or_b32 v171, v15, 5, v171
    v_and_or_b32 v171, v43, 15, v171
    v_accvgpr_read_b32 v172, a28
    v_and_b32 v15, 7, v172
    v_lshlrev_b32 v172, 8, v172
    v_lshl_or_b32 v172, v15, 5, v172
    v_and_or_b32 v172, v44, 15, v172
    v_accvgpr_read_b32 v173, a29
    v_and_b32 v15, 7, v173
    v_lshlrev_b32 v173, 8, v173
    v_lshl_or_b32 v173, v15, 5, v173
    v_and_or_b32 v173, v45, 15, v173
    v_accvgpr_read_b32 v174, a30
    v_and_b32 v15, 7, v174
    v_lshlrev_b32 v174, 8, v174
    v_lshl_or_b32 v174, v15, 5, v174
    v_and_or_b32 v174, v46, 15, v174
    v_accvgpr_read_b32 v175, a31
    v_and_b32 v15, 7, v175
    v_lshlrev_b32 v175, 8, v175
    v_lshl_or_b32 v175, v15, 5, v175
    v_and_or_b32 v175, v47, 15, v175
    s_waitcnt lgkmcnt(0)
    v_lshlrev_b32 v160, 2, v160
    ds_write_b32 v160, v168 offset:4096
    v_lshlrev_b32 v161, 2, v161
    ds_write_b32 v161, v169 offset:4096
    v_lshlrev_b32 v162, 2, v162
    ds_write_b32 v162, v170 offset:4096
    v_lshlrev_b32 v163, 2, v163
    ds_write_b32 v163, v171 offset:4096
    v_lshlrev_b32 v164, 2, v164
    ds_write_b32 v164, v172 offset:4096
    v_lshlrev_b32 v165, 2, v165
    ds_write_b32 v165, v173 offset:4096
    v_lshlrev_b32 v166, 2, v166
    ds_write_b32 v166, v174 offset:4096
    v_lshlrev_b32 v167, 2, v167
    ds_write_b32 v167, v175 offset:4096
    v_lshrrev_b32 v160, 4, v48
    v_lshlrev_b32 v160, 2, v160
    ds_add_rtn_u32 v160, v160, v14
    v_lshrrev_b32 v161, 4, v49
    v_lshlrev_b32 v161, 2, v161
    ds_add_rtn_u32 v161, v161, v14
    v_lshrrev_b32 v162, 4, v50
    v_lshlrev_b32 v162, 2, v162
    ds_add_rtn_u32 v162, v162, v14
    v_lshrrev_b32 v163, 4, v51
    v_lshlrev_b32 v163, 2, v163
    ds_add_rtn_u32 v163, v163, v14
    v_lshrrev_b32 v164, 4, v52
    v_lshlrev_b32 v164, 2, v164
    ds_add_rtn_u32 v164, v164, v14
    v_lshrrev_b32 v165, 4, v53
    v_lshlrev_b32 v165, 2, v165
    ds_add_rtn_u32 v165, v165, v14
    v_lshrrev_b32 v166, 4, v54
    v_lshlrev_b32 v166, 2, v166
    ds_add_rtn_u32 v166, v166, v14
    v_lshrrev_b32 v167, 4, v55
    v_lshlrev_b32 v167, 2, v167
    ds_add_rtn_u32 v167, v167, v14
    v_accvgpr_read_b32 v168, a32
    v_and_b32 v15, 7, v168
    v_lshlrev_b32 v168, 8, v168
    v_lshl_or_b32 v168, v15, 5, v168
    v_and_or_b32 v168, v48, 15, v168
    v_accvgpr_read_b32 v169, a33
    v_and_b32 v15, 7, v169
    v_lshlrev_b32 v169, 8, v169
    v_lshl_or_b32 v169, v15, 5, v169
    v_and_or_b32 v169, v49, 15, v169
    v_accvgpr_read_b32 v170, a34
    v_and_b32 v15, 7, v170
    v_lshlrev_b32 v170, 8, v170
    v_lshl_or_b32 v170, v15, 5, v170
    v_and_or_b32 v170, v50, 15, v170
    v_accvgpr_read_b32 v171, a35
    v_and_b32 v15, 7, v171
    v_lshlrev_b32 v171, 8, v171
    v_lshl_or_b32 v171, v15, 5, v171
    v_and_or_b32 v171, v51, 15, v171
    v_accvgpr_read_b32 v172, a36
    v_and_b32 v15, 7, v172
    v_lshlrev_b32 v172, 8, v172
    v_lshl_or_b32 v172, v15, 5, v172
    v_and_or_b32 v172, v52, 15, v172
    v_accvgpr_read_b32 v173, a37
    v_and_b32 v15, 7, v173
    v_lshlrev_b32 v173, 8, v173
    v_lshl_or_b32 v173, v15, 5, v173
    v_and_or_b32 v173, v53, 15, v173
    v_accvgpr_read_b32 v174, a38
    v_and_b32 v15, 7, v174
    v_lshlrev_b32 v174, 8, v174
    v_lshl_or_b32 v174, v15, 5, v174
    v_and_or_b32 v174, v54, 15, v174
    v_accvgpr_read_b32 v175, a39
    v_and_b32 v15, 7, v175
    v_lshlrev_b32 v175, 8, v175
    v_lshl_or_b32 v175, v15, 5, v175
    v_and_or_b32 v175, v55, 15, v175
    s_waitcnt lgkmcnt(0)
    v_lshlrev_b32 v160, 2, v160
    ds_write_b32 v160, v168 offset:4096
    v_lshlrev_b32 v161, 2, v161
    ds_write_b32 v161, v169 offset:4096
    v_lshlrev_b32 v162, 2, v162
    ds_write_b32 v162, v170 offset:4096
    v_lshlrev_b32 v163, 2, v163
    ds_write_b32 v163, v171 offset:4096
    v_lshlrev_b32 v164, 2, v164
    ds_write_b32 v164, v172 offset:4096
    v_lshlrev_b32 v165, 2, v165
    ds_write_b32 v165, v173 offset:4096
    v_lshlrev_b32 v166, 2, v166
    ds_write_b32 v166, v174 offset:4096
    v_lshlrev_b32 v167, 2, v167
    ds_write_b32 v167, v175 offset:4096
    v_lshrrev_b32 v160, 4, v56
    v_lshlrev_b32 v160, 2, v160
    ds_add_rtn_u32 v160, v160, v14
    v_lshrrev_b32 v161, 4, v57
    v_lshlrev_b32 v161, 2, v161
    ds_add_rtn_u32 v161, v161, v14
    v_lshrrev_b32 v162, 4, v58
    v_lshlrev_b32 v162, 2, v162
    ds_add_rtn_u32 v162, v162, v14
    v_lshrrev_b32 v163, 4, v59
    v_lshlrev_b32 v163, 2, v163
    ds_add_rtn_u32 v163, v163, v14
    v_lshrrev_b32 v164, 4, v60
    v_lshlrev_b32 v164, 2, v164
    ds_add_rtn_u32 v164, v164, v14
    v_lshrrev_b32 v165, 4, v61
    v_lshlrev_b32 v165, 2, v165
    ds_add_rtn_u32 v165, v165, v14
    v_lshrrev_b32 v166, 4, v62
    v_lshlrev_b32 v166, 2, v166
    ds_add_rtn_u32 v166, v166, v14
    v_lshrrev_b32 v167, 4, v63
    v_lshlrev_b32 v167, 2, v167
    ds_add_rtn_u32 v167, v167, v14
    v_accvgpr_read_b32 v168, a40
    v_and_b32 v15, 7, v168
    v_lshlrev_b32 v168, 8, v168
    v_lshl_or_b32 v168, v15, 5, v168
    v_and_or_b32 v168, v56, 15, v168
    v_accvgpr_read_b32 v169, a41
    v_and_b32 v15, 7, v169
    v_lshlrev_b32 v169, 8, v169
    v_lshl_or_b32 v169, v15, 5, v169
    v_and_or_b32 v169, v57, 15, v169
    v_accvgpr_read_b32 v170, a42
    v_and_b32 v15, 7, v170
    v_lshlrev_b32 v170, 8, v170
    v_lshl_or_b32 v170, v15, 5, v170
    v_and_or_b32 v170, v58, 15, v170
    v_accvgpr_read_b32 v171, a43
    v_and_b32 v15, 7, v171
    v_lshlrev_b32 v171, 8, v171
    v_lshl_or_b32 v171, v15, 5, v171
    v_and_or_b32 v171, v59, 15, v171
    v_accvgpr_read_b32 v172, a44
    v_and_b32 v15, 7, v172
    v_lshlrev_b32 v172, 8, v172
    v_lshl_or_b32 v172, v15, 5, v172
    v_and_or_b32 v172, v60, 15, v172
    v_accvgpr_read_b32 v173, a45
    v_and_b32 v15, 7, v173
    v_lshlrev_b32 v173, 8, v173
    v_lshl_or_b32 v173, v15, 5, v173
    v_and_or_b32 v173, v61, 15, v173
    v_accvgpr_read_b32 v174, a46
    v_and_b32 v15, 7, v174
    v_lshlrev_b32 v174, 8, v174
    v_lshl_or_b32 v174, v15, 5, v174
    v_and_or_b32 v174, v62, 15, v174
    v_accvgpr_read_b32 v175, a47
    v_and_b32 v15, 7, v175
    v_lshlrev_b32 v175, 8, v175
    v_lshl_or_b32 v175, v15, 5, v175
    v_and_or_b32 v175, v63, 15, v175
    s_waitcnt lgkmcnt(0)
    v_lshlrev_b32 v160, 2, v160
    ds_write_b32 v160, v168 offset:4096
    v_lshlrev_b32 v161, 2, v161
    ds_write_b32 v161, v169 offset:4096
    v_lshlrev_b32 v162, 2, v162
    ds_write_b32 v162, v170 offset:4096
    v_lshlrev_b32 v163, 2, v163
    ds_write_b32 v163, v171 offset:4096
    v_lshlrev_b32 v164, 2, v164
    ds_write_b32 v164, v172 offset:4096
    v_lshlrev_b32 v165, 2, v165
    ds_write_b32 v165, v173 offset:4096
    v_lshlrev_b32 v166, 2, v166
    ds_write_b32 v166, v174 offset:4096
    v_lshlrev_b32 v167, 2, v167
    ds_write_b32 v167, v175 offset:4096
    v_lshrrev_b32 v160, 4, v64
    v_lshlrev_b32 v160, 2, v160
    ds_add_rtn_u32 v160, v160, v14
    v_lshrrev_b32 v161, 4, v65
    v_lshlrev_b32 v161, 2, v161
    ds_add_rtn_u32 v161, v161, v14
    v_lshrrev_b32 v162, 4, v66
    v_lshlrev_b32 v162, 2, v162
    ds_add_rtn_u32 v162, v162, v14
    v_lshrrev_b32 v163, 4, v67
    v_lshlrev_b32 v163, 2, v163
    ds_add_rtn_u32 v163, v163, v14
    v_lshrrev_b32 v164, 4, v68
    v_lshlrev_b32 v164, 2, v164
    ds_add_rtn_u32 v164, v164, v14
    v_lshrrev_b32 v165, 4, v69
    v_lshlrev_b32 v165, 2, v165
    ds_add_rtn_u32 v165, v165, v14
    v_lshrrev_b32 v166, 4, v70
    v_lshlrev_b32 v166, 2, v166
    ds_add_rtn_u32 v166, v166, v14
    v_lshrrev_b32 v167, 4, v71
    v_lshlrev_b32 v167, 2, v167
    ds_add_rtn_u32 v167, v167, v14
    v_accvgpr_read_b32 v168, a48
    v_and_b32 v15, 7, v168
    v_lshlrev_b32 v168, 8, v168
    v_lshl_or_b32 v168, v15, 5, v168
    v_and_or_b32 v168, v64, 15, v168
    v_accvgpr_read_b32 v169, a49
    v_and_b32 v15, 7, v169
    v_lshlrev_b32 v169, 8, v169
    v_lshl_or_b32 v169, v15, 5, v169
    v_and_or_b32 v169, v65, 15, v169
    v_accvgpr_read_b32 v170, a50
    v_and_b32 v15, 7, v170
    v_lshlrev_b32 v170, 8, v170
    v_lshl_or_b32 v170, v15, 5, v170
    v_and_or_b32 v170, v66, 15, v170
    v_accvgpr_read_b32 v171, a51
    v_and_b32 v15, 7, v171
    v_lshlrev_b32 v171, 8, v171
    v_lshl_or_b32 v171, v15, 5, v171
    v_and_or_b32 v171, v67, 15, v171
    v_accvgpr_read_b32 v172, a52
    v_and_b32 v15, 7, v172
    v_lshlrev_b32 v172, 8, v172
    v_lshl_or_b32 v172, v15, 5, v172
    v_and_or_b32 v172, v68, 15, v172
    v_accvgpr_read_b32 v173, a53
    v_and_b32 v15, 7, v173
    v_lshlrev_b32 v173, 8, v173
    v_lshl_or_b32 v173, v15, 5, v173
    v_and_or_b32 v173, v69, 15, v173
    v_accvgpr_read_b32 v174, a54
    v_and_b32 v15, 7, v174
    v_lshlrev_b32 v174, 8, v174
    v_lshl_or_b32 v174, v15, 5, v174
    v_and_or_b32 v174, v70, 15, v174
    v_accvgpr_read_b32 v175, a55
    v_and_b32 v15, 7, v175
    v_lshlrev_b32 v175, 8, v175
    v_lshl_or_b32 v175, v15, 5, v175
    v_and_or_b32 v175, v71, 15, v175
    s_waitcnt lgkmcnt(0)
    v_lshlrev_b32 v160, 2, v160
    ds_write_b32 v160, v168 offset:4096
    v_lshlrev_b32 v161, 2, v161
    ds_write_b32 v161, v169 offset:4096
    v_lshlrev_b32 v162, 2, v162
    ds_write_b32 v162, v170 offset:4096
    v_lshlrev_b32 v163, 2, v163
    ds_write_b32 v163, v171 offset:4096
    v_lshlrev_b32 v164, 2, v164
    ds_write_b32 v164, v172 offset:4096
    v_lshlrev_b32 v165, 2, v165
    ds_write_b32 v165, v173 offset:4096
    v_lshlrev_b32 v166, 2, v166
    ds_write_b32 v166, v174 offset:4096
    v_lshlrev_b32 v167, 2, v167
    ds_write_b32 v167, v175 offset:4096
    v_lshrrev_b32 v160, 4, v72
    v_lshlrev_b32 v160, 2, v160
    ds_add_rtn_u32 v160, v160, v14
    v_lshrrev_b32 v161, 4, v73
    v_lshlrev_b32 v161, 2, v161
    ds_add_rtn_u32 v161, v161, v14
    v_lshrrev_b32 v162, 4, v74
    v_lshlrev_b32 v162, 2, v162
    ds_add_rtn_u32 v162, v162, v14
    v_lshrrev_b32 v163, 4, v75
    v_lshlrev_b32 v163, 2, v163
    ds_add_rtn_u32 v163, v163, v14
    v_lshrrev_b32 v164, 4, v76
    v_lshlrev_b32 v164, 2, v164
    ds_add_rtn_u32 v164, v164, v14
    v_lshrrev_b32 v165, 4, v77
    v_lshlrev_b32 v165, 2, v165
    ds_add_rtn_u32 v165, v165, v14
    v_lshrrev_b32 v166, 4, v78
    v_lshlrev_b32 v166, 2, v166
    ds_add_rtn_u32 v166, v166, v14
    v_lshrrev_b32 v167, 4, v79
    v_lshlrev_b32 v167, 2, v167
    ds_add_rtn_u32 v167, v167, v14
    v_accvgpr_read_b32 v168, a56
    v_and_b32 v15, 7, v168
    v_lshlrev_b32 v168, 8, v168
    v_lshl_or_b32 v168, v15, 5, v168
    v_and_or_b32 v168, v72, 15, v168
    v_accvgpr_read_b32 v169, a57
    v_and_b32 v15, 7, v169
    v_lshlrev_b32 v169, 8, v169
    v_lshl_or_b32 v169, v15, 5, v169
    v_and_or_b32 v169, v73, 15, v169
    v_accvgpr_read_b32 v170, a58
    v_and_b32 v15, 7, v170
    v_lshlrev_b32 v170, 8, v170
    v_lshl_or_b32 v170, v15, 5, v170
    v_and_or_b32 v170, v74, 15, v170
    v_accvgpr_read_b32 v171, a59
    v_and_b32 v15, 7, v171
    v_lshlrev_b32 v171, 8, v171
    v_lshl_or_b32 v171, v15, 5, v171
    v_and_or_b32 v171, v75, 15, v171
    v_accvgpr_read_b32 v172, a60
    v_and_b32 v15, 7, v172
    v_lshlrev_b32 v172, 8, v172
    v_lshl_or_b32 v172, v15, 5, v172
    v_and_or_b32 v172, v76, 15, v172
    v_accvgpr_read_b32 v173, a61
    v_and_b32 v15, 7, v173
    v_lshlrev_b32 v173, 8, v173
    v_lshl_or_b32 v173, v15, 5, v173
    v_and_or_b32 v173, v77, 15, v173
    v_accvgpr_read_b32 v174, a62
    v_and_b32 v15, 7, v174
    v_lshlrev_b32 v174, 8, v174
    v_lshl_or_b32 v174, v15, 5, v174
    v_and_or_b32 v174, v78, 15, v174
    v_accvgpr_read_b32 v175, a63
    v_and_b32 v15, 7, v175
    v_lshlrev_b32 v175, 8, v175
    v_lshl_or_b32 v175, v15, 5, v175
    v_and_or_b32 v175, v79, 15, v175
    s_waitcnt lgkmcnt(0)
    v_lshlrev_b32 v160, 2, v160
    ds_write_b32 v160, v168 offset:4096
    v_lshlrev_b32 v161, 2, v161
    ds_write_b32 v161, v169 offset:4096
    v_lshlrev_b32 v162, 2, v162
    ds_write_b32 v162, v170 offset:4096
    v_lshlrev_b32 v163, 2, v163
    ds_write_b32 v163, v171 offset:4096
    v_lshlrev_b32 v164, 2, v164
    ds_write_b32 v164, v172 offset:4096
    v_lshlrev_b32 v165, 2, v165
    ds_write_b32 v165, v173 offset:4096
    v_lshlrev_b32 v166, 2, v166
    ds_write_b32 v166, v174 offset:4096
    v_lshlrev_b32 v167, 2, v167
    ds_write_b32 v167, v175 offset:4096
    v_lshrrev_b32 v160, 4, v80
    v_lshlrev_b32 v160, 2, v160
    ds_add_rtn_u32 v160, v160, v14
    v_lshrrev_b32 v161, 4, v81
    v_lshlrev_b32 v161, 2, v161
    ds_add_rtn_u32 v161, v161, v14
    v_lshrrev_b32 v162, 4, v82
    v_lshlrev_b32 v162, 2, v162
    ds_add_rtn_u32 v162, v162, v14
    v_lshrrev_b32 v163, 4, v83
    v_lshlrev_b32 v163, 2, v163
    ds_add_rtn_u32 v163, v163, v14
    v_lshrrev_b32 v164, 4, v84
    v_lshlrev_b32 v164, 2, v164
    ds_add_rtn_u32 v164, v164, v14
    v_lshrrev_b32 v165, 4, v85
    v_lshlrev_b32 v165, 2, v165
    ds_add_rtn_u32 v165, v165, v14
    v_lshrrev_b32 v166, 4, v86
    v_lshlrev_b32 v166, 2, v166
    ds_add_rtn_u32 v166, v166, v14
    v_lshrrev_b32 v167, 4, v87
    v_lshlrev_b32 v167, 2, v167
    ds_add_rtn_u32 v167, v167, v14
    v_accvgpr_read_b32 v168, a64
    v_and_b32 v15, 7, v168
    v_lshlrev_b32 v168, 8, v168
    v_lshl_or_b32 v168, v15, 5, v168
    v_and_or_b32 v168, v80, 15, v168
    v_accvgpr_read_b32 v169, a65
    v_and_b32 v15, 7, v169
    v_lshlrev_b32 v169, 8, v169
    v_lshl_or_b32 v169, v15, 5, v169
    v_and_or_b32 v169, v81, 15, v169
    v_accvgpr_read_b32 v170, a66
    v_and_b32 v15, 7, v170
    v_lshlrev_b32 v170, 8, v170
    v_lshl_or_b32 v170, v15, 5, v170
    v_and_or_b32 v170, v82, 15, v170
    v_accvgpr_read_b32 v171, a67
    v_and_b32 v15, 7, v171
    v_lshlrev_b32 v171, 8, v171
    v_lshl_or_b32 v171, v15, 5, v171
    v_and_or_b32 v171, v83, 15, v171
    v_accvgpr_read_b32 v172, a68
    v_and_b32 v15, 7, v172
    v_lshlrev_b32 v172, 8, v172
    v_lshl_or_b32 v172, v15, 5, v172
    v_and_or_b32 v172, v84, 15, v172
    v_accvgpr_read_b32 v173, a69
    v_and_b32 v15, 7, v173
    v_lshlrev_b32 v173, 8, v173
    v_lshl_or_b32 v173, v15, 5, v173
    v_and_or_b32 v173, v85, 15, v173
    v_accvgpr_read_b32 v174, a70
    v_and_b32 v15, 7, v174
    v_lshlrev_b32 v174, 8, v174
    v_lshl_or_b32 v174, v15, 5, v174
    v_and_or_b32 v174, v86, 15, v174
    v_accvgpr_read_b32 v175, a71
    v_and_b32 v15, 7, v175
    v_lshlrev_b32 v175, 8, v175
    v_lshl_or_b32 v175, v15, 5, v175
    v_and_or_b32 v175, v87, 15, v175
    s_waitcnt lgkmcnt(0)
    v_lshlrev_b32 v160, 2, v160
    ds_write_b32 v160, v168 offset:4096
    v_lshlrev_b32 v161, 2, v161
    ds_write_b32 v161, v169 offset:4096
    v_lshlrev_b32 v162, 2, v162
    ds_write_b32 v162, v170 offset:4096
    v_lshlrev_b32 v163, 2, v163
    ds_write_b32 v163, v171 offset:4096
    v_lshlrev_b32 v164, 2, v164
    ds_write_b32 v164, v172 offset:4096
    v_lshlrev_b32 v165, 2, v165
    ds_write_b32 v165, v173 offset:4096
    v_lshlrev_b32 v166, 2, v166
    ds_write_b32 v166, v174 offset:4096
    v_lshlrev_b32 v167, 2, v167
    ds_write_b32 v167, v175 offset:4096
    v_lshrrev_b32 v160, 4, v88
    v_lshlrev_b32 v160, 2, v160
    ds_add_rtn_u32 v160, v160, v14
    v_lshrrev_b32 v161, 4, v89
    v_lshlrev_b32 v161, 2, v161
    ds_add_rtn_u32 v161, v161, v14
    v_lshrrev_b32 v162, 4, v90
    v_lshlrev_b32 v162, 2, v162
    ds_add_rtn_u32 v162, v162, v14
    v_lshrrev_b32 v163, 4, v91
    v_lshlrev_b32 v163, 2, v163
    ds_add_rtn_u32 v163, v163, v14
    v_lshrrev_b32 v164, 4, v92
    v_lshlrev_b32 v164, 2, v164
    ds_add_rtn_u32 v164, v164, v14
    v_lshrrev_b32 v165, 4, v93
    v_lshlrev_b32 v165, 2, v165
    ds_add_rtn_u32 v165, v165, v14
    v_lshrrev_b32 v166, 4, v94
    v_lshlrev_b32 v166, 2, v166
    ds_add_rtn_u32 v166, v166, v14
    v_lshrrev_b32 v167, 4, v95
    v_lshlrev_b32 v167, 2, v167
    ds_add_rtn_u32 v167, v167, v14
    v_accvgpr_read_b32 v168, a72
    v_and_b32 v15, 7, v168
    v_lshlrev_b32 v168, 8, v168
    v_lshl_or_b32 v168, v15, 5, v168
    v_and_or_b32 v168, v88, 15, v168
    v_accvgpr_read_b32 v169, a73
    v_and_b32 v15, 7, v169
    v_lshlrev_b32 v169, 8, v169
    v_lshl_or_b32 v169, v15, 5, v169
    v_and_or_b32 v169, v89, 15, v169
    v_accvgpr_read_b32 v170, a74
    v_and_b32 v15, 7, v170
    v_lshlrev_b32 v170, 8, v170
    v_lshl_or_b32 v170, v15, 5, v170
    v_and_or_b32 v170, v90, 15, v170
    v_accvgpr_read_b32 v171, a75
    v_and_b32 v15, 7, v171
    v_lshlrev_b32 v171, 8, v171
    v_lshl_or_b32 v171, v15, 5, v171
    v_and_or_b32 v171, v91, 15, v171
    v_accvgpr_read_b32 v172, a76
    v_and_b32 v15, 7, v172
    v_lshlrev_b32 v172, 8, v172
    v_lshl_or_b32 v172, v15, 5, v172
    v_and_or_b32 v172, v92, 15, v172
    v_accvgpr_read_b32 v173, a77
    v_and_b32 v15, 7, v173
    v_lshlrev_b32 v173, 8, v173
    v_lshl_or_b32 v173, v15, 5, v173
    v_and_or_b32 v173, v93, 15, v173
    v_accvgpr_read_b32 v174, a78
    v_and_b32 v15, 7, v174
    v_lshlrev_b32 v174, 8, v174
    v_lshl_or_b32 v174, v15, 5, v174
    v_and_or_b32 v174, v94, 15, v174
    v_accvgpr_read_b32 v175, a79
    v_and_b32 v15, 7, v175
    v_lshlrev_b32 v175, 8, v175
    v_lshl_or_b32 v175, v15, 5, v175
    v_and_or_b32 v175, v95, 15, v175
    s_waitcnt lgkmcnt(0)
    v_lshlrev_b32 v160, 2, v160
    ds_write_b32 v160, v168 offset:4096
    v_lshlrev_b32 v161, 2, v161
    ds_write_b32 v161, v169 offset:4096
    v_lshlrev_b32 v162, 2, v162
    ds_write_b32 v162, v170 offset:4096
    v_lshlrev_b32 v163, 2, v163
    ds_write_b32 v163, v171 offset:4096
    v_lshlrev_b32 v164, 2, v164
    ds_write_b32 v164, v172 offset:4096
    v_lshlrev_b32 v165, 2, v165
    ds_write_b32 v165, v173 offset:4096
    v_lshlrev_b32 v166, 2, v166
    ds_write_b32 v166, v174 offset:4096
    v_lshlrev_b32 v167, 2, v167
    ds_write_b32 v167, v175 offset:4096
    v_lshrrev_b32 v160, 4, v96
    v_lshlrev_b32 v160, 2, v160
    ds_add_rtn_u32 v160, v160, v14
    v_lshrrev_b32 v161, 4, v97
    v_lshlrev_b32 v161, 2, v161
    ds_add_rtn_u32 v161, v161, v14
    v_lshrrev_b32 v162, 4, v98
    v_lshlrev_b32 v162, 2, v162
    ds_add_rtn_u32 v162, v162, v14
    v_lshrrev_b32 v163, 4, v99
    v_lshlrev_b32 v163, 2, v163
    ds_add_rtn_u32 v163, v163, v14
    v_lshrrev_b32 v164, 4, v100
    v_lshlrev_b32 v164, 2, v164
    ds_add_rtn_u32 v164, v164, v14
    v_lshrrev_b32 v165, 4, v101
    v_lshlrev_b32 v165, 2, v165
    ds_add_rtn_u32 v165, v165, v14
    v_lshrrev_b32 v166, 4, v102
    v_lshlrev_b32 v166, 2, v166
    ds_add_rtn_u32 v166, v166, v14
    v_lshrrev_b32 v167, 4, v103
    v_lshlrev_b32 v167, 2, v167
    ds_add_rtn_u32 v167, v167, v14
    v_accvgpr_read_b32 v168, a80
    v_and_b32 v15, 7, v168
    v_lshlrev_b32 v168, 8, v168
    v_lshl_or_b32 v168, v15, 5, v168
    v_and_or_b32 v168, v96, 15, v168
    v_accvgpr_read_b32 v169, a81
    v_and_b32 v15, 7, v169
    v_lshlrev_b32 v169, 8, v169
    v_lshl_or_b32 v169, v15, 5, v169
    v_and_or_b32 v169, v97, 15, v169
    v_accvgpr_read_b32 v170, a82
    v_and_b32 v15, 7, v170
    v_lshlrev_b32 v170, 8, v170
    v_lshl_or_b32 v170, v15, 5, v170
    v_and_or_b32 v170, v98, 15, v170
    v_accvgpr_read_b32 v171, a83
    v_and_b32 v15, 7, v171
    v_lshlrev_b32 v171, 8, v171
    v_lshl_or_b32 v171, v15, 5, v171
    v_and_or_b32 v171, v99, 15, v171
    v_accvgpr_read_b32 v172, a84
    v_and_b32 v15, 7, v172
    v_lshlrev_b32 v172, 8, v172
    v_lshl_or_b32 v172, v15, 5, v172
    v_and_or_b32 v172, v100, 15, v172
    v_accvgpr_read_b32 v173, a85
    v_and_b32 v15, 7, v173
    v_lshlrev_b32 v173, 8, v173
    v_lshl_or_b32 v173, v15, 5, v173
    v_and_or_b32 v173, v101, 15, v173
    v_accvgpr_read_b32 v174, a86
    v_and_b32 v15, 7, v174
    v_lshlrev_b32 v174, 8, v174
    v_lshl_or_b32 v174, v15, 5, v174
    v_and_or_b32 v174, v102, 15, v174
    v_accvgpr_read_b32 v175, a87
    v_and_b32 v15, 7, v175
    v_lshlrev_b32 v175, 8, v175
    v_lshl_or_b32 v175, v15, 5, v175
    v_and_or_b32 v175, v103, 15, v175
    s_waitcnt lgkmcnt(0)
    v_lshlrev_b32 v160, 2, v160
    ds_write_b32 v160, v168 offset:4096
    v_lshlrev_b32 v161, 2, v161
    ds_write_b32 v161, v169 offset:4096
    v_lshlrev_b32 v162, 2, v162
    ds_write_b32 v162, v170 offset:4096
    v_lshlrev_b32 v163, 2, v163
    ds_write_b32 v163, v171 offset:4096
    v_lshlrev_b32 v164, 2, v164
    ds_write_b32 v164, v172 offset:4096
    v_lshlrev_b32 v165, 2, v165
    ds_write_b32 v165, v173 offset:4096
    v_lshlrev_b32 v166, 2, v166
    ds_write_b32 v166, v174 offset:4096
    v_lshlrev_b32 v167, 2, v167
    ds_write_b32 v167, v175 offset:4096
    v_lshrrev_b32 v160, 4, v104
    v_lshlrev_b32 v160, 2, v160
    ds_add_rtn_u32 v160, v160, v14
    v_lshrrev_b32 v161, 4, v105
    v_lshlrev_b32 v161, 2, v161
    ds_add_rtn_u32 v161, v161, v14
    v_lshrrev_b32 v162, 4, v106
    v_lshlrev_b32 v162, 2, v162
    ds_add_rtn_u32 v162, v162, v14
    v_lshrrev_b32 v163, 4, v107
    v_lshlrev_b32 v163, 2, v163
    ds_add_rtn_u32 v163, v163, v14
    v_lshrrev_b32 v164, 4, v108
    v_lshlrev_b32 v164, 2, v164
    ds_add_rtn_u32 v164, v164, v14
    v_lshrrev_b32 v165, 4, v109
    v_lshlrev_b32 v165, 2, v165
    ds_add_rtn_u32 v165, v165, v14
    v_lshrrev_b32 v166, 4, v110
    v_lshlrev_b32 v166, 2, v166
    ds_add_rtn_u32 v166, v166, v14
    v_lshrrev_b32 v167, 4, v111
    v_lshlrev_b32 v167, 2, v167
    ds_add_rtn_u32 v167, v167, v14
    v_accvgpr_read_b32 v168, a88
    v_and_b32 v15, 7, v168
    v_lshlrev_b32 v168, 8, v168
    v_lshl_or_b32 v168, v15, 5, v168
    v_and_or_b32 v168, v104, 15, v168
    v_accvgpr_read_b32 v169, a89
    v_and_b32 v15, 7, v169
    v_lshlrev_b32 v169, 8, v169
    v_lshl_or_b32 v169, v15, 5, v169
    v_and_or_b32 v169, v105, 15, v169
    v_accvgpr_read_b32 v170, a90
    v_and_b32 v15, 7, v170
    v_lshlrev_b32 v170, 8, v170
    v_lshl_or_b32 v170, v15, 5, v170
    v_and_or_b32 v170, v106, 15, v170
    v_accvgpr_read_b32 v171, a91
    v_and_b32 v15, 7, v171
    v_lshlrev_b32 v171, 8, v171
    v_lshl_or_b32 v171, v15, 5, v171
    v_and_or_b32 v171, v107, 15, v171
    v_accvgpr_read_b32 v172, a92
    v_and_b32 v15, 7, v172
    v_lshlrev_b32 v172, 8, v172
    v_lshl_or_b32 v172, v15, 5, v172
    v_and_or_b32 v172, v108, 15, v172
    v_accvgpr_read_b32 v173, a93
    v_and_b32 v15, 7, v173
    v_lshlrev_b32 v173, 8, v173
    v_lshl_or_b32 v173, v15, 5, v173
    v_and_or_b32 v173, v109, 15, v173
    v_accvgpr_read_b32 v174, a94
    v_and_b32 v15, 7, v174
    v_lshlrev_b32 v174, 8, v174
    v_lshl_or_b32 v174, v15, 5, v174
    v_and_or_b32 v174, v110, 15, v174
    v_accvgpr_read_b32 v175, a95
    v_and_b32 v15, 7, v175
    v_lshlrev_b32 v175, 8, v175
    v_lshl_or_b32 v175, v15, 5, v175
    v_and_or_b32 v175, v111, 15, v175
    s_waitcnt lgkmcnt(0)
    v_lshlrev_b32 v160, 2, v160
    ds_write_b32 v160, v168 offset:4096
    v_lshlrev_b32 v161, 2, v161
    ds_write_b32 v161, v169 offset:4096
    v_lshlrev_b32 v162, 2, v162
    ds_write_b32 v162, v170 offset:4096
    v_lshlrev_b32 v163, 2, v163
    ds_write_b32 v163, v171 offset:4096
    v_lshlrev_b32 v164, 2, v164
    ds_write_b32 v164, v172 offset:4096
    v_lshlrev_b32 v165, 2, v165
    ds_write_b32 v165, v173 offset:4096
    v_lshlrev_b32 v166, 2, v166
    ds_write_b32 v166, v174 offset:4096
    v_lshlrev_b32 v167, 2, v167
    ds_write_b32 v167, v175 offset:4096
    v_lshrrev_b32 v160, 4, v112
    v_lshlrev_b32 v160, 2, v160
    ds_add_rtn_u32 v160, v160, v14
    v_lshrrev_b32 v161, 4, v113
    v_lshlrev_b32 v161, 2, v161
    ds_add_rtn_u32 v161, v161, v14
    v_lshrrev_b32 v162, 4, v114
    v_lshlrev_b32 v162, 2, v162
    ds_add_rtn_u32 v162, v162, v14
    v_lshrrev_b32 v163, 4, v115
    v_lshlrev_b32 v163, 2, v163
    ds_add_rtn_u32 v163, v163, v14
    v_lshrrev_b32 v164, 4, v116
    v_lshlrev_b32 v164, 2, v164
    ds_add_rtn_u32 v164, v164, v14
    v_lshrrev_b32 v165, 4, v117
    v_lshlrev_b32 v165, 2, v165
    ds_add_rtn_u32 v165, v165, v14
    v_lshrrev_b32 v166, 4, v118
    v_lshlrev_b32 v166, 2, v166
    ds_add_rtn_u32 v166, v166, v14
    v_lshrrev_b32 v167, 4, v119
    v_lshlrev_b32 v167, 2, v167
    ds_add_rtn_u32 v167, v167, v14
    v_accvgpr_read_b32 v168, a96
    v_and_b32 v15, 7, v168
    v_lshlrev_b32 v168, 8, v168
    v_lshl_or_b32 v168, v15, 5, v168
    v_and_or_b32 v168, v112, 15, v168
    v_accvgpr_read_b32 v169, a97
    v_and_b32 v15, 7, v169
    v_lshlrev_b32 v169, 8, v169
    v_lshl_or_b32 v169, v15, 5, v169
    v_and_or_b32 v169, v113, 15, v169
    v_accvgpr_read_b32 v170, a98
    v_and_b32 v15, 7, v170
    v_lshlrev_b32 v170, 8, v170
    v_lshl_or_b32 v170, v15, 5, v170
    v_and_or_b32 v170, v114, 15, v170
    v_accvgpr_read_b32 v171, a99
    v_and_b32 v15, 7, v171
    v_lshlrev_b32 v171, 8, v171
    v_lshl_or_b32 v171, v15, 5, v171
    v_and_or_b32 v171, v115, 15, v171
    v_accvgpr_read_b32 v172, a100
    v_and_b32 v15, 7, v172
    v_lshlrev_b32 v172, 8, v172
    v_lshl_or_b32 v172, v15, 5, v172
    v_and_or_b32 v172, v116, 15, v172
    v_accvgpr_read_b32 v173, a101
    v_and_b32 v15, 7, v173
    v_lshlrev_b32 v173, 8, v173
    v_lshl_or_b32 v173, v15, 5, v173
    v_and_or_b32 v173, v117, 15, v173
    v_accvgpr_read_b32 v174, a102
    v_and_b32 v15, 7, v174
    v_lshlrev_b32 v174, 8, v174
    v_lshl_or_b32 v174, v15, 5, v174
    v_and_or_b32 v174, v118, 15, v174
    v_accvgpr_read_b32 v175, a103
    v_and_b32 v15, 7, v175
    v_lshlrev_b32 v175, 8, v175
    v_lshl_or_b32 v175, v15, 5, v175
    v_and_or_b32 v175, v119, 15, v175
    s_waitcnt lgkmcnt(0)
    v_lshlrev_b32 v160, 2, v160
    ds_write_b32 v160, v168 offset:4096
    v_lshlrev_b32 v161, 2, v161
    ds_write_b32 v161, v169 offset:4096
    v_lshlrev_b32 v162, 2, v162
    ds_write_b32 v162, v170 offset:4096
    v_lshlrev_b32 v163, 2, v163
    ds_write_b32 v163, v171 offset:4096
    v_lshlrev_b32 v164, 2, v164
    ds_write_b32 v164, v172 offset:4096
    v_lshlrev_b32 v165, 2, v165
    ds_write_b32 v165, v173 offset:4096
    v_lshlrev_b32 v166, 2, v166
    ds_write_b32 v166, v174 offset:4096
    v_lshlrev_b32 v167, 2, v167
    ds_write_b32 v167, v175 offset:4096
    v_lshrrev_b32 v160, 4, v120
    v_lshlrev_b32 v160, 2, v160
    ds_add_rtn_u32 v160, v160, v14
    v_lshrrev_b32 v161, 4, v121
    v_lshlrev_b32 v161, 2, v161
    ds_add_rtn_u32 v161, v161, v14
    v_lshrrev_b32 v162, 4, v122
    v_lshlrev_b32 v162, 2, v162
    ds_add_rtn_u32 v162, v162, v14
    v_lshrrev_b32 v163, 4, v123
    v_lshlrev_b32 v163, 2, v163
    ds_add_rtn_u32 v163, v163, v14
    v_lshrrev_b32 v164, 4, v124
    v_lshlrev_b32 v164, 2, v164
    ds_add_rtn_u32 v164, v164, v14
    v_lshrrev_b32 v165, 4, v125
    v_lshlrev_b32 v165, 2, v165
    ds_add_rtn_u32 v165, v165, v14
    v_lshrrev_b32 v166, 4, v126
    v_lshlrev_b32 v166, 2, v166
    ds_add_rtn_u32 v166, v166, v14
    v_lshrrev_b32 v167, 4, v127
    v_lshlrev_b32 v167, 2, v167
    ds_add_rtn_u32 v167, v167, v14
    v_accvgpr_read_b32 v168, a104
    v_and_b32 v15, 7, v168
    v_lshlrev_b32 v168, 8, v168
    v_lshl_or_b32 v168, v15, 5, v168
    v_and_or_b32 v168, v120, 15, v168
    v_accvgpr_read_b32 v169, a105
    v_and_b32 v15, 7, v169
    v_lshlrev_b32 v169, 8, v169
    v_lshl_or_b32 v169, v15, 5, v169
    v_and_or_b32 v169, v121, 15, v169
    v_accvgpr_read_b32 v170, a106
    v_and_b32 v15, 7, v170
    v_lshlrev_b32 v170, 8, v170
    v_lshl_or_b32 v170, v15, 5, v170
    v_and_or_b32 v170, v122, 15, v170
    v_accvgpr_read_b32 v171, a107
    v_and_b32 v15, 7, v171
    v_lshlrev_b32 v171, 8, v171
    v_lshl_or_b32 v171, v15, 5, v171
    v_and_or_b32 v171, v123, 15, v171
    v_accvgpr_read_b32 v172, a108
    v_and_b32 v15, 7, v172
    v_lshlrev_b32 v172, 8, v172
    v_lshl_or_b32 v172, v15, 5, v172
    v_and_or_b32 v172, v124, 15, v172
    v_accvgpr_read_b32 v173, a109
    v_and_b32 v15, 7, v173
    v_lshlrev_b32 v173, 8, v173
    v_lshl_or_b32 v173, v15, 5, v173
    v_and_or_b32 v173, v125, 15, v173
    v_accvgpr_read_b32 v174, a110
    v_and_b32 v15, 7, v174
    v_lshlrev_b32 v174, 8, v174
    v_lshl_or_b32 v174, v15, 5, v174
    v_and_or_b32 v174, v126, 15, v174
    v_accvgpr_read_b32 v175, a111
    v_and_b32 v15, 7, v175
    v_lshlrev_b32 v175, 8, v175
    v_lshl_or_b32 v175, v15, 5, v175
    v_and_or_b32 v175, v127, 15, v175
    s_waitcnt lgkmcnt(0)
    v_lshlrev_b32 v160, 2, v160
    ds_write_b32 v160, v168 offset:4096
    v_lshlrev_b32 v161, 2, v161
    ds_write_b32 v161, v169 offset:4096
    v_lshlrev_b32 v162, 2, v162
    ds_write_b32 v162, v170 offset:4096
    v_lshlrev_b32 v163, 2, v163
    ds_write_b32 v163, v171 offset:4096
    v_lshlrev_b32 v164, 2, v164
    ds_write_b32 v164, v172 offset:4096
    v_lshlrev_b32 v165, 2, v165
    ds_write_b32 v165, v173 offset:4096
    v_lshlrev_b32 v166, 2, v166
    ds_write_b32 v166, v174 offset:4096
    v_lshlrev_b32 v167, 2, v167
    ds_write_b32 v167, v175 offset:4096
    v_lshrrev_b32 v160, 4, v128
    v_lshlrev_b32 v160, 2, v160
    ds_add_rtn_u32 v160, v160, v14
    v_lshrrev_b32 v161, 4, v129
    v_lshlrev_b32 v161, 2, v161
    ds_add_rtn_u32 v161, v161, v14
    v_lshrrev_b32 v162, 4, v130
    v_lshlrev_b32 v162, 2, v162
    ds_add_rtn_u32 v162, v162, v14
    v_lshrrev_b32 v163, 4, v131
    v_lshlrev_b32 v163, 2, v163
    ds_add_rtn_u32 v163, v163, v14
    v_lshrrev_b32 v164, 4, v132
    v_lshlrev_b32 v164, 2, v164
    ds_add_rtn_u32 v164, v164, v14
    v_lshrrev_b32 v165, 4, v133
    v_lshlrev_b32 v165, 2, v165
    ds_add_rtn_u32 v165, v165, v14
    v_lshrrev_b32 v166, 4, v134
    v_lshlrev_b32 v166, 2, v166
    ds_add_rtn_u32 v166, v166, v14
    v_lshrrev_b32 v167, 4, v135
    v_lshlrev_b32 v167, 2, v167
    ds_add_rtn_u32 v167, v167, v14
    v_accvgpr_read_b32 v168, a112
    v_and_b32 v15, 7, v168
    v_lshlrev_b32 v168, 8, v168
    v_lshl_or_b32 v168, v15, 5, v168
    v_and_or_b32 v168, v128, 15, v168
    v_accvgpr_read_b32 v169, a113
    v_and_b32 v15, 7, v169
    v_lshlrev_b32 v169, 8, v169
    v_lshl_or_b32 v169, v15, 5, v169
    v_and_or_b32 v169, v129, 15, v169
    v_accvgpr_read_b32 v170, a114
    v_and_b32 v15, 7, v170
    v_lshlrev_b32 v170, 8, v170
    v_lshl_or_b32 v170, v15, 5, v170
    v_and_or_b32 v170, v130, 15, v170
    v_accvgpr_read_b32 v171, a115
    v_and_b32 v15, 7, v171
    v_lshlrev_b32 v171, 8, v171
    v_lshl_or_b32 v171, v15, 5, v171
    v_and_or_b32 v171, v131, 15, v171
    v_accvgpr_read_b32 v172, a116
    v_and_b32 v15, 7, v172
    v_lshlrev_b32 v172, 8, v172
    v_lshl_or_b32 v172, v15, 5, v172
    v_and_or_b32 v172, v132, 15, v172
    v_accvgpr_read_b32 v173, a117
    v_and_b32 v15, 7, v173
    v_lshlrev_b32 v173, 8, v173
    v_lshl_or_b32 v173, v15, 5, v173
    v_and_or_b32 v173, v133, 15, v173
    v_accvgpr_read_b32 v174, a118
    v_and_b32 v15, 7, v174
    v_lshlrev_b32 v174, 8, v174
    v_lshl_or_b32 v174, v15, 5, v174
    v_and_or_b32 v174, v134, 15, v174
    v_accvgpr_read_b32 v175, a119
    v_and_b32 v15, 7, v175
    v_lshlrev_b32 v175, 8, v175
    v_lshl_or_b32 v175, v15, 5, v175
    v_and_or_b32 v175, v135, 15, v175
    s_waitcnt lgkmcnt(0)
    v_lshlrev_b32 v160, 2, v160
    ds_write_b32 v160, v168 offset:4096
    v_lshlrev_b32 v161, 2, v161
    ds_write_b32 v161, v169 offset:4096
    v_lshlrev_b32 v162, 2, v162
    ds_write_b32 v162, v170 offset:4096
    v_lshlrev_b32 v163, 2, v163
    ds_write_b32 v163, v171 offset:4096
    v_lshlrev_b32 v164, 2, v164
    ds_write_b32 v164, v172 offset:4096
    v_lshlrev_b32 v165, 2, v165
    ds_write_b32 v165, v173 offset:4096
    v_lshlrev_b32 v166, 2, v166
    ds_write_b32 v166, v174 offset:4096
    v_lshlrev_b32 v167, 2, v167
    ds_write_b32 v167, v175 offset:4096
    v_lshrrev_b32 v160, 4, v136
    v_lshlrev_b32 v160, 2, v160
    ds_add_rtn_u32 v160, v160, v14
    v_lshrrev_b32 v161, 4, v137
    v_lshlrev_b32 v161, 2, v161
    ds_add_rtn_u32 v161, v161, v14
    v_lshrrev_b32 v162, 4, v138
    v_lshlrev_b32 v162, 2, v162
    ds_add_rtn_u32 v162, v162, v14
    v_lshrrev_b32 v163, 4, v139
    v_lshlrev_b32 v163, 2, v163
    ds_add_rtn_u32 v163, v163, v14
    v_lshrrev_b32 v164, 4, v140
    v_lshlrev_b32 v164, 2, v164
    ds_add_rtn_u32 v164, v164, v14
    v_lshrrev_b32 v165, 4, v141
    v_lshlrev_b32 v165, 2, v165
    ds_add_rtn_u32 v165, v165, v14
    v_lshrrev_b32 v166, 4, v142
    v_lshlrev_b32 v166, 2, v166
    ds_add_rtn_u32 v166, v166, v14
    v_lshrrev_b32 v167, 4, v143
    v_lshlrev_b32 v167, 2, v167
    ds_add_rtn_u32 v167, v167, v14
    v_accvgpr_read_b32 v168, a120
    v_and_b32 v15, 7, v168
    v_lshlrev_b32 v168, 8, v168
    v_lshl_or_b32 v168, v15, 5, v168
    v_and_or_b32 v168, v136, 15, v168
    v_accvgpr_read_b32 v169, a121
    v_and_b32 v15, 7, v169
    v_lshlrev_b32 v169, 8, v169
    v_lshl_or_b32 v169, v15, 5, v169
    v_and_or_b32 v169, v137, 15, v169
    v_accvgpr_read_b32 v170, a122
    v_and_b32 v15, 7, v170
    v_lshlrev_b32 v170, 8, v170
    v_lshl_or_b32 v170, v15, 5, v170
    v_and_or_b32 v170, v138, 15, v170
    v_accvgpr_read_b32 v171, a123
    v_and_b32 v15, 7, v171
    v_lshlrev_b32 v171, 8, v171
    v_lshl_or_b32 v171, v15, 5, v171
    v_and_or_b32 v171, v139, 15, v171
    v_accvgpr_read_b32 v172, a124
    v_and_b32 v15, 7, v172
    v_lshlrev_b32 v172, 8, v172
    v_lshl_or_b32 v172, v15, 5, v172
    v_and_or_b32 v172, v140, 15, v172
    v_accvgpr_read_b32 v173, a125
    v_and_b32 v15, 7, v173
    v_lshlrev_b32 v173, 8, v173
    v_lshl_or_b32 v173, v15, 5, v173
    v_and_or_b32 v173, v141, 15, v173
    v_accvgpr_read_b32 v174, a126
    v_and_b32 v15, 7, v174
    v_lshlrev_b32 v174, 8, v174
    v_lshl_or_b32 v174, v15, 5, v174
    v_and_or_b32 v174, v142, 15, v174
    v_accvgpr_read_b32 v175, a127
    v_and_b32 v15, 7, v175
    v_lshlrev_b32 v175, 8, v175
    v_lshl_or_b32 v175, v15, 5, v175
    v_and_or_b32 v175, v143, 15, v175
    s_waitcnt lgkmcnt(0)
    v_lshlrev_b32 v160, 2, v160
    ds_write_b32 v160, v168 offset:4096
    v_lshlrev_b32 v161, 2, v161
    ds_write_b32 v161, v169 offset:4096
    v_lshlrev_b32 v162, 2, v162
    ds_write_b32 v162, v170 offset:4096
    v_lshlrev_b32 v163, 2, v163
    ds_write_b32 v163, v171 offset:4096
    v_lshlrev_b32 v164, 2, v164
    ds_write_b32 v164, v172 offset:4096
    v_lshlrev_b32 v165, 2, v165
    ds_write_b32 v165, v173 offset:4096
    v_lshlrev_b32 v166, 2, v166
    ds_write_b32 v166, v174 offset:4096
    v_lshlrev_b32 v167, 2, v167
    ds_write_b32 v167, v175 offset:4096
    v_lshrrev_b32 v160, 4, v144
    v_lshlrev_b32 v160, 2, v160
    ds_add_rtn_u32 v160, v160, v14
    v_lshrrev_b32 v161, 4, v145
    v_lshlrev_b32 v161, 2, v161
    ds_add_rtn_u32 v161, v161, v14
    v_lshrrev_b32 v162, 4, v146
    v_lshlrev_b32 v162, 2, v162
    ds_add_rtn_u32 v162, v162, v14
    v_lshrrev_b32 v163, 4, v147
    v_lshlrev_b32 v163, 2, v163
    ds_add_rtn_u32 v163, v163, v14
    v_lshrrev_b32 v164, 4, v148
    v_lshlrev_b32 v164, 2, v164
    ds_add_rtn_u32 v164, v164, v14
    v_lshrrev_b32 v165, 4, v149
    v_lshlrev_b32 v165, 2, v165
    ds_add_rtn_u32 v165, v165, v14
    v_lshrrev_b32 v166, 4, v150
    v_lshlrev_b32 v166, 2, v166
    ds_add_rtn_u32 v166, v166, v14
    v_lshrrev_b32 v167, 4, v151
    v_lshlrev_b32 v167, 2, v167
    ds_add_rtn_u32 v167, v167, v14
    v_accvgpr_read_b32 v168, a128
    v_and_b32 v15, 7, v168
    v_lshlrev_b32 v168, 8, v168
    v_lshl_or_b32 v168, v15, 5, v168
    v_and_or_b32 v168, v144, 15, v168
    v_accvgpr_read_b32 v169, a129
    v_and_b32 v15, 7, v169
    v_lshlrev_b32 v169, 8, v169
    v_lshl_or_b32 v169, v15, 5, v169
    v_and_or_b32 v169, v145, 15, v169
    v_accvgpr_read_b32 v170, a130
    v_and_b32 v15, 7, v170
    v_lshlrev_b32 v170, 8, v170
    v_lshl_or_b32 v170, v15, 5, v170
    v_and_or_b32 v170, v146, 15, v170
    v_accvgpr_read_b32 v171, a131
    v_and_b32 v15, 7, v171
    v_lshlrev_b32 v171, 8, v171
    v_lshl_or_b32 v171, v15, 5, v171
    v_and_or_b32 v171, v147, 15, v171
    v_accvgpr_read_b32 v172, a132
    v_and_b32 v15, 7, v172
    v_lshlrev_b32 v172, 8, v172
    v_lshl_or_b32 v172, v15, 5, v172
    v_and_or_b32 v172, v148, 15, v172
    v_accvgpr_read_b32 v173, a133
    v_and_b32 v15, 7, v173
    v_lshlrev_b32 v173, 8, v173
    v_lshl_or_b32 v173, v15, 5, v173
    v_and_or_b32 v173, v149, 15, v173
    v_accvgpr_read_b32 v174, a134
    v_and_b32 v15, 7, v174
    v_lshlrev_b32 v174, 8, v174
    v_lshl_or_b32 v174, v15, 5, v174
    v_and_or_b32 v174, v150, 15, v174
    v_accvgpr_read_b32 v175, a135
    v_and_b32 v15, 7, v175
    v_lshlrev_b32 v175, 8, v175
    v_lshl_or_b32 v175, v15, 5, v175
    v_and_or_b32 v175, v151, 15, v175
    s_waitcnt lgkmcnt(0)
    v_lshlrev_b32 v160, 2, v160
    ds_write_b32 v160, v168 offset:4096
    v_lshlrev_b32 v161, 2, v161
    ds_write_b32 v161, v169 offset:4096
    v_lshlrev_b32 v162, 2, v162
    ds_write_b32 v162, v170 offset:4096
    v_lshlrev_b32 v163, 2, v163
    ds_write_b32 v163, v171 offset:4096
    v_lshlrev_b32 v164, 2, v164
    ds_write_b32 v164, v172 offset:4096
    v_lshlrev_b32 v165, 2, v165
    ds_write_b32 v165, v173 offset:4096
    v_lshlrev_b32 v166, 2, v166
    ds_write_b32 v166, v174 offset:4096
    v_lshlrev_b32 v167, 2, v167
    ds_write_b32 v167, v175 offset:4096
    v_lshrrev_b32 v160, 4, v152
    v_lshlrev_b32 v160, 2, v160
    ds_add_rtn_u32 v160, v160, v14
    v_lshrrev_b32 v161, 4, v153
    v_lshlrev_b32 v161, 2, v161
    ds_add_rtn_u32 v161, v161, v14
    v_lshrrev_b32 v162, 4, v154
    v_lshlrev_b32 v162, 2, v162
    ds_add_rtn_u32 v162, v162, v14
    v_lshrrev_b32 v163, 4, v155
    v_lshlrev_b32 v163, 2, v163
    ds_add_rtn_u32 v163, v163, v14
    v_lshrrev_b32 v164, 4, v156
    v_lshlrev_b32 v164, 2, v164
    ds_add_rtn_u32 v164, v164, v14
    v_lshrrev_b32 v165, 4, v157
    v_lshlrev_b32 v165, 2, v165
    ds_add_rtn_u32 v165, v165, v14
    v_lshrrev_b32 v166, 4, v158
    v_lshlrev_b32 v166, 2, v166
    ds_add_rtn_u32 v166, v166, v14
    v_lshrrev_b32 v167, 4, v159
    v_lshlrev_b32 v167, 2, v167
    ds_add_rtn_u32 v167, v167, v14
    v_accvgpr_read_b32 v168, a136
    v_and_b32 v15, 7, v168
    v_lshlrev_b32 v168, 8, v168
    v_lshl_or_b32 v168, v15, 5, v168
    v_and_or_b32 v168, v152, 15, v168
    v_accvgpr_read_b32 v169, a137
    v_and_b32 v15, 7, v169
    v_lshlrev_b32 v169, 8, v169
    v_lshl_or_b32 v169, v15, 5, v169
    v_and_or_b32 v169, v153, 15, v169
    v_accvgpr_read_b32 v170, a138
    v_and_b32 v15, 7, v170
    v_lshlrev_b32 v170, 8, v170
    v_lshl_or_b32 v170, v15, 5, v170
    v_and_or_b32 v170, v154, 15, v170
    v_accvgpr_read_b32 v171, a139
    v_and_b32 v15, 7, v171
    v_lshlrev_b32 v171, 8, v171
    v_lshl_or_b32 v171, v15, 5, v171
    v_and_or_b32 v171, v155, 15, v171
    v_accvgpr_read_b32 v172, a140
    v_and_b32 v15, 7, v172
    v_lshlrev_b32 v172, 8, v172
    v_lshl_or_b32 v172, v15, 5, v172
    v_and_or_b32 v172, v156, 15, v172
    v_accvgpr_read_b32 v173, a141
    v_and_b32 v15, 7, v173
    v_lshlrev_b32 v173, 8, v173
    v_lshl_or_b32 v173, v15, 5, v173
    v_and_or_b32 v173, v157, 15, v173
    v_accvgpr_read_b32 v174, a142
    v_and_b32 v15, 7, v174
    v_lshlrev_b32 v174, 8, v174
    v_lshl_or_b32 v174, v15, 5, v174
    v_and_or_b32 v174, v158, 15, v174
    v_accvgpr_read_b32 v175, a143
    v_and_b32 v15, 7, v175
    v_lshlrev_b32 v175, 8, v175
    v_lshl_or_b32 v175, v15, 5, v175
    v_and_or_b32 v175, v159, 15, v175
    s_waitcnt lgkmcnt(0)
    v_lshlrev_b32 v160, 2, v160
    ds_write_b32 v160, v168 offset:4096
    v_lshlrev_b32 v161, 2, v161
    ds_write_b32 v161, v169 offset:4096
    v_lshlrev_b32 v162, 2, v162
    ds_write_b32 v162, v170 offset:4096
    v_lshlrev_b32 v163, 2, v163
    ds_write_b32 v163, v171 offset:4096
    v_lshlrev_b32 v164, 2, v164
    ds_write_b32 v164, v172 offset:4096
    v_lshlrev_b32 v165, 2, v165
    ds_write_b32 v165, v173 offset:4096
    v_lshlrev_b32 v166, 2, v166
    ds_write_b32 v166, v174 offset:4096
    v_lshlrev_b32 v167, 2, v167
    ds_write_b32 v167, v175 offset:4096
    s_waitcnt lgkmcnt(0)
    s_barrier
    s_mul_i32 s37, s34, 159744
    ds_read_b128 v[16:19], v1 offset:4096
    ds_read_b128 v[20:23], v1 offset:8192
    ds_read_b128 v[24:27], v1 offset:12288
    ds_read_b128 v[28:31], v1 offset:16384
    ds_read_b128 v[32:35], v1 offset:20480
    ds_read_b128 v[36:39], v1 offset:24576
    ds_read_b128 v[40:43], v1 offset:28672
    ds_read_b128 v[44:47], v1 offset:32768
    ds_read_b128 v[48:51], v1 offset:36864
    ds_read_b128 v[52:55], v1 offset:40960
    ds_read_b128 v[56:59], v1 offset:45056
    ds_read_b128 v[60:63], v1 offset:49152
    ds_read_b128 v[64:67], v1 offset:53248
    s_waitcnt lgkmcnt(12)
    buffer_store_dwordx4 v[16:19], v1, s[28:31], s37 offen sc1
    s_add_u32 s37, s37, 4096
    s_waitcnt lgkmcnt(11)
    buffer_store_dwordx4 v[20:23], v1, s[28:31], s37 offen sc1
    s_add_u32 s37, s37, 4096
    s_waitcnt lgkmcnt(10)
    buffer_store_dwordx4 v[24:27], v1, s[28:31], s37 offen sc1
    s_add_u32 s37, s37, 4096
    s_waitcnt lgkmcnt(9)
    buffer_store_dwordx4 v[28:31], v1, s[28:31], s37 offen sc1
    s_add_u32 s37, s37, 4096
    s_waitcnt lgkmcnt(8)
    buffer_store_dwordx4 v[32:35], v1, s[28:31], s37 offen sc1
    s_add_u32 s37, s37, 4096
    s_waitcnt lgkmcnt(7)
    buffer_store_dwordx4 v[36:39], v1, s[28:31], s37 offen sc1
    s_add_u32 s37, s37, 4096
    s_waitcnt lgkmcnt(6)
    buffer_store_dwordx4 v[40:43], v1, s[28:31], s37 offen sc1
    s_add_u32 s37, s37, 4096
    s_waitcnt lgkmcnt(5)
    buffer_store_dwordx4 v[44:47], v1, s[28:31], s37 offen sc1
    s_add_u32 s37, s37, 4096
    s_waitcnt lgkmcnt(4)
    buffer_store_dwordx4 v[48:51], v1, s[28:31], s37 offen sc1
    s_add_u32 s37, s37, 4096
    s_waitcnt lgkmcnt(3)
    buffer_store_dwordx4 v[52:55], v1, s[28:31], s37 offen sc1
    s_add_u32 s37, s37, 4096
    s_waitcnt lgkmcnt(2)
    buffer_store_dwordx4 v[56:59], v1, s[28:31], s37 offen sc1
    s_add_u32 s37, s37, 4096
    s_waitcnt lgkmcnt(1)
    buffer_store_dwordx4 v[60:63], v1, s[28:31], s37 offen sc1
    s_add_u32 s37, s37, 4096
    s_waitcnt lgkmcnt(0)
    buffer_store_dwordx4 v[64:67], v1, s[28:31], s37 offen sc1
    s_add_u32 s37, s37, 4096
    ds_read_b128 v[68:71], v1 offset:57344
    ds_read_b128 v[72:75], v1 offset:61440
    ds_read_b128 v[76:79], v2 offset:0
    ds_read_b128 v[80:83], v2 offset:4096
    ds_read_b128 v[84:87], v2 offset:8192
    ds_read_b128 v[88:91], v2 offset:12288
    ds_read_b128 v[92:95], v2 offset:16384
    ds_read_b128 v[96:99], v2 offset:20480
    ds_read_b128 v[100:103], v2 offset:24576
    ds_read_b128 v[104:107], v2 offset:28672
    ds_read_b128 v[108:111], v2 offset:32768
    ds_read_b128 v[112:115], v2 offset:36864
    ds_read_b128 v[116:119], v2 offset:40960
    s_waitcnt lgkmcnt(12)
    buffer_store_dwordx4 v[68:71], v1, s[28:31], s37 offen sc1
    s_add_u32 s37, s37, 4096
    s_waitcnt lgkmcnt(11)
    buffer_store_dwordx4 v[72:75], v1, s[28:31], s37 offen sc1
    s_add_u32 s37, s37, 4096
    s_waitcnt lgkmcnt(10)
    buffer_store_dwordx4 v[76:79], v1, s[28:31], s37 offen sc1
    s_add_u32 s37, s37, 4096
    s_waitcnt lgkmcnt(9)
    buffer_store_dwordx4 v[80:83], v1, s[28:31], s37 offen sc1
    s_add_u32 s37, s37, 4096
    s_waitcnt lgkmcnt(8)
    buffer_store_dwordx4 v[84:87], v1, s[28:31], s37 offen sc1
    s_add_u32 s37, s37, 4096
    s_waitcnt lgkmcnt(7)
    buffer_store_dwordx4 v[88:91], v1, s[28:31], s37 offen sc1
    s_add_u32 s37, s37, 4096
    s_waitcnt lgkmcnt(6)
    buffer_store_dwordx4 v[92:95], v1, s[28:31], s37 offen sc1
    s_add_u32 s37, s37, 4096
    s_waitcnt lgkmcnt(5)
    buffer_store_dwordx4 v[96:99], v1, s[28:31], s37 offen sc1
    s_add_u32 s37, s37, 4096
    s_waitcnt lgkmcnt(4)
    buffer_store_dwordx4 v[100:103], v1, s[28:31], s37 offen sc1
    s_add_u32 s37, s37, 4096
    s_waitcnt lgkmcnt(3)
    buffer_store_dwordx4 v[104:107], v1, s[28:31], s37 offen sc1
    s_add_u32 s37, s37, 4096
    s_waitcnt lgkmcnt(2)
    buffer_store_dwordx4 v[108:111], v1, s[28:31], s37 offen sc1
    s_add_u32 s37, s37, 4096
    s_waitcnt lgkmcnt(1)
    buffer_store_dwordx4 v[112:115], v1, s[28:31], s37 offen sc1
    s_add_u32 s37, s37, 4096
    s_waitcnt lgkmcnt(0)
    buffer_store_dwordx4 v[116:119], v1, s[28:31], s37 offen sc1
    s_add_u32 s37, s37, 4096
    ds_read_b128 v[16:19], v2 offset:45056
    ds_read_b128 v[20:23], v2 offset:49152
    ds_read_b128 v[24:27], v2 offset:53248
    ds_read_b128 v[28:31], v2 offset:57344
    ds_read_b128 v[32:35], v2 offset:61440
    ds_read_b128 v[36:39], v3 offset:0
    ds_read_b128 v[40:43], v3 offset:4096
    ds_read_b128 v[44:47], v3 offset:8192
    ds_read_b128 v[48:51], v3 offset:12288
    ds_read_b128 v[52:55], v3 offset:16384
    ds_read_b128 v[56:59], v3 offset:20480
    ds_read_b128 v[60:63], v3 offset:24576
    ds_read_b128 v[64:67], v3 offset:28672
    s_waitcnt lgkmcnt(12)
    buffer_store_dwordx4 v[16:19], v1, s[28:31], s37 offen sc1
    s_add_u32 s37, s37, 4096
    s_waitcnt lgkmcnt(11)
    buffer_store_dwordx4 v[20:23], v1, s[28:31], s37 offen sc1
    s_add_u32 s37, s37, 4096
    s_waitcnt lgkmcnt(10)
    buffer_store_dwordx4 v[24:27], v1, s[28:31], s37 offen sc1
    s_add_u32 s37, s37, 4096
    s_waitcnt lgkmcnt(9)
    buffer_store_dwordx4 v[28:31], v1, s[28:31], s37 offen sc1
    s_add_u32 s37, s37, 4096
    s_waitcnt lgkmcnt(8)
    buffer_store_dwordx4 v[32:35], v1, s[28:31], s37 offen sc1
    s_add_u32 s37, s37, 4096
    s_waitcnt lgkmcnt(7)
    buffer_store_dwordx4 v[36:39], v1, s[28:31], s37 offen sc1
    s_add_u32 s37, s37, 4096
    s_waitcnt lgkmcnt(6)
    buffer_store_dwordx4 v[40:43], v1, s[28:31], s37 offen sc1
    s_add_u32 s37, s37, 4096
    s_waitcnt lgkmcnt(5)
    buffer_store_dwordx4 v[44:47], v1, s[28:31], s37 offen sc1
    s_add_u32 s37, s37, 4096
    s_waitcnt lgkmcnt(4)
    buffer_store_dwordx4 v[48:51], v1, s[28:31], s37 offen sc1
    s_add_u32 s37, s37, 4096
    s_waitcnt lgkmcnt(3)
    buffer_store_dwordx4 v[52:55], v1, s[28:31], s37 offen sc1
    s_add_u32 s37, s37, 4096
    s_waitcnt lgkmcnt(2)
    buffer_store_dwordx4 v[56:59], v1, s[28:31], s37 offen sc1
    s_add_u32 s37, s37, 4096
    s_waitcnt lgkmcnt(1)
    buffer_store_dwordx4 v[60:63], v1, s[28:31], s37 offen sc1
    s_add_u32 s37, s37, 4096
    s_waitcnt lgkmcnt(0)
    buffer_store_dwordx4 v[64:67], v1, s[28:31], s37 offen sc1
    s_add_u32 s37, s37, 4096
    s_waitcnt vmcnt(0)
    s_barrier
    s_cmp_lg_u32 s3, 0
    s_cbranch_scc1 L_w23
    v_mov_b32 v8, 0
    s_mov_b32 s41, 0x20000
L_rsb:
    buffer_load_dword v9, v8, s[96:99], 0 offen sc1
    s_waitcnt vmcnt(0)
    v_cmp_ne_u32 vcc, 1, v9
    s_cbranch_vccz L_rsokb
    s_sub_u32 s41, s41, 1
    s_cmp_lg_u32 s41, 0
    s_cbranch_scc1 L_rsb

L_rsokb:
    s_lshl_b32 s33, s34, 2
    s_add_u32 s33, s33, 12800
    v_mov_b32 v9, 1
    s_mov_b64 exec, 1
    buffer_store_dword v9, v8, s[20:23], s33 offen sc1

    s_mov_b64 exec, -1
L_w23:
    s_sub_u32 s35, s34, 1
    s_cmp_ge_u32 s35, 4
    s_cbranch_scc1 L2_done
    s_load_dwordx2 s[6:7], s[0:1], 64
    s_load_dwordx2 s[24:25], s[0:1], 56
    s_load_dwordx2 s[26:27], s[0:1], 32
    v_and_b32 v2, 15, v0
    v_lshrrev_b32 v3, 4, v0
    s_and_b32 s28, s35, 1
    s_lshr_b32 s29, s35, 1
    v_mov_b32 v8, 0
    s_waitcnt lgkmcnt(0)
    s_cmp_eq_u32 s28, 0
    s_cselect_b32 s24, s24, s26
    s_cselect_b32 s25, s25, s27

    s_add_u32 s8, s6, 0
    s_addc_u32 s9, s7, 0
    s_mov_b32 s10, 32768
    s_mov_b32 s11, 0x20000
    s_add_u32 s12, s24, 0
    s_addc_u32 s13, s25, 0
    s_mov_b32 s14, 32768
    s_mov_b32 s15, 0x20000
    s_add_u32 s16, s4, 9502720
    s_addc_u32 s17, s5, 0
    s_mov_b32 s18, 65536
    s_mov_b32 s19, 0x20000
    v_lshlrev_b32 v5, 1, v3
    v_xor_b32 v5, v5, v2
    v_lshlrev_b32 v5, 4, v5
    v_lshl_add_u32 v5, v3, 8, v5
    v_xor_b32 v6, 0x80, v5
    s_lshl_b32 s36, s3, 13
    s_add_u32 s37, s36, 4096

    s_add_u32 m0, s36, 0
    s_nop 0
    buffer_load_dwordx4 v5, s[8:11], s36 offen offset:0 lds
    buffer_load_dwordx4 v5, s[8:11], s36 offen offset:1024 lds
    buffer_load_dwordx4 v6, s[8:11], s36 offen offset:2048 lds
    buffer_load_dwordx4 v6, s[8:11], s36 offen offset:3072 lds
    s_add_u32 m0, s37, 0
    s_nop 0
    buffer_load_dwordx4 v5, s[8:11], s37 offen offset:0 lds
    buffer_load_dwordx4 v5, s[8:11], s37 offen offset:1024 lds
    buffer_load_dwordx4 v6, s[8:11], s37 offen offset:2048 lds
    buffer_load_dwordx4 v6, s[8:11], s37 offen offset:3072 lds
    s_add_u32 m0, s36, 32768
    s_nop 0
    buffer_load_dwordx4 v5, s[12:15], s36 offen offset:0 lds
    buffer_load_dwordx4 v6, s[12:15], s36 offen offset:1024 lds
    buffer_load_dwordx4 v5, s[12:15], s36 offen offset:2048 lds
    buffer_load_dwordx4 v6, s[12:15], s36 offen offset:3072 lds
    s_add_u32 m0, s37, 32768
    s_nop 0
    buffer_load_dwordx4 v5, s[12:15], s37 offen offset:0 lds
    buffer_load_dwordx4 v6, s[12:15], s37 offen offset:1024 lds
    buffer_load_dwordx4 v5, s[12:15], s37 offen offset:2048 lds
    buffer_load_dwordx4 v6, s[12:15], s37 offen offset:3072 lds
    v_bfe_u32 v26, v0, 2, 2
    v_and_b32 v27, 1, v3
    v_lshl_add_u32 v27, v27, 2, v26
    v_lshlrev_b32 v27, 1, v27
    v_and_b32 v28, 3, v0
    v_xor_b32 v27, v27, v28
    v_lshl_add_u32 v26, v3, 3, v26
    v_lshlrev_b32 v26, 8, v26
    s_lshl_b32 s33, s3, 2
    v_xor_b32 v28, s33, v27
    v_lshl_add_u32 v7, v28, 4, v26
    s_lshl_b32 s33, s29, 3
    v_add_u32 v7, s33, v7
    v_and_b32 v26, 7, v2
    v_lshlrev_b32 v26, 1, v26
    v_xor_b32 v26, v26, v3
    v_lshlrev_b32 v27, 8, v2

    v_xor_b32 v28, 0, v26
    v_lshl_add_u32 v12, v28, 4, v27
    v_xor_b32 v28, 4, v26
    v_lshl_add_u32 v13, v28, 4, v27
    v_xor_b32 v28, 8, v26
    v_lshl_add_u32 v14, v28, 4, v27
    v_xor_b32 v28, 12, v26
    v_lshl_add_u32 v15, v28, 4, v27
    s_waitcnt vmcnt(0)
    s_barrier
    ds_read_b64_tr_b16 v[32:33], v7 offset:0
    ds_read_b64_tr_b16 v[34:35], v7 offset:1024
    ds_read_b64_tr_b16 v[36:37], v7 offset:8192
    ds_read_b64_tr_b16 v[38:39], v7 offset:9216
    ds_read_b64_tr_b16 v[40:41], v7 offset:16384
    ds_read_b64_tr_b16 v[42:43], v7 offset:17408
    ds_read_b64_tr_b16 v[44:45], v7 offset:24576
    ds_read_b64_tr_b16 v[46:47], v7 offset:25600
    ds_read_b128 v[128:131], v12 offset:32768
    ds_read_b128 v[132:135], v13 offset:32768
    ds_read_b128 v[136:139], v14 offset:32768
    ds_read_b128 v[140:143], v15 offset:32768
    ds_read_b128 v[144:147], v12 offset:36864
    ds_read_b128 v[148:151], v13 offset:36864
    ds_read_b128 v[152:155], v14 offset:36864
    ds_read_b128 v[156:159], v15 offset:36864
    ds_read_b128 v[160:163], v12 offset:40960
    ds_read_b128 v[164:167], v13 offset:40960
    ds_read_b128 v[168:171], v14 offset:40960
    ds_read_b128 v[172:175], v15 offset:40960
    s_waitcnt lgkmcnt(8)
    v_mfma_f32_16x16x32_bf16 v[64:67], v[128:131], v[32:35], 0
    v_mfma_f32_16x16x32_bf16 v[64:67], v[132:135], v[36:39], v[64:67]
    v_mfma_f32_16x16x32_bf16 v[64:67], v[136:139], v[40:43], v[64:67]
    v_mfma_f32_16x16x32_bf16 v[64:67], v[140:143], v[44:47], v[64:67]
    ds_read_b128 v[176:179], v12 offset:45056
    ds_read_b128 v[180:183], v13 offset:45056
    ds_read_b128 v[184:187], v14 offset:45056
    ds_read_b128 v[188:191], v15 offset:45056
    s_waitcnt lgkmcnt(8)
    v_mfma_f32_16x16x32_bf16 v[68:71], v[144:147], v[32:35], 0
    v_mfma_f32_16x16x32_bf16 v[68:71], v[148:151], v[36:39], v[68:71]
    v_mfma_f32_16x16x32_bf16 v[68:71], v[152:155], v[40:43], v[68:71]
    v_mfma_f32_16x16x32_bf16 v[68:71], v[156:159], v[44:47], v[68:71]
    ds_read_b128 v[192:195], v12 offset:49152
    ds_read_b128 v[196:199], v13 offset:49152
    ds_read_b128 v[200:203], v14 offset:49152
    ds_read_b128 v[204:207], v15 offset:49152
    s_waitcnt lgkmcnt(8)
    v_mfma_f32_16x16x32_bf16 v[72:75], v[160:163], v[32:35], 0
    v_mfma_f32_16x16x32_bf16 v[72:75], v[164:167], v[36:39], v[72:75]
    v_mfma_f32_16x16x32_bf16 v[72:75], v[168:171], v[40:43], v[72:75]
    v_mfma_f32_16x16x32_bf16 v[72:75], v[172:175], v[44:47], v[72:75]
    ds_read_b128 v[208:211], v12 offset:53248
    ds_read_b128 v[212:215], v13 offset:53248
    ds_read_b128 v[216:219], v14 offset:53248
    ds_read_b128 v[220:223], v15 offset:53248
    s_waitcnt lgkmcnt(8)
    v_mfma_f32_16x16x32_bf16 v[76:79], v[176:179], v[32:35], 0
    v_mfma_f32_16x16x32_bf16 v[76:79], v[180:183], v[36:39], v[76:79]
    v_mfma_f32_16x16x32_bf16 v[76:79], v[184:187], v[40:43], v[76:79]
    v_mfma_f32_16x16x32_bf16 v[76:79], v[188:191], v[44:47], v[76:79]
    ds_read_b128 v[224:227], v12 offset:57344
    ds_read_b128 v[228:231], v13 offset:57344
    ds_read_b128 v[232:235], v14 offset:57344
    ds_read_b128 v[236:239], v15 offset:57344
    s_waitcnt lgkmcnt(8)
    v_mfma_f32_16x16x32_bf16 v[80:83], v[192:195], v[32:35], 0
    v_mfma_f32_16x16x32_bf16 v[80:83], v[196:199], v[36:39], v[80:83]
    v_mfma_f32_16x16x32_bf16 v[80:83], v[200:203], v[40:43], v[80:83]
    v_mfma_f32_16x16x32_bf16 v[80:83], v[204:207], v[44:47], v[80:83]
    ds_read_b128 v[240:243], v12 offset:61440
    ds_read_b128 v[244:247], v13 offset:61440
    ds_read_b128 v[248:251], v14 offset:61440
    ds_read_b128 v[252:255], v15 offset:61440
    s_waitcnt lgkmcnt(8)
    v_mfma_f32_16x16x32_bf16 v[84:87], v[208:211], v[32:35], 0
    v_mfma_f32_16x16x32_bf16 v[84:87], v[212:215], v[36:39], v[84:87]
    v_mfma_f32_16x16x32_bf16 v[84:87], v[216:219], v[40:43], v[84:87]
    v_mfma_f32_16x16x32_bf16 v[84:87], v[220:223], v[44:47], v[84:87]
    s_waitcnt lgkmcnt(4)
    v_mfma_f32_16x16x32_bf16 v[88:91], v[224:227], v[32:35], 0
    v_mfma_f32_16x16x32_bf16 v[88:91], v[228:231], v[36:39], v[88:91]
    v_mfma_f32_16x16x32_bf16 v[88:91], v[232:235], v[40:43], v[88:91]
    v_mfma_f32_16x16x32_bf16 v[88:91], v[236:239], v[44:47], v[88:91]
    s_waitcnt lgkmcnt(0)
    v_mfma_f32_16x16x32_bf16 v[92:95], v[240:243], v[32:35], 0
    v_mfma_f32_16x16x32_bf16 v[92:95], v[244:247], v[36:39], v[92:95]
    v_mfma_f32_16x16x32_bf16 v[92:95], v[248:251], v[40:43], v[92:95]
    v_mfma_f32_16x16x32_bf16 v[92:95], v[252:255], v[44:47], v[92:95]
    s_nop 7
    v_cmp_eq_u32 vcc, 3, v3
    v_lshlrev_b32 v27, 4, v0
    s_lshl_b32 s33, s3, 14
    s_lshl_b32 s32, s28, 12
    s_add_u32 s33, s33, s32
    s_lshl_b32 s32, s29, 13
    s_add_u32 s33, s33, s32

    v_add_f32 v24, v64, v65
    v_add_f32 v29, v66, v67
    v_add_f32 v24, v24, v68
    v_add_f32 v29, v29, v69
    v_add_f32 v24, v24, v70
    v_add_f32 v29, v29, v71
    v_add_f32 v24, v24, v72
    v_add_f32 v29, v29, v73
    v_add_f32 v24, v24, v74
    v_add_f32 v29, v29, v75
    v_add_f32 v24, v24, v76
    v_add_f32 v29, v29, v77
    v_add_f32 v24, v24, v78
    v_add_f32 v29, v29, v79
    v_add_f32 v24, v24, v80
    v_add_f32 v29, v29, v81
    v_add_f32 v24, v24, v82
    v_add_f32 v29, v29, v83
    v_add_f32 v24, v24, v84
    v_add_f32 v29, v29, v85
    v_add_f32 v24, v24, v86
    v_add_f32 v29, v29, v87
    v_add_f32 v24, v24, v88
    v_add_f32 v29, v29, v89
    v_add_f32 v24, v24, v90
    v_add_f32 v29, v29, v91
    v_add_f32 v24, v24, v92
    v_add_f32 v29, v29, v93
    v_add_f32 v24, v24, v94
    v_add_f32 v29, v29, v95
    v_add_f32 v24, v24, v29
    v_mov_b32 v25, v24
    s_nop 1
    v_permlane16_swap_b32 v24, v25
    v_add_f32 v24, v24, v25
    v_mov_b32 v25, v24
    s_nop 1
    v_permlane32_swap_b32 v24, v25
    v_add_f32 v24, v24, v25
    v_mov_b32 v25, v95
    v_mov_b32 v26, v95
    s_nop 1
    v_permlane16_swap_b32 v25, v26
    v_mov_b32 v25, v26
    s_nop 1
    v_permlane32_swap_b32 v25, v26
    v_mul_f32 v24, 0x3db504f3, v24
    v_sub_f32 v24, v26, v24
    v_mul_f32 v24, 0x3dc69217, v24
    v_add_f32 v64, v64, v24
    v_add_f32 v65, v65, v24
    v_add_f32 v66, v66, v24
    v_add_f32 v67, v67, v24
    v_add_f32 v68, v68, v24
    v_add_f32 v69, v69, v24
    v_add_f32 v70, v70, v24
    v_add_f32 v71, v71, v24
    v_add_f32 v72, v72, v24
    v_add_f32 v73, v73, v24
    v_add_f32 v74, v74, v24
    v_add_f32 v75, v75, v24
    v_add_f32 v76, v76, v24
    v_add_f32 v77, v77, v24
    v_add_f32 v78, v78, v24
    v_add_f32 v79, v79, v24
    v_add_f32 v80, v80, v24
    v_add_f32 v81, v81, v24
    v_add_f32 v82, v82, v24
    v_add_f32 v83, v83, v24
    v_add_f32 v84, v84, v24
    v_add_f32 v85, v85, v24
    v_add_f32 v86, v86, v24
    v_add_f32 v87, v87, v24
    v_add_f32 v88, v88, v24
    v_add_f32 v89, v89, v24
    v_add_f32 v90, v90, v24
    v_add_f32 v91, v91, v24
    v_add_f32 v92, v92, v24
    v_add_f32 v93, v93, v24
    v_add_f32 v94, v94, v24
    v_add_f32 v95, v95, v24
    v_cndmask_b32 v95, v95, 0, vcc
    v_cvt_pk_bf16_f32 v128, v64, v65
    v_cvt_pk_bf16_f32 v129, v66, v67
    v_cvt_pk_bf16_f32 v130, v68, v69
    v_cvt_pk_bf16_f32 v131, v70, v71
    buffer_store_dwordx4 v[128:131], v27, s[16:19], s33 offen offset:0 sc1
    v_cvt_pk_bf16_f32 v132, v72, v73
    v_cvt_pk_bf16_f32 v133, v74, v75
    v_cvt_pk_bf16_f32 v134, v76, v77
    v_cvt_pk_bf16_f32 v135, v78, v79
    buffer_store_dwordx4 v[132:135], v27, s[16:19], s33 offen offset:1024 sc1
    v_cvt_pk_bf16_f32 v136, v80, v81
    v_cvt_pk_bf16_f32 v137, v82, v83
    v_cvt_pk_bf16_f32 v138, v84, v85
    v_cvt_pk_bf16_f32 v139, v86, v87
    buffer_store_dwordx4 v[136:139], v27, s[16:19], s33 offen offset:2048 sc1
    v_cvt_pk_bf16_f32 v140, v88, v89
    v_cvt_pk_bf16_f32 v141, v90, v91
    v_cvt_pk_bf16_f32 v142, v92, v93
    v_cvt_pk_bf16_f32 v143, v94, v95
    buffer_store_dwordx4 v[140:143], v27, s[16:19], s33 offen offset:3072 sc1
    s_waitcnt vmcnt(0)
    s_barrier
    s_cmp_lg_u32 s3, 0
    s_cbranch_scc1 L2_done
    s_lshl_b32 s33, s35, 2
    s_add_u32 s33, s33, 12544
    v_mov_b32 v9, 1
    s_mov_b64 exec, 1
    buffer_store_dword v9, v8, s[20:23], s33 offen sc1
    s_endpgm

.p2align 8
L_code_end:
.section .rodata,"a"
.p2align 6
.amdhsa_kernel gather_scatter__hybrid_graph_tf_graphgps__graph_kernel
  .amdhsa_next_free_vgpr 512
  .amdhsa_next_free_sgpr 102
  .amdhsa_accum_offset 256
  .amdhsa_group_segment_fixed_size 0
  .amdhsa_kernarg_size 96
  .amdhsa_user_sgpr_count 2
  .amdhsa_user_sgpr_kernarg_segment_ptr 1
  .amdhsa_system_sgpr_workgroup_id_x 1
.end_amdhsa_kernel
```
